```python
import torch

def _softmax(x, axis=-1):
    return torch.softmax(x, dim=axis)

def _gelu(x):
    return torch.nn.functional.gelu(x, approximate='tanh')

def _silu(x):
    return torch.nn.functional.silu(x)

def _sigmoid(x):
    return torch.sigmoid(x)

def _layernorm(x, axis=-1, eps=1e-05):
    m = x.mean(dim=axis, keepdim=True)
    v = x.var(dim=axis, keepdim=True, unbiased=False)
    return (x - m) / torch.sqrt(v + eps)

def _scatter_add(tgt, idx, src, axis=0):
    return tgt.clone().index_add_(axis, idx, src)

def _segment_sum(src, seg, n):
    out = torch.zeros((n,) + src.shape[1:], dtype=src.dtype)
    return out.index_add_(0, seg, src)

def _pad(x, pw):
    flat = tuple((v for pair in reversed(pw) for v in pair))
    return torch.nn.functional.pad(x, flat)
kernel_name = 'parallel_sum__linear_kernel_hedgehog__mixer_gmlp__prompt'

def setup_inputs():

    _w = lambda a: (lambda t: t.to(torch.bfloat16) if t.is_floating_point() else t)(torch.as_tensor(a))

    def _A_setup():
        B, S, D, H = (1, 2048, 576, 32)
        Dh = D // H
        return {'x': _w((lambda *s: torch.randn(*s, dtype=torch.bfloat16) * 0.05)(B, S, D)), 'wqkv': _w((lambda *s: torch.randn(*s, dtype=torch.bfloat16) * 0.4)(D, 3 * D)), 'w_phi': _w((lambda *s: torch.randn(*s, dtype=torch.bfloat16) * 0.4)(H, Dh, Dh) * Dh ** (-0.5)), 'wo': _w((lambda *s: torch.randn(*s, dtype=torch.bfloat16) * 0.4)(D, D))}
    _A_in = _A_setup()

    def _B_setup():
        B, S, D, F = (1, 2048, 576, 4608)
        Fh = F // 2
        return {'x': _w((lambda *s: torch.randn(*s, dtype=torch.bfloat16) * 0.05)(B, S, D)), 'w_in': _w((lambda *s: torch.randn(*s, dtype=torch.bfloat16) * 0.4)(D, 2 * Fh)), 'w_sp': _w(0.01 * (lambda *s: torch.randn(*s, dtype=torch.bfloat16) * 0.4)(S, S)), 'b_sp': _w(1.0 + 0.01 * (lambda *s: torch.randn(*s, dtype=torch.bfloat16) * 0.05)(S)), 'w_out': _w((lambda *s: torch.randn(*s, dtype=torch.bfloat16) * 0.05)(Fh, D))}
    _B_in = _B_setup()
    return {'A_x': _A_in['x'], 'A_wqkv': _A_in['wqkv'], 'A_w_phi': _A_in['w_phi'], 'A_wo': _A_in['wo'], 'B_x': _B_in['x'], 'B_w_in': _B_in['w_in'], 'B_w_sp': _B_in['w_sp'], 'B_b_sp': _B_in['b_sp'], 'B_w_out': _B_in['w_out']}

def reference(A_x, A_wqkv, A_w_phi, A_wo, B_x, B_w_in, B_w_sp, B_b_sp, B_w_out):

    def _A_ref(x, wqkv, w_phi, wo):
        B, S, D = x.shape
        H = 32
        Dh = D // H
        qkv = (lambda x, *d: x.permute(*d))((x @ wqkv).reshape(B, S, 3, H, Dh), 2, 0, 3, 1, 4)
        q, k, v = (qkv[0], qkv[1], qkv[2])
        pq = torch.einsum('bhsd,hdf->bhsf', q, w_phi)
        pk = torch.einsum('bhsd,hdf->bhsf', k, w_phi)
        phi_q = torch.concatenate([_softmax(pq, axis=-1), _softmax(-pq, axis=-1)], axis=-1)
        phi_k = torch.concatenate([_softmax(pk, axis=-1), _softmax(-pk, axis=-1)], axis=-1)
        kv = torch.einsum('bhsf,bhsd->bhfd', phi_k, v)
        z = torch.einsum('bhsf->bhf', phi_k)
        num = torch.einsum('bhqf,bhfd->bhqd', phi_q, kv)
        den = torch.einsum('bhqf,bhf->bhq', phi_q, z)[..., None] + 1e-06
        o = num / den
        return (lambda x, *d: x.permute(*d))(o, 0, 2, 1, 3).reshape(B, S, D) @ wo

    def _B_ref(x, w_in, w_sp, b_sp, w_out):
        B, S, D = x.shape
        F = w_in.shape[-1]
        Fh = F // 2
        z = _gelu(torch.einsum('bsd,df->bsf', x, w_in))
        z1 = z[..., :Fh].clone()
        z2 = _layernorm(z[..., Fh:], axis=-1)
        g = torch.einsum('ts,bsf->btf', w_sp, z2) + b_sp[None, :, None]
        return torch.einsum('bsf,fd->bsd', z1 * g, w_out)
    x = A_x
    xn = _layernorm(x, axis=-1)
    return x + _A_ref(xn, A_wqkv, A_w_phi, A_wo) + _B_ref(xn, B_w_in, B_w_sp, B_b_sp, B_w_out)
```

```asm
; @launch grid=(256,1,1) block=(512,1,1) lds=163840
.amdgcn_target "amdgcn-amd-amdhsa--gfx950"
.text
.globl parallel_sum__linear_kernel_hedgehog__mixer_gmlp__prompt_kernel
.p2align 8
.type parallel_sum__linear_kernel_hedgehog__mixer_gmlp__prompt_kernel,@function
parallel_sum__linear_kernel_hedgehog__mixer_gmlp__prompt_kernel:
    s_cmp_ge_u32 s2, 256
    s_cbranch_scc1 L_end
    s_load_dwordx8 s[4:11], s[0:1], 0
    s_load_dwordx8 s[12:19], s[0:1], 32
    s_load_dwordx8 s[20:27], s[0:1], 64
    s_and_b32 s64, s2, 7
    s_lshr_b32 s65, s2, 3
    s_lshr_b32 s66, s64, 1
    s_lshl_b32 s66, s66, 2
    s_lshr_b32 s67, s65, 3
    s_add_u32 s60, s66, s67
    s_and_b32 s66, s64, 1
    s_lshl_b32 s66, s66, 3
    s_and_b32 s67, s65, 7
    s_add_u32 s61, s66, s67
    v_lshrrev_b32 v2, 6, v0
    v_and_b32 v1, 63, v0
    v_readfirstlane_b32 s62, v2
    s_getpc_b64 s[64:65]
Lcb_p_1:
    s_add_u32 s64, s64, parallel_sum__linear_kernel_hedgehog__mixer_gmlp__prompt_kernel-Lcb_p_1
    s_addc_u32 s65, s65, 0-((parallel_sum__linear_kernel_hedgehog__mixer_gmlp__prompt_kernel-Lcb_p_1)>>63)
    s_lshr_b32 s66, s2, 3
    s_lshl_b32 s66, s66, 3
    s_add_u32 s66, s66, s62
    s_mul_i32 s66, s66, 384
    v_lshlrev_b32 v4, 7, v1
    v_add_u32 v4, s66, v4
    s_mov_b32 s67, L_end-parallel_sum__linear_kernel_hedgehog__mixer_gmlp__prompt_kernel
    v_cmp_gt_u32 vcc, s67, v4
    s_nop 0
    s_and_b32 exec_lo, vcc_lo, 0x7
    s_mov_b32 exec_hi, 0
    s_cbranch_execz Lcp_p_2
    global_load_dword v110, v4, s[64:65]
Lcp_p_2:
    s_mov_b64 exec, -1
    v_lshrrev_b32 v8, 3, v1
    v_and_b32 v3, 7, v1
    v_xor_b32 v3, v3, v8
    v_lshrrev_b32 v4, 2, v8
    v_and_b32 v5, 3, v8
    v_lshl_add_u32 v4, v4, 3, v5
    s_and_b32 s63, s62, 3
    s_lshl_b32 s64, s63, 5
    v_add_u32 v4, s64, v4
    v_mul_u32_u24 v4, 1152, v4
    v_lshl_add_u32 v4, v3, 4, v4
    s_and_b32 s66, s61, 7
    s_mul_i32 s66, s66, 18432
    s_mul_i32 s67, s62, 2304
    s_add_u32 s66, s66, s67
    v_lshlrev_b32 v6, 7, v1
    s_mul_i32 s64, s60, 147456
    v_and_b32 v2, 15, v1
    v_lshrrev_b32 v3, 4, v1
    s_waitcnt lgkmcnt(0)
    s_add_u32 s28, s4, s64
    s_addc_u32 s29, s5, 0
    s_mov_b32 s30, 147456
    s_mov_b32 s31, 0x20000
    s_mov_b64 exec, 0x3ffff
    buffer_load_dword v111, v6, s[28:31], s66 offen
    s_mov_b64 exec, -1
    s_cmp_ge_u32 s62, 4
    s_cbranch_scc1 L_roleB
    v_add_u32 v5, 17408, v4
    v_add_u32 v9, 4608, v4
    v_add_u32 v10, 22016, v4
    s_mul_i32 s68, s63, 18432
    s_add_u32 m0, s68, 0
    s_mov_b32 s66, 0
    buffer_load_dwordx4 v4, s[28:31], s66 offen offset:0 lds
    buffer_load_dwordx4 v5, s[28:31], s66 offen offset:1024 lds
    s_add_u32 m0, s68, 2048
    s_mov_b32 s66, 128
    buffer_load_dwordx4 v4, s[28:31], s66 offen offset:0 lds
    buffer_load_dwordx4 v5, s[28:31], s66 offen offset:1024 lds
    s_add_u32 m0, s68, 4096
    s_mov_b32 s66, 256
    buffer_load_dwordx4 v4, s[28:31], s66 offen offset:0 lds
    buffer_load_dwordx4 v5, s[28:31], s66 offen offset:1024 lds
    s_add_u32 m0, s68, 6144
    s_mov_b32 s66, 384
    buffer_load_dwordx4 v4, s[28:31], s66 offen offset:0 lds
    buffer_load_dwordx4 v5, s[28:31], s66 offen offset:1024 lds
    s_add_u32 m0, s68, 8192
    s_mov_b32 s66, 512
    buffer_load_dwordx4 v4, s[28:31], s66 offen offset:0 lds
    buffer_load_dwordx4 v5, s[28:31], s66 offen offset:1024 lds
    s_add_u32 m0, s68, 10240
    s_mov_b32 s66, 640
    buffer_load_dwordx4 v4, s[28:31], s66 offen offset:0 lds
    buffer_load_dwordx4 v5, s[28:31], s66 offen offset:1024 lds
    s_add_u32 m0, s68, 12288
    s_mov_b32 s66, 768
    buffer_load_dwordx4 v4, s[28:31], s66 offen offset:0 lds
    buffer_load_dwordx4 v5, s[28:31], s66 offen offset:1024 lds
    s_add_u32 m0, s68, 14336
    s_mov_b32 s66, 896
    buffer_load_dwordx4 v4, s[28:31], s66 offen offset:0 lds
    buffer_load_dwordx4 v5, s[28:31], s66 offen offset:1024 lds
    s_add_u32 m0, s68, 16384
    s_mov_b32 s66, 1024
    buffer_load_dwordx4 v4, s[28:31], s66 offen offset:0 lds
    buffer_load_dwordx4 v5, s[28:31], s66 offen offset:1024 lds
    s_add_u32 m0, s68, 73728
    s_mov_b32 s66, 0
    buffer_load_dwordx4 v9, s[28:31], s66 offen offset:0 lds
    buffer_load_dwordx4 v10, s[28:31], s66 offen offset:1024 lds
    s_add_u32 m0, s68, 75776
    s_mov_b32 s66, 128
    buffer_load_dwordx4 v9, s[28:31], s66 offen offset:0 lds
    buffer_load_dwordx4 v10, s[28:31], s66 offen offset:1024 lds
    s_add_u32 m0, s68, 77824
    s_mov_b32 s66, 256
    buffer_load_dwordx4 v9, s[28:31], s66 offen offset:0 lds
    buffer_load_dwordx4 v10, s[28:31], s66 offen offset:1024 lds
    s_mov_b32 s101, 0
    s_mov_b32 s36, s26
    s_mov_b32 s37, s27
    s_mov_b32 s38, 268435456
    s_mov_b32 s39, 0x20000
    s_mov_b32 s80, 0xbdd2d3e8
    s_mov_b32 s81, 0x3fb8aa3b
    s_mov_b32 s82, 0x3f803f80
    s_mov_b32 s83, 0xffff0000
    v_and_b32 v11, 7, v2
    v_lshrrev_b32 v12, 3, v2
    v_lshlrev_b32 v12, 10, v12
    v_lshl_add_u32 v12, v11, 7, v12
    v_add_u32 v12, s68, v12
    v_xor_b32 v6, v3, v11
    v_lshl_add_u32 v6, v6, 4, v12
    v_xor_b32 v7, 64, v6
    v_add_u32 v12, 73728, v6
    v_add_u32 v13, 73728, v7
    v_mov_b32 v16, s82
    v_mov_b32 v17, s82
    v_mov_b32 v18, s82
    v_mov_b32 v19, s82
    v_and_b32 v8, 3, v2
    v_lshrrev_b32 v11, 2, v2
    v_cmp_eq_u32 s[72:73], 1, v8
    v_cmp_eq_u32 s[74:75], 2, v8
    v_cmp_eq_u32 s[76:77], 3, v8
    v_cmp_eq_u32 s[78:79], v11, v3
    v_lshlrev_b32 v20, 3, v3
    v_sub_u32 v20, v2, v20
    v_mov_b32 v21, 0x3f80
    v_and_b32 v22, 1, v20
    v_lshlrev_b32 v22, 4, v22
    v_lshlrev_b32 v21, v22, v21
    v_ashrrev_i32 v20, 1, v20
    v_cmp_eq_i32 vcc, 0, v20
    s_nop 1
    v_cndmask_b32 v96, 0, v21, vcc
    v_cmp_eq_i32 vcc, 1, v20
    s_nop 1
    v_cndmask_b32 v97, 0, v21, vcc
    v_cmp_eq_i32 vcc, 2, v20
    s_nop 1
    v_cndmask_b32 v98, 0, v21, vcc
    v_cmp_eq_i32 vcc, 3, v20
    s_nop 1
    v_cndmask_b32 v99, 0, v21, vcc
    v_cmp_eq_i32 vcc, -8, v20
    s_nop 1
    v_cndmask_b32 v100, 0, v21, vcc
    v_cmp_eq_i32 vcc, -7, v20
    s_nop 1
    v_cndmask_b32 v101, 0, v21, vcc
    v_cmp_eq_i32 vcc, -6, v20
    s_nop 1
    v_cndmask_b32 v102, 0, v21, vcc
    v_cmp_eq_i32 vcc, -5, v20
    s_nop 1
    v_cndmask_b32 v103, 0, v21, vcc
    s_add_u32 m0, s68, 79872
    s_mov_b32 s66, 384
    buffer_load_dwordx4 v9, s[28:31], s66 offen offset:0 lds
    buffer_load_dwordx4 v10, s[28:31], s66 offen offset:1024 lds
    s_waitcnt vmcnt(24)
    ds_read_b128 v[112:115], v6 offset:0
    ds_read_b128 v[120:123], v7 offset:0
    s_add_u32 m0, s68, 81920
    s_mov_b32 s66, 512
    buffer_load_dwordx4 v9, s[28:31], s66 offen offset:0 lds
    buffer_load_dwordx4 v10, s[28:31], s66 offen offset:1024 lds
    s_waitcnt vmcnt(24)
    ds_read_b128 v[128:131], v6 offset:2048
    ds_read_b128 v[136:139], v7 offset:2048
    s_waitcnt lgkmcnt(2)
    v_mfma_f32_16x16x32_bf16 v[64:67], v[16:19], v[112:115], 0
    v_mfma_f32_16x16x32_bf16 v[68:71], v[112:115], v[112:115], 0
    v_mfma_f32_16x16x32_bf16 v[64:67], v[16:19], v[120:123], v[64:67]
    v_mfma_f32_16x16x32_bf16 v[68:71], v[120:123], v[120:123], v[68:71]
    s_add_u32 m0, s68, 83968
    s_mov_b32 s66, 640
    buffer_load_dwordx4 v9, s[28:31], s66 offen offset:0 lds
    buffer_load_dwordx4 v10, s[28:31], s66 offen offset:1024 lds
    s_waitcnt vmcnt(24)
    ds_read_b128 v[144:147], v6 offset:4096
    ds_read_b128 v[152:155], v7 offset:4096
    s_waitcnt lgkmcnt(2)
    v_mfma_f32_16x16x32_bf16 v[64:67], v[16:19], v[128:131], v[64:67]
    v_mfma_f32_16x16x32_bf16 v[68:71], v[128:131], v[128:131], v[68:71]
    v_mfma_f32_16x16x32_bf16 v[64:67], v[16:19], v[136:139], v[64:67]
    v_mfma_f32_16x16x32_bf16 v[68:71], v[136:139], v[136:139], v[68:71]
    s_add_u32 m0, s68, 86016
    s_mov_b32 s66, 768
    buffer_load_dwordx4 v9, s[28:31], s66 offen offset:0 lds
    buffer_load_dwordx4 v10, s[28:31], s66 offen offset:1024 lds
    s_waitcnt vmcnt(24)
    ds_read_b128 v[160:163], v6 offset:6144
    ds_read_b128 v[168:171], v7 offset:6144
    s_waitcnt lgkmcnt(2)
    v_mfma_f32_16x16x32_bf16 v[64:67], v[16:19], v[144:147], v[64:67]
    v_mfma_f32_16x16x32_bf16 v[68:71], v[144:147], v[144:147], v[68:71]
    v_mfma_f32_16x16x32_bf16 v[64:67], v[16:19], v[152:155], v[64:67]
    v_mfma_f32_16x16x32_bf16 v[68:71], v[152:155], v[152:155], v[68:71]
    s_add_u32 m0, s68, 88064
    s_mov_b32 s66, 896
    buffer_load_dwordx4 v9, s[28:31], s66 offen offset:0 lds
    buffer_load_dwordx4 v10, s[28:31], s66 offen offset:1024 lds
    s_waitcnt vmcnt(24)
    ds_read_b128 v[176:179], v6 offset:8192
    ds_read_b128 v[184:187], v7 offset:8192
    s_waitcnt lgkmcnt(2)
    v_mfma_f32_16x16x32_bf16 v[64:67], v[16:19], v[160:163], v[64:67]
    v_mfma_f32_16x16x32_bf16 v[68:71], v[160:163], v[160:163], v[68:71]
    v_mfma_f32_16x16x32_bf16 v[64:67], v[16:19], v[168:171], v[64:67]
    v_mfma_f32_16x16x32_bf16 v[68:71], v[168:171], v[168:171], v[68:71]
    s_add_u32 m0, s68, 90112
    s_mov_b32 s66, 1024
    buffer_load_dwordx4 v9, s[28:31], s66 offen offset:0 lds
    buffer_load_dwordx4 v10, s[28:31], s66 offen offset:1024 lds
    s_waitcnt vmcnt(24)
    ds_read_b128 v[192:195], v6 offset:10240
    ds_read_b128 v[200:203], v7 offset:10240
    s_waitcnt lgkmcnt(2)
    v_mfma_f32_16x16x32_bf16 v[64:67], v[16:19], v[176:179], v[64:67]
    v_mfma_f32_16x16x32_bf16 v[68:71], v[176:179], v[176:179], v[68:71]
    v_mfma_f32_16x16x32_bf16 v[64:67], v[16:19], v[184:187], v[64:67]
    v_mfma_f32_16x16x32_bf16 v[68:71], v[184:187], v[184:187], v[68:71]
    s_waitcnt vmcnt(22)
    ds_read_b128 v[208:211], v6 offset:12288
    ds_read_b128 v[216:219], v7 offset:12288
    s_waitcnt lgkmcnt(2)
    v_mfma_f32_16x16x32_bf16 v[64:67], v[16:19], v[192:195], v[64:67]
    v_mfma_f32_16x16x32_bf16 v[68:71], v[192:195], v[192:195], v[68:71]
    v_mfma_f32_16x16x32_bf16 v[64:67], v[16:19], v[200:203], v[64:67]
    v_mfma_f32_16x16x32_bf16 v[68:71], v[200:203], v[200:203], v[68:71]
    s_waitcnt vmcnt(20)
    ds_read_b128 v[224:227], v6 offset:14336
    ds_read_b128 v[232:235], v7 offset:14336
    s_waitcnt lgkmcnt(2)
    v_mfma_f32_16x16x32_bf16 v[64:67], v[16:19], v[208:211], v[64:67]
    v_mfma_f32_16x16x32_bf16 v[68:71], v[208:211], v[208:211], v[68:71]
    v_mfma_f32_16x16x32_bf16 v[64:67], v[16:19], v[216:219], v[64:67]
    v_mfma_f32_16x16x32_bf16 v[68:71], v[216:219], v[216:219], v[68:71]
    s_waitcnt vmcnt(18)
    ds_read_b128 v[240:243], v6 offset:16384
    ds_read_b128 v[248:251], v7 offset:16384
    s_waitcnt lgkmcnt(2)
    v_mfma_f32_16x16x32_bf16 v[64:67], v[16:19], v[224:227], v[64:67]
    v_mfma_f32_16x16x32_bf16 v[68:71], v[224:227], v[224:227], v[68:71]
    v_mfma_f32_16x16x32_bf16 v[64:67], v[16:19], v[232:235], v[64:67]
    v_mfma_f32_16x16x32_bf16 v[68:71], v[232:235], v[232:235], v[68:71]
    s_waitcnt lgkmcnt(0)
    v_mfma_f32_16x16x32_bf16 v[64:67], v[16:19], v[240:243], v[64:67]
    v_mfma_f32_16x16x32_bf16 v[68:71], v[240:243], v[240:243], v[68:71]
    v_mfma_f32_16x16x32_bf16 v[64:67], v[16:19], v[248:251], v[64:67]
    v_mfma_f32_16x16x32_bf16 v[68:71], v[248:251], v[248:251], v[68:71]
    s_barrier
    s_nop 6
    v_cndmask_b32 v68, v68, v69, s[72:73]
    v_cndmask_b32 v68, v68, v70, s[74:75]
    v_cndmask_b32 v68, v68, v71, s[76:77]
    v_cndmask_b32 v68, 0, v68, s[78:79]
    v_mul_f32 v80, 0xbae38e39, v64
    v_mul_f32 v81, 0xbae38e39, v64
    v_mul_f32 v82, 0xbae38e39, v64
    v_mul_f32 v83, 0xbae38e39, v64
    v_mov_b32 v69, v68
    s_nop 1
    v_permlane16_swap_b32 v68, v69
    v_add_f32 v68, v68, v69
    v_mov_b32 v69, v68
    s_nop 1
    v_permlane32_swap_b32 v68, v69
    v_add_f32 v68, v68, v69
    v_mul_f32 v88, 0x3ae38e39, v68
    v_fma_f32 v88, -v80, v80, v88
    v_max_f32 v88, 0, v88
    v_add_f32 v88, 0x3727c5ac, v88
    v_rsq_f32 v90, v88
    v_rsq_f32 v91, v88
    v_mfma_f32_16x16x32_bf16 v[40:43], v[96:99], v[112:115], v[80:83]
    v_mfma_f32_16x16x32_bf16 v[44:47], v[100:103], v[112:115], v[80:83]
    v_mfma_f32_16x16x32_bf16 v[48:51], v[96:99], v[120:123], v[80:83]
    v_mfma_f32_16x16x32_bf16 v[52:55], v[100:103], v[120:123], v[80:83]
    s_nop 4
    v_pk_mul_f32 v[40:41], v[40:41], v[90:91]
    v_pk_mul_f32 v[42:43], v[42:43], v[90:91]
    v_pk_mul_f32 v[44:45], v[44:45], v[90:91]
    v_pk_mul_f32 v[46:47], v[46:47], v[90:91]
    v_mfma_f32_16x16x32_bf16 v[56:59], v[96:99], v[128:131], v[80:83]
    v_mfma_f32_16x16x32_bf16 v[60:63], v[100:103], v[128:131], v[80:83]
    v_cvt_pk_bf16_f32 v112, v40, v41
    v_cvt_pk_bf16_f32 v113, v42, v43
    v_cvt_pk_bf16_f32 v114, v44, v45
    v_cvt_pk_bf16_f32 v115, v46, v47
    v_pk_mul_f32 v[48:49], v[48:49], v[90:91]
    v_pk_mul_f32 v[50:51], v[50:51], v[90:91]
    v_pk_mul_f32 v[52:53], v[52:53], v[90:91]
    v_pk_mul_f32 v[54:55], v[54:55], v[90:91]
    v_mfma_f32_16x16x32_bf16 v[40:43], v[96:99], v[136:139], v[80:83]
    v_mfma_f32_16x16x32_bf16 v[44:47], v[100:103], v[136:139], v[80:83]
    v_cvt_pk_bf16_f32 v120, v48, v49
    v_cvt_pk_bf16_f32 v121, v50, v51
    v_cvt_pk_bf16_f32 v122, v52, v53
    v_cvt_pk_bf16_f32 v123, v54, v55
    v_pk_mul_f32 v[56:57], v[56:57], v[90:91]
    v_pk_mul_f32 v[58:59], v[58:59], v[90:91]
    v_pk_mul_f32 v[60:61], v[60:61], v[90:91]
    v_pk_mul_f32 v[62:63], v[62:63], v[90:91]
    v_mfma_f32_16x16x32_bf16 v[48:51], v[96:99], v[144:147], v[80:83]
    v_mfma_f32_16x16x32_bf16 v[52:55], v[100:103], v[144:147], v[80:83]
    v_cvt_pk_bf16_f32 v128, v56, v57
    v_cvt_pk_bf16_f32 v129, v58, v59
    v_cvt_pk_bf16_f32 v130, v60, v61
    v_cvt_pk_bf16_f32 v131, v62, v63
    v_pk_mul_f32 v[40:41], v[40:41], v[90:91]
    v_pk_mul_f32 v[42:43], v[42:43], v[90:91]
    v_pk_mul_f32 v[44:45], v[44:45], v[90:91]
    v_pk_mul_f32 v[46:47], v[46:47], v[90:91]
    v_mfma_f32_16x16x32_bf16 v[56:59], v[96:99], v[152:155], v[80:83]
    v_mfma_f32_16x16x32_bf16 v[60:63], v[100:103], v[152:155], v[80:83]
    v_cvt_pk_bf16_f32 v136, v40, v41
    v_cvt_pk_bf16_f32 v137, v42, v43
    v_cvt_pk_bf16_f32 v138, v44, v45
    v_cvt_pk_bf16_f32 v139, v46, v47
    v_pk_mul_f32 v[48:49], v[48:49], v[90:91]
    v_pk_mul_f32 v[50:51], v[50:51], v[90:91]
    v_pk_mul_f32 v[52:53], v[52:53], v[90:91]
    v_pk_mul_f32 v[54:55], v[54:55], v[90:91]
    v_mfma_f32_16x16x32_bf16 v[40:43], v[96:99], v[160:163], v[80:83]
    v_mfma_f32_16x16x32_bf16 v[44:47], v[100:103], v[160:163], v[80:83]
    v_cvt_pk_bf16_f32 v144, v48, v49
    v_cvt_pk_bf16_f32 v145, v50, v51
    v_cvt_pk_bf16_f32 v146, v52, v53
    v_cvt_pk_bf16_f32 v147, v54, v55
    s_waitcnt vmcnt(16)
    ds_read_b128 v[116:119], v12 offset:0
    ds_read_b128 v[124:127], v13 offset:0
    v_pk_mul_f32 v[56:57], v[56:57], v[90:91]
    v_pk_mul_f32 v[58:59], v[58:59], v[90:91]
    v_pk_mul_f32 v[60:61], v[60:61], v[90:91]
    v_pk_mul_f32 v[62:63], v[62:63], v[90:91]
    v_mfma_f32_16x16x32_bf16 v[48:51], v[96:99], v[168:171], v[80:83]
    v_mfma_f32_16x16x32_bf16 v[52:55], v[100:103], v[168:171], v[80:83]
    v_cvt_pk_bf16_f32 v152, v56, v57
    v_cvt_pk_bf16_f32 v153, v58, v59
    v_cvt_pk_bf16_f32 v154, v60, v61
    v_cvt_pk_bf16_f32 v155, v62, v63
    s_waitcnt vmcnt(14)
    ds_read_b128 v[132:135], v12 offset:2048
    ds_read_b128 v[140:143], v13 offset:2048
    s_waitcnt lgkmcnt(2)
    v_mfma_f32_16x16x32_bf16 v[72:75], v[16:19], v[116:119], 0
    v_mfma_f32_16x16x32_bf16 v[76:79], v[116:119], v[116:119], 0
    v_mfma_f32_16x16x32_bf16 v[72:75], v[16:19], v[124:127], v[72:75]
    v_mfma_f32_16x16x32_bf16 v[76:79], v[124:127], v[124:127], v[76:79]
    v_pk_mul_f32 v[40:41], v[40:41], v[90:91]
    v_pk_mul_f32 v[42:43], v[42:43], v[90:91]
    v_pk_mul_f32 v[44:45], v[44:45], v[90:91]
    v_pk_mul_f32 v[46:47], v[46:47], v[90:91]
    v_mfma_f32_16x16x32_bf16 v[56:59], v[96:99], v[176:179], v[80:83]
    v_mfma_f32_16x16x32_bf16 v[60:63], v[100:103], v[176:179], v[80:83]
    v_cvt_pk_bf16_f32 v160, v40, v41
    v_cvt_pk_bf16_f32 v161, v42, v43
    v_cvt_pk_bf16_f32 v162, v44, v45
    v_cvt_pk_bf16_f32 v163, v46, v47
    s_waitcnt vmcnt(12)
    ds_read_b128 v[148:151], v12 offset:4096
    ds_read_b128 v[156:159], v13 offset:4096
    s_waitcnt lgkmcnt(2)
    v_mfma_f32_16x16x32_bf16 v[72:75], v[16:19], v[132:135], v[72:75]
    v_mfma_f32_16x16x32_bf16 v[76:79], v[132:135], v[132:135], v[76:79]
    v_mfma_f32_16x16x32_bf16 v[72:75], v[16:19], v[140:143], v[72:75]
    v_mfma_f32_16x16x32_bf16 v[76:79], v[140:143], v[140:143], v[76:79]
    v_pk_mul_f32 v[48:49], v[48:49], v[90:91]
    v_pk_mul_f32 v[50:51], v[50:51], v[90:91]
    v_pk_mul_f32 v[52:53], v[52:53], v[90:91]
    v_pk_mul_f32 v[54:55], v[54:55], v[90:91]
    v_mfma_f32_16x16x32_bf16 v[40:43], v[96:99], v[184:187], v[80:83]
    v_mfma_f32_16x16x32_bf16 v[44:47], v[100:103], v[184:187], v[80:83]
    v_cvt_pk_bf16_f32 v168, v48, v49
    v_cvt_pk_bf16_f32 v169, v50, v51
    v_cvt_pk_bf16_f32 v170, v52, v53
    v_cvt_pk_bf16_f32 v171, v54, v55
    s_waitcnt vmcnt(10)
    ds_read_b128 v[164:167], v12 offset:6144
    ds_read_b128 v[172:175], v13 offset:6144
    s_waitcnt lgkmcnt(2)
    v_mfma_f32_16x16x32_bf16 v[72:75], v[16:19], v[148:151], v[72:75]
    v_mfma_f32_16x16x32_bf16 v[76:79], v[148:151], v[148:151], v[76:79]
    v_mfma_f32_16x16x32_bf16 v[72:75], v[16:19], v[156:159], v[72:75]
    v_mfma_f32_16x16x32_bf16 v[76:79], v[156:159], v[156:159], v[76:79]
    v_pk_mul_f32 v[56:57], v[56:57], v[90:91]
    v_pk_mul_f32 v[58:59], v[58:59], v[90:91]
    v_pk_mul_f32 v[60:61], v[60:61], v[90:91]
    v_pk_mul_f32 v[62:63], v[62:63], v[90:91]
    v_mfma_f32_16x16x32_bf16 v[48:51], v[96:99], v[192:195], v[80:83]
    v_mfma_f32_16x16x32_bf16 v[52:55], v[100:103], v[192:195], v[80:83]
    v_cvt_pk_bf16_f32 v176, v56, v57
    v_cvt_pk_bf16_f32 v177, v58, v59
    v_cvt_pk_bf16_f32 v178, v60, v61
    v_cvt_pk_bf16_f32 v179, v62, v63
    s_waitcnt vmcnt(8)
    ds_read_b128 v[180:183], v12 offset:8192
    ds_read_b128 v[188:191], v13 offset:8192
    s_waitcnt lgkmcnt(2)
    v_mfma_f32_16x16x32_bf16 v[72:75], v[16:19], v[164:167], v[72:75]
    v_mfma_f32_16x16x32_bf16 v[76:79], v[164:167], v[164:167], v[76:79]
    v_mfma_f32_16x16x32_bf16 v[72:75], v[16:19], v[172:175], v[72:75]
    v_mfma_f32_16x16x32_bf16 v[76:79], v[172:175], v[172:175], v[76:79]
    v_pk_mul_f32 v[40:41], v[40:41], v[90:91]
    v_pk_mul_f32 v[42:43], v[42:43], v[90:91]
    v_pk_mul_f32 v[44:45], v[44:45], v[90:91]
    v_pk_mul_f32 v[46:47], v[46:47], v[90:91]
    v_mfma_f32_16x16x32_bf16 v[56:59], v[96:99], v[200:203], v[80:83]
    v_mfma_f32_16x16x32_bf16 v[60:63], v[100:103], v[200:203], v[80:83]
    v_cvt_pk_bf16_f32 v184, v40, v41
    v_cvt_pk_bf16_f32 v185, v42, v43
    v_cvt_pk_bf16_f32 v186, v44, v45
    v_cvt_pk_bf16_f32 v187, v46, v47
    s_waitcnt vmcnt(6)
    ds_read_b128 v[196:199], v12 offset:10240
    ds_read_b128 v[204:207], v13 offset:10240
    s_waitcnt lgkmcnt(2)
    v_mfma_f32_16x16x32_bf16 v[72:75], v[16:19], v[180:183], v[72:75]
    v_mfma_f32_16x16x32_bf16 v[76:79], v[180:183], v[180:183], v[76:79]
    v_mfma_f32_16x16x32_bf16 v[72:75], v[16:19], v[188:191], v[72:75]
    v_mfma_f32_16x16x32_bf16 v[76:79], v[188:191], v[188:191], v[76:79]
    v_pk_mul_f32 v[48:49], v[48:49], v[90:91]
    v_pk_mul_f32 v[50:51], v[50:51], v[90:91]
    v_pk_mul_f32 v[52:53], v[52:53], v[90:91]
    v_pk_mul_f32 v[54:55], v[54:55], v[90:91]
    v_mfma_f32_16x16x32_bf16 v[40:43], v[96:99], v[208:211], v[80:83]
    v_mfma_f32_16x16x32_bf16 v[44:47], v[100:103], v[208:211], v[80:83]
    v_cvt_pk_bf16_f32 v192, v48, v49
    v_cvt_pk_bf16_f32 v193, v50, v51
    v_cvt_pk_bf16_f32 v194, v52, v53
    v_cvt_pk_bf16_f32 v195, v54, v55
    s_waitcnt vmcnt(4)
    ds_read_b128 v[212:215], v12 offset:12288
    ds_read_b128 v[220:223], v13 offset:12288
    s_waitcnt lgkmcnt(2)
    v_mfma_f32_16x16x32_bf16 v[72:75], v[16:19], v[196:199], v[72:75]
    v_mfma_f32_16x16x32_bf16 v[76:79], v[196:199], v[196:199], v[76:79]
    v_mfma_f32_16x16x32_bf16 v[72:75], v[16:19], v[204:207], v[72:75]
    v_mfma_f32_16x16x32_bf16 v[76:79], v[204:207], v[204:207], v[76:79]
    v_pk_mul_f32 v[56:57], v[56:57], v[90:91]
    v_pk_mul_f32 v[58:59], v[58:59], v[90:91]
    v_pk_mul_f32 v[60:61], v[60:61], v[90:91]
    v_pk_mul_f32 v[62:63], v[62:63], v[90:91]
    v_mfma_f32_16x16x32_bf16 v[48:51], v[96:99], v[216:219], v[80:83]
    v_mfma_f32_16x16x32_bf16 v[52:55], v[100:103], v[216:219], v[80:83]
    v_cvt_pk_bf16_f32 v200, v56, v57
    v_cvt_pk_bf16_f32 v201, v58, v59
    v_cvt_pk_bf16_f32 v202, v60, v61
    v_cvt_pk_bf16_f32 v203, v62, v63
    s_waitcnt vmcnt(2)
    ds_read_b128 v[228:231], v12 offset:14336
    ds_read_b128 v[236:239], v13 offset:14336
    s_waitcnt lgkmcnt(2)
    v_mfma_f32_16x16x32_bf16 v[72:75], v[16:19], v[212:215], v[72:75]
    v_mfma_f32_16x16x32_bf16 v[76:79], v[212:215], v[212:215], v[76:79]
    v_mfma_f32_16x16x32_bf16 v[72:75], v[16:19], v[220:223], v[72:75]
    v_mfma_f32_16x16x32_bf16 v[76:79], v[220:223], v[220:223], v[76:79]
    v_pk_mul_f32 v[40:41], v[40:41], v[90:91]
    v_pk_mul_f32 v[42:43], v[42:43], v[90:91]
    v_pk_mul_f32 v[44:45], v[44:45], v[90:91]
    v_pk_mul_f32 v[46:47], v[46:47], v[90:91]
    v_mfma_f32_16x16x32_bf16 v[56:59], v[96:99], v[224:227], v[80:83]
    v_mfma_f32_16x16x32_bf16 v[60:63], v[100:103], v[224:227], v[80:83]
    v_cvt_pk_bf16_f32 v208, v40, v41
    v_cvt_pk_bf16_f32 v209, v42, v43
    v_cvt_pk_bf16_f32 v210, v44, v45
    v_cvt_pk_bf16_f32 v211, v46, v47
    s_waitcnt vmcnt(0)
    ds_read_b128 v[244:247], v12 offset:16384
    ds_read_b128 v[252:255], v13 offset:16384
    s_waitcnt lgkmcnt(2)
    v_mfma_f32_16x16x32_bf16 v[72:75], v[16:19], v[228:231], v[72:75]
    v_mfma_f32_16x16x32_bf16 v[76:79], v[228:231], v[228:231], v[76:79]
    v_mfma_f32_16x16x32_bf16 v[72:75], v[16:19], v[236:239], v[72:75]
    v_mfma_f32_16x16x32_bf16 v[76:79], v[236:239], v[236:239], v[76:79]
    v_pk_mul_f32 v[48:49], v[48:49], v[90:91]
    v_pk_mul_f32 v[50:51], v[50:51], v[90:91]
    v_pk_mul_f32 v[52:53], v[52:53], v[90:91]
    v_pk_mul_f32 v[54:55], v[54:55], v[90:91]
    v_mfma_f32_16x16x32_bf16 v[40:43], v[96:99], v[232:235], v[80:83]
    v_mfma_f32_16x16x32_bf16 v[44:47], v[100:103], v[232:235], v[80:83]
    v_cvt_pk_bf16_f32 v216, v48, v49
    v_cvt_pk_bf16_f32 v217, v50, v51
    v_cvt_pk_bf16_f32 v218, v52, v53
    v_cvt_pk_bf16_f32 v219, v54, v55
    s_waitcnt lgkmcnt(0)
    v_mfma_f32_16x16x32_bf16 v[72:75], v[16:19], v[244:247], v[72:75]
    v_mfma_f32_16x16x32_bf16 v[76:79], v[244:247], v[244:247], v[76:79]
    v_mfma_f32_16x16x32_bf16 v[72:75], v[16:19], v[252:255], v[72:75]
    v_mfma_f32_16x16x32_bf16 v[76:79], v[252:255], v[252:255], v[76:79]
    v_pk_mul_f32 v[56:57], v[56:57], v[90:91]
    v_pk_mul_f32 v[58:59], v[58:59], v[90:91]
    v_pk_mul_f32 v[60:61], v[60:61], v[90:91]
    v_pk_mul_f32 v[62:63], v[62:63], v[90:91]
    v_mfma_f32_16x16x32_bf16 v[48:51], v[96:99], v[240:243], v[80:83]
    v_mfma_f32_16x16x32_bf16 v[52:55], v[100:103], v[240:243], v[80:83]
    v_cvt_pk_bf16_f32 v224, v56, v57
    v_cvt_pk_bf16_f32 v225, v58, v59
    v_cvt_pk_bf16_f32 v226, v60, v61
    v_cvt_pk_bf16_f32 v227, v62, v63
    v_pk_mul_f32 v[40:41], v[40:41], v[90:91]
    v_pk_mul_f32 v[42:43], v[42:43], v[90:91]
    v_pk_mul_f32 v[44:45], v[44:45], v[90:91]
    v_pk_mul_f32 v[46:47], v[46:47], v[90:91]
    v_mfma_f32_16x16x32_bf16 v[56:59], v[96:99], v[248:251], v[80:83]
    v_mfma_f32_16x16x32_bf16 v[60:63], v[100:103], v[248:251], v[80:83]
    v_cvt_pk_bf16_f32 v232, v40, v41
    v_cvt_pk_bf16_f32 v233, v42, v43
    v_cvt_pk_bf16_f32 v234, v44, v45
    v_cvt_pk_bf16_f32 v235, v46, v47
    v_pk_mul_f32 v[48:49], v[48:49], v[90:91]
    v_pk_mul_f32 v[50:51], v[50:51], v[90:91]
    v_pk_mul_f32 v[52:53], v[52:53], v[90:91]
    v_pk_mul_f32 v[54:55], v[54:55], v[90:91]
    v_cvt_pk_bf16_f32 v240, v48, v49
    v_cvt_pk_bf16_f32 v241, v50, v51
    v_cvt_pk_bf16_f32 v242, v52, v53
    v_cvt_pk_bf16_f32 v243, v54, v55
    v_pk_mul_f32 v[56:57], v[56:57], v[90:91]
    v_pk_mul_f32 v[58:59], v[58:59], v[90:91]
    v_pk_mul_f32 v[60:61], v[60:61], v[90:91]
    v_pk_mul_f32 v[62:63], v[62:63], v[90:91]
    v_cvt_pk_bf16_f32 v248, v56, v57
    v_cvt_pk_bf16_f32 v249, v58, v59
    v_cvt_pk_bf16_f32 v250, v60, v61
    v_cvt_pk_bf16_f32 v251, v62, v63
    v_cndmask_b32 v76, v76, v77, s[72:73]
    v_cndmask_b32 v76, v76, v78, s[74:75]
    v_cndmask_b32 v76, v76, v79, s[76:77]
    v_cndmask_b32 v76, 0, v76, s[78:79]
    v_mul_f32 v84, 0xbae38e39, v72
    v_mul_f32 v85, 0xbae38e39, v72
    v_mul_f32 v86, 0xbae38e39, v72
    v_mul_f32 v87, 0xbae38e39, v72
    v_mov_b32 v77, v76
    s_nop 1
    v_permlane16_swap_b32 v76, v77
    v_add_f32 v76, v76, v77
    v_mov_b32 v77, v76
    s_nop 1
    v_permlane32_swap_b32 v76, v77
    v_add_f32 v76, v76, v77
    v_mul_f32 v89, 0x3ae38e39, v76
    v_fma_f32 v89, -v84, v84, v89
    v_max_f32 v89, 0, v89
    v_add_f32 v89, 0x3727c5ac, v89
    v_rsq_f32 v92, v89
    v_rsq_f32 v93, v89
    v_mfma_f32_16x16x32_bf16 v[40:43], v[96:99], v[116:119], v[84:87]
    v_mfma_f32_16x16x32_bf16 v[44:47], v[100:103], v[116:119], v[84:87]
    v_mfma_f32_16x16x32_bf16 v[48:51], v[96:99], v[124:127], v[84:87]
    v_mfma_f32_16x16x32_bf16 v[52:55], v[100:103], v[124:127], v[84:87]
    s_nop 4
    v_pk_mul_f32 v[40:41], v[40:41], v[92:93]
    v_pk_mul_f32 v[42:43], v[42:43], v[92:93]
    v_pk_mul_f32 v[44:45], v[44:45], v[92:93]
    v_pk_mul_f32 v[46:47], v[46:47], v[92:93]
    v_mfma_f32_16x16x32_bf16 v[56:59], v[96:99], v[132:135], v[84:87]
    v_mfma_f32_16x16x32_bf16 v[60:63], v[100:103], v[132:135], v[84:87]
    v_cvt_pk_bf16_f32 v116, v40, v41
    v_cvt_pk_bf16_f32 v117, v42, v43
    v_cvt_pk_bf16_f32 v118, v44, v45
    v_cvt_pk_bf16_f32 v119, v46, v47
    v_pk_mul_f32 v[48:49], v[48:49], v[92:93]
    v_pk_mul_f32 v[50:51], v[50:51], v[92:93]
    v_pk_mul_f32 v[52:53], v[52:53], v[92:93]
    v_pk_mul_f32 v[54:55], v[54:55], v[92:93]
    v_mfma_f32_16x16x32_bf16 v[40:43], v[96:99], v[140:143], v[84:87]
    v_mfma_f32_16x16x32_bf16 v[44:47], v[100:103], v[140:143], v[84:87]
    v_cvt_pk_bf16_f32 v124, v48, v49
    v_cvt_pk_bf16_f32 v125, v50, v51
    v_cvt_pk_bf16_f32 v126, v52, v53
    v_cvt_pk_bf16_f32 v127, v54, v55
    v_pk_mul_f32 v[56:57], v[56:57], v[92:93]
    v_pk_mul_f32 v[58:59], v[58:59], v[92:93]
    v_pk_mul_f32 v[60:61], v[60:61], v[92:93]
    v_pk_mul_f32 v[62:63], v[62:63], v[92:93]
    v_mfma_f32_16x16x32_bf16 v[48:51], v[96:99], v[148:151], v[84:87]
    v_mfma_f32_16x16x32_bf16 v[52:55], v[100:103], v[148:151], v[84:87]
    v_cvt_pk_bf16_f32 v132, v56, v57
    v_cvt_pk_bf16_f32 v133, v58, v59
    v_cvt_pk_bf16_f32 v134, v60, v61
    v_cvt_pk_bf16_f32 v135, v62, v63
    v_pk_mul_f32 v[40:41], v[40:41], v[92:93]
    v_pk_mul_f32 v[42:43], v[42:43], v[92:93]
    v_pk_mul_f32 v[44:45], v[44:45], v[92:93]
    v_pk_mul_f32 v[46:47], v[46:47], v[92:93]
    v_mfma_f32_16x16x32_bf16 v[56:59], v[96:99], v[156:159], v[84:87]
    v_mfma_f32_16x16x32_bf16 v[60:63], v[100:103], v[156:159], v[84:87]
    v_cvt_pk_bf16_f32 v140, v40, v41
    v_cvt_pk_bf16_f32 v141, v42, v43
    v_cvt_pk_bf16_f32 v142, v44, v45
    v_cvt_pk_bf16_f32 v143, v46, v47
    v_pk_mul_f32 v[48:49], v[48:49], v[92:93]
    v_pk_mul_f32 v[50:51], v[50:51], v[92:93]
    v_pk_mul_f32 v[52:53], v[52:53], v[92:93]
    v_pk_mul_f32 v[54:55], v[54:55], v[92:93]
    v_mfma_f32_16x16x32_bf16 v[40:43], v[96:99], v[164:167], v[84:87]
    v_mfma_f32_16x16x32_bf16 v[44:47], v[100:103], v[164:167], v[84:87]
    v_cvt_pk_bf16_f32 v148, v48, v49
    v_cvt_pk_bf16_f32 v149, v50, v51
    v_cvt_pk_bf16_f32 v150, v52, v53
    v_cvt_pk_bf16_f32 v151, v54, v55
    v_pk_mul_f32 v[56:57], v[56:57], v[92:93]
    v_pk_mul_f32 v[58:59], v[58:59], v[92:93]
    v_pk_mul_f32 v[60:61], v[60:61], v[92:93]
    v_pk_mul_f32 v[62:63], v[62:63], v[92:93]
    v_mfma_f32_16x16x32_bf16 v[48:51], v[96:99], v[172:175], v[84:87]
    v_mfma_f32_16x16x32_bf16 v[52:55], v[100:103], v[172:175], v[84:87]
    v_cvt_pk_bf16_f32 v156, v56, v57
    v_cvt_pk_bf16_f32 v157, v58, v59
    v_cvt_pk_bf16_f32 v158, v60, v61
    v_cvt_pk_bf16_f32 v159, v62, v63
    v_pk_mul_f32 v[40:41], v[40:41], v[92:93]
    v_pk_mul_f32 v[42:43], v[42:43], v[92:93]
    v_pk_mul_f32 v[44:45], v[44:45], v[92:93]
    v_pk_mul_f32 v[46:47], v[46:47], v[92:93]
    v_mfma_f32_16x16x32_bf16 v[56:59], v[96:99], v[180:183], v[84:87]
    v_mfma_f32_16x16x32_bf16 v[60:63], v[100:103], v[180:183], v[84:87]
    v_cvt_pk_bf16_f32 v164, v40, v41
    v_cvt_pk_bf16_f32 v165, v42, v43
    v_cvt_pk_bf16_f32 v166, v44, v45
    v_cvt_pk_bf16_f32 v167, v46, v47
    v_pk_mul_f32 v[48:49], v[48:49], v[92:93]
    v_pk_mul_f32 v[50:51], v[50:51], v[92:93]
    v_pk_mul_f32 v[52:53], v[52:53], v[92:93]
    v_pk_mul_f32 v[54:55], v[54:55], v[92:93]
    v_mfma_f32_16x16x32_bf16 v[40:43], v[96:99], v[188:191], v[84:87]
    v_mfma_f32_16x16x32_bf16 v[44:47], v[100:103], v[188:191], v[84:87]
    v_cvt_pk_bf16_f32 v172, v48, v49
    v_cvt_pk_bf16_f32 v173, v50, v51
    v_cvt_pk_bf16_f32 v174, v52, v53
    v_cvt_pk_bf16_f32 v175, v54, v55
    v_pk_mul_f32 v[56:57], v[56:57], v[92:93]
    v_pk_mul_f32 v[58:59], v[58:59], v[92:93]
    v_pk_mul_f32 v[60:61], v[60:61], v[92:93]
    v_pk_mul_f32 v[62:63], v[62:63], v[92:93]
    v_mfma_f32_16x16x32_bf16 v[48:51], v[96:99], v[196:199], v[84:87]
    v_mfma_f32_16x16x32_bf16 v[52:55], v[100:103], v[196:199], v[84:87]
    v_cvt_pk_bf16_f32 v180, v56, v57
    v_cvt_pk_bf16_f32 v181, v58, v59
    v_cvt_pk_bf16_f32 v182, v60, v61
    v_cvt_pk_bf16_f32 v183, v62, v63
    v_pk_mul_f32 v[40:41], v[40:41], v[92:93]
    v_pk_mul_f32 v[42:43], v[42:43], v[92:93]
    v_pk_mul_f32 v[44:45], v[44:45], v[92:93]
    v_pk_mul_f32 v[46:47], v[46:47], v[92:93]
    v_mfma_f32_16x16x32_bf16 v[56:59], v[96:99], v[204:207], v[84:87]
    v_mfma_f32_16x16x32_bf16 v[60:63], v[100:103], v[204:207], v[84:87]
    v_cvt_pk_bf16_f32 v188, v40, v41
    v_cvt_pk_bf16_f32 v189, v42, v43
    v_cvt_pk_bf16_f32 v190, v44, v45
    v_cvt_pk_bf16_f32 v191, v46, v47
    v_pk_mul_f32 v[48:49], v[48:49], v[92:93]
    v_pk_mul_f32 v[50:51], v[50:51], v[92:93]
    v_pk_mul_f32 v[52:53], v[52:53], v[92:93]
    v_pk_mul_f32 v[54:55], v[54:55], v[92:93]
    v_mfma_f32_16x16x32_bf16 v[40:43], v[96:99], v[212:215], v[84:87]
    v_mfma_f32_16x16x32_bf16 v[44:47], v[100:103], v[212:215], v[84:87]
    v_cvt_pk_bf16_f32 v196, v48, v49
    v_cvt_pk_bf16_f32 v197, v50, v51
    v_cvt_pk_bf16_f32 v198, v52, v53
    v_cvt_pk_bf16_f32 v199, v54, v55
    v_pk_mul_f32 v[56:57], v[56:57], v[92:93]
    v_pk_mul_f32 v[58:59], v[58:59], v[92:93]
    v_pk_mul_f32 v[60:61], v[60:61], v[92:93]
    v_pk_mul_f32 v[62:63], v[62:63], v[92:93]
    v_mfma_f32_16x16x32_bf16 v[48:51], v[96:99], v[220:223], v[84:87]
    v_mfma_f32_16x16x32_bf16 v[52:55], v[100:103], v[220:223], v[84:87]
    v_cvt_pk_bf16_f32 v204, v56, v57
    v_cvt_pk_bf16_f32 v205, v58, v59
    v_cvt_pk_bf16_f32 v206, v60, v61
    v_cvt_pk_bf16_f32 v207, v62, v63
    v_pk_mul_f32 v[40:41], v[40:41], v[92:93]
    v_pk_mul_f32 v[42:43], v[42:43], v[92:93]
    v_pk_mul_f32 v[44:45], v[44:45], v[92:93]
    v_pk_mul_f32 v[46:47], v[46:47], v[92:93]
    v_mfma_f32_16x16x32_bf16 v[56:59], v[96:99], v[228:231], v[84:87]
    v_mfma_f32_16x16x32_bf16 v[60:63], v[100:103], v[228:231], v[84:87]
    v_cvt_pk_bf16_f32 v212, v40, v41
    v_cvt_pk_bf16_f32 v213, v42, v43
    v_cvt_pk_bf16_f32 v214, v44, v45
    v_cvt_pk_bf16_f32 v215, v46, v47
    v_pk_mul_f32 v[48:49], v[48:49], v[92:93]
    v_pk_mul_f32 v[50:51], v[50:51], v[92:93]
    v_pk_mul_f32 v[52:53], v[52:53], v[92:93]
    v_pk_mul_f32 v[54:55], v[54:55], v[92:93]
    v_mfma_f32_16x16x32_bf16 v[40:43], v[96:99], v[236:239], v[84:87]
    v_mfma_f32_16x16x32_bf16 v[44:47], v[100:103], v[236:239], v[84:87]
    v_cvt_pk_bf16_f32 v220, v48, v49
    v_cvt_pk_bf16_f32 v221, v50, v51
    v_cvt_pk_bf16_f32 v222, v52, v53
    v_cvt_pk_bf16_f32 v223, v54, v55
    v_pk_mul_f32 v[56:57], v[56:57], v[92:93]
    v_pk_mul_f32 v[58:59], v[58:59], v[92:93]
    v_pk_mul_f32 v[60:61], v[60:61], v[92:93]
    v_pk_mul_f32 v[62:63], v[62:63], v[92:93]
    v_mfma_f32_16x16x32_bf16 v[48:51], v[96:99], v[244:247], v[84:87]
    v_mfma_f32_16x16x32_bf16 v[52:55], v[100:103], v[244:247], v[84:87]
    v_cvt_pk_bf16_f32 v228, v56, v57
    v_cvt_pk_bf16_f32 v229, v58, v59
    v_cvt_pk_bf16_f32 v230, v60, v61
    v_cvt_pk_bf16_f32 v231, v62, v63
    v_pk_mul_f32 v[40:41], v[40:41], v[92:93]
    v_pk_mul_f32 v[42:43], v[42:43], v[92:93]
    v_pk_mul_f32 v[44:45], v[44:45], v[92:93]
    v_pk_mul_f32 v[46:47], v[46:47], v[92:93]
    v_mfma_f32_16x16x32_bf16 v[56:59], v[96:99], v[252:255], v[84:87]
    v_mfma_f32_16x16x32_bf16 v[60:63], v[100:103], v[252:255], v[84:87]
    v_cvt_pk_bf16_f32 v236, v40, v41
    v_cvt_pk_bf16_f32 v237, v42, v43
    v_cvt_pk_bf16_f32 v238, v44, v45
    v_cvt_pk_bf16_f32 v239, v46, v47
    v_pk_mul_f32 v[48:49], v[48:49], v[92:93]
    v_pk_mul_f32 v[50:51], v[50:51], v[92:93]
    v_pk_mul_f32 v[52:53], v[52:53], v[92:93]
    v_pk_mul_f32 v[54:55], v[54:55], v[92:93]
    v_cvt_pk_bf16_f32 v244, v48, v49
    v_cvt_pk_bf16_f32 v245, v50, v51
    v_cvt_pk_bf16_f32 v246, v52, v53
    v_cvt_pk_bf16_f32 v247, v54, v55
    v_pk_mul_f32 v[56:57], v[56:57], v[92:93]
    v_pk_mul_f32 v[58:59], v[58:59], v[92:93]
    v_pk_mul_f32 v[60:61], v[60:61], v[92:93]
    v_pk_mul_f32 v[62:63], v[62:63], v[92:93]
    v_cvt_pk_bf16_f32 v252, v56, v57
    v_cvt_pk_bf16_f32 v253, v58, v59
    v_cvt_pk_bf16_f32 v254, v60, v61
    v_cvt_pk_bf16_f32 v255, v62, v63
    v_lshrrev_b32 v4, 2, v2
    v_and_b32 v5, 3, v2
    v_lshl_add_u32 v4, v3, 2, v4
    v_and_b32 v6, 6, v4
    v_lshrrev_b32 v12, 1, v5
    v_and_b32 v13, 1, v5
    v_lshlrev_b32 v13, 3, v13
    v_lshl_add_u32 v13, v4, 7, v13
    v_xor_b32 v7, 0, v6
    v_add_u32 v7, v7, v12
    v_lshl_add_u32 v7, v7, 4, v13
    v_xor_b32 v8, 2, v6
    v_add_u32 v8, v8, v12
    v_lshl_add_u32 v8, v8, 4, v13
    v_xor_b32 v9, 4, v6
    v_add_u32 v9, v9, v12
    v_lshl_add_u32 v9, v9, 4, v13
    v_xor_b32 v10, 6, v6
    v_add_u32 v10, v10, v12
    v_lshl_add_u32 v10, v10, 4, v13
    v_lshlrev_b32 v11, 5, v4
    v_lshl_add_u32 v11, v5, 3, v11
    v_mul_u32_u24 v12, 288, v4
    v_mov_b32 v0, v5
    v_lshl_add_u32 v5, v0, 3, v12
    v_mul_u32_u24 v4, 48, v0
    v_lshrrev_b32 v6, 1, v0
    v_lshl_add_u32 v4, v6, 3, v4
    v_add_u32 v4, v4, v12
    v_and_b32 v0, 1, v0
    v_mul_u32_u24 v0, 48, v0
    v_add3_u32 v12, v0, v12, 64
    v_add_u32 v12, 160, v12
    v_lshlrev_b32 v13, 4, v1
    s_mul_i32 s64, s63, 12288
    s_add_u32 s64, s64, 92160
    v_add_u32 v13, s64, v13
    s_barrier
    v_add_u32 v7, 110592, v7
    v_add_u32 v8, 110592, v8
    v_add_u32 v9, 110592, v9
    v_add_u32 v10, 110592, v10
    v_add_u32 v11, 110592, v11
    ds_read_b64_tr_b16 v[16:17], v7 offset:36864
    ds_read_b64_tr_b16 v[18:19], v7 offset:38912
    ds_read_b64_tr_b16 v[20:21], v8 offset:36864
    ds_read_b64_tr_b16 v[22:23], v8 offset:38912
    ds_read_b64_tr_b16 v[24:25], v9 offset:36864
    ds_read_b64_tr_b16 v[26:27], v9 offset:38912
    ds_read_b64_tr_b16 v[28:29], v10 offset:36864
    ds_read_b64_tr_b16 v[30:31], v10 offset:38912
    ds_read_b64_tr_b16 v[32:33], v11 offset:49152
    ds_read_b64_tr_b16 v[34:35], v11 offset:49664
    s_waitcnt lgkmcnt(6)
    v_mfma_f32_16x16x32_bf16 v[72:75], v[112:115], v[16:19], 0
    ds_read_b64_tr_b16 v[36:37], v7 offset:40960
    v_mfma_f32_16x16x32_bf16 v[76:79], v[116:119], v[16:19], 0
    ds_read_b64_tr_b16 v[38:39], v7 offset:43008
    v_mfma_f32_16x16x32_bf16 v[80:83], v[112:115], v[20:23], 0
    ds_read_b64_tr_b16 v[16:17], v8 offset:40960
    v_mfma_f32_16x16x32_bf16 v[84:87], v[116:119], v[20:23], 0
    ds_read_b64_tr_b16 v[18:19], v8 offset:43008
    s_waitcnt lgkmcnt(6)
    v_mfma_f32_16x16x32_bf16 v[88:91], v[112:115], v[24:27], 0
    ds_read_b64_tr_b16 v[20:21], v9 offset:40960
    v_mfma_f32_16x16x32_bf16 v[92:95], v[116:119], v[24:27], 0
    ds_read_b64_tr_b16 v[22:23], v9 offset:43008
    v_mfma_f32_16x16x32_bf16 v[96:99], v[112:115], v[28:31], 0
    ds_read_b64_tr_b16 v[24:25], v10 offset:40960
    v_mfma_f32_16x16x32_bf16 v[100:103], v[116:119], v[28:31], 0
    ds_read_b64_tr_b16 v[26:27], v10 offset:43008
    s_waitcnt lgkmcnt(6)
    v_mfma_f32_16x16x32_bf16 v[104:107], v[112:115], v[32:35], 0
    ds_read_b64_tr_b16 v[28:29], v11 offset:50176
    v_mfma_f32_16x16x32_bf16 v[108:111], v[116:119], v[32:35], 0
    ds_read_b64_tr_b16 v[30:31], v11 offset:50688
    v_mfma_f32_16x16x32_bf16 v[72:75], v[120:123], v[36:39], v[72:75]
    ds_read_b64_tr_b16 v[32:33], v7 offset:45056
    v_mfma_f32_16x16x32_bf16 v[76:79], v[124:127], v[36:39], v[76:79]
    ds_read_b64_tr_b16 v[34:35], v7 offset:47104
    s_waitcnt lgkmcnt(6)
    v_mfma_f32_16x16x32_bf16 v[80:83], v[120:123], v[16:19], v[80:83]
    ds_read_b64_tr_b16 v[36:37], v8 offset:45056
    v_mfma_f32_16x16x32_bf16 v[84:87], v[124:127], v[16:19], v[84:87]
    ds_read_b64_tr_b16 v[38:39], v8 offset:47104
    v_mfma_f32_16x16x32_bf16 v[88:91], v[120:123], v[20:23], v[88:91]
    ds_read_b64_tr_b16 v[16:17], v9 offset:45056
    v_mfma_f32_16x16x32_bf16 v[92:95], v[124:127], v[20:23], v[92:95]
    ds_read_b64_tr_b16 v[18:19], v9 offset:47104
    s_waitcnt lgkmcnt(6)
    v_mfma_f32_16x16x32_bf16 v[96:99], v[120:123], v[24:27], v[96:99]
    ds_read_b64_tr_b16 v[20:21], v10 offset:45056
    v_mfma_f32_16x16x32_bf16 v[100:103], v[124:127], v[24:27], v[100:103]
    ds_read_b64_tr_b16 v[22:23], v10 offset:47104
    v_mfma_f32_16x16x32_bf16 v[104:107], v[120:123], v[28:31], v[104:107]
    ds_read_b64_tr_b16 v[24:25], v11 offset:51200
    v_mfma_f32_16x16x32_bf16 v[108:111], v[124:127], v[28:31], v[108:111]
    ds_read_b64_tr_b16 v[26:27], v11 offset:51712
    s_waitcnt lgkmcnt(6)
    v_mfma_f32_16x16x32_bf16 v[72:75], v[128:131], v[32:35], v[72:75]
    s_barrier
    v_subrev_u32 v7, 110592, v7
    v_subrev_u32 v8, 110592, v8
    v_subrev_u32 v9, 110592, v9
    v_subrev_u32 v10, 110592, v10
    v_subrev_u32 v11, 110592, v11
    ds_read_b64_tr_b16 v[28:29], v7 offset:0
    v_mfma_f32_16x16x32_bf16 v[76:79], v[132:135], v[32:35], v[76:79]
    ds_read_b64_tr_b16 v[30:31], v7 offset:2048
    v_mfma_f32_16x16x32_bf16 v[80:83], v[128:131], v[36:39], v[80:83]
    ds_read_b64_tr_b16 v[32:33], v8 offset:0
    v_mfma_f32_16x16x32_bf16 v[84:87], v[132:135], v[36:39], v[84:87]
    ds_read_b64_tr_b16 v[34:35], v8 offset:2048
    s_waitcnt lgkmcnt(6)
    v_mfma_f32_16x16x32_bf16 v[88:91], v[128:131], v[16:19], v[88:91]
    ds_read_b64_tr_b16 v[36:37], v9 offset:0
    v_mfma_f32_16x16x32_bf16 v[92:95], v[132:135], v[16:19], v[92:95]
    ds_read_b64_tr_b16 v[38:39], v9 offset:2048
    v_mfma_f32_16x16x32_bf16 v[96:99], v[128:131], v[20:23], v[96:99]
    ds_read_b64_tr_b16 v[16:17], v10 offset:0
    v_mfma_f32_16x16x32_bf16 v[100:103], v[132:135], v[20:23], v[100:103]
    ds_read_b64_tr_b16 v[18:19], v10 offset:2048
    s_waitcnt lgkmcnt(6)
    v_mfma_f32_16x16x32_bf16 v[104:107], v[128:131], v[24:27], v[104:107]
    ds_read_b64_tr_b16 v[20:21], v11 offset:12288
    v_mfma_f32_16x16x32_bf16 v[108:111], v[132:135], v[24:27], v[108:111]
    ds_read_b64_tr_b16 v[22:23], v11 offset:12800
    v_mfma_f32_16x16x32_bf16 v[72:75], v[136:139], v[28:31], v[72:75]
    ds_read_b64_tr_b16 v[24:25], v7 offset:4096
    v_mfma_f32_16x16x32_bf16 v[76:79], v[140:143], v[28:31], v[76:79]
    ds_read_b64_tr_b16 v[26:27], v7 offset:6144
    s_waitcnt lgkmcnt(6)
    v_mfma_f32_16x16x32_bf16 v[80:83], v[136:139], v[32:35], v[80:83]
    ds_read_b64_tr_b16 v[28:29], v8 offset:4096
    v_mfma_f32_16x16x32_bf16 v[84:87], v[140:143], v[32:35], v[84:87]
    ds_read_b64_tr_b16 v[30:31], v8 offset:6144
    v_mfma_f32_16x16x32_bf16 v[88:91], v[136:139], v[36:39], v[88:91]
    ds_read_b64_tr_b16 v[32:33], v9 offset:4096
    v_mfma_f32_16x16x32_bf16 v[92:95], v[140:143], v[36:39], v[92:95]
    ds_read_b64_tr_b16 v[34:35], v9 offset:6144
    s_waitcnt lgkmcnt(6)
    v_mfma_f32_16x16x32_bf16 v[96:99], v[136:139], v[16:19], v[96:99]
    ds_read_b64_tr_b16 v[36:37], v10 offset:4096
    v_mfma_f32_16x16x32_bf16 v[100:103], v[140:143], v[16:19], v[100:103]
    ds_read_b64_tr_b16 v[38:39], v10 offset:6144
    v_mfma_f32_16x16x32_bf16 v[104:107], v[136:139], v[20:23], v[104:107]
    ds_read_b64_tr_b16 v[16:17], v11 offset:13312
    v_mfma_f32_16x16x32_bf16 v[108:111], v[140:143], v[20:23], v[108:111]
    ds_read_b64_tr_b16 v[18:19], v11 offset:13824
    s_waitcnt lgkmcnt(6)
    v_mfma_f32_16x16x32_bf16 v[72:75], v[144:147], v[24:27], v[72:75]
    ds_read_b64_tr_b16 v[20:21], v7 offset:8192
    v_mfma_f32_16x16x32_bf16 v[76:79], v[148:151], v[24:27], v[76:79]
    ds_read_b64_tr_b16 v[22:23], v7 offset:10240
    v_mfma_f32_16x16x32_bf16 v[80:83], v[144:147], v[28:31], v[80:83]
    ds_read_b64_tr_b16 v[24:25], v8 offset:8192
    v_mfma_f32_16x16x32_bf16 v[84:87], v[148:151], v[28:31], v[84:87]
    ds_read_b64_tr_b16 v[26:27], v8 offset:10240
    s_waitcnt lgkmcnt(6)
    v_mfma_f32_16x16x32_bf16 v[88:91], v[144:147], v[32:35], v[88:91]
    ds_read_b64_tr_b16 v[28:29], v9 offset:8192
    v_mfma_f32_16x16x32_bf16 v[92:95], v[148:151], v[32:35], v[92:95]
    ds_read_b64_tr_b16 v[30:31], v9 offset:10240
    v_mfma_f32_16x16x32_bf16 v[96:99], v[144:147], v[36:39], v[96:99]
    ds_read_b64_tr_b16 v[32:33], v10 offset:8192
    v_mfma_f32_16x16x32_bf16 v[100:103], v[148:151], v[36:39], v[100:103]
    ds_read_b64_tr_b16 v[34:35], v10 offset:10240
    s_waitcnt lgkmcnt(6)
    v_mfma_f32_16x16x32_bf16 v[104:107], v[144:147], v[16:19], v[104:107]
    ds_read_b64_tr_b16 v[36:37], v11 offset:14336
    v_mfma_f32_16x16x32_bf16 v[108:111], v[148:151], v[16:19], v[108:111]
    ds_read_b64_tr_b16 v[38:39], v11 offset:14848
    v_mfma_f32_16x16x32_bf16 v[72:75], v[152:155], v[20:23], v[72:75]
    s_barrier
    ds_read_b64_tr_b16 v[16:17], v7 offset:18432
    v_mfma_f32_16x16x32_bf16 v[76:79], v[156:159], v[20:23], v[76:79]
    ds_read_b64_tr_b16 v[18:19], v7 offset:20480
    s_waitcnt lgkmcnt(6)
    v_mfma_f32_16x16x32_bf16 v[80:83], v[152:155], v[24:27], v[80:83]
    ds_read_b64_tr_b16 v[20:21], v8 offset:18432
    v_mfma_f32_16x16x32_bf16 v[84:87], v[156:159], v[24:27], v[84:87]
    ds_read_b64_tr_b16 v[22:23], v8 offset:20480
    v_mfma_f32_16x16x32_bf16 v[88:91], v[152:155], v[28:31], v[88:91]
    ds_read_b64_tr_b16 v[24:25], v9 offset:18432
    v_mfma_f32_16x16x32_bf16 v[92:95], v[156:159], v[28:31], v[92:95]
    ds_read_b64_tr_b16 v[26:27], v9 offset:20480
    s_waitcnt lgkmcnt(6)
    v_mfma_f32_16x16x32_bf16 v[96:99], v[152:155], v[32:35], v[96:99]
    ds_read_b64_tr_b16 v[28:29], v10 offset:18432
    v_mfma_f32_16x16x32_bf16 v[100:103], v[156:159], v[32:35], v[100:103]
    ds_read_b64_tr_b16 v[30:31], v10 offset:20480
    v_mfma_f32_16x16x32_bf16 v[104:107], v[152:155], v[36:39], v[104:107]
    ds_read_b64_tr_b16 v[32:33], v11 offset:30720
    v_mfma_f32_16x16x32_bf16 v[108:111], v[156:159], v[36:39], v[108:111]
    ds_read_b64_tr_b16 v[34:35], v11 offset:31232
    s_waitcnt lgkmcnt(6)
    v_mfma_f32_16x16x32_bf16 v[72:75], v[160:163], v[16:19], v[72:75]
    ds_read_b64_tr_b16 v[36:37], v7 offset:22528
    v_mfma_f32_16x16x32_bf16 v[76:79], v[164:167], v[16:19], v[76:79]
    ds_read_b64_tr_b16 v[38:39], v7 offset:24576
    v_mfma_f32_16x16x32_bf16 v[80:83], v[160:163], v[20:23], v[80:83]
    ds_read_b64_tr_b16 v[16:17], v8 offset:22528
    v_mfma_f32_16x16x32_bf16 v[84:87], v[164:167], v[20:23], v[84:87]
    ds_read_b64_tr_b16 v[18:19], v8 offset:24576
    s_waitcnt lgkmcnt(6)
    v_mfma_f32_16x16x32_bf16 v[88:91], v[160:163], v[24:27], v[88:91]
    ds_read_b64_tr_b16 v[20:21], v9 offset:22528
    v_mfma_f32_16x16x32_bf16 v[92:95], v[164:167], v[24:27], v[92:95]
    ds_read_b64_tr_b16 v[22:23], v9 offset:24576
    v_mfma_f32_16x16x32_bf16 v[96:99], v[160:163], v[28:31], v[96:99]
    ds_read_b64_tr_b16 v[24:25], v10 offset:22528
    v_mfma_f32_16x16x32_bf16 v[100:103], v[164:167], v[28:31], v[100:103]
    ds_read_b64_tr_b16 v[26:27], v10 offset:24576
    s_waitcnt lgkmcnt(6)
    v_mfma_f32_16x16x32_bf16 v[104:107], v[160:163], v[32:35], v[104:107]
    ds_read_b64_tr_b16 v[28:29], v11 offset:31744
    v_mfma_f32_16x16x32_bf16 v[108:111], v[164:167], v[32:35], v[108:111]
    ds_read_b64_tr_b16 v[30:31], v11 offset:32256
    v_mfma_f32_16x16x32_bf16 v[72:75], v[168:171], v[36:39], v[72:75]
    ds_read_b64_tr_b16 v[32:33], v7 offset:26624
    v_mfma_f32_16x16x32_bf16 v[76:79], v[172:175], v[36:39], v[76:79]
    ds_read_b64_tr_b16 v[34:35], v7 offset:28672
    s_waitcnt lgkmcnt(6)
    v_mfma_f32_16x16x32_bf16 v[80:83], v[168:171], v[16:19], v[80:83]
    ds_read_b64_tr_b16 v[36:37], v8 offset:26624
    v_mfma_f32_16x16x32_bf16 v[84:87], v[172:175], v[16:19], v[84:87]
    ds_read_b64_tr_b16 v[38:39], v8 offset:28672
    v_mfma_f32_16x16x32_bf16 v[88:91], v[168:171], v[20:23], v[88:91]
    ds_read_b64_tr_b16 v[16:17], v9 offset:26624
    v_mfma_f32_16x16x32_bf16 v[92:95], v[172:175], v[20:23], v[92:95]
    ds_read_b64_tr_b16 v[18:19], v9 offset:28672
    s_waitcnt lgkmcnt(6)
    v_mfma_f32_16x16x32_bf16 v[96:99], v[168:171], v[24:27], v[96:99]
    ds_read_b64_tr_b16 v[20:21], v10 offset:26624
    v_mfma_f32_16x16x32_bf16 v[100:103], v[172:175], v[24:27], v[100:103]
    ds_read_b64_tr_b16 v[22:23], v10 offset:28672
    v_mfma_f32_16x16x32_bf16 v[104:107], v[168:171], v[28:31], v[104:107]
    ds_read_b64_tr_b16 v[24:25], v11 offset:32768
    v_mfma_f32_16x16x32_bf16 v[108:111], v[172:175], v[28:31], v[108:111]
    ds_read_b64_tr_b16 v[26:27], v11 offset:33280
    s_waitcnt lgkmcnt(6)
    v_mfma_f32_16x16x32_bf16 v[72:75], v[176:179], v[32:35], v[72:75]
    s_barrier
    ds_read_b64_tr_b16 v[28:29], v7 offset:36864
    v_mfma_f32_16x16x32_bf16 v[76:79], v[180:183], v[32:35], v[76:79]
    ds_read_b64_tr_b16 v[30:31], v7 offset:38912
    v_mfma_f32_16x16x32_bf16 v[80:83], v[176:179], v[36:39], v[80:83]
    ds_read_b64_tr_b16 v[32:33], v8 offset:36864
    v_mfma_f32_16x16x32_bf16 v[84:87], v[180:183], v[36:39], v[84:87]
    ds_read_b64_tr_b16 v[34:35], v8 offset:38912
    s_waitcnt lgkmcnt(6)
    v_mfma_f32_16x16x32_bf16 v[88:91], v[176:179], v[16:19], v[88:91]
    ds_read_b64_tr_b16 v[36:37], v9 offset:36864
    v_mfma_f32_16x16x32_bf16 v[92:95], v[180:183], v[16:19], v[92:95]
    ds_read_b64_tr_b16 v[38:39], v9 offset:38912
    v_mfma_f32_16x16x32_bf16 v[96:99], v[176:179], v[20:23], v[96:99]
    ds_read_b64_tr_b16 v[16:17], v10 offset:36864
    v_mfma_f32_16x16x32_bf16 v[100:103], v[180:183], v[20:23], v[100:103]
    ds_read_b64_tr_b16 v[18:19], v10 offset:38912
    s_waitcnt lgkmcnt(6)
    v_mfma_f32_16x16x32_bf16 v[104:107], v[176:179], v[24:27], v[104:107]
    ds_read_b64_tr_b16 v[20:21], v11 offset:49152
    v_mfma_f32_16x16x32_bf16 v[108:111], v[180:183], v[24:27], v[108:111]
    ds_read_b64_tr_b16 v[22:23], v11 offset:49664
    v_mfma_f32_16x16x32_bf16 v[72:75], v[184:187], v[28:31], v[72:75]
    ds_read_b64_tr_b16 v[24:25], v7 offset:40960
    v_mfma_f32_16x16x32_bf16 v[76:79], v[188:191], v[28:31], v[76:79]
    ds_read_b64_tr_b16 v[26:27], v7 offset:43008
    s_waitcnt lgkmcnt(6)
    v_mfma_f32_16x16x32_bf16 v[80:83], v[184:187], v[32:35], v[80:83]
    ds_read_b64_tr_b16 v[28:29], v8 offset:40960
    v_mfma_f32_16x16x32_bf16 v[84:87], v[188:191], v[32:35], v[84:87]
    ds_read_b64_tr_b16 v[30:31], v8 offset:43008
    v_mfma_f32_16x16x32_bf16 v[88:91], v[184:187], v[36:39], v[88:91]
    ds_read_b64_tr_b16 v[32:33], v9 offset:40960
    v_mfma_f32_16x16x32_bf16 v[92:95], v[188:191], v[36:39], v[92:95]
    ds_read_b64_tr_b16 v[34:35], v9 offset:43008
    s_waitcnt lgkmcnt(6)
    v_mfma_f32_16x16x32_bf16 v[96:99], v[184:187], v[16:19], v[96:99]
    ds_read_b64_tr_b16 v[36:37], v10 offset:40960
    v_mfma_f32_16x16x32_bf16 v[100:103], v[188:191], v[16:19], v[100:103]
    ds_read_b64_tr_b16 v[38:39], v10 offset:43008
    v_mfma_f32_16x16x32_bf16 v[104:107], v[184:187], v[20:23], v[104:107]
    ds_read_b64_tr_b16 v[16:17], v11 offset:50176
    v_mfma_f32_16x16x32_bf16 v[108:111], v[188:191], v[20:23], v[108:111]
    ds_read_b64_tr_b16 v[18:19], v11 offset:50688
    s_waitcnt lgkmcnt(6)
    v_mfma_f32_16x16x32_bf16 v[72:75], v[192:195], v[24:27], v[72:75]
    ds_read_b64_tr_b16 v[20:21], v7 offset:45056
    v_mfma_f32_16x16x32_bf16 v[76:79], v[196:199], v[24:27], v[76:79]
    ds_read_b64_tr_b16 v[22:23], v7 offset:47104
    v_mfma_f32_16x16x32_bf16 v[80:83], v[192:195], v[28:31], v[80:83]
    ds_read_b64_tr_b16 v[24:25], v8 offset:45056
    v_mfma_f32_16x16x32_bf16 v[84:87], v[196:199], v[28:31], v[84:87]
    ds_read_b64_tr_b16 v[26:27], v8 offset:47104
    s_waitcnt lgkmcnt(6)
    v_mfma_f32_16x16x32_bf16 v[88:91], v[192:195], v[32:35], v[88:91]
    ds_read_b64_tr_b16 v[28:29], v9 offset:45056
    v_mfma_f32_16x16x32_bf16 v[92:95], v[196:199], v[32:35], v[92:95]
    ds_read_b64_tr_b16 v[30:31], v9 offset:47104
    v_mfma_f32_16x16x32_bf16 v[96:99], v[192:195], v[36:39], v[96:99]
    ds_read_b64_tr_b16 v[32:33], v10 offset:45056
    v_mfma_f32_16x16x32_bf16 v[100:103], v[196:199], v[36:39], v[100:103]
    ds_read_b64_tr_b16 v[34:35], v10 offset:47104
    s_waitcnt lgkmcnt(6)
    v_mfma_f32_16x16x32_bf16 v[104:107], v[192:195], v[16:19], v[104:107]
    ds_read_b64_tr_b16 v[36:37], v11 offset:51200
    v_mfma_f32_16x16x32_bf16 v[108:111], v[196:199], v[16:19], v[108:111]
    ds_read_b64_tr_b16 v[38:39], v11 offset:51712
    v_mfma_f32_16x16x32_bf16 v[72:75], v[200:203], v[20:23], v[72:75]
    s_barrier
    ds_read_b64_tr_b16 v[16:17], v7 offset:55296
    v_mfma_f32_16x16x32_bf16 v[76:79], v[204:207], v[20:23], v[76:79]
    ds_read_b64_tr_b16 v[18:19], v7 offset:57344
    s_waitcnt lgkmcnt(6)
    v_mfma_f32_16x16x32_bf16 v[80:83], v[200:203], v[24:27], v[80:83]
    ds_read_b64_tr_b16 v[20:21], v8 offset:55296
    v_mfma_f32_16x16x32_bf16 v[84:87], v[204:207], v[24:27], v[84:87]
    ds_read_b64_tr_b16 v[22:23], v8 offset:57344
    v_mfma_f32_16x16x32_bf16 v[88:91], v[200:203], v[28:31], v[88:91]
    ds_read_b64_tr_b16 v[24:25], v9 offset:55296
    v_mfma_f32_16x16x32_bf16 v[92:95], v[204:207], v[28:31], v[92:95]
    ds_read_b64_tr_b16 v[26:27], v9 offset:57344
    s_waitcnt lgkmcnt(6)
    v_mfma_f32_16x16x32_bf16 v[96:99], v[200:203], v[32:35], v[96:99]
    ds_read_b64_tr_b16 v[28:29], v10 offset:55296
    v_mfma_f32_16x16x32_bf16 v[100:103], v[204:207], v[32:35], v[100:103]
    ds_read_b64_tr_b16 v[30:31], v10 offset:57344
    v_mfma_f32_16x16x32_bf16 v[104:107], v[200:203], v[36:39], v[104:107]
    v_add_u32 v7, 55296, v7
    v_add_u32 v8, 55296, v8
    v_add_u32 v9, 55296, v9
    v_add_u32 v10, 55296, v10
    v_add_u32 v11, 55296, v11
    ds_read_b64_tr_b16 v[32:33], v11 offset:12288
    v_mfma_f32_16x16x32_bf16 v[108:111], v[204:207], v[36:39], v[108:111]
    ds_read_b64_tr_b16 v[34:35], v11 offset:12800
    s_waitcnt lgkmcnt(6)
    v_mfma_f32_16x16x32_bf16 v[72:75], v[208:211], v[16:19], v[72:75]
    ds_read_b64_tr_b16 v[36:37], v7 offset:4096
    v_mfma_f32_16x16x32_bf16 v[76:79], v[212:215], v[16:19], v[76:79]
    ds_read_b64_tr_b16 v[38:39], v7 offset:6144
    v_mfma_f32_16x16x32_bf16 v[80:83], v[208:211], v[20:23], v[80:83]
    ds_read_b64_tr_b16 v[16:17], v8 offset:4096
    v_mfma_f32_16x16x32_bf16 v[84:87], v[212:215], v[20:23], v[84:87]
    ds_read_b64_tr_b16 v[18:19], v8 offset:6144
    s_waitcnt lgkmcnt(6)
    v_mfma_f32_16x16x32_bf16 v[88:91], v[208:211], v[24:27], v[88:91]
    ds_read_b64_tr_b16 v[20:21], v9 offset:4096
    v_mfma_f32_16x16x32_bf16 v[92:95], v[212:215], v[24:27], v[92:95]
    ds_read_b64_tr_b16 v[22:23], v9 offset:6144
    v_mfma_f32_16x16x32_bf16 v[96:99], v[208:211], v[28:31], v[96:99]
    ds_read_b64_tr_b16 v[24:25], v10 offset:4096
    v_mfma_f32_16x16x32_bf16 v[100:103], v[212:215], v[28:31], v[100:103]
    ds_read_b64_tr_b16 v[26:27], v10 offset:6144
    s_waitcnt lgkmcnt(6)
    v_mfma_f32_16x16x32_bf16 v[104:107], v[208:211], v[32:35], v[104:107]
    ds_read_b64_tr_b16 v[28:29], v11 offset:13312
    v_mfma_f32_16x16x32_bf16 v[108:111], v[212:215], v[32:35], v[108:111]
    ds_read_b64_tr_b16 v[30:31], v11 offset:13824
    v_mfma_f32_16x16x32_bf16 v[72:75], v[216:219], v[36:39], v[72:75]
    ds_read_b64_tr_b16 v[32:33], v7 offset:8192
    v_mfma_f32_16x16x32_bf16 v[76:79], v[220:223], v[36:39], v[76:79]
    ds_read_b64_tr_b16 v[34:35], v7 offset:10240
    s_waitcnt lgkmcnt(6)
    v_mfma_f32_16x16x32_bf16 v[80:83], v[216:219], v[16:19], v[80:83]
    ds_read_b64_tr_b16 v[36:37], v8 offset:8192
    v_mfma_f32_16x16x32_bf16 v[84:87], v[220:223], v[16:19], v[84:87]
    ds_read_b64_tr_b16 v[38:39], v8 offset:10240
    v_mfma_f32_16x16x32_bf16 v[88:91], v[216:219], v[20:23], v[88:91]
    ds_read_b64_tr_b16 v[16:17], v9 offset:8192
    v_mfma_f32_16x16x32_bf16 v[92:95], v[220:223], v[20:23], v[92:95]
    ds_read_b64_tr_b16 v[18:19], v9 offset:10240
    s_waitcnt lgkmcnt(6)
    v_mfma_f32_16x16x32_bf16 v[96:99], v[216:219], v[24:27], v[96:99]
    ds_read_b64_tr_b16 v[20:21], v10 offset:8192
    v_mfma_f32_16x16x32_bf16 v[100:103], v[220:223], v[24:27], v[100:103]
    ds_read_b64_tr_b16 v[22:23], v10 offset:10240
    v_mfma_f32_16x16x32_bf16 v[104:107], v[216:219], v[28:31], v[104:107]
    ds_read_b64_tr_b16 v[24:25], v11 offset:14336
    v_mfma_f32_16x16x32_bf16 v[108:111], v[220:223], v[28:31], v[108:111]
    ds_read_b64_tr_b16 v[26:27], v11 offset:14848
    s_waitcnt lgkmcnt(6)
    v_mfma_f32_16x16x32_bf16 v[72:75], v[224:227], v[32:35], v[72:75]
    s_barrier
    ds_read_b64_tr_b16 v[28:29], v7 offset:18432
    v_mfma_f32_16x16x32_bf16 v[76:79], v[228:231], v[32:35], v[76:79]
    ds_read_b64_tr_b16 v[30:31], v7 offset:20480
    v_mfma_f32_16x16x32_bf16 v[80:83], v[224:227], v[36:39], v[80:83]
    ds_read_b64_tr_b16 v[32:33], v8 offset:18432
    v_mfma_f32_16x16x32_bf16 v[84:87], v[228:231], v[36:39], v[84:87]
    ds_read_b64_tr_b16 v[34:35], v8 offset:20480
    s_waitcnt lgkmcnt(6)
    v_mfma_f32_16x16x32_bf16 v[88:91], v[224:227], v[16:19], v[88:91]
    ds_read_b64_tr_b16 v[36:37], v9 offset:18432
    v_mfma_f32_16x16x32_bf16 v[92:95], v[228:231], v[16:19], v[92:95]
    ds_read_b64_tr_b16 v[38:39], v9 offset:20480
    v_mfma_f32_16x16x32_bf16 v[96:99], v[224:227], v[20:23], v[96:99]
    ds_read_b64_tr_b16 v[16:17], v10 offset:18432
    v_mfma_f32_16x16x32_bf16 v[100:103], v[228:231], v[20:23], v[100:103]
    ds_read_b64_tr_b16 v[18:19], v10 offset:20480
    s_waitcnt lgkmcnt(6)
    v_mfma_f32_16x16x32_bf16 v[104:107], v[224:227], v[24:27], v[104:107]
    ds_read_b64_tr_b16 v[20:21], v11 offset:30720
    v_mfma_f32_16x16x32_bf16 v[108:111], v[228:231], v[24:27], v[108:111]
    ds_read_b64_tr_b16 v[22:23], v11 offset:31232
    v_mfma_f32_16x16x32_bf16 v[72:75], v[232:235], v[28:31], v[72:75]
    ds_read_b64_tr_b16 v[24:25], v7 offset:22528
    v_mfma_f32_16x16x32_bf16 v[76:79], v[236:239], v[28:31], v[76:79]
    ds_read_b64_tr_b16 v[26:27], v7 offset:24576
    s_waitcnt lgkmcnt(6)
    v_mfma_f32_16x16x32_bf16 v[80:83], v[232:235], v[32:35], v[80:83]
    ds_read_b64_tr_b16 v[28:29], v8 offset:22528
    v_mfma_f32_16x16x32_bf16 v[84:87], v[236:239], v[32:35], v[84:87]
    ds_read_b64_tr_b16 v[30:31], v8 offset:24576
    v_mfma_f32_16x16x32_bf16 v[88:91], v[232:235], v[36:39], v[88:91]
    ds_read_b64_tr_b16 v[32:33], v9 offset:22528
    v_mfma_f32_16x16x32_bf16 v[92:95], v[236:239], v[36:39], v[92:95]
    ds_read_b64_tr_b16 v[34:35], v9 offset:24576
    s_waitcnt lgkmcnt(6)
    v_mfma_f32_16x16x32_bf16 v[96:99], v[232:235], v[16:19], v[96:99]
    ds_read_b64_tr_b16 v[36:37], v10 offset:22528
    v_mfma_f32_16x16x32_bf16 v[100:103], v[236:239], v[16:19], v[100:103]
    ds_read_b64_tr_b16 v[38:39], v10 offset:24576
    v_mfma_f32_16x16x32_bf16 v[104:107], v[232:235], v[20:23], v[104:107]
    ds_read_b64_tr_b16 v[16:17], v11 offset:31744
    v_mfma_f32_16x16x32_bf16 v[108:111], v[236:239], v[20:23], v[108:111]
    ds_read_b64_tr_b16 v[18:19], v11 offset:32256
    s_waitcnt lgkmcnt(6)
    v_mfma_f32_16x16x32_bf16 v[72:75], v[240:243], v[24:27], v[72:75]
    ds_read_b64_tr_b16 v[20:21], v7 offset:26624
    v_mfma_f32_16x16x32_bf16 v[76:79], v[244:247], v[24:27], v[76:79]
    ds_read_b64_tr_b16 v[22:23], v7 offset:28672
    v_mfma_f32_16x16x32_bf16 v[80:83], v[240:243], v[28:31], v[80:83]
    ds_read_b64_tr_b16 v[24:25], v8 offset:26624
    v_mfma_f32_16x16x32_bf16 v[84:87], v[244:247], v[28:31], v[84:87]
    ds_read_b64_tr_b16 v[26:27], v8 offset:28672
    s_waitcnt lgkmcnt(6)
    v_mfma_f32_16x16x32_bf16 v[88:91], v[240:243], v[32:35], v[88:91]
    ds_read_b64_tr_b16 v[28:29], v9 offset:26624
    v_mfma_f32_16x16x32_bf16 v[92:95], v[244:247], v[32:35], v[92:95]
    ds_read_b64_tr_b16 v[30:31], v9 offset:28672
    v_mfma_f32_16x16x32_bf16 v[96:99], v[240:243], v[36:39], v[96:99]
    ds_read_b64_tr_b16 v[32:33], v10 offset:26624
    v_mfma_f32_16x16x32_bf16 v[100:103], v[244:247], v[36:39], v[100:103]
    ds_read_b64_tr_b16 v[34:35], v10 offset:28672
    s_waitcnt lgkmcnt(6)
    v_mfma_f32_16x16x32_bf16 v[104:107], v[240:243], v[16:19], v[104:107]
    ds_read_b64_tr_b16 v[36:37], v11 offset:32768
    v_mfma_f32_16x16x32_bf16 v[108:111], v[244:247], v[16:19], v[108:111]
    ds_read_b64_tr_b16 v[38:39], v11 offset:33280
    v_mfma_f32_16x16x32_bf16 v[72:75], v[248:251], v[20:23], v[72:75]
    s_barrier
    v_subrev_u32 v7, 55296, v7
    v_subrev_u32 v8, 55296, v8
    v_subrev_u32 v9, 55296, v9
    v_subrev_u32 v10, 55296, v10
    v_subrev_u32 v11, 55296, v11
    ds_read_b64_tr_b16 v[16:17], v7 offset:0
    v_mfma_f32_16x16x32_bf16 v[76:79], v[252:255], v[20:23], v[76:79]
    ds_read_b64_tr_b16 v[18:19], v7 offset:2048
    s_waitcnt lgkmcnt(6)
    v_mfma_f32_16x16x32_bf16 v[80:83], v[248:251], v[24:27], v[80:83]
    ds_read_b64_tr_b16 v[20:21], v8 offset:0
    v_mfma_f32_16x16x32_bf16 v[84:87], v[252:255], v[24:27], v[84:87]
    ds_read_b64_tr_b16 v[22:23], v8 offset:2048
    v_mfma_f32_16x16x32_bf16 v[88:91], v[248:251], v[28:31], v[88:91]
    ds_read_b64_tr_b16 v[24:25], v9 offset:0
    v_mfma_f32_16x16x32_bf16 v[92:95], v[252:255], v[28:31], v[92:95]
    ds_read_b64_tr_b16 v[26:27], v9 offset:2048
    s_waitcnt lgkmcnt(6)
    v_mfma_f32_16x16x32_bf16 v[96:99], v[248:251], v[32:35], v[96:99]
    ds_read_b64_tr_b16 v[28:29], v10 offset:0
    v_mfma_f32_16x16x32_bf16 v[100:103], v[252:255], v[32:35], v[100:103]
    ds_read_b64_tr_b16 v[30:31], v10 offset:2048
    v_mfma_f32_16x16x32_bf16 v[104:107], v[248:251], v[36:39], v[104:107]
    ds_read_b64_tr_b16 v[32:33], v7 offset:4096
    v_mfma_f32_16x16x32_bf16 v[108:111], v[252:255], v[36:39], v[108:111]
    ds_read_b64_tr_b16 v[34:35], v7 offset:6144
    s_waitcnt lgkmcnt(6)
    v_mfma_f32_16x16x32_bf16 v[40:43], v[112:115], v[16:19], 0
    ds_read_b64_tr_b16 v[36:37], v8 offset:4096
    v_mfma_f32_16x16x32_bf16 v[44:47], v[116:119], v[16:19], 0
    ds_read_b64_tr_b16 v[38:39], v8 offset:6144
    v_mfma_f32_16x16x32_bf16 v[48:51], v[112:115], v[20:23], 0
    ds_read_b64_tr_b16 v[16:17], v9 offset:4096
    v_mfma_f32_16x16x32_bf16 v[52:55], v[116:119], v[20:23], 0
    ds_read_b64_tr_b16 v[18:19], v9 offset:6144
    s_waitcnt lgkmcnt(6)
    v_mfma_f32_16x16x32_bf16 v[56:59], v[112:115], v[24:27], 0
    ds_read_b64_tr_b16 v[20:21], v10 offset:4096
    v_mfma_f32_16x16x32_bf16 v[60:63], v[116:119], v[24:27], 0
    ds_read_b64_tr_b16 v[22:23], v10 offset:6144
    v_mfma_f32_16x16x32_bf16 v[64:67], v[112:115], v[28:31], 0
    ds_read_b64_tr_b16 v[24:25], v7 offset:8192
    v_mfma_f32_16x16x32_bf16 v[68:71], v[116:119], v[28:31], 0
    ds_read_b64_tr_b16 v[26:27], v7 offset:10240
    s_waitcnt lgkmcnt(6)
    v_mfma_f32_16x16x32_bf16 v[40:43], v[120:123], v[32:35], v[40:43]
    ds_read_b64_tr_b16 v[28:29], v8 offset:8192
    v_mfma_f32_16x16x32_bf16 v[44:47], v[124:127], v[32:35], v[44:47]
    ds_read_b64_tr_b16 v[30:31], v8 offset:10240
    v_mfma_f32_16x16x32_bf16 v[48:51], v[120:123], v[36:39], v[48:51]
    ds_read_b64_tr_b16 v[32:33], v9 offset:8192
    v_mfma_f32_16x16x32_bf16 v[52:55], v[124:127], v[36:39], v[52:55]
    ds_read_b64_tr_b16 v[34:35], v9 offset:10240
    s_waitcnt lgkmcnt(6)
    v_mfma_f32_16x16x32_bf16 v[56:59], v[120:123], v[16:19], v[56:59]
    ds_read_b64_tr_b16 v[36:37], v10 offset:8192
    v_mfma_f32_16x16x32_bf16 v[60:63], v[124:127], v[16:19], v[60:63]
    ds_read_b64_tr_b16 v[38:39], v10 offset:10240
    v_mfma_f32_16x16x32_bf16 v[64:67], v[120:123], v[20:23], v[64:67]
    s_barrier
    ds_read_b64_tr_b16 v[16:17], v7 offset:18432
    v_mfma_f32_16x16x32_bf16 v[68:71], v[124:127], v[20:23], v[68:71]
    ds_read_b64_tr_b16 v[18:19], v7 offset:20480
    s_waitcnt lgkmcnt(6)
    v_mfma_f32_16x16x32_bf16 v[40:43], v[128:131], v[24:27], v[40:43]
    ds_read_b64_tr_b16 v[20:21], v8 offset:18432
    v_mfma_f32_16x16x32_bf16 v[44:47], v[132:135], v[24:27], v[44:47]
    ds_read_b64_tr_b16 v[22:23], v8 offset:20480
    v_mfma_f32_16x16x32_bf16 v[48:51], v[128:131], v[28:31], v[48:51]
    ds_read_b64_tr_b16 v[24:25], v9 offset:18432
    v_mfma_f32_16x16x32_bf16 v[52:55], v[132:135], v[28:31], v[52:55]
    ds_read_b64_tr_b16 v[26:27], v9 offset:20480
    s_waitcnt lgkmcnt(6)
    v_mfma_f32_16x16x32_bf16 v[56:59], v[128:131], v[32:35], v[56:59]
    ds_read_b64_tr_b16 v[28:29], v10 offset:18432
    v_mfma_f32_16x16x32_bf16 v[60:63], v[132:135], v[32:35], v[60:63]
    ds_read_b64_tr_b16 v[30:31], v10 offset:20480
    v_mfma_f32_16x16x32_bf16 v[64:67], v[128:131], v[36:39], v[64:67]
    ds_read_b64_tr_b16 v[32:33], v7 offset:22528
    v_mfma_f32_16x16x32_bf16 v[68:71], v[132:135], v[36:39], v[68:71]
    ds_read_b64_tr_b16 v[34:35], v7 offset:24576
    s_waitcnt lgkmcnt(6)
    v_mfma_f32_16x16x32_bf16 v[40:43], v[136:139], v[16:19], v[40:43]
    ds_read_b64_tr_b16 v[36:37], v8 offset:22528
    v_mfma_f32_16x16x32_bf16 v[44:47], v[140:143], v[16:19], v[44:47]
    ds_read_b64_tr_b16 v[38:39], v8 offset:24576
    v_mfma_f32_16x16x32_bf16 v[48:51], v[136:139], v[20:23], v[48:51]
    ds_read_b64_tr_b16 v[16:17], v9 offset:22528
    v_mfma_f32_16x16x32_bf16 v[52:55], v[140:143], v[20:23], v[52:55]
    ds_read_b64_tr_b16 v[18:19], v9 offset:24576
    s_waitcnt lgkmcnt(6)
    v_mfma_f32_16x16x32_bf16 v[56:59], v[136:139], v[24:27], v[56:59]
    ds_read_b64_tr_b16 v[20:21], v10 offset:22528
    v_mfma_f32_16x16x32_bf16 v[60:63], v[140:143], v[24:27], v[60:63]
    ds_read_b64_tr_b16 v[22:23], v10 offset:24576
    v_mfma_f32_16x16x32_bf16 v[64:67], v[136:139], v[28:31], v[64:67]
    ds_read_b64_tr_b16 v[24:25], v7 offset:26624
    v_mfma_f32_16x16x32_bf16 v[68:71], v[140:143], v[28:31], v[68:71]
    ds_read_b64_tr_b16 v[26:27], v7 offset:28672
    s_waitcnt lgkmcnt(6)
    v_mfma_f32_16x16x32_bf16 v[40:43], v[144:147], v[32:35], v[40:43]
    ds_read_b64_tr_b16 v[28:29], v8 offset:26624
    v_mfma_f32_16x16x32_bf16 v[44:47], v[148:151], v[32:35], v[44:47]
    ds_read_b64_tr_b16 v[30:31], v8 offset:28672
    v_mfma_f32_16x16x32_bf16 v[48:51], v[144:147], v[36:39], v[48:51]
    ds_read_b64_tr_b16 v[32:33], v9 offset:26624
    v_mfma_f32_16x16x32_bf16 v[52:55], v[148:151], v[36:39], v[52:55]
    ds_read_b64_tr_b16 v[34:35], v9 offset:28672
    s_waitcnt lgkmcnt(6)
    v_mfma_f32_16x16x32_bf16 v[56:59], v[144:147], v[16:19], v[56:59]
    ds_read_b64_tr_b16 v[36:37], v10 offset:26624
    v_mfma_f32_16x16x32_bf16 v[60:63], v[148:151], v[16:19], v[60:63]
    ds_read_b64_tr_b16 v[38:39], v10 offset:28672
    v_mfma_f32_16x16x32_bf16 v[64:67], v[144:147], v[20:23], v[64:67]
    s_barrier
    ds_read_b64_tr_b16 v[16:17], v7 offset:36864
    v_mfma_f32_16x16x32_bf16 v[68:71], v[148:151], v[20:23], v[68:71]
    ds_read_b64_tr_b16 v[18:19], v7 offset:38912
    s_waitcnt lgkmcnt(6)
    v_mfma_f32_16x16x32_bf16 v[40:43], v[152:155], v[24:27], v[40:43]
    ds_read_b64_tr_b16 v[20:21], v8 offset:36864
    v_mfma_f32_16x16x32_bf16 v[44:47], v[156:159], v[24:27], v[44:47]
    ds_read_b64_tr_b16 v[22:23], v8 offset:38912
    v_mfma_f32_16x16x32_bf16 v[48:51], v[152:155], v[28:31], v[48:51]
    ds_read_b64_tr_b16 v[24:25], v9 offset:36864
    v_mfma_f32_16x16x32_bf16 v[52:55], v[156:159], v[28:31], v[52:55]
    ds_read_b64_tr_b16 v[26:27], v9 offset:38912
    s_waitcnt lgkmcnt(6)
    v_mfma_f32_16x16x32_bf16 v[56:59], v[152:155], v[32:35], v[56:59]
    ds_read_b64_tr_b16 v[28:29], v10 offset:36864
    v_mfma_f32_16x16x32_bf16 v[60:63], v[156:159], v[32:35], v[60:63]
    ds_read_b64_tr_b16 v[30:31], v10 offset:38912
    v_mfma_f32_16x16x32_bf16 v[64:67], v[152:155], v[36:39], v[64:67]
    ds_read_b64_tr_b16 v[32:33], v7 offset:40960
    v_mfma_f32_16x16x32_bf16 v[68:71], v[156:159], v[36:39], v[68:71]
    ds_read_b64_tr_b16 v[34:35], v7 offset:43008
    s_waitcnt lgkmcnt(6)
    v_mfma_f32_16x16x32_bf16 v[40:43], v[160:163], v[16:19], v[40:43]
    ds_read_b64_tr_b16 v[36:37], v8 offset:40960
    v_mfma_f32_16x16x32_bf16 v[44:47], v[164:167], v[16:19], v[44:47]
    ds_read_b64_tr_b16 v[38:39], v8 offset:43008
    v_mfma_f32_16x16x32_bf16 v[48:51], v[160:163], v[20:23], v[48:51]
    ds_read_b64_tr_b16 v[16:17], v9 offset:40960
    v_mfma_f32_16x16x32_bf16 v[52:55], v[164:167], v[20:23], v[52:55]
    ds_read_b64_tr_b16 v[18:19], v9 offset:43008
    s_waitcnt lgkmcnt(6)
    v_mfma_f32_16x16x32_bf16 v[56:59], v[160:163], v[24:27], v[56:59]
    ds_read_b64_tr_b16 v[20:21], v10 offset:40960
    v_mfma_f32_16x16x32_bf16 v[60:63], v[164:167], v[24:27], v[60:63]
    ds_read_b64_tr_b16 v[22:23], v10 offset:43008
    v_mfma_f32_16x16x32_bf16 v[64:67], v[160:163], v[28:31], v[64:67]
    ds_read_b64_tr_b16 v[24:25], v7 offset:45056
    v_mfma_f32_16x16x32_bf16 v[68:71], v[164:167], v[28:31], v[68:71]
    ds_read_b64_tr_b16 v[26:27], v7 offset:47104
    s_waitcnt lgkmcnt(6)
    v_mfma_f32_16x16x32_bf16 v[40:43], v[168:171], v[32:35], v[40:43]
    ds_read_b64_tr_b16 v[28:29], v8 offset:45056
    v_mfma_f32_16x16x32_bf16 v[44:47], v[172:175], v[32:35], v[44:47]
    ds_read_b64_tr_b16 v[30:31], v8 offset:47104
    v_mfma_f32_16x16x32_bf16 v[48:51], v[168:171], v[36:39], v[48:51]
    ds_read_b64_tr_b16 v[32:33], v9 offset:45056
    v_mfma_f32_16x16x32_bf16 v[52:55], v[172:175], v[36:39], v[52:55]
    ds_read_b64_tr_b16 v[34:35], v9 offset:47104
    s_waitcnt lgkmcnt(6)
    v_mfma_f32_16x16x32_bf16 v[56:59], v[168:171], v[16:19], v[56:59]
    ds_read_b64_tr_b16 v[36:37], v10 offset:45056
    v_mfma_f32_16x16x32_bf16 v[60:63], v[172:175], v[16:19], v[60:63]
    ds_read_b64_tr_b16 v[38:39], v10 offset:47104
    v_mfma_f32_16x16x32_bf16 v[64:67], v[168:171], v[20:23], v[64:67]
    s_barrier
    ds_read_b64_tr_b16 v[16:17], v7 offset:55296
    v_mfma_f32_16x16x32_bf16 v[68:71], v[172:175], v[20:23], v[68:71]
    ds_read_b64_tr_b16 v[18:19], v7 offset:57344
    s_waitcnt lgkmcnt(6)
    v_mfma_f32_16x16x32_bf16 v[40:43], v[176:179], v[24:27], v[40:43]
    ds_read_b64_tr_b16 v[20:21], v8 offset:55296
    v_mfma_f32_16x16x32_bf16 v[44:47], v[180:183], v[24:27], v[44:47]
    ds_read_b64_tr_b16 v[22:23], v8 offset:57344
    v_mfma_f32_16x16x32_bf16 v[48:51], v[176:179], v[28:31], v[48:51]
    ds_read_b64_tr_b16 v[24:25], v9 offset:55296
    v_mfma_f32_16x16x32_bf16 v[52:55], v[180:183], v[28:31], v[52:55]
    ds_read_b64_tr_b16 v[26:27], v9 offset:57344
    s_waitcnt lgkmcnt(6)
    v_mfma_f32_16x16x32_bf16 v[56:59], v[176:179], v[32:35], v[56:59]
    ds_read_b64_tr_b16 v[28:29], v10 offset:55296
    v_mfma_f32_16x16x32_bf16 v[60:63], v[180:183], v[32:35], v[60:63]
    ds_read_b64_tr_b16 v[30:31], v10 offset:57344
    v_mfma_f32_16x16x32_bf16 v[64:67], v[176:179], v[36:39], v[64:67]
    ds_read_b64_tr_b16 v[32:33], v7 offset:59392
    v_mfma_f32_16x16x32_bf16 v[68:71], v[180:183], v[36:39], v[68:71]
    ds_read_b64_tr_b16 v[34:35], v7 offset:61440
    s_waitcnt lgkmcnt(6)
    v_mfma_f32_16x16x32_bf16 v[40:43], v[184:187], v[16:19], v[40:43]
    ds_read_b64_tr_b16 v[36:37], v8 offset:59392
    v_mfma_f32_16x16x32_bf16 v[44:47], v[188:191], v[16:19], v[44:47]
    ds_read_b64_tr_b16 v[38:39], v8 offset:61440
    v_mfma_f32_16x16x32_bf16 v[48:51], v[184:187], v[20:23], v[48:51]
    ds_read_b64_tr_b16 v[16:17], v9 offset:59392
    v_mfma_f32_16x16x32_bf16 v[52:55], v[188:191], v[20:23], v[52:55]
    ds_read_b64_tr_b16 v[18:19], v9 offset:61440
    s_waitcnt lgkmcnt(6)
    v_mfma_f32_16x16x32_bf16 v[56:59], v[184:187], v[24:27], v[56:59]
    ds_read_b64_tr_b16 v[20:21], v10 offset:59392
    v_mfma_f32_16x16x32_bf16 v[60:63], v[188:191], v[24:27], v[60:63]
    ds_read_b64_tr_b16 v[22:23], v10 offset:61440
    v_mfma_f32_16x16x32_bf16 v[64:67], v[184:187], v[28:31], v[64:67]
    ds_read_b64_tr_b16 v[24:25], v7 offset:63488
    v_mfma_f32_16x16x32_bf16 v[68:71], v[188:191], v[28:31], v[68:71]
    v_add_u32 v7, 55296, v7
    v_add_u32 v8, 55296, v8
    v_add_u32 v9, 55296, v9
    v_add_u32 v10, 55296, v10
    v_add_u32 v11, 55296, v11
    ds_read_b64_tr_b16 v[26:27], v7 offset:10240
    s_waitcnt lgkmcnt(6)
    v_mfma_f32_16x16x32_bf16 v[40:43], v[192:195], v[32:35], v[40:43]
    ds_read_b64_tr_b16 v[28:29], v8 offset:8192
    v_mfma_f32_16x16x32_bf16 v[44:47], v[196:199], v[32:35], v[44:47]
    ds_read_b64_tr_b16 v[30:31], v8 offset:10240
    v_mfma_f32_16x16x32_bf16 v[48:51], v[192:195], v[36:39], v[48:51]
    ds_read_b64_tr_b16 v[32:33], v9 offset:8192
    v_mfma_f32_16x16x32_bf16 v[52:55], v[196:199], v[36:39], v[52:55]
    ds_read_b64_tr_b16 v[34:35], v9 offset:10240
    s_waitcnt lgkmcnt(6)
    v_mfma_f32_16x16x32_bf16 v[56:59], v[192:195], v[16:19], v[56:59]
    ds_read_b64_tr_b16 v[36:37], v10 offset:8192
    v_mfma_f32_16x16x32_bf16 v[60:63], v[196:199], v[16:19], v[60:63]
    ds_read_b64_tr_b16 v[38:39], v10 offset:10240
    v_mfma_f32_16x16x32_bf16 v[64:67], v[192:195], v[20:23], v[64:67]
    s_barrier
    ds_read_b64_tr_b16 v[16:17], v7 offset:18432
    v_mfma_f32_16x16x32_bf16 v[68:71], v[196:199], v[20:23], v[68:71]
    ds_read_b64_tr_b16 v[18:19], v7 offset:20480
    s_waitcnt lgkmcnt(6)
    v_mfma_f32_16x16x32_bf16 v[40:43], v[200:203], v[24:27], v[40:43]
    ds_read_b64_tr_b16 v[20:21], v8 offset:18432
    v_mfma_f32_16x16x32_bf16 v[44:47], v[204:207], v[24:27], v[44:47]
    ds_read_b64_tr_b16 v[22:23], v8 offset:20480
    v_mfma_f32_16x16x32_bf16 v[48:51], v[200:203], v[28:31], v[48:51]
    ds_read_b64_tr_b16 v[24:25], v9 offset:18432
    v_mfma_f32_16x16x32_bf16 v[52:55], v[204:207], v[28:31], v[52:55]
    ds_read_b64_tr_b16 v[26:27], v9 offset:20480
    s_waitcnt lgkmcnt(6)
    v_mfma_f32_16x16x32_bf16 v[56:59], v[200:203], v[32:35], v[56:59]
    ds_read_b64_tr_b16 v[28:29], v10 offset:18432
    v_mfma_f32_16x16x32_bf16 v[60:63], v[204:207], v[32:35], v[60:63]
    ds_read_b64_tr_b16 v[30:31], v10 offset:20480
    v_mfma_f32_16x16x32_bf16 v[64:67], v[200:203], v[36:39], v[64:67]
    ds_read_b64_tr_b16 v[32:33], v7 offset:22528
    v_mfma_f32_16x16x32_bf16 v[68:71], v[204:207], v[36:39], v[68:71]
    ds_read_b64_tr_b16 v[34:35], v7 offset:24576
    s_waitcnt lgkmcnt(6)
    v_mfma_f32_16x16x32_bf16 v[40:43], v[208:211], v[16:19], v[40:43]
    ds_read_b64_tr_b16 v[36:37], v8 offset:22528
    v_mfma_f32_16x16x32_bf16 v[44:47], v[212:215], v[16:19], v[44:47]
    ds_read_b64_tr_b16 v[38:39], v8 offset:24576
    v_mfma_f32_16x16x32_bf16 v[48:51], v[208:211], v[20:23], v[48:51]
    ds_read_b64_tr_b16 v[16:17], v9 offset:22528
    v_mfma_f32_16x16x32_bf16 v[52:55], v[212:215], v[20:23], v[52:55]
    ds_read_b64_tr_b16 v[18:19], v9 offset:24576
    s_waitcnt lgkmcnt(6)
    v_mfma_f32_16x16x32_bf16 v[56:59], v[208:211], v[24:27], v[56:59]
    ds_read_b64_tr_b16 v[20:21], v10 offset:22528
    v_mfma_f32_16x16x32_bf16 v[60:63], v[212:215], v[24:27], v[60:63]
    ds_read_b64_tr_b16 v[22:23], v10 offset:24576
    v_mfma_f32_16x16x32_bf16 v[64:67], v[208:211], v[28:31], v[64:67]
    ds_read_b64_tr_b16 v[24:25], v7 offset:26624
    v_mfma_f32_16x16x32_bf16 v[68:71], v[212:215], v[28:31], v[68:71]
    ds_read_b64_tr_b16 v[26:27], v7 offset:28672
    s_waitcnt lgkmcnt(6)
    v_mfma_f32_16x16x32_bf16 v[40:43], v[216:219], v[32:35], v[40:43]
    ds_read_b64_tr_b16 v[28:29], v8 offset:26624
    v_mfma_f32_16x16x32_bf16 v[44:47], v[220:223], v[32:35], v[44:47]
    ds_read_b64_tr_b16 v[30:31], v8 offset:28672
    v_mfma_f32_16x16x32_bf16 v[48:51], v[216:219], v[36:39], v[48:51]
    ds_read_b64_tr_b16 v[32:33], v9 offset:26624
    v_mfma_f32_16x16x32_bf16 v[52:55], v[220:223], v[36:39], v[52:55]
    ds_read_b64_tr_b16 v[34:35], v9 offset:28672
    s_waitcnt lgkmcnt(6)
    v_mfma_f32_16x16x32_bf16 v[56:59], v[216:219], v[16:19], v[56:59]
    ds_read_b64_tr_b16 v[36:37], v10 offset:26624
    v_mfma_f32_16x16x32_bf16 v[60:63], v[220:223], v[16:19], v[60:63]
    ds_read_b64_tr_b16 v[38:39], v10 offset:28672
    v_mfma_f32_16x16x32_bf16 v[64:67], v[216:219], v[20:23], v[64:67]
    s_barrier
    v_subrev_u32 v7, 55296, v7
    v_subrev_u32 v8, 55296, v8
    v_subrev_u32 v9, 55296, v9
    v_subrev_u32 v10, 55296, v10
    v_subrev_u32 v11, 55296, v11
    ds_read_b64_tr_b16 v[16:17], v7 offset:0
    v_mfma_f32_16x16x32_bf16 v[68:71], v[220:223], v[20:23], v[68:71]
    ds_read_b64_tr_b16 v[18:19], v7 offset:2048
    s_waitcnt lgkmcnt(6)
    v_mfma_f32_16x16x32_bf16 v[40:43], v[224:227], v[24:27], v[40:43]
    ds_read_b64_tr_b16 v[20:21], v8 offset:0
    v_mfma_f32_16x16x32_bf16 v[44:47], v[228:231], v[24:27], v[44:47]
    ds_read_b64_tr_b16 v[22:23], v8 offset:2048
    v_mfma_f32_16x16x32_bf16 v[48:51], v[224:227], v[28:31], v[48:51]
    ds_read_b64_tr_b16 v[24:25], v9 offset:0
    v_mfma_f32_16x16x32_bf16 v[52:55], v[228:231], v[28:31], v[52:55]
    ds_read_b64_tr_b16 v[26:27], v9 offset:2048
    s_waitcnt lgkmcnt(6)
    v_mfma_f32_16x16x32_bf16 v[56:59], v[224:227], v[32:35], v[56:59]
    ds_read_b64_tr_b16 v[28:29], v10 offset:0
    v_mfma_f32_16x16x32_bf16 v[60:63], v[228:231], v[32:35], v[60:63]
    ds_read_b64_tr_b16 v[30:31], v10 offset:2048
    v_mfma_f32_16x16x32_bf16 v[64:67], v[224:227], v[36:39], v[64:67]
    ds_read_b64_tr_b16 v[32:33], v7 offset:4096
    v_mfma_f32_16x16x32_bf16 v[68:71], v[228:231], v[36:39], v[68:71]
    ds_read_b64_tr_b16 v[34:35], v7 offset:6144
    s_waitcnt lgkmcnt(6)
    v_mfma_f32_16x16x32_bf16 v[40:43], v[232:235], v[16:19], v[40:43]
    ds_read_b64_tr_b16 v[36:37], v8 offset:4096
    v_mfma_f32_16x16x32_bf16 v[44:47], v[236:239], v[16:19], v[44:47]
    ds_read_b64_tr_b16 v[38:39], v8 offset:6144
    v_mfma_f32_16x16x32_bf16 v[48:51], v[232:235], v[20:23], v[48:51]
    ds_read_b64_tr_b16 v[16:17], v9 offset:4096
    v_mfma_f32_16x16x32_bf16 v[52:55], v[236:239], v[20:23], v[52:55]
    ds_read_b64_tr_b16 v[18:19], v9 offset:6144
    s_waitcnt lgkmcnt(6)
    v_mfma_f32_16x16x32_bf16 v[56:59], v[232:235], v[24:27], v[56:59]
    ds_read_b64_tr_b16 v[20:21], v10 offset:4096
    v_mfma_f32_16x16x32_bf16 v[60:63], v[236:239], v[24:27], v[60:63]
    ds_read_b64_tr_b16 v[22:23], v10 offset:6144
    v_mfma_f32_16x16x32_bf16 v[64:67], v[232:235], v[28:31], v[64:67]
    ds_read_b64_tr_b16 v[24:25], v7 offset:8192
    v_mfma_f32_16x16x32_bf16 v[68:71], v[236:239], v[28:31], v[68:71]
    ds_read_b64_tr_b16 v[26:27], v7 offset:10240
    s_waitcnt lgkmcnt(6)
    v_mfma_f32_16x16x32_bf16 v[40:43], v[240:243], v[32:35], v[40:43]
    ds_read_b64_tr_b16 v[28:29], v8 offset:8192
    v_mfma_f32_16x16x32_bf16 v[44:47], v[244:247], v[32:35], v[44:47]
    ds_read_b64_tr_b16 v[30:31], v8 offset:10240
    v_mfma_f32_16x16x32_bf16 v[48:51], v[240:243], v[36:39], v[48:51]
    ds_read_b64_tr_b16 v[32:33], v9 offset:8192
    v_mfma_f32_16x16x32_bf16 v[52:55], v[244:247], v[36:39], v[52:55]
    ds_read_b64_tr_b16 v[34:35], v9 offset:10240
    s_waitcnt lgkmcnt(6)
    v_mfma_f32_16x16x32_bf16 v[56:59], v[240:243], v[16:19], v[56:59]
    ds_read_b64_tr_b16 v[36:37], v10 offset:8192
    v_mfma_f32_16x16x32_bf16 v[60:63], v[244:247], v[16:19], v[60:63]
    ds_read_b64_tr_b16 v[38:39], v10 offset:10240
    v_mfma_f32_16x16x32_bf16 v[64:67], v[240:243], v[20:23], v[64:67]
    v_mfma_f32_16x16x32_bf16 v[68:71], v[244:247], v[20:23], v[68:71]
    s_waitcnt lgkmcnt(4)
    v_mfma_f32_16x16x32_bf16 v[40:43], v[248:251], v[24:27], v[40:43]
    v_mfma_f32_16x16x32_bf16 v[44:47], v[252:255], v[24:27], v[44:47]
    v_mfma_f32_16x16x32_bf16 v[48:51], v[248:251], v[28:31], v[48:51]
    v_mfma_f32_16x16x32_bf16 v[52:55], v[252:255], v[28:31], v[52:55]
    s_waitcnt lgkmcnt(0)
    v_mfma_f32_16x16x32_bf16 v[56:59], v[248:251], v[32:35], v[56:59]
    v_mfma_f32_16x16x32_bf16 v[60:63], v[252:255], v[32:35], v[60:63]
    v_mfma_f32_16x16x32_bf16 v[64:67], v[248:251], v[36:39], v[64:67]
    v_mfma_f32_16x16x32_bf16 v[68:71], v[252:255], v[36:39], v[68:71]
LA_pz:
    v_mov_b32 v0, 0xc0135761
    v_mov_b32 v1, 0xc0135761
    s_mov_b32 s74, 0xbdd2d3e8
    s_mov_b32 s75, 0xbdd2d3e8
    s_mov_b32 s76, 1.0
    s_mov_b32 s77, 1.0
    s_lshl_b32 s64, s60, 4
    s_add_u32 s64, s64, s61
    s_lshl_b32 s64, s64, 10
    s_lshl_b32 s65, s63, 8
    s_add_u32 s64, s64, s65
    s_add_u32 s64, s64, 23068672
    v_lshlrev_b32 v6, 6, v3
    v_pk_mul_f32 v[16:17], v[72:73], v[72:73]
    v_pk_mul_f32 v[18:19], v[74:75], v[74:75]
    v_pk_mul_f32 v[20:21], v[76:77], v[76:77]
    v_pk_mul_f32 v[22:23], v[78:79], v[78:79]
    v_pk_fma_f32 v[16:17], v[16:17], s[74:75], v[0:1]
    v_pk_fma_f32 v[18:19], v[18:19], s[74:75], v[0:1]
    v_pk_fma_f32 v[20:21], v[20:21], s[74:75], v[0:1]
    v_pk_fma_f32 v[22:23], v[22:23], s[74:75], v[0:1]
    v_pk_mul_f32 v[16:17], v[16:17], v[72:73]
    v_pk_mul_f32 v[18:19], v[18:19], v[74:75]
    v_pk_mul_f32 v[20:21], v[20:21], v[76:77]
    v_pk_mul_f32 v[22:23], v[22:23], v[78:79]
    v_exp_f32 v16, v16
    v_exp_f32 v17, v17
    v_exp_f32 v18, v18
    v_exp_f32 v19, v19
    v_exp_f32 v20, v20
    v_exp_f32 v21, v21
    v_exp_f32 v22, v22
    v_exp_f32 v23, v23
    v_pk_add_f32 v[16:17], v[16:17], s[76:77]
    v_pk_add_f32 v[18:19], v[18:19], s[76:77]
    v_pk_add_f32 v[20:21], v[20:21], s[76:77]
    v_pk_add_f32 v[22:23], v[22:23], s[76:77]
    v_rcp_f32 v16, v16
    v_rcp_f32 v17, v17
    v_rcp_f32 v18, v18
    v_rcp_f32 v19, v19
    v_rcp_f32 v20, v20
    v_rcp_f32 v21, v21
    v_rcp_f32 v22, v22
    v_rcp_f32 v23, v23
    v_pk_mul_f32 v[72:73], v[72:73], v[16:17]
    v_pk_mul_f32 v[74:75], v[74:75], v[18:19]
    v_pk_mul_f32 v[76:77], v[76:77], v[20:21]
    v_pk_mul_f32 v[78:79], v[78:79], v[22:23]
    v_pk_mul_f32 v[26:27], v[72:73], v[72:73]
    v_pk_mov_b32 v[24:25], v[72:73], v[72:73] op_sel:[0,1]
    v_pk_mul_f32 v[30:31], v[74:75], v[74:75]
    v_pk_mov_b32 v[28:29], v[74:75], v[74:75] op_sel:[0,1]
    v_pk_mul_f32 v[34:35], v[76:77], v[76:77]
    v_pk_mov_b32 v[32:33], v[76:77], v[76:77] op_sel:[0,1]
    v_pk_mul_f32 v[38:39], v[78:79], v[78:79]
    v_pk_mov_b32 v[36:37], v[78:79], v[78:79] op_sel:[0,1]
    v_cvt_pk_bf16_f32 v72, v72, v73
    v_cvt_pk_bf16_f32 v73, v74, v75
    v_cvt_pk_bf16_f32 v74, v76, v77
    v_cvt_pk_bf16_f32 v75, v78, v79
    ds_write_b128 v13, v[72:75] offset:4096
    v_pk_mul_f32 v[16:17], v[80:81], v[80:81]
    v_pk_mul_f32 v[18:19], v[82:83], v[82:83]
    v_pk_mul_f32 v[20:21], v[84:85], v[84:85]
    v_pk_mul_f32 v[22:23], v[86:87], v[86:87]
    v_pk_fma_f32 v[16:17], v[16:17], s[74:75], v[0:1]
    v_pk_fma_f32 v[18:19], v[18:19], s[74:75], v[0:1]
    v_pk_fma_f32 v[20:21], v[20:21], s[74:75], v[0:1]
    v_pk_fma_f32 v[22:23], v[22:23], s[74:75], v[0:1]
    v_pk_mul_f32 v[16:17], v[16:17], v[80:81]
    v_pk_mul_f32 v[18:19], v[18:19], v[82:83]
    v_pk_mul_f32 v[20:21], v[20:21], v[84:85]
    v_pk_mul_f32 v[22:23], v[22:23], v[86:87]
    v_exp_f32 v16, v16
    v_exp_f32 v17, v17
    v_exp_f32 v18, v18
    v_exp_f32 v19, v19
    v_exp_f32 v20, v20
    v_exp_f32 v21, v21
    v_exp_f32 v22, v22
    v_exp_f32 v23, v23
    v_pk_add_f32 v[16:17], v[16:17], s[76:77]
    v_pk_add_f32 v[18:19], v[18:19], s[76:77]
    v_pk_add_f32 v[20:21], v[20:21], s[76:77]
    v_pk_add_f32 v[22:23], v[22:23], s[76:77]
    v_rcp_f32 v16, v16
    v_rcp_f32 v17, v17
    v_rcp_f32 v18, v18
    v_rcp_f32 v19, v19
    v_rcp_f32 v20, v20
    v_rcp_f32 v21, v21
    v_rcp_f32 v22, v22
    v_rcp_f32 v23, v23
    v_pk_mul_f32 v[80:81], v[80:81], v[16:17]
    v_pk_mul_f32 v[82:83], v[82:83], v[18:19]
    v_pk_mul_f32 v[84:85], v[84:85], v[20:21]
    v_pk_mul_f32 v[86:87], v[86:87], v[22:23]
    v_pk_fma_f32 v[26:27], v[80:81], v[80:81], v[26:27]
    v_pk_add_f32 v[24:25], v[24:25], v[80:81]
    v_pk_fma_f32 v[30:31], v[82:83], v[82:83], v[30:31]
    v_pk_add_f32 v[28:29], v[28:29], v[82:83]
    v_pk_fma_f32 v[34:35], v[84:85], v[84:85], v[34:35]
    v_pk_add_f32 v[32:33], v[32:33], v[84:85]
    v_pk_fma_f32 v[38:39], v[86:87], v[86:87], v[38:39]
    v_pk_add_f32 v[36:37], v[36:37], v[86:87]
    v_cvt_pk_bf16_f32 v80, v80, v81
    v_cvt_pk_bf16_f32 v81, v82, v83
    v_cvt_pk_bf16_f32 v82, v84, v85
    v_cvt_pk_bf16_f32 v83, v86, v87
    ds_write_b128 v13, v[80:83] offset:5120
    v_pk_mul_f32 v[16:17], v[88:89], v[88:89]
    v_pk_mul_f32 v[18:19], v[90:91], v[90:91]
    v_pk_mul_f32 v[20:21], v[92:93], v[92:93]
    v_pk_mul_f32 v[22:23], v[94:95], v[94:95]
    v_pk_fma_f32 v[16:17], v[16:17], s[74:75], v[0:1]
    v_pk_fma_f32 v[18:19], v[18:19], s[74:75], v[0:1]
    v_pk_fma_f32 v[20:21], v[20:21], s[74:75], v[0:1]
    v_pk_fma_f32 v[22:23], v[22:23], s[74:75], v[0:1]
    v_pk_mul_f32 v[16:17], v[16:17], v[88:89]
    v_pk_mul_f32 v[18:19], v[18:19], v[90:91]
    v_pk_mul_f32 v[20:21], v[20:21], v[92:93]
    v_pk_mul_f32 v[22:23], v[22:23], v[94:95]
    v_exp_f32 v16, v16
    v_exp_f32 v17, v17
    v_exp_f32 v18, v18
    v_exp_f32 v19, v19
    v_exp_f32 v20, v20
    v_exp_f32 v21, v21
    v_exp_f32 v22, v22
    v_exp_f32 v23, v23
    v_pk_add_f32 v[16:17], v[16:17], s[76:77]
    v_pk_add_f32 v[18:19], v[18:19], s[76:77]
    v_pk_add_f32 v[20:21], v[20:21], s[76:77]
    v_pk_add_f32 v[22:23], v[22:23], s[76:77]
    v_rcp_f32 v16, v16
    v_rcp_f32 v17, v17
    v_rcp_f32 v18, v18
    v_rcp_f32 v19, v19
    v_rcp_f32 v20, v20
    v_rcp_f32 v21, v21
    v_rcp_f32 v22, v22
    v_rcp_f32 v23, v23
    v_pk_mul_f32 v[88:89], v[88:89], v[16:17]
    v_pk_mul_f32 v[90:91], v[90:91], v[18:19]
    v_pk_mul_f32 v[92:93], v[92:93], v[20:21]
    v_pk_mul_f32 v[94:95], v[94:95], v[22:23]
    v_pk_fma_f32 v[26:27], v[88:89], v[88:89], v[26:27]
    v_pk_add_f32 v[24:25], v[24:25], v[88:89]
    v_pk_fma_f32 v[30:31], v[90:91], v[90:91], v[30:31]
    v_pk_add_f32 v[28:29], v[28:29], v[90:91]
    v_pk_fma_f32 v[34:35], v[92:93], v[92:93], v[34:35]
    v_pk_add_f32 v[32:33], v[32:33], v[92:93]
    v_pk_fma_f32 v[38:39], v[94:95], v[94:95], v[38:39]
    v_pk_add_f32 v[36:37], v[36:37], v[94:95]
    v_cvt_pk_bf16_f32 v88, v88, v89
    v_cvt_pk_bf16_f32 v89, v90, v91
    v_cvt_pk_bf16_f32 v90, v92, v93
    v_cvt_pk_bf16_f32 v91, v94, v95
    ds_write_b128 v13, v[88:91] offset:6144
    v_pk_mul_f32 v[16:17], v[96:97], v[96:97]
    v_pk_mul_f32 v[18:19], v[98:99], v[98:99]
    v_pk_mul_f32 v[20:21], v[100:101], v[100:101]
    v_pk_mul_f32 v[22:23], v[102:103], v[102:103]
    v_pk_fma_f32 v[16:17], v[16:17], s[74:75], v[0:1]
    v_pk_fma_f32 v[18:19], v[18:19], s[74:75], v[0:1]
    v_pk_fma_f32 v[20:21], v[20:21], s[74:75], v[0:1]
    v_pk_fma_f32 v[22:23], v[22:23], s[74:75], v[0:1]
    v_pk_mul_f32 v[16:17], v[16:17], v[96:97]
    v_pk_mul_f32 v[18:19], v[18:19], v[98:99]
    v_pk_mul_f32 v[20:21], v[20:21], v[100:101]
    v_pk_mul_f32 v[22:23], v[22:23], v[102:103]
    v_exp_f32 v16, v16
    v_exp_f32 v17, v17
    v_exp_f32 v18, v18
    v_exp_f32 v19, v19
    v_exp_f32 v20, v20
    v_exp_f32 v21, v21
    v_exp_f32 v22, v22
    v_exp_f32 v23, v23
    v_pk_add_f32 v[16:17], v[16:17], s[76:77]
    v_pk_add_f32 v[18:19], v[18:19], s[76:77]
    v_pk_add_f32 v[20:21], v[20:21], s[76:77]
    v_pk_add_f32 v[22:23], v[22:23], s[76:77]
    v_rcp_f32 v16, v16
    v_rcp_f32 v17, v17
    v_rcp_f32 v18, v18
    v_rcp_f32 v19, v19
    v_rcp_f32 v20, v20
    v_rcp_f32 v21, v21
    v_rcp_f32 v22, v22
    v_rcp_f32 v23, v23
    v_pk_mul_f32 v[96:97], v[96:97], v[16:17]
    v_pk_mul_f32 v[98:99], v[98:99], v[18:19]
    v_pk_mul_f32 v[100:101], v[100:101], v[20:21]
    v_pk_mul_f32 v[102:103], v[102:103], v[22:23]
    v_pk_fma_f32 v[26:27], v[96:97], v[96:97], v[26:27]
    v_pk_add_f32 v[24:25], v[24:25], v[96:97]
    v_pk_fma_f32 v[30:31], v[98:99], v[98:99], v[30:31]
    v_pk_add_f32 v[28:29], v[28:29], v[98:99]
    v_pk_fma_f32 v[34:35], v[100:101], v[100:101], v[34:35]
    v_pk_add_f32 v[32:33], v[32:33], v[100:101]
    v_pk_fma_f32 v[38:39], v[102:103], v[102:103], v[38:39]
    v_pk_add_f32 v[36:37], v[36:37], v[102:103]
    v_cvt_pk_bf16_f32 v96, v96, v97
    v_cvt_pk_bf16_f32 v97, v98, v99
    v_cvt_pk_bf16_f32 v98, v100, v101
    v_cvt_pk_bf16_f32 v99, v102, v103
    ds_write_b128 v13, v[96:99] offset:7168
    v_pk_mul_f32 v[16:17], v[104:105], v[104:105]
    v_pk_mul_f32 v[18:19], v[106:107], v[106:107]
    v_pk_mul_f32 v[20:21], v[108:109], v[108:109]
    v_pk_mul_f32 v[22:23], v[110:111], v[110:111]
    v_pk_fma_f32 v[16:17], v[16:17], s[74:75], v[0:1]
    v_pk_fma_f32 v[18:19], v[18:19], s[74:75], v[0:1]
    v_pk_fma_f32 v[20:21], v[20:21], s[74:75], v[0:1]
    v_pk_fma_f32 v[22:23], v[22:23], s[74:75], v[0:1]
    v_pk_mul_f32 v[16:17], v[16:17], v[104:105]
    v_pk_mul_f32 v[18:19], v[18:19], v[106:107]
    v_pk_mul_f32 v[20:21], v[20:21], v[108:109]
    v_pk_mul_f32 v[22:23], v[22:23], v[110:111]
    v_exp_f32 v16, v16
    v_exp_f32 v17, v17
    v_exp_f32 v18, v18
    v_exp_f32 v19, v19
    v_exp_f32 v20, v20
    v_exp_f32 v21, v21
    v_exp_f32 v22, v22
    v_exp_f32 v23, v23
    v_pk_add_f32 v[16:17], v[16:17], s[76:77]
    v_pk_add_f32 v[18:19], v[18:19], s[76:77]
    v_pk_add_f32 v[20:21], v[20:21], s[76:77]
    v_pk_add_f32 v[22:23], v[22:23], s[76:77]
    v_rcp_f32 v16, v16
    v_rcp_f32 v17, v17
    v_rcp_f32 v18, v18
    v_rcp_f32 v19, v19
    v_rcp_f32 v20, v20
    v_rcp_f32 v21, v21
    v_rcp_f32 v22, v22
    v_rcp_f32 v23, v23
    v_pk_mul_f32 v[104:105], v[104:105], v[16:17]
    v_pk_mul_f32 v[106:107], v[106:107], v[18:19]
    v_pk_mul_f32 v[108:109], v[108:109], v[20:21]
    v_pk_mul_f32 v[110:111], v[110:111], v[22:23]
    v_pk_fma_f32 v[26:27], v[104:105], v[104:105], v[26:27]
    v_pk_add_f32 v[24:25], v[24:25], v[104:105]
    v_pk_fma_f32 v[30:31], v[106:107], v[106:107], v[30:31]
    v_pk_add_f32 v[28:29], v[28:29], v[106:107]
    v_pk_fma_f32 v[34:35], v[108:109], v[108:109], v[34:35]
    v_pk_add_f32 v[32:33], v[32:33], v[108:109]
    v_pk_fma_f32 v[38:39], v[110:111], v[110:111], v[38:39]
    v_pk_add_f32 v[36:37], v[36:37], v[110:111]
    v_cvt_pk_bf16_f32 v104, v104, v105
    v_cvt_pk_bf16_f32 v105, v106, v107
    v_cvt_pk_bf16_f32 v106, v108, v109
    v_cvt_pk_bf16_f32 v107, v110, v111
    ds_write_b128 v13, v[104:107] offset:8192
    v_pk_mul_f32 v[16:17], v[40:41], v[40:41]
    v_pk_mul_f32 v[18:19], v[42:43], v[42:43]
    v_pk_mul_f32 v[20:21], v[44:45], v[44:45]
    v_pk_mul_f32 v[22:23], v[46:47], v[46:47]
    v_pk_fma_f32 v[16:17], v[16:17], s[74:75], v[0:1]
    v_pk_fma_f32 v[18:19], v[18:19], s[74:75], v[0:1]
    v_pk_fma_f32 v[20:21], v[20:21], s[74:75], v[0:1]
    v_pk_fma_f32 v[22:23], v[22:23], s[74:75], v[0:1]
    v_pk_mul_f32 v[16:17], v[16:17], v[40:41]
    v_pk_mul_f32 v[18:19], v[18:19], v[42:43]
    v_pk_mul_f32 v[20:21], v[20:21], v[44:45]
    v_pk_mul_f32 v[22:23], v[22:23], v[46:47]
    v_exp_f32 v16, v16
    v_exp_f32 v17, v17
    v_exp_f32 v18, v18
    v_exp_f32 v19, v19
    v_exp_f32 v20, v20
    v_exp_f32 v21, v21
    v_exp_f32 v22, v22
    v_exp_f32 v23, v23
    v_pk_add_f32 v[16:17], v[16:17], s[76:77]
    v_pk_add_f32 v[18:19], v[18:19], s[76:77]
    v_pk_add_f32 v[20:21], v[20:21], s[76:77]
    v_pk_add_f32 v[22:23], v[22:23], s[76:77]
    v_rcp_f32 v16, v16
    v_rcp_f32 v17, v17
    v_rcp_f32 v18, v18
    v_rcp_f32 v19, v19
    v_rcp_f32 v20, v20
    v_rcp_f32 v21, v21
    v_rcp_f32 v22, v22
    v_rcp_f32 v23, v23
    v_pk_mul_f32 v[40:41], v[40:41], v[16:17]
    v_pk_mul_f32 v[42:43], v[42:43], v[18:19]
    v_pk_mul_f32 v[44:45], v[44:45], v[20:21]
    v_pk_mul_f32 v[46:47], v[46:47], v[22:23]
    v_pk_fma_f32 v[26:27], v[40:41], v[40:41], v[26:27]
    v_pk_add_f32 v[24:25], v[24:25], v[40:41]
    v_pk_fma_f32 v[30:31], v[42:43], v[42:43], v[30:31]
    v_pk_add_f32 v[28:29], v[28:29], v[42:43]
    v_pk_fma_f32 v[34:35], v[44:45], v[44:45], v[34:35]
    v_pk_add_f32 v[32:33], v[32:33], v[44:45]
    v_pk_fma_f32 v[38:39], v[46:47], v[46:47], v[38:39]
    v_pk_add_f32 v[36:37], v[36:37], v[46:47]
    v_cvt_pk_bf16_f32 v40, v40, v41
    v_cvt_pk_bf16_f32 v41, v42, v43
    v_cvt_pk_bf16_f32 v42, v44, v45
    v_cvt_pk_bf16_f32 v43, v46, v47
    ds_write_b128 v13, v[40:43] offset:0
    v_pk_mul_f32 v[16:17], v[48:49], v[48:49]
    v_pk_mul_f32 v[18:19], v[50:51], v[50:51]
    v_pk_mul_f32 v[20:21], v[52:53], v[52:53]
    v_pk_mul_f32 v[22:23], v[54:55], v[54:55]
    v_pk_fma_f32 v[16:17], v[16:17], s[74:75], v[0:1]
    v_pk_fma_f32 v[18:19], v[18:19], s[74:75], v[0:1]
    v_pk_fma_f32 v[20:21], v[20:21], s[74:75], v[0:1]
    v_pk_fma_f32 v[22:23], v[22:23], s[74:75], v[0:1]
    v_pk_mul_f32 v[16:17], v[16:17], v[48:49]
    v_pk_mul_f32 v[18:19], v[18:19], v[50:51]
    v_pk_mul_f32 v[20:21], v[20:21], v[52:53]
    v_pk_mul_f32 v[22:23], v[22:23], v[54:55]
    v_exp_f32 v16, v16
    v_exp_f32 v17, v17
    v_exp_f32 v18, v18
    v_exp_f32 v19, v19
    v_exp_f32 v20, v20
    v_exp_f32 v21, v21
    v_exp_f32 v22, v22
    v_exp_f32 v23, v23
    v_pk_add_f32 v[16:17], v[16:17], s[76:77]
    v_pk_add_f32 v[18:19], v[18:19], s[76:77]
    v_pk_add_f32 v[20:21], v[20:21], s[76:77]
    v_pk_add_f32 v[22:23], v[22:23], s[76:77]
    v_rcp_f32 v16, v16
    v_rcp_f32 v17, v17
    v_rcp_f32 v18, v18
    v_rcp_f32 v19, v19
    v_rcp_f32 v20, v20
    v_rcp_f32 v21, v21
    v_rcp_f32 v22, v22
    v_rcp_f32 v23, v23
    v_pk_mul_f32 v[48:49], v[48:49], v[16:17]
    v_pk_mul_f32 v[50:51], v[50:51], v[18:19]
    v_pk_mul_f32 v[52:53], v[52:53], v[20:21]
    v_pk_mul_f32 v[54:55], v[54:55], v[22:23]
    v_pk_fma_f32 v[26:27], v[48:49], v[48:49], v[26:27]
    v_pk_add_f32 v[24:25], v[24:25], v[48:49]
    v_pk_fma_f32 v[30:31], v[50:51], v[50:51], v[30:31]
    v_pk_add_f32 v[28:29], v[28:29], v[50:51]
    v_pk_fma_f32 v[34:35], v[52:53], v[52:53], v[34:35]
    v_pk_add_f32 v[32:33], v[32:33], v[52:53]
    v_pk_fma_f32 v[38:39], v[54:55], v[54:55], v[38:39]
    v_pk_add_f32 v[36:37], v[36:37], v[54:55]
    v_cvt_pk_bf16_f32 v48, v48, v49
    v_cvt_pk_bf16_f32 v49, v50, v51
    v_cvt_pk_bf16_f32 v50, v52, v53
    v_cvt_pk_bf16_f32 v51, v54, v55
    ds_write_b128 v13, v[48:51] offset:1024
    v_pk_mul_f32 v[16:17], v[56:57], v[56:57]
    v_pk_mul_f32 v[18:19], v[58:59], v[58:59]
    v_pk_mul_f32 v[20:21], v[60:61], v[60:61]
    v_pk_mul_f32 v[22:23], v[62:63], v[62:63]
    v_pk_fma_f32 v[16:17], v[16:17], s[74:75], v[0:1]
    v_pk_fma_f32 v[18:19], v[18:19], s[74:75], v[0:1]
    v_pk_fma_f32 v[20:21], v[20:21], s[74:75], v[0:1]
    v_pk_fma_f32 v[22:23], v[22:23], s[74:75], v[0:1]
    v_pk_mul_f32 v[16:17], v[16:17], v[56:57]
    v_pk_mul_f32 v[18:19], v[18:19], v[58:59]
    v_pk_mul_f32 v[20:21], v[20:21], v[60:61]
    v_pk_mul_f32 v[22:23], v[22:23], v[62:63]
    v_exp_f32 v16, v16
    v_exp_f32 v17, v17
    v_exp_f32 v18, v18
    v_exp_f32 v19, v19
    v_exp_f32 v20, v20
    v_exp_f32 v21, v21
    v_exp_f32 v22, v22
    v_exp_f32 v23, v23
    v_pk_add_f32 v[16:17], v[16:17], s[76:77]
    v_pk_add_f32 v[18:19], v[18:19], s[76:77]
    v_pk_add_f32 v[20:21], v[20:21], s[76:77]
    v_pk_add_f32 v[22:23], v[22:23], s[76:77]
    v_rcp_f32 v16, v16
    v_rcp_f32 v17, v17
    v_rcp_f32 v18, v18
    v_rcp_f32 v19, v19
    v_rcp_f32 v20, v20
    v_rcp_f32 v21, v21
    v_rcp_f32 v22, v22
    v_rcp_f32 v23, v23
    v_pk_mul_f32 v[56:57], v[56:57], v[16:17]
    v_pk_mul_f32 v[58:59], v[58:59], v[18:19]
    v_pk_mul_f32 v[60:61], v[60:61], v[20:21]
    v_pk_mul_f32 v[62:63], v[62:63], v[22:23]
    v_pk_fma_f32 v[26:27], v[56:57], v[56:57], v[26:27]
    v_pk_add_f32 v[24:25], v[24:25], v[56:57]
    v_pk_fma_f32 v[30:31], v[58:59], v[58:59], v[30:31]
    v_pk_add_f32 v[28:29], v[28:29], v[58:59]
    v_pk_fma_f32 v[34:35], v[60:61], v[60:61], v[34:35]
    v_pk_add_f32 v[32:33], v[32:33], v[60:61]
    v_pk_fma_f32 v[38:39], v[62:63], v[62:63], v[38:39]
    v_pk_add_f32 v[36:37], v[36:37], v[62:63]
    v_cvt_pk_bf16_f32 v56, v56, v57
    v_cvt_pk_bf16_f32 v57, v58, v59
    v_cvt_pk_bf16_f32 v58, v60, v61
    v_cvt_pk_bf16_f32 v59, v62, v63
    ds_write_b128 v13, v[56:59] offset:2048
    v_pk_mul_f32 v[16:17], v[64:65], v[64:65]
    v_pk_mul_f32 v[18:19], v[66:67], v[66:67]
    v_pk_mul_f32 v[20:21], v[68:69], v[68:69]
    v_pk_mul_f32 v[22:23], v[70:71], v[70:71]
    v_pk_fma_f32 v[16:17], v[16:17], s[74:75], v[0:1]
    v_pk_fma_f32 v[18:19], v[18:19], s[74:75], v[0:1]
    v_pk_fma_f32 v[20:21], v[20:21], s[74:75], v[0:1]
    v_pk_fma_f32 v[22:23], v[22:23], s[74:75], v[0:1]
    v_pk_mul_f32 v[16:17], v[16:17], v[64:65]
    v_pk_mul_f32 v[18:19], v[18:19], v[66:67]
    v_pk_mul_f32 v[20:21], v[20:21], v[68:69]
    v_pk_mul_f32 v[22:23], v[22:23], v[70:71]
    v_exp_f32 v16, v16
    v_exp_f32 v17, v17
    v_exp_f32 v18, v18
    v_exp_f32 v19, v19
    v_exp_f32 v20, v20
    v_exp_f32 v21, v21
    v_exp_f32 v22, v22
    v_exp_f32 v23, v23
    v_pk_add_f32 v[16:17], v[16:17], s[76:77]
    v_pk_add_f32 v[18:19], v[18:19], s[76:77]
    v_pk_add_f32 v[20:21], v[20:21], s[76:77]
    v_pk_add_f32 v[22:23], v[22:23], s[76:77]
    v_rcp_f32 v16, v16
    v_rcp_f32 v17, v17
    v_rcp_f32 v18, v18
    v_rcp_f32 v19, v19
    v_rcp_f32 v20, v20
    v_rcp_f32 v21, v21
    v_rcp_f32 v22, v22
    v_rcp_f32 v23, v23
    v_pk_mul_f32 v[64:65], v[64:65], v[16:17]
    v_pk_mul_f32 v[66:67], v[66:67], v[18:19]
    v_pk_mul_f32 v[68:69], v[68:69], v[20:21]
    v_pk_mul_f32 v[70:71], v[70:71], v[22:23]
    v_pk_fma_f32 v[26:27], v[64:65], v[64:65], v[26:27]
    v_pk_add_f32 v[24:25], v[24:25], v[64:65]
    v_pk_fma_f32 v[30:31], v[66:67], v[66:67], v[30:31]
    v_pk_add_f32 v[28:29], v[28:29], v[66:67]
    v_pk_fma_f32 v[34:35], v[68:69], v[68:69], v[34:35]
    v_pk_add_f32 v[32:33], v[32:33], v[68:69]
    v_pk_fma_f32 v[38:39], v[70:71], v[70:71], v[38:39]
    v_pk_add_f32 v[36:37], v[36:37], v[70:71]
    v_cvt_pk_bf16_f32 v64, v64, v65
    v_cvt_pk_bf16_f32 v65, v66, v67
    v_cvt_pk_bf16_f32 v66, v68, v69
    v_cvt_pk_bf16_f32 v67, v70, v71
    ds_write_b128 v13, v[64:67] offset:3072
    v_add_f32_dpp v24, v24, v24 row_ror:8 row_mask:0xf bank_mask:0xf
    v_add_f32_dpp v25, v25, v25 row_ror:8 row_mask:0xf bank_mask:0xf
    v_add_f32_dpp v26, v26, v26 row_ror:8 row_mask:0xf bank_mask:0xf
    v_add_f32_dpp v27, v27, v27 row_ror:8 row_mask:0xf bank_mask:0xf
    v_add_f32_dpp v28, v28, v28 row_ror:8 row_mask:0xf bank_mask:0xf
    v_add_f32_dpp v29, v29, v29 row_ror:8 row_mask:0xf bank_mask:0xf
    v_add_f32_dpp v30, v30, v30 row_ror:8 row_mask:0xf bank_mask:0xf
    v_add_f32_dpp v31, v31, v31 row_ror:8 row_mask:0xf bank_mask:0xf
    v_add_f32_dpp v32, v32, v32 row_ror:8 row_mask:0xf bank_mask:0xf
    v_add_f32_dpp v33, v33, v33 row_ror:8 row_mask:0xf bank_mask:0xf
    v_add_f32_dpp v34, v34, v34 row_ror:8 row_mask:0xf bank_mask:0xf
    v_add_f32_dpp v35, v35, v35 row_ror:8 row_mask:0xf bank_mask:0xf
    v_add_f32_dpp v36, v36, v36 row_ror:8 row_mask:0xf bank_mask:0xf
    v_add_f32_dpp v37, v37, v37 row_ror:8 row_mask:0xf bank_mask:0xf
    v_add_f32_dpp v38, v38, v38 row_ror:8 row_mask:0xf bank_mask:0xf
    v_add_f32_dpp v39, v39, v39 row_ror:8 row_mask:0xf bank_mask:0xf
    v_add_f32_dpp v24, v24, v24 row_ror:4 row_mask:0xf bank_mask:0xf
    v_add_f32_dpp v25, v25, v25 row_ror:4 row_mask:0xf bank_mask:0xf
    v_add_f32_dpp v26, v26, v26 row_ror:4 row_mask:0xf bank_mask:0xf
    v_add_f32_dpp v27, v27, v27 row_ror:4 row_mask:0xf bank_mask:0xf
    v_add_f32_dpp v28, v28, v28 row_ror:4 row_mask:0xf bank_mask:0xf
    v_add_f32_dpp v29, v29, v29 row_ror:4 row_mask:0xf bank_mask:0xf
    v_add_f32_dpp v30, v30, v30 row_ror:4 row_mask:0xf bank_mask:0xf
    v_add_f32_dpp v31, v31, v31 row_ror:4 row_mask:0xf bank_mask:0xf
    v_add_f32_dpp v32, v32, v32 row_ror:4 row_mask:0xf bank_mask:0xf
    v_add_f32_dpp v33, v33, v33 row_ror:4 row_mask:0xf bank_mask:0xf
    v_add_f32_dpp v34, v34, v34 row_ror:4 row_mask:0xf bank_mask:0xf
    v_add_f32_dpp v35, v35, v35 row_ror:4 row_mask:0xf bank_mask:0xf
    v_add_f32_dpp v36, v36, v36 row_ror:4 row_mask:0xf bank_mask:0xf
    v_add_f32_dpp v37, v37, v37 row_ror:4 row_mask:0xf bank_mask:0xf
    v_add_f32_dpp v38, v38, v38 row_ror:4 row_mask:0xf bank_mask:0xf
    v_add_f32_dpp v39, v39, v39 row_ror:4 row_mask:0xf bank_mask:0xf
    v_add_f32_dpp v24, v24, v24 row_ror:2 row_mask:0xf bank_mask:0xf
    v_add_f32_dpp v25, v25, v25 row_ror:2 row_mask:0xf bank_mask:0xf
    v_add_f32_dpp v26, v26, v26 row_ror:2 row_mask:0xf bank_mask:0xf
    v_add_f32_dpp v27, v27, v27 row_ror:2 row_mask:0xf bank_mask:0xf
    v_add_f32_dpp v28, v28, v28 row_ror:2 row_mask:0xf bank_mask:0xf
    v_add_f32_dpp v29, v29, v29 row_ror:2 row_mask:0xf bank_mask:0xf
    v_add_f32_dpp v30, v30, v30 row_ror:2 row_mask:0xf bank_mask:0xf
    v_add_f32_dpp v31, v31, v31 row_ror:2 row_mask:0xf bank_mask:0xf
    v_add_f32_dpp v32, v32, v32 row_ror:2 row_mask:0xf bank_mask:0xf
    v_add_f32_dpp v33, v33, v33 row_ror:2 row_mask:0xf bank_mask:0xf
    v_add_f32_dpp v34, v34, v34 row_ror:2 row_mask:0xf bank_mask:0xf
    v_add_f32_dpp v35, v35, v35 row_ror:2 row_mask:0xf bank_mask:0xf
    v_add_f32_dpp v36, v36, v36 row_ror:2 row_mask:0xf bank_mask:0xf
    v_add_f32_dpp v37, v37, v37 row_ror:2 row_mask:0xf bank_mask:0xf
    v_add_f32_dpp v38, v38, v38 row_ror:2 row_mask:0xf bank_mask:0xf
    v_add_f32_dpp v39, v39, v39 row_ror:2 row_mask:0xf bank_mask:0xf
    v_add_f32_dpp v24, v24, v24 row_ror:1 row_mask:0xf bank_mask:0xf
    v_add_f32_dpp v25, v25, v25 row_ror:1 row_mask:0xf bank_mask:0xf
    v_add_f32_dpp v26, v26, v26 row_ror:1 row_mask:0xf bank_mask:0xf
    v_add_f32_dpp v27, v27, v27 row_ror:1 row_mask:0xf bank_mask:0xf
    v_add_f32_dpp v28, v28, v28 row_ror:1 row_mask:0xf bank_mask:0xf
    v_add_f32_dpp v29, v29, v29 row_ror:1 row_mask:0xf bank_mask:0xf
    v_add_f32_dpp v30, v30, v30 row_ror:1 row_mask:0xf bank_mask:0xf
    v_add_f32_dpp v31, v31, v31 row_ror:1 row_mask:0xf bank_mask:0xf
    v_add_f32_dpp v32, v32, v32 row_ror:1 row_mask:0xf bank_mask:0xf
    v_add_f32_dpp v33, v33, v33 row_ror:1 row_mask:0xf bank_mask:0xf
    v_add_f32_dpp v34, v34, v34 row_ror:1 row_mask:0xf bank_mask:0xf
    v_add_f32_dpp v35, v35, v35 row_ror:1 row_mask:0xf bank_mask:0xf
    v_add_f32_dpp v36, v36, v36 row_ror:1 row_mask:0xf bank_mask:0xf
    v_add_f32_dpp v37, v37, v37 row_ror:1 row_mask:0xf bank_mask:0xf
    v_add_f32_dpp v38, v38, v38 row_ror:1 row_mask:0xf bank_mask:0xf
    v_add_f32_dpp v39, v39, v39 row_ror:1 row_mask:0xf bank_mask:0xf
    s_mov_b32 exec_lo, 0x00010001
    s_mov_b32 exec_hi, 0x00010001
    buffer_store_dwordx4 v[24:27], v6, s[36:39], s64 offen offset:0 sc1
    buffer_store_dwordx4 v[28:31], v6, s[36:39], s64 offen offset:16 sc1
    buffer_store_dwordx4 v[32:35], v6, s[36:39], s64 offen offset:32 sc1
    buffer_store_dwordx4 v[36:39], v6, s[36:39], s64 offen offset:48 sc1
    s_mov_b64 exec, -1
    s_waitcnt lgkmcnt(0)
    s_barrier
    ds_read_b64_tr_b16 v[16:17], v7 offset:18432
    ds_read_b64_tr_b16 v[18:19], v7 offset:20480
    ds_read_b64_tr_b16 v[20:21], v8 offset:18432
    ds_read_b64_tr_b16 v[22:23], v8 offset:20480
    ds_read_b64_tr_b16 v[24:25], v9 offset:18432
    ds_read_b64_tr_b16 v[26:27], v9 offset:20480
    ds_read_b64_tr_b16 v[28:29], v10 offset:18432
    ds_read_b64_tr_b16 v[30:31], v10 offset:20480
    ds_read_b64_tr_b16 v[32:33], v7 offset:22528
    ds_read_b64_tr_b16 v[34:35], v7 offset:24576
    s_waitcnt lgkmcnt(6)
    v_mfma_f32_16x16x32_bf16 v[72:75], v[16:19], v[112:115], 0
    ds_read_b64_tr_b16 v[36:37], v8 offset:22528
    v_mfma_f32_16x16x32_bf16 v[76:79], v[16:19], v[116:119], 0
    ds_read_b64_tr_b16 v[38:39], v8 offset:24576
    v_mfma_f32_16x16x32_bf16 v[80:83], v[20:23], v[112:115], 0
    ds_read_b64_tr_b16 v[16:17], v9 offset:22528
    v_mfma_f32_16x16x32_bf16 v[84:87], v[20:23], v[116:119], 0
    ds_read_b64_tr_b16 v[18:19], v9 offset:24576
    s_waitcnt lgkmcnt(6)
    v_mfma_f32_16x16x32_bf16 v[88:91], v[24:27], v[112:115], 0
    ds_read_b64_tr_b16 v[20:21], v10 offset:22528
    v_mfma_f32_16x16x32_bf16 v[92:95], v[24:27], v[116:119], 0
    ds_read_b64_tr_b16 v[22:23], v10 offset:24576
    v_mfma_f32_16x16x32_bf16 v[96:99], v[28:31], v[112:115], 0
    ds_read_b64_tr_b16 v[24:25], v7 offset:26624
    v_mfma_f32_16x16x32_bf16 v[100:103], v[28:31], v[116:119], 0
    ds_read_b64_tr_b16 v[26:27], v7 offset:28672
    s_waitcnt lgkmcnt(6)
    v_mfma_f32_16x16x32_bf16 v[72:75], v[32:35], v[120:123], v[72:75]
    ds_read_b64_tr_b16 v[28:29], v8 offset:26624
    v_mfma_f32_16x16x32_bf16 v[76:79], v[32:35], v[124:127], v[76:79]
    ds_read_b64_tr_b16 v[30:31], v8 offset:28672
    v_mfma_f32_16x16x32_bf16 v[80:83], v[36:39], v[120:123], v[80:83]
    ds_read_b64_tr_b16 v[32:33], v9 offset:26624
    v_mfma_f32_16x16x32_bf16 v[84:87], v[36:39], v[124:127], v[84:87]
    ds_read_b64_tr_b16 v[34:35], v9 offset:28672
    s_waitcnt lgkmcnt(6)
    v_mfma_f32_16x16x32_bf16 v[88:91], v[16:19], v[120:123], v[88:91]
    ds_read_b64_tr_b16 v[36:37], v10 offset:26624
    v_mfma_f32_16x16x32_bf16 v[92:95], v[16:19], v[124:127], v[92:95]
    ds_read_b64_tr_b16 v[38:39], v10 offset:28672
    v_mfma_f32_16x16x32_bf16 v[96:99], v[20:23], v[120:123], v[96:99]
    s_barrier
    ds_read_b64_tr_b16 v[16:17], v7 offset:36864
    v_mfma_f32_16x16x32_bf16 v[100:103], v[20:23], v[124:127], v[100:103]
    ds_read_b64_tr_b16 v[18:19], v7 offset:38912
    s_waitcnt lgkmcnt(6)
    v_mfma_f32_16x16x32_bf16 v[72:75], v[24:27], v[128:131], v[72:75]
    ds_read_b64_tr_b16 v[20:21], v8 offset:36864
    v_mfma_f32_16x16x32_bf16 v[76:79], v[24:27], v[132:135], v[76:79]
    ds_read_b64_tr_b16 v[22:23], v8 offset:38912
    v_mfma_f32_16x16x32_bf16 v[80:83], v[28:31], v[128:131], v[80:83]
    ds_read_b64_tr_b16 v[24:25], v9 offset:36864
    v_mfma_f32_16x16x32_bf16 v[84:87], v[28:31], v[132:135], v[84:87]
    ds_read_b64_tr_b16 v[26:27], v9 offset:38912
    s_waitcnt lgkmcnt(6)
    v_mfma_f32_16x16x32_bf16 v[88:91], v[32:35], v[128:131], v[88:91]
    ds_read_b64_tr_b16 v[28:29], v10 offset:36864
    v_mfma_f32_16x16x32_bf16 v[92:95], v[32:35], v[132:135], v[92:95]
    ds_read_b64_tr_b16 v[30:31], v10 offset:38912
    v_mfma_f32_16x16x32_bf16 v[96:99], v[36:39], v[128:131], v[96:99]
    ds_read_b64_tr_b16 v[32:33], v7 offset:40960
    v_mfma_f32_16x16x32_bf16 v[100:103], v[36:39], v[132:135], v[100:103]
    ds_read_b64_tr_b16 v[34:35], v7 offset:43008
    s_waitcnt lgkmcnt(6)
    v_mfma_f32_16x16x32_bf16 v[72:75], v[16:19], v[136:139], v[72:75]
    ds_read_b64_tr_b16 v[36:37], v8 offset:40960
    v_mfma_f32_16x16x32_bf16 v[76:79], v[16:19], v[140:143], v[76:79]
    ds_read_b64_tr_b16 v[38:39], v8 offset:43008
    v_mfma_f32_16x16x32_bf16 v[80:83], v[20:23], v[136:139], v[80:83]
    ds_read_b64_tr_b16 v[16:17], v9 offset:40960
    v_mfma_f32_16x16x32_bf16 v[84:87], v[20:23], v[140:143], v[84:87]
    ds_read_b64_tr_b16 v[18:19], v9 offset:43008
    s_waitcnt lgkmcnt(6)
    v_mfma_f32_16x16x32_bf16 v[88:91], v[24:27], v[136:139], v[88:91]
    ds_read_b64_tr_b16 v[20:21], v10 offset:40960
    v_mfma_f32_16x16x32_bf16 v[92:95], v[24:27], v[140:143], v[92:95]
    ds_read_b64_tr_b16 v[22:23], v10 offset:43008
    v_mfma_f32_16x16x32_bf16 v[96:99], v[28:31], v[136:139], v[96:99]
    ds_read_b64_tr_b16 v[24:25], v7 offset:45056
    v_mfma_f32_16x16x32_bf16 v[100:103], v[28:31], v[140:143], v[100:103]
    ds_read_b64_tr_b16 v[26:27], v7 offset:47104
    s_waitcnt lgkmcnt(6)
    v_mfma_f32_16x16x32_bf16 v[72:75], v[32:35], v[144:147], v[72:75]
    ds_read_b64_tr_b16 v[28:29], v8 offset:45056
    v_mfma_f32_16x16x32_bf16 v[76:79], v[32:35], v[148:151], v[76:79]
    ds_read_b64_tr_b16 v[30:31], v8 offset:47104
    v_mfma_f32_16x16x32_bf16 v[80:83], v[36:39], v[144:147], v[80:83]
    ds_read_b64_tr_b16 v[32:33], v9 offset:45056
    v_mfma_f32_16x16x32_bf16 v[84:87], v[36:39], v[148:151], v[84:87]
    ds_read_b64_tr_b16 v[34:35], v9 offset:47104
    s_waitcnt lgkmcnt(6)
    v_mfma_f32_16x16x32_bf16 v[88:91], v[16:19], v[144:147], v[88:91]
    ds_read_b64_tr_b16 v[36:37], v10 offset:45056
    v_mfma_f32_16x16x32_bf16 v[92:95], v[16:19], v[148:151], v[92:95]
    ds_read_b64_tr_b16 v[38:39], v10 offset:47104
    v_mfma_f32_16x16x32_bf16 v[96:99], v[20:23], v[144:147], v[96:99]
    s_barrier
    ds_read_b64_tr_b16 v[16:17], v7 offset:55296
    v_mfma_f32_16x16x32_bf16 v[100:103], v[20:23], v[148:151], v[100:103]
    ds_read_b64_tr_b16 v[18:19], v7 offset:57344
    s_waitcnt lgkmcnt(6)
    v_mfma_f32_16x16x32_bf16 v[72:75], v[24:27], v[152:155], v[72:75]
    ds_read_b64_tr_b16 v[20:21], v8 offset:55296
    v_mfma_f32_16x16x32_bf16 v[76:79], v[24:27], v[156:159], v[76:79]
    ds_read_b64_tr_b16 v[22:23], v8 offset:57344
    v_mfma_f32_16x16x32_bf16 v[80:83], v[28:31], v[152:155], v[80:83]
    ds_read_b64_tr_b16 v[24:25], v9 offset:55296
    v_mfma_f32_16x16x32_bf16 v[84:87], v[28:31], v[156:159], v[84:87]
    ds_read_b64_tr_b16 v[26:27], v9 offset:57344
    s_waitcnt lgkmcnt(6)
    v_mfma_f32_16x16x32_bf16 v[88:91], v[32:35], v[152:155], v[88:91]
    ds_read_b64_tr_b16 v[28:29], v10 offset:55296
    v_mfma_f32_16x16x32_bf16 v[92:95], v[32:35], v[156:159], v[92:95]
    ds_read_b64_tr_b16 v[30:31], v10 offset:57344
    v_mfma_f32_16x16x32_bf16 v[96:99], v[36:39], v[152:155], v[96:99]
    ds_read_b64_tr_b16 v[32:33], v7 offset:59392
    v_mfma_f32_16x16x32_bf16 v[100:103], v[36:39], v[156:159], v[100:103]
    ds_read_b64_tr_b16 v[34:35], v7 offset:61440
    s_waitcnt lgkmcnt(6)
    v_mfma_f32_16x16x32_bf16 v[72:75], v[16:19], v[160:163], v[72:75]
    ds_read_b64_tr_b16 v[36:37], v8 offset:59392
    v_mfma_f32_16x16x32_bf16 v[76:79], v[16:19], v[164:167], v[76:79]
    ds_read_b64_tr_b16 v[38:39], v8 offset:61440
    v_mfma_f32_16x16x32_bf16 v[80:83], v[20:23], v[160:163], v[80:83]
    ds_read_b64_tr_b16 v[16:17], v9 offset:59392
    v_mfma_f32_16x16x32_bf16 v[84:87], v[20:23], v[164:167], v[84:87]
    ds_read_b64_tr_b16 v[18:19], v9 offset:61440
    s_waitcnt lgkmcnt(6)
    v_mfma_f32_16x16x32_bf16 v[88:91], v[24:27], v[160:163], v[88:91]
    ds_read_b64_tr_b16 v[20:21], v10 offset:59392
    v_mfma_f32_16x16x32_bf16 v[92:95], v[24:27], v[164:167], v[92:95]
    ds_read_b64_tr_b16 v[22:23], v10 offset:61440
    v_mfma_f32_16x16x32_bf16 v[96:99], v[28:31], v[160:163], v[96:99]
    ds_read_b64_tr_b16 v[24:25], v7 offset:63488
    v_mfma_f32_16x16x32_bf16 v[100:103], v[28:31], v[164:167], v[100:103]
    v_add_u32 v7, 55296, v7
    v_add_u32 v8, 55296, v8
    v_add_u32 v9, 55296, v9
    v_add_u32 v10, 55296, v10
    v_add_u32 v11, 55296, v11
    ds_read_b64_tr_b16 v[26:27], v7 offset:10240
    s_waitcnt lgkmcnt(6)
    v_mfma_f32_16x16x32_bf16 v[72:75], v[32:35], v[168:171], v[72:75]
    ds_read_b64_tr_b16 v[28:29], v8 offset:8192
    v_mfma_f32_16x16x32_bf16 v[76:79], v[32:35], v[172:175], v[76:79]
    ds_read_b64_tr_b16 v[30:31], v8 offset:10240
    v_mfma_f32_16x16x32_bf16 v[80:83], v[36:39], v[168:171], v[80:83]
    ds_read_b64_tr_b16 v[32:33], v9 offset:8192
    v_mfma_f32_16x16x32_bf16 v[84:87], v[36:39], v[172:175], v[84:87]
    ds_read_b64_tr_b16 v[34:35], v9 offset:10240
    s_waitcnt lgkmcnt(6)
    v_mfma_f32_16x16x32_bf16 v[88:91], v[16:19], v[168:171], v[88:91]
    ds_read_b64_tr_b16 v[36:37], v10 offset:8192
    v_mfma_f32_16x16x32_bf16 v[92:95], v[16:19], v[172:175], v[92:95]
    ds_read_b64_tr_b16 v[38:39], v10 offset:10240
    v_mfma_f32_16x16x32_bf16 v[96:99], v[20:23], v[168:171], v[96:99]
    s_barrier
    ds_read_b64_tr_b16 v[16:17], v7 offset:18432
    v_mfma_f32_16x16x32_bf16 v[100:103], v[20:23], v[172:175], v[100:103]
    ds_read_b64_tr_b16 v[18:19], v7 offset:20480
    s_waitcnt lgkmcnt(6)
    v_mfma_f32_16x16x32_bf16 v[72:75], v[24:27], v[176:179], v[72:75]
    ds_read_b64_tr_b16 v[20:21], v8 offset:18432
    v_mfma_f32_16x16x32_bf16 v[76:79], v[24:27], v[180:183], v[76:79]
    ds_read_b64_tr_b16 v[22:23], v8 offset:20480
    v_mfma_f32_16x16x32_bf16 v[80:83], v[28:31], v[176:179], v[80:83]
    ds_read_b64_tr_b16 v[24:25], v9 offset:18432
    v_mfma_f32_16x16x32_bf16 v[84:87], v[28:31], v[180:183], v[84:87]
    ds_read_b64_tr_b16 v[26:27], v9 offset:20480
    s_waitcnt lgkmcnt(6)
    v_mfma_f32_16x16x32_bf16 v[88:91], v[32:35], v[176:179], v[88:91]
    ds_read_b64_tr_b16 v[28:29], v10 offset:18432
    v_mfma_f32_16x16x32_bf16 v[92:95], v[32:35], v[180:183], v[92:95]
    ds_read_b64_tr_b16 v[30:31], v10 offset:20480
    v_mfma_f32_16x16x32_bf16 v[96:99], v[36:39], v[176:179], v[96:99]
    ds_read_b64_tr_b16 v[32:33], v7 offset:22528
    v_mfma_f32_16x16x32_bf16 v[100:103], v[36:39], v[180:183], v[100:103]
    ds_read_b64_tr_b16 v[34:35], v7 offset:24576
    s_waitcnt lgkmcnt(6)
    v_mfma_f32_16x16x32_bf16 v[72:75], v[16:19], v[184:187], v[72:75]
    ds_read_b64_tr_b16 v[36:37], v8 offset:22528
    v_mfma_f32_16x16x32_bf16 v[76:79], v[16:19], v[188:191], v[76:79]
    ds_read_b64_tr_b16 v[38:39], v8 offset:24576
    v_mfma_f32_16x16x32_bf16 v[80:83], v[20:23], v[184:187], v[80:83]
    ds_read_b64_tr_b16 v[16:17], v9 offset:22528
    v_mfma_f32_16x16x32_bf16 v[84:87], v[20:23], v[188:191], v[84:87]
    ds_read_b64_tr_b16 v[18:19], v9 offset:24576
    s_waitcnt lgkmcnt(6)
    v_mfma_f32_16x16x32_bf16 v[88:91], v[24:27], v[184:187], v[88:91]
    ds_read_b64_tr_b16 v[20:21], v10 offset:22528
    v_mfma_f32_16x16x32_bf16 v[92:95], v[24:27], v[188:191], v[92:95]
    ds_read_b64_tr_b16 v[22:23], v10 offset:24576
    v_mfma_f32_16x16x32_bf16 v[96:99], v[28:31], v[184:187], v[96:99]
    ds_read_b64_tr_b16 v[24:25], v7 offset:26624
    v_mfma_f32_16x16x32_bf16 v[100:103], v[28:31], v[188:191], v[100:103]
    ds_read_b64_tr_b16 v[26:27], v7 offset:28672
    s_waitcnt lgkmcnt(6)
    v_mfma_f32_16x16x32_bf16 v[72:75], v[32:35], v[192:195], v[72:75]
    ds_read_b64_tr_b16 v[28:29], v8 offset:26624
    v_mfma_f32_16x16x32_bf16 v[76:79], v[32:35], v[196:199], v[76:79]
    ds_read_b64_tr_b16 v[30:31], v8 offset:28672
    v_mfma_f32_16x16x32_bf16 v[80:83], v[36:39], v[192:195], v[80:83]
    ds_read_b64_tr_b16 v[32:33], v9 offset:26624
    v_mfma_f32_16x16x32_bf16 v[84:87], v[36:39], v[196:199], v[84:87]
    ds_read_b64_tr_b16 v[34:35], v9 offset:28672
    s_waitcnt lgkmcnt(6)
    v_mfma_f32_16x16x32_bf16 v[88:91], v[16:19], v[192:195], v[88:91]
    ds_read_b64_tr_b16 v[36:37], v10 offset:26624
    v_mfma_f32_16x16x32_bf16 v[92:95], v[16:19], v[196:199], v[92:95]
    ds_read_b64_tr_b16 v[38:39], v10 offset:28672
    v_mfma_f32_16x16x32_bf16 v[96:99], v[20:23], v[192:195], v[96:99]
    s_barrier
    v_subrev_u32 v7, 55296, v7
    v_subrev_u32 v8, 55296, v8
    v_subrev_u32 v9, 55296, v9
    v_subrev_u32 v10, 55296, v10
    v_subrev_u32 v11, 55296, v11
    ds_read_b64_tr_b16 v[16:17], v7 offset:0
    v_mfma_f32_16x16x32_bf16 v[100:103], v[20:23], v[196:199], v[100:103]
    ds_read_b64_tr_b16 v[18:19], v7 offset:2048
    s_waitcnt lgkmcnt(6)
    v_mfma_f32_16x16x32_bf16 v[72:75], v[24:27], v[200:203], v[72:75]
    ds_read_b64_tr_b16 v[20:21], v8 offset:0
    v_mfma_f32_16x16x32_bf16 v[76:79], v[24:27], v[204:207], v[76:79]
    ds_read_b64_tr_b16 v[22:23], v8 offset:2048
    v_mfma_f32_16x16x32_bf16 v[80:83], v[28:31], v[200:203], v[80:83]
    ds_read_b64_tr_b16 v[24:25], v9 offset:0
    v_mfma_f32_16x16x32_bf16 v[84:87], v[28:31], v[204:207], v[84:87]
    ds_read_b64_tr_b16 v[26:27], v9 offset:2048
    s_waitcnt lgkmcnt(6)
    v_mfma_f32_16x16x32_bf16 v[88:91], v[32:35], v[200:203], v[88:91]
    ds_read_b64_tr_b16 v[28:29], v10 offset:0
    v_mfma_f32_16x16x32_bf16 v[92:95], v[32:35], v[204:207], v[92:95]
    ds_read_b64_tr_b16 v[30:31], v10 offset:2048
    v_mfma_f32_16x16x32_bf16 v[96:99], v[36:39], v[200:203], v[96:99]
    ds_read_b64_tr_b16 v[32:33], v7 offset:4096
    v_mfma_f32_16x16x32_bf16 v[100:103], v[36:39], v[204:207], v[100:103]
    ds_read_b64_tr_b16 v[34:35], v7 offset:6144
    s_waitcnt lgkmcnt(6)
    v_mfma_f32_16x16x32_bf16 v[72:75], v[16:19], v[208:211], v[72:75]
    ds_read_b64_tr_b16 v[36:37], v8 offset:4096
    v_mfma_f32_16x16x32_bf16 v[76:79], v[16:19], v[212:215], v[76:79]
    ds_read_b64_tr_b16 v[38:39], v8 offset:6144
    v_mfma_f32_16x16x32_bf16 v[80:83], v[20:23], v[208:211], v[80:83]
    ds_read_b64_tr_b16 v[16:17], v9 offset:4096
    v_mfma_f32_16x16x32_bf16 v[84:87], v[20:23], v[212:215], v[84:87]
    ds_read_b64_tr_b16 v[18:19], v9 offset:6144
    s_waitcnt lgkmcnt(6)
    v_mfma_f32_16x16x32_bf16 v[88:91], v[24:27], v[208:211], v[88:91]
    ds_read_b64_tr_b16 v[20:21], v10 offset:4096
    v_mfma_f32_16x16x32_bf16 v[92:95], v[24:27], v[212:215], v[92:95]
    ds_read_b64_tr_b16 v[22:23], v10 offset:6144
    v_mfma_f32_16x16x32_bf16 v[96:99], v[28:31], v[208:211], v[96:99]
    ds_read_b64_tr_b16 v[24:25], v7 offset:8192
    v_mfma_f32_16x16x32_bf16 v[100:103], v[28:31], v[212:215], v[100:103]
    ds_read_b64_tr_b16 v[26:27], v7 offset:10240
    s_waitcnt lgkmcnt(6)
    v_mfma_f32_16x16x32_bf16 v[72:75], v[32:35], v[216:219], v[72:75]
    ds_read_b64_tr_b16 v[28:29], v8 offset:8192
    v_mfma_f32_16x16x32_bf16 v[76:79], v[32:35], v[220:223], v[76:79]
    ds_read_b64_tr_b16 v[30:31], v8 offset:10240
    v_mfma_f32_16x16x32_bf16 v[80:83], v[36:39], v[216:219], v[80:83]
    ds_read_b64_tr_b16 v[32:33], v9 offset:8192
    v_mfma_f32_16x16x32_bf16 v[84:87], v[36:39], v[220:223], v[84:87]
    ds_read_b64_tr_b16 v[34:35], v9 offset:10240
    s_waitcnt lgkmcnt(6)
    v_mfma_f32_16x16x32_bf16 v[88:91], v[16:19], v[216:219], v[88:91]
    ds_read_b64_tr_b16 v[36:37], v10 offset:8192
    v_mfma_f32_16x16x32_bf16 v[92:95], v[16:19], v[220:223], v[92:95]
    ds_read_b64_tr_b16 v[38:39], v10 offset:10240
    v_mfma_f32_16x16x32_bf16 v[96:99], v[20:23], v[216:219], v[96:99]
    s_barrier
    ds_read_b64_tr_b16 v[16:17], v7 offset:18432
    v_mfma_f32_16x16x32_bf16 v[100:103], v[20:23], v[220:223], v[100:103]
    ds_read_b64_tr_b16 v[18:19], v7 offset:20480
    s_waitcnt lgkmcnt(6)
    v_mfma_f32_16x16x32_bf16 v[72:75], v[24:27], v[224:227], v[72:75]
    ds_read_b64_tr_b16 v[20:21], v8 offset:18432
    v_mfma_f32_16x16x32_bf16 v[76:79], v[24:27], v[228:231], v[76:79]
    ds_read_b64_tr_b16 v[22:23], v8 offset:20480
    v_mfma_f32_16x16x32_bf16 v[80:83], v[28:31], v[224:227], v[80:83]
    ds_read_b64_tr_b16 v[24:25], v9 offset:18432
    v_mfma_f32_16x16x32_bf16 v[84:87], v[28:31], v[228:231], v[84:87]
    ds_read_b64_tr_b16 v[26:27], v9 offset:20480
    s_waitcnt lgkmcnt(6)
    v_mfma_f32_16x16x32_bf16 v[88:91], v[32:35], v[224:227], v[88:91]
    ds_read_b64_tr_b16 v[28:29], v10 offset:18432
    v_mfma_f32_16x16x32_bf16 v[92:95], v[32:35], v[228:231], v[92:95]
    ds_read_b64_tr_b16 v[30:31], v10 offset:20480
    v_mfma_f32_16x16x32_bf16 v[96:99], v[36:39], v[224:227], v[96:99]
    ds_read_b64_tr_b16 v[32:33], v7 offset:22528
    v_mfma_f32_16x16x32_bf16 v[100:103], v[36:39], v[228:231], v[100:103]
    ds_read_b64_tr_b16 v[34:35], v7 offset:24576
    s_waitcnt lgkmcnt(6)
    v_mfma_f32_16x16x32_bf16 v[72:75], v[16:19], v[232:235], v[72:75]
    ds_read_b64_tr_b16 v[36:37], v8 offset:22528
    v_mfma_f32_16x16x32_bf16 v[76:79], v[16:19], v[236:239], v[76:79]
    ds_read_b64_tr_b16 v[38:39], v8 offset:24576
    v_mfma_f32_16x16x32_bf16 v[80:83], v[20:23], v[232:235], v[80:83]
    ds_read_b64_tr_b16 v[16:17], v9 offset:22528
    v_mfma_f32_16x16x32_bf16 v[84:87], v[20:23], v[236:239], v[84:87]
    ds_read_b64_tr_b16 v[18:19], v9 offset:24576
    s_waitcnt lgkmcnt(6)
    v_mfma_f32_16x16x32_bf16 v[88:91], v[24:27], v[232:235], v[88:91]
    ds_read_b64_tr_b16 v[20:21], v10 offset:22528
    v_mfma_f32_16x16x32_bf16 v[92:95], v[24:27], v[236:239], v[92:95]
    ds_read_b64_tr_b16 v[22:23], v10 offset:24576
    v_mfma_f32_16x16x32_bf16 v[96:99], v[28:31], v[232:235], v[96:99]
    ds_read_b64_tr_b16 v[24:25], v7 offset:26624
    v_mfma_f32_16x16x32_bf16 v[100:103], v[28:31], v[236:239], v[100:103]
    ds_read_b64_tr_b16 v[26:27], v7 offset:28672
    s_waitcnt lgkmcnt(6)
    v_mfma_f32_16x16x32_bf16 v[72:75], v[32:35], v[240:243], v[72:75]
    ds_read_b64_tr_b16 v[28:29], v8 offset:26624
    v_mfma_f32_16x16x32_bf16 v[76:79], v[32:35], v[244:247], v[76:79]
    ds_read_b64_tr_b16 v[30:31], v8 offset:28672
    v_mfma_f32_16x16x32_bf16 v[80:83], v[36:39], v[240:243], v[80:83]
    ds_read_b64_tr_b16 v[32:33], v9 offset:26624
    v_mfma_f32_16x16x32_bf16 v[84:87], v[36:39], v[244:247], v[84:87]
    ds_read_b64_tr_b16 v[34:35], v9 offset:28672
    s_waitcnt lgkmcnt(6)
    v_mfma_f32_16x16x32_bf16 v[88:91], v[16:19], v[240:243], v[88:91]
    ds_read_b64_tr_b16 v[36:37], v10 offset:26624
    v_mfma_f32_16x16x32_bf16 v[92:95], v[16:19], v[244:247], v[92:95]
    ds_read_b64_tr_b16 v[38:39], v10 offset:28672
    v_mfma_f32_16x16x32_bf16 v[96:99], v[20:23], v[240:243], v[96:99]
    s_barrier
    ds_read_b64_tr_b16 v[16:17], v7 offset:36864
    v_mfma_f32_16x16x32_bf16 v[100:103], v[20:23], v[244:247], v[100:103]
    ds_read_b64_tr_b16 v[18:19], v7 offset:38912
    s_waitcnt lgkmcnt(6)
    v_mfma_f32_16x16x32_bf16 v[72:75], v[24:27], v[248:251], v[72:75]
    ds_read_b64_tr_b16 v[20:21], v8 offset:36864
    v_mfma_f32_16x16x32_bf16 v[76:79], v[24:27], v[252:255], v[76:79]
    ds_read_b64_tr_b16 v[22:23], v8 offset:38912
    v_mfma_f32_16x16x32_bf16 v[80:83], v[28:31], v[248:251], v[80:83]
    ds_read_b64_tr_b16 v[24:25], v9 offset:36864
    v_mfma_f32_16x16x32_bf16 v[84:87], v[28:31], v[252:255], v[84:87]
    ds_read_b64_tr_b16 v[26:27], v9 offset:38912
    s_waitcnt lgkmcnt(6)
    v_mfma_f32_16x16x32_bf16 v[88:91], v[32:35], v[248:251], v[88:91]
    ds_read_b64_tr_b16 v[28:29], v10 offset:36864
    v_mfma_f32_16x16x32_bf16 v[92:95], v[32:35], v[252:255], v[92:95]
    ds_read_b64_tr_b16 v[30:31], v10 offset:38912
    v_mfma_f32_16x16x32_bf16 v[96:99], v[36:39], v[248:251], v[96:99]
    ds_read_b64_tr_b16 v[32:33], v11 offset:49152
    v_mfma_f32_16x16x32_bf16 v[100:103], v[36:39], v[252:255], v[100:103]
    ds_read_b64_tr_b16 v[34:35], v11 offset:49664
    s_waitcnt lgkmcnt(6)
    v_mfma_f32_16x16x32_bf16 v[104:107], v[16:19], v[112:115], 0
    ds_read_b64_tr_b16 v[36:37], v7 offset:40960
    v_mfma_f32_16x16x32_bf16 v[108:111], v[16:19], v[116:119], 0
    ds_read_b64_tr_b16 v[38:39], v7 offset:43008
    v_mfma_f32_16x16x32_bf16 v[40:43], v[20:23], v[112:115], 0
    ds_read_b64_tr_b16 v[16:17], v8 offset:40960
    v_mfma_f32_16x16x32_bf16 v[44:47], v[20:23], v[116:119], 0
    ds_read_b64_tr_b16 v[18:19], v8 offset:43008
    s_waitcnt lgkmcnt(6)
    v_mfma_f32_16x16x32_bf16 v[48:51], v[24:27], v[112:115], 0
    ds_read_b64_tr_b16 v[20:21], v9 offset:40960
    v_mfma_f32_16x16x32_bf16 v[52:55], v[24:27], v[116:119], 0
    ds_read_b64_tr_b16 v[22:23], v9 offset:43008
    v_mfma_f32_16x16x32_bf16 v[56:59], v[28:31], v[112:115], 0
    ds_read_b64_tr_b16 v[24:25], v10 offset:40960
    v_mfma_f32_16x16x32_bf16 v[60:63], v[28:31], v[116:119], 0
    ds_read_b64_tr_b16 v[26:27], v10 offset:43008
    v_cvt_pk_bf16_f32 v72, v72, v73
    v_cvt_pk_bf16_f32 v73, v74, v75
    v_cvt_pk_bf16_f32 v74, v76, v77
    v_cvt_pk_bf16_f32 v75, v78, v79
    ds_write_b128 v13, v[72:75] offset:0
    s_waitcnt lgkmcnt(7)
    v_mfma_f32_16x16x32_bf16 v[64:67], v[32:35], v[112:115], 0
    ds_read_b64_tr_b16 v[28:29], v11 offset:50176
    v_mfma_f32_16x16x32_bf16 v[68:71], v[32:35], v[116:119], 0
    ds_read_b64_tr_b16 v[30:31], v11 offset:50688
    v_mfma_f32_16x16x32_bf16 v[104:107], v[36:39], v[120:123], v[104:107]
    ds_read_b64_tr_b16 v[32:33], v7 offset:45056
    v_mfma_f32_16x16x32_bf16 v[108:111], v[36:39], v[124:127], v[108:111]
    ds_read_b64_tr_b16 v[34:35], v7 offset:47104
    s_waitcnt lgkmcnt(7)
    v_mfma_f32_16x16x32_bf16 v[40:43], v[16:19], v[120:123], v[40:43]
    ds_read_b64_tr_b16 v[36:37], v8 offset:45056
    v_mfma_f32_16x16x32_bf16 v[44:47], v[16:19], v[124:127], v[44:47]
    ds_read_b64_tr_b16 v[38:39], v8 offset:47104
    v_mfma_f32_16x16x32_bf16 v[48:51], v[20:23], v[120:123], v[48:51]
    ds_read_b64_tr_b16 v[16:17], v9 offset:45056
    v_mfma_f32_16x16x32_bf16 v[52:55], v[20:23], v[124:127], v[52:55]
    ds_read_b64_tr_b16 v[18:19], v9 offset:47104
    s_waitcnt lgkmcnt(6)
    v_mfma_f32_16x16x32_bf16 v[56:59], v[24:27], v[120:123], v[56:59]
    ds_read_b64_tr_b16 v[20:21], v10 offset:45056
    v_mfma_f32_16x16x32_bf16 v[60:63], v[24:27], v[124:127], v[60:63]
    ds_read_b64_tr_b16 v[22:23], v10 offset:47104
    v_mfma_f32_16x16x32_bf16 v[64:67], v[28:31], v[120:123], v[64:67]
    ds_read_b64_tr_b16 v[24:25], v11 offset:51200
    v_mfma_f32_16x16x32_bf16 v[68:71], v[28:31], v[124:127], v[68:71]
    ds_read_b64_tr_b16 v[26:27], v11 offset:51712
    v_cvt_pk_bf16_f32 v80, v80, v81
    v_cvt_pk_bf16_f32 v81, v82, v83
    v_cvt_pk_bf16_f32 v82, v84, v85
    v_cvt_pk_bf16_f32 v83, v86, v87
    ds_write_b128 v13, v[80:83] offset:1024
    s_waitcnt lgkmcnt(7)
    v_mfma_f32_16x16x32_bf16 v[104:107], v[32:35], v[128:131], v[104:107]
    s_barrier
    ds_read_b64_tr_b16 v[28:29], v7 offset:55296
    v_mfma_f32_16x16x32_bf16 v[108:111], v[32:35], v[132:135], v[108:111]
    ds_read_b64_tr_b16 v[30:31], v7 offset:57344
    v_mfma_f32_16x16x32_bf16 v[40:43], v[36:39], v[128:131], v[40:43]
    ds_read_b64_tr_b16 v[32:33], v8 offset:55296
    v_mfma_f32_16x16x32_bf16 v[44:47], v[36:39], v[132:135], v[44:47]
    ds_read_b64_tr_b16 v[34:35], v8 offset:57344
    s_waitcnt lgkmcnt(7)
    v_mfma_f32_16x16x32_bf16 v[48:51], v[16:19], v[128:131], v[48:51]
    ds_read_b64_tr_b16 v[36:37], v9 offset:55296
    v_mfma_f32_16x16x32_bf16 v[52:55], v[16:19], v[132:135], v[52:55]
    ds_read_b64_tr_b16 v[38:39], v9 offset:57344
    v_mfma_f32_16x16x32_bf16 v[56:59], v[20:23], v[128:131], v[56:59]
    ds_read_b64_tr_b16 v[16:17], v10 offset:55296
    v_mfma_f32_16x16x32_bf16 v[60:63], v[20:23], v[132:135], v[60:63]
    ds_read_b64_tr_b16 v[18:19], v10 offset:57344
    s_waitcnt lgkmcnt(6)
    v_mfma_f32_16x16x32_bf16 v[64:67], v[24:27], v[128:131], v[64:67]
    v_add_u32 v7, 55296, v7
    v_add_u32 v8, 55296, v8
    v_add_u32 v9, 55296, v9
    v_add_u32 v10, 55296, v10
    v_add_u32 v11, 55296, v11
    ds_read_b64_tr_b16 v[20:21], v11 offset:12288
    v_mfma_f32_16x16x32_bf16 v[68:71], v[24:27], v[132:135], v[68:71]
    ds_read_b64_tr_b16 v[22:23], v11 offset:12800
    v_mfma_f32_16x16x32_bf16 v[104:107], v[28:31], v[136:139], v[104:107]
    ds_read_b64_tr_b16 v[24:25], v7 offset:4096
    v_mfma_f32_16x16x32_bf16 v[108:111], v[28:31], v[140:143], v[108:111]
    ds_read_b64_tr_b16 v[26:27], v7 offset:6144
    v_cvt_pk_bf16_f32 v88, v88, v89
    v_cvt_pk_bf16_f32 v89, v90, v91
    v_cvt_pk_bf16_f32 v90, v92, v93
    v_cvt_pk_bf16_f32 v91, v94, v95
    ds_write_b128 v13, v[88:91] offset:2048
    s_waitcnt lgkmcnt(7)
    v_mfma_f32_16x16x32_bf16 v[40:43], v[32:35], v[136:139], v[40:43]
    ds_read_b64_tr_b16 v[28:29], v8 offset:4096
    v_mfma_f32_16x16x32_bf16 v[44:47], v[32:35], v[140:143], v[44:47]
    ds_read_b64_tr_b16 v[30:31], v8 offset:6144
    v_mfma_f32_16x16x32_bf16 v[48:51], v[36:39], v[136:139], v[48:51]
    ds_read_b64_tr_b16 v[32:33], v9 offset:4096
    v_mfma_f32_16x16x32_bf16 v[52:55], v[36:39], v[140:143], v[52:55]
    ds_read_b64_tr_b16 v[34:35], v9 offset:6144
    s_waitcnt lgkmcnt(7)
    v_mfma_f32_16x16x32_bf16 v[56:59], v[16:19], v[136:139], v[56:59]
    ds_read_b64_tr_b16 v[36:37], v10 offset:4096
    v_mfma_f32_16x16x32_bf16 v[60:63], v[16:19], v[140:143], v[60:63]
    ds_read_b64_tr_b16 v[38:39], v10 offset:6144
    v_mfma_f32_16x16x32_bf16 v[64:67], v[20:23], v[136:139], v[64:67]
    ds_read_b64_tr_b16 v[16:17], v11 offset:13312
    v_mfma_f32_16x16x32_bf16 v[68:71], v[20:23], v[140:143], v[68:71]
    ds_read_b64_tr_b16 v[18:19], v11 offset:13824
    s_waitcnt lgkmcnt(6)
    v_mfma_f32_16x16x32_bf16 v[104:107], v[24:27], v[144:147], v[104:107]
    ds_read_b64_tr_b16 v[20:21], v7 offset:8192
    v_mfma_f32_16x16x32_bf16 v[108:111], v[24:27], v[148:151], v[108:111]
    ds_read_b64_tr_b16 v[22:23], v7 offset:10240
    v_mfma_f32_16x16x32_bf16 v[40:43], v[28:31], v[144:147], v[40:43]
    ds_read_b64_tr_b16 v[24:25], v8 offset:8192
    v_mfma_f32_16x16x32_bf16 v[44:47], v[28:31], v[148:151], v[44:47]
    ds_read_b64_tr_b16 v[26:27], v8 offset:10240
    v_cvt_pk_bf16_f32 v96, v96, v97
    v_cvt_pk_bf16_f32 v97, v98, v99
    v_cvt_pk_bf16_f32 v98, v100, v101
    v_cvt_pk_bf16_f32 v99, v102, v103
    ds_write_b128 v13, v[96:99] offset:3072
    s_waitcnt lgkmcnt(7)
    v_mfma_f32_16x16x32_bf16 v[48:51], v[32:35], v[144:147], v[48:51]
    ds_read_b64_tr_b16 v[28:29], v9 offset:8192
    v_mfma_f32_16x16x32_bf16 v[52:55], v[32:35], v[148:151], v[52:55]
    ds_read_b64_tr_b16 v[30:31], v9 offset:10240
    v_mfma_f32_16x16x32_bf16 v[56:59], v[36:39], v[144:147], v[56:59]
    ds_read_b64_tr_b16 v[32:33], v10 offset:8192
    v_mfma_f32_16x16x32_bf16 v[60:63], v[36:39], v[148:151], v[60:63]
    ds_read_b64_tr_b16 v[34:35], v10 offset:10240
    s_waitcnt lgkmcnt(7)
    v_mfma_f32_16x16x32_bf16 v[64:67], v[16:19], v[144:147], v[64:67]
    ds_read_b64_tr_b16 v[36:37], v11 offset:14336
    v_mfma_f32_16x16x32_bf16 v[68:71], v[16:19], v[148:151], v[68:71]
    ds_read_b64_tr_b16 v[38:39], v11 offset:14848
    v_mfma_f32_16x16x32_bf16 v[104:107], v[20:23], v[152:155], v[104:107]
    s_barrier
    ds_read_b64_tr_b16 v[16:17], v7 offset:18432
    v_mfma_f32_16x16x32_bf16 v[108:111], v[20:23], v[156:159], v[108:111]
    ds_read_b64_tr_b16 v[18:19], v7 offset:20480
    s_waitcnt lgkmcnt(6)
    v_mfma_f32_16x16x32_bf16 v[40:43], v[24:27], v[152:155], v[40:43]
    ds_read_b64_tr_b16 v[20:21], v8 offset:18432
    v_mfma_f32_16x16x32_bf16 v[44:47], v[24:27], v[156:159], v[44:47]
    ds_read_b64_tr_b16 v[22:23], v8 offset:20480
    v_mfma_f32_16x16x32_bf16 v[48:51], v[28:31], v[152:155], v[48:51]
    ds_read_b64_tr_b16 v[24:25], v9 offset:18432
    v_mfma_f32_16x16x32_bf16 v[52:55], v[28:31], v[156:159], v[52:55]
    ds_read_b64_tr_b16 v[26:27], v9 offset:20480
    s_waitcnt lgkmcnt(6)
    v_mfma_f32_16x16x32_bf16 v[56:59], v[32:35], v[152:155], v[56:59]
    ds_read_b64_tr_b16 v[28:29], v10 offset:18432
    v_mfma_f32_16x16x32_bf16 v[60:63], v[32:35], v[156:159], v[60:63]
    ds_read_b64_tr_b16 v[30:31], v10 offset:20480
    v_mfma_f32_16x16x32_bf16 v[64:67], v[36:39], v[152:155], v[64:67]
    ds_read_b64_tr_b16 v[32:33], v11 offset:30720
    v_mfma_f32_16x16x32_bf16 v[68:71], v[36:39], v[156:159], v[68:71]
    ds_read_b64_tr_b16 v[34:35], v11 offset:31232
    s_waitcnt lgkmcnt(6)
    v_mfma_f32_16x16x32_bf16 v[104:107], v[16:19], v[160:163], v[104:107]
    ds_read_b64_tr_b16 v[36:37], v7 offset:22528
    v_mfma_f32_16x16x32_bf16 v[108:111], v[16:19], v[164:167], v[108:111]
    ds_read_b64_tr_b16 v[38:39], v7 offset:24576
    v_mfma_f32_16x16x32_bf16 v[40:43], v[20:23], v[160:163], v[40:43]
    ds_read_b64_tr_b16 v[16:17], v8 offset:22528
    v_mfma_f32_16x16x32_bf16 v[44:47], v[20:23], v[164:167], v[44:47]
    ds_read_b64_tr_b16 v[18:19], v8 offset:24576
    s_waitcnt lgkmcnt(6)
    v_mfma_f32_16x16x32_bf16 v[48:51], v[24:27], v[160:163], v[48:51]
    ds_read_b64_tr_b16 v[20:21], v9 offset:22528
    v_mfma_f32_16x16x32_bf16 v[52:55], v[24:27], v[164:167], v[52:55]
    ds_read_b64_tr_b16 v[22:23], v9 offset:24576
    v_mfma_f32_16x16x32_bf16 v[56:59], v[28:31], v[160:163], v[56:59]
    ds_read_b64_tr_b16 v[24:25], v10 offset:22528
    v_mfma_f32_16x16x32_bf16 v[60:63], v[28:31], v[164:167], v[60:63]
    ds_read_b64_tr_b16 v[26:27], v10 offset:24576
    s_waitcnt lgkmcnt(6)
    v_mfma_f32_16x16x32_bf16 v[64:67], v[32:35], v[160:163], v[64:67]
    ds_read_b64_tr_b16 v[28:29], v11 offset:31744
    v_mfma_f32_16x16x32_bf16 v[68:71], v[32:35], v[164:167], v[68:71]
    ds_read_b64_tr_b16 v[30:31], v11 offset:32256
    v_mfma_f32_16x16x32_bf16 v[104:107], v[36:39], v[168:171], v[104:107]
    ds_read_b64_tr_b16 v[32:33], v7 offset:26624
    v_mfma_f32_16x16x32_bf16 v[108:111], v[36:39], v[172:175], v[108:111]
    ds_read_b64_tr_b16 v[34:35], v7 offset:28672
    s_waitcnt lgkmcnt(6)
    v_mfma_f32_16x16x32_bf16 v[40:43], v[16:19], v[168:171], v[40:43]
    ds_read_b64_tr_b16 v[36:37], v8 offset:26624
    v_mfma_f32_16x16x32_bf16 v[44:47], v[16:19], v[172:175], v[44:47]
    ds_read_b64_tr_b16 v[38:39], v8 offset:28672
    v_mfma_f32_16x16x32_bf16 v[48:51], v[20:23], v[168:171], v[48:51]
    ds_read_b64_tr_b16 v[16:17], v9 offset:26624
    v_mfma_f32_16x16x32_bf16 v[52:55], v[20:23], v[172:175], v[52:55]
    ds_read_b64_tr_b16 v[18:19], v9 offset:28672
    s_waitcnt lgkmcnt(6)
    v_mfma_f32_16x16x32_bf16 v[56:59], v[24:27], v[168:171], v[56:59]
    ds_read_b64_tr_b16 v[20:21], v10 offset:26624
    v_mfma_f32_16x16x32_bf16 v[60:63], v[24:27], v[172:175], v[60:63]
    ds_read_b64_tr_b16 v[22:23], v10 offset:28672
    v_mfma_f32_16x16x32_bf16 v[64:67], v[28:31], v[168:171], v[64:67]
    ds_read_b64_tr_b16 v[24:25], v11 offset:32768
    v_mfma_f32_16x16x32_bf16 v[68:71], v[28:31], v[172:175], v[68:71]
    ds_read_b64_tr_b16 v[26:27], v11 offset:33280
    s_waitcnt lgkmcnt(6)
    v_mfma_f32_16x16x32_bf16 v[104:107], v[32:35], v[176:179], v[104:107]
    s_barrier
    v_subrev_u32 v7, 55296, v7
    v_subrev_u32 v8, 55296, v8
    v_subrev_u32 v9, 55296, v9
    v_subrev_u32 v10, 55296, v10
    v_subrev_u32 v11, 55296, v11
    ds_read_b64_tr_b16 v[28:29], v7 offset:0
    v_mfma_f32_16x16x32_bf16 v[108:111], v[32:35], v[180:183], v[108:111]
    ds_read_b64_tr_b16 v[30:31], v7 offset:2048
    v_mfma_f32_16x16x32_bf16 v[40:43], v[36:39], v[176:179], v[40:43]
    ds_read_b64_tr_b16 v[32:33], v8 offset:0
    v_mfma_f32_16x16x32_bf16 v[44:47], v[36:39], v[180:183], v[44:47]
    ds_read_b64_tr_b16 v[34:35], v8 offset:2048
    s_waitcnt lgkmcnt(6)
    v_mfma_f32_16x16x32_bf16 v[48:51], v[16:19], v[176:179], v[48:51]
    ds_read_b64_tr_b16 v[36:37], v9 offset:0
    v_mfma_f32_16x16x32_bf16 v[52:55], v[16:19], v[180:183], v[52:55]
    ds_read_b64_tr_b16 v[38:39], v9 offset:2048
    v_mfma_f32_16x16x32_bf16 v[56:59], v[20:23], v[176:179], v[56:59]
    ds_read_b64_tr_b16 v[16:17], v10 offset:0
    v_mfma_f32_16x16x32_bf16 v[60:63], v[20:23], v[180:183], v[60:63]
    ds_read_b64_tr_b16 v[18:19], v10 offset:2048
    s_waitcnt lgkmcnt(6)
    v_mfma_f32_16x16x32_bf16 v[64:67], v[24:27], v[176:179], v[64:67]
    ds_read_b64_tr_b16 v[20:21], v11 offset:12288
    v_mfma_f32_16x16x32_bf16 v[68:71], v[24:27], v[180:183], v[68:71]
    ds_read_b64_tr_b16 v[22:23], v11 offset:12800
    v_mfma_f32_16x16x32_bf16 v[104:107], v[28:31], v[184:187], v[104:107]
    ds_read_b64_tr_b16 v[24:25], v7 offset:4096
    v_mfma_f32_16x16x32_bf16 v[108:111], v[28:31], v[188:191], v[108:111]
    ds_read_b64_tr_b16 v[26:27], v7 offset:6144
    s_waitcnt lgkmcnt(6)
    v_mfma_f32_16x16x32_bf16 v[40:43], v[32:35], v[184:187], v[40:43]
    ds_read_b64_tr_b16 v[28:29], v8 offset:4096
    v_mfma_f32_16x16x32_bf16 v[44:47], v[32:35], v[188:191], v[44:47]
    ds_read_b64_tr_b16 v[30:31], v8 offset:6144
    v_mfma_f32_16x16x32_bf16 v[48:51], v[36:39], v[184:187], v[48:51]
    ds_read_b64_tr_b16 v[32:33], v9 offset:4096
    v_mfma_f32_16x16x32_bf16 v[52:55], v[36:39], v[188:191], v[52:55]
    ds_read_b64_tr_b16 v[34:35], v9 offset:6144
    s_waitcnt lgkmcnt(6)
    v_mfma_f32_16x16x32_bf16 v[56:59], v[16:19], v[184:187], v[56:59]
    ds_read_b64_tr_b16 v[36:37], v10 offset:4096
    v_mfma_f32_16x16x32_bf16 v[60:63], v[16:19], v[188:191], v[60:63]
    ds_read_b64_tr_b16 v[38:39], v10 offset:6144
    v_mfma_f32_16x16x32_bf16 v[64:67], v[20:23], v[184:187], v[64:67]
    ds_read_b64_tr_b16 v[16:17], v11 offset:13312
    v_mfma_f32_16x16x32_bf16 v[68:71], v[20:23], v[188:191], v[68:71]
    ds_read_b64_tr_b16 v[18:19], v11 offset:13824
    s_waitcnt lgkmcnt(6)
    v_mfma_f32_16x16x32_bf16 v[104:107], v[24:27], v[192:195], v[104:107]
    ds_read_b64_tr_b16 v[20:21], v7 offset:8192
    v_mfma_f32_16x16x32_bf16 v[108:111], v[24:27], v[196:199], v[108:111]
    ds_read_b64_tr_b16 v[22:23], v7 offset:10240
    v_mfma_f32_16x16x32_bf16 v[40:43], v[28:31], v[192:195], v[40:43]
    ds_read_b64_tr_b16 v[24:25], v8 offset:8192
    v_mfma_f32_16x16x32_bf16 v[44:47], v[28:31], v[196:199], v[44:47]
    ds_read_b64_tr_b16 v[26:27], v8 offset:10240
    s_waitcnt lgkmcnt(6)
    v_mfma_f32_16x16x32_bf16 v[48:51], v[32:35], v[192:195], v[48:51]
    ds_read_b64_tr_b16 v[28:29], v9 offset:8192
    v_mfma_f32_16x16x32_bf16 v[52:55], v[32:35], v[196:199], v[52:55]
    ds_read_b64_tr_b16 v[30:31], v9 offset:10240
    v_mfma_f32_16x16x32_bf16 v[56:59], v[36:39], v[192:195], v[56:59]
    ds_read_b64_tr_b16 v[32:33], v10 offset:8192
    v_mfma_f32_16x16x32_bf16 v[60:63], v[36:39], v[196:199], v[60:63]
    ds_read_b64_tr_b16 v[34:35], v10 offset:10240
    s_waitcnt lgkmcnt(6)
    v_mfma_f32_16x16x32_bf16 v[64:67], v[16:19], v[192:195], v[64:67]
    ds_read_b64_tr_b16 v[36:37], v11 offset:14336
    v_mfma_f32_16x16x32_bf16 v[68:71], v[16:19], v[196:199], v[68:71]
    ds_read_b64_tr_b16 v[38:39], v11 offset:14848
    v_mfma_f32_16x16x32_bf16 v[104:107], v[20:23], v[200:203], v[104:107]
    s_barrier
    ds_read_b64_tr_b16 v[16:17], v7 offset:18432
    v_mfma_f32_16x16x32_bf16 v[108:111], v[20:23], v[204:207], v[108:111]
    ds_read_b64_tr_b16 v[18:19], v7 offset:20480
    s_waitcnt lgkmcnt(6)
    v_mfma_f32_16x16x32_bf16 v[40:43], v[24:27], v[200:203], v[40:43]
    ds_read_b64_tr_b16 v[20:21], v8 offset:18432
    v_mfma_f32_16x16x32_bf16 v[44:47], v[24:27], v[204:207], v[44:47]
    ds_read_b64_tr_b16 v[22:23], v8 offset:20480
    v_mfma_f32_16x16x32_bf16 v[48:51], v[28:31], v[200:203], v[48:51]
    ds_read_b64_tr_b16 v[24:25], v9 offset:18432
    v_mfma_f32_16x16x32_bf16 v[52:55], v[28:31], v[204:207], v[52:55]
    ds_read_b64_tr_b16 v[26:27], v9 offset:20480
    s_waitcnt lgkmcnt(6)
    v_mfma_f32_16x16x32_bf16 v[56:59], v[32:35], v[200:203], v[56:59]
    ds_read_b64_tr_b16 v[28:29], v10 offset:18432
    v_mfma_f32_16x16x32_bf16 v[60:63], v[32:35], v[204:207], v[60:63]
    ds_read_b64_tr_b16 v[30:31], v10 offset:20480
    v_mfma_f32_16x16x32_bf16 v[64:67], v[36:39], v[200:203], v[64:67]
    ds_read_b64_tr_b16 v[32:33], v11 offset:30720
    v_mfma_f32_16x16x32_bf16 v[68:71], v[36:39], v[204:207], v[68:71]
    ds_read_b64_tr_b16 v[34:35], v11 offset:31232
    s_waitcnt lgkmcnt(6)
    v_mfma_f32_16x16x32_bf16 v[104:107], v[16:19], v[208:211], v[104:107]
    ds_read_b64_tr_b16 v[36:37], v7 offset:22528
    v_mfma_f32_16x16x32_bf16 v[108:111], v[16:19], v[212:215], v[108:111]
    ds_read_b64_tr_b16 v[38:39], v7 offset:24576
    v_mfma_f32_16x16x32_bf16 v[40:43], v[20:23], v[208:211], v[40:43]
    ds_read_b64_tr_b16 v[16:17], v8 offset:22528
    v_mfma_f32_16x16x32_bf16 v[44:47], v[20:23], v[212:215], v[44:47]
    ds_read_b64_tr_b16 v[18:19], v8 offset:24576
    s_waitcnt lgkmcnt(6)
    v_mfma_f32_16x16x32_bf16 v[48:51], v[24:27], v[208:211], v[48:51]
    ds_read_b64_tr_b16 v[20:21], v9 offset:22528
    v_mfma_f32_16x16x32_bf16 v[52:55], v[24:27], v[212:215], v[52:55]
    ds_read_b64_tr_b16 v[22:23], v9 offset:24576
    v_mfma_f32_16x16x32_bf16 v[56:59], v[28:31], v[208:211], v[56:59]
    ds_read_b64_tr_b16 v[24:25], v10 offset:22528
    v_mfma_f32_16x16x32_bf16 v[60:63], v[28:31], v[212:215], v[60:63]
    ds_read_b64_tr_b16 v[26:27], v10 offset:24576
    s_waitcnt lgkmcnt(6)
    v_mfma_f32_16x16x32_bf16 v[64:67], v[32:35], v[208:211], v[64:67]
    ds_read_b64_tr_b16 v[28:29], v11 offset:31744
    v_mfma_f32_16x16x32_bf16 v[68:71], v[32:35], v[212:215], v[68:71]
    ds_read_b64_tr_b16 v[30:31], v11 offset:32256
    v_mfma_f32_16x16x32_bf16 v[104:107], v[36:39], v[216:219], v[104:107]
    ds_read_b64_tr_b16 v[32:33], v7 offset:26624
    v_mfma_f32_16x16x32_bf16 v[108:111], v[36:39], v[220:223], v[108:111]
    ds_read_b64_tr_b16 v[34:35], v7 offset:28672
    s_waitcnt lgkmcnt(6)
    v_mfma_f32_16x16x32_bf16 v[40:43], v[16:19], v[216:219], v[40:43]
    ds_read_b64_tr_b16 v[36:37], v8 offset:26624
    v_mfma_f32_16x16x32_bf16 v[44:47], v[16:19], v[220:223], v[44:47]
    ds_read_b64_tr_b16 v[38:39], v8 offset:28672
    v_mfma_f32_16x16x32_bf16 v[48:51], v[20:23], v[216:219], v[48:51]
    ds_read_b64_tr_b16 v[16:17], v9 offset:26624
    v_mfma_f32_16x16x32_bf16 v[52:55], v[20:23], v[220:223], v[52:55]
    ds_read_b64_tr_b16 v[18:19], v9 offset:28672
    s_waitcnt lgkmcnt(6)
    v_mfma_f32_16x16x32_bf16 v[56:59], v[24:27], v[216:219], v[56:59]
    ds_read_b64_tr_b16 v[20:21], v10 offset:26624
    v_mfma_f32_16x16x32_bf16 v[60:63], v[24:27], v[220:223], v[60:63]
    ds_read_b64_tr_b16 v[22:23], v10 offset:28672
    v_mfma_f32_16x16x32_bf16 v[64:67], v[28:31], v[216:219], v[64:67]
    ds_read_b64_tr_b16 v[24:25], v11 offset:32768
    v_mfma_f32_16x16x32_bf16 v[68:71], v[28:31], v[220:223], v[68:71]
    ds_read_b64_tr_b16 v[26:27], v11 offset:33280
    s_waitcnt lgkmcnt(6)
    v_mfma_f32_16x16x32_bf16 v[104:107], v[32:35], v[224:227], v[104:107]
    s_barrier
    ds_read_b64_tr_b16 v[28:29], v7 offset:36864
    v_mfma_f32_16x16x32_bf16 v[108:111], v[32:35], v[228:231], v[108:111]
    ds_read_b64_tr_b16 v[30:31], v7 offset:38912
    v_mfma_f32_16x16x32_bf16 v[40:43], v[36:39], v[224:227], v[40:43]
    ds_read_b64_tr_b16 v[32:33], v8 offset:36864
    v_mfma_f32_16x16x32_bf16 v[44:47], v[36:39], v[228:231], v[44:47]
    ds_read_b64_tr_b16 v[34:35], v8 offset:38912
    s_waitcnt lgkmcnt(6)
    v_mfma_f32_16x16x32_bf16 v[48:51], v[16:19], v[224:227], v[48:51]
    ds_read_b64_tr_b16 v[36:37], v9 offset:36864
    v_mfma_f32_16x16x32_bf16 v[52:55], v[16:19], v[228:231], v[52:55]
    ds_read_b64_tr_b16 v[38:39], v9 offset:38912
    v_mfma_f32_16x16x32_bf16 v[56:59], v[20:23], v[224:227], v[56:59]
    ds_read_b64_tr_b16 v[16:17], v10 offset:36864
    v_mfma_f32_16x16x32_bf16 v[60:63], v[20:23], v[228:231], v[60:63]
    ds_read_b64_tr_b16 v[18:19], v10 offset:38912
    s_waitcnt lgkmcnt(6)
    v_mfma_f32_16x16x32_bf16 v[64:67], v[24:27], v[224:227], v[64:67]
    ds_read_b64_tr_b16 v[20:21], v11 offset:49152
    v_mfma_f32_16x16x32_bf16 v[68:71], v[24:27], v[228:231], v[68:71]
    ds_read_b64_tr_b16 v[22:23], v11 offset:49664
    v_mfma_f32_16x16x32_bf16 v[104:107], v[28:31], v[232:235], v[104:107]
    ds_read_b64_tr_b16 v[24:25], v7 offset:40960
    v_mfma_f32_16x16x32_bf16 v[108:111], v[28:31], v[236:239], v[108:111]
    ds_read_b64_tr_b16 v[26:27], v7 offset:43008
    s_waitcnt lgkmcnt(6)
    v_mfma_f32_16x16x32_bf16 v[40:43], v[32:35], v[232:235], v[40:43]
    ds_read_b64_tr_b16 v[28:29], v8 offset:40960
    v_mfma_f32_16x16x32_bf16 v[44:47], v[32:35], v[236:239], v[44:47]
    ds_read_b64_tr_b16 v[30:31], v8 offset:43008
    v_mfma_f32_16x16x32_bf16 v[48:51], v[36:39], v[232:235], v[48:51]
    ds_read_b64_tr_b16 v[32:33], v9 offset:40960
    v_mfma_f32_16x16x32_bf16 v[52:55], v[36:39], v[236:239], v[52:55]
    ds_read_b64_tr_b16 v[34:35], v9 offset:43008
    s_waitcnt lgkmcnt(6)
    v_mfma_f32_16x16x32_bf16 v[56:59], v[16:19], v[232:235], v[56:59]
    ds_read_b64_tr_b16 v[36:37], v10 offset:40960
    v_mfma_f32_16x16x32_bf16 v[60:63], v[16:19], v[236:239], v[60:63]
    ds_read_b64_tr_b16 v[38:39], v10 offset:43008
    v_mfma_f32_16x16x32_bf16 v[64:67], v[20:23], v[232:235], v[64:67]
    ds_read_b64_tr_b16 v[16:17], v11 offset:50176
    v_mfma_f32_16x16x32_bf16 v[68:71], v[20:23], v[236:239], v[68:71]
    ds_read_b64_tr_b16 v[18:19], v11 offset:50688
    s_waitcnt lgkmcnt(6)
    v_mfma_f32_16x16x32_bf16 v[104:107], v[24:27], v[240:243], v[104:107]
    ds_read_b64_tr_b16 v[20:21], v7 offset:45056
    v_mfma_f32_16x16x32_bf16 v[108:111], v[24:27], v[244:247], v[108:111]
    ds_read_b64_tr_b16 v[22:23], v7 offset:47104
    v_mfma_f32_16x16x32_bf16 v[40:43], v[28:31], v[240:243], v[40:43]
    ds_read_b64_tr_b16 v[24:25], v8 offset:45056
    v_mfma_f32_16x16x32_bf16 v[44:47], v[28:31], v[244:247], v[44:47]
    ds_read_b64_tr_b16 v[26:27], v8 offset:47104
    s_waitcnt lgkmcnt(6)
    v_mfma_f32_16x16x32_bf16 v[48:51], v[32:35], v[240:243], v[48:51]
    ds_read_b64_tr_b16 v[28:29], v9 offset:45056
    v_mfma_f32_16x16x32_bf16 v[52:55], v[32:35], v[244:247], v[52:55]
    ds_read_b64_tr_b16 v[30:31], v9 offset:47104
    v_mfma_f32_16x16x32_bf16 v[56:59], v[36:39], v[240:243], v[56:59]
    ds_read_b64_tr_b16 v[32:33], v10 offset:45056
    v_mfma_f32_16x16x32_bf16 v[60:63], v[36:39], v[244:247], v[60:63]
    ds_read_b64_tr_b16 v[34:35], v10 offset:47104
    s_waitcnt lgkmcnt(6)
    v_mfma_f32_16x16x32_bf16 v[64:67], v[16:19], v[240:243], v[64:67]
    ds_read_b64_tr_b16 v[36:37], v11 offset:51200
    v_mfma_f32_16x16x32_bf16 v[68:71], v[16:19], v[244:247], v[68:71]
    ds_read_b64_tr_b16 v[38:39], v11 offset:51712
    v_mfma_f32_16x16x32_bf16 v[104:107], v[20:23], v[248:251], v[104:107]
    s_barrier
    ds_read_b64_tr_b16 v[16:17], v4 offset:55296
    v_mfma_f32_16x16x32_bf16 v[108:111], v[20:23], v[252:255], v[108:111]
    ds_read_b64_tr_b16 v[18:19], v4 offset:59904
    s_waitcnt lgkmcnt(6)
    v_mfma_f32_16x16x32_bf16 v[40:43], v[24:27], v[248:251], v[40:43]
    ds_read_b64_tr_b16 v[20:21], v4 offset:55304
    v_mfma_f32_16x16x32_bf16 v[44:47], v[24:27], v[252:255], v[44:47]
    ds_read_b64_tr_b16 v[22:23], v4 offset:59912
    v_mfma_f32_16x16x32_bf16 v[48:51], v[28:31], v[248:251], v[48:51]
    ds_read_b64_tr_b16 v[24:25], v4 offset:55312
    v_mfma_f32_16x16x32_bf16 v[52:55], v[28:31], v[252:255], v[52:55]
    ds_read_b64_tr_b16 v[26:27], v4 offset:59920
    s_waitcnt lgkmcnt(6)
    v_mfma_f32_16x16x32_bf16 v[56:59], v[32:35], v[248:251], v[56:59]
    ds_read_b64_tr_b16 v[28:29], v4 offset:55320
    v_mfma_f32_16x16x32_bf16 v[60:63], v[32:35], v[252:255], v[60:63]
    ds_read_b64_tr_b16 v[30:31], v4 offset:59928
    v_mfma_f32_16x16x32_bf16 v[64:67], v[36:39], v[248:251], v[64:67]
    ds_read_b64_tr_b16 v[32:33], v4 offset:64512
    v_mfma_f32_16x16x32_bf16 v[68:71], v[36:39], v[252:255], v[68:71]
    v_add_u32 v4, 55296, v4
    v_add_u32 v5, 55296, v5
    v_add_u32 v12, 55296, v12
    ds_read_b64_tr_b16 v[34:35], v4 offset:13824
    s_waitcnt lgkmcnt(6)
    v_mfma_f32_16x16x32_bf16 v[72:75], v[16:19], v[112:115], 0
    ds_read_b64_tr_b16 v[36:37], v4 offset:9224
    v_mfma_f32_16x16x32_bf16 v[76:79], v[16:19], v[116:119], 0
    ds_read_b64_tr_b16 v[38:39], v4 offset:13832
    v_cvt_pk_bf16_f32 v104, v104, v105
    v_cvt_pk_bf16_f32 v105, v106, v107
    v_cvt_pk_bf16_f32 v106, v108, v109
    v_cvt_pk_bf16_f32 v107, v110, v111
    ds_write_b128 v13, v[104:107] offset:4096
    v_mfma_f32_16x16x32_bf16 v[80:83], v[20:23], v[112:115], 0
    ds_read_b64_tr_b16 v[16:17], v4 offset:9232
    v_mfma_f32_16x16x32_bf16 v[84:87], v[20:23], v[116:119], 0
    ds_read_b64_tr_b16 v[18:19], v4 offset:13840
    s_waitcnt lgkmcnt(7)
    v_mfma_f32_16x16x32_bf16 v[88:91], v[24:27], v[112:115], 0
    ds_read_b64_tr_b16 v[20:21], v4 offset:9240
    v_mfma_f32_16x16x32_bf16 v[92:95], v[24:27], v[116:119], 0
    ds_read_b64_tr_b16 v[22:23], v4 offset:13848
    v_cvt_pk_bf16_f32 v40, v40, v41
    v_cvt_pk_bf16_f32 v41, v42, v43
    v_cvt_pk_bf16_f32 v42, v44, v45
    v_cvt_pk_bf16_f32 v43, v46, v47
    ds_write_b128 v13, v[40:43] offset:5120
    v_mfma_f32_16x16x32_bf16 v[96:99], v[28:31], v[112:115], 0
    ds_read_b64_tr_b16 v[24:25], v4 offset:32
    v_mfma_f32_16x16x32_bf16 v[100:103], v[28:31], v[116:119], 0
    ds_read_b64_tr_b16 v[26:27], v4 offset:4640
    s_waitcnt lgkmcnt(8)
    v_mfma_f32_16x16x32_bf16 v[72:75], v[32:35], v[120:123], v[72:75]
    ds_read_b64_tr_b16 v[28:29], v4 offset:9248
    v_mfma_f32_16x16x32_bf16 v[76:79], v[32:35], v[124:127], v[76:79]
    ds_read_b64_tr_b16 v[30:31], v4 offset:13856
    v_cvt_pk_bf16_f32 v48, v48, v49
    v_cvt_pk_bf16_f32 v49, v50, v51
    v_cvt_pk_bf16_f32 v50, v52, v53
    v_cvt_pk_bf16_f32 v51, v54, v55
    ds_write_b128 v13, v[48:51] offset:6144
    v_mfma_f32_16x16x32_bf16 v[80:83], v[36:39], v[120:123], v[80:83]
    ds_read_b64_tr_b16 v[32:33], v5 offset:192
    v_mfma_f32_16x16x32_bf16 v[84:87], v[36:39], v[124:127], v[84:87]
    ds_read_b64_tr_b16 v[34:35], v5 offset:4800
    s_waitcnt lgkmcnt(8)
    v_mfma_f32_16x16x32_bf16 v[88:91], v[16:19], v[120:123], v[88:91]
    ds_read_b64_tr_b16 v[36:37], v5 offset:9408
    v_mfma_f32_16x16x32_bf16 v[92:95], v[16:19], v[124:127], v[92:95]
    ds_read_b64_tr_b16 v[38:39], v5 offset:14016
    v_cvt_pk_bf16_f32 v56, v56, v57
    v_cvt_pk_bf16_f32 v57, v58, v59
    v_cvt_pk_bf16_f32 v58, v60, v61
    v_cvt_pk_bf16_f32 v59, v62, v63
    ds_write_b128 v13, v[56:59] offset:7168
    v_mfma_f32_16x16x32_bf16 v[96:99], v[20:23], v[120:123], v[96:99]
    ds_read_b64_tr_b16 v[16:17], v5 offset:240
    v_mfma_f32_16x16x32_bf16 v[100:103], v[20:23], v[124:127], v[100:103]
    ds_read_b64_tr_b16 v[18:19], v5 offset:4848
    s_waitcnt lgkmcnt(8)
    v_mfma_f32_16x16x32_bf16 v[104:107], v[24:27], v[112:115], 0
    ds_read_b64_tr_b16 v[20:21], v5 offset:9456
    v_mfma_f32_16x16x32_bf16 v[108:111], v[24:27], v[116:119], 0
    ds_read_b64_tr_b16 v[22:23], v5 offset:14064
    v_cvt_pk_bf16_f32 v64, v64, v65
    v_cvt_pk_bf16_f32 v65, v66, v67
    v_cvt_pk_bf16_f32 v66, v68, v69
    v_cvt_pk_bf16_f32 v67, v70, v71
    ds_write_b128 v13, v[64:67] offset:8192
    v_mfma_f32_16x16x32_bf16 v[104:107], v[28:31], v[120:123], v[104:107]
    ds_read_b64_tr_b16 v[24:25], v12 offset:0
    v_mfma_f32_16x16x32_bf16 v[108:111], v[28:31], v[124:127], v[108:111]
    ds_read_b64_tr_b16 v[26:27], v12 offset:4608
    s_waitcnt lgkmcnt(8)
    v_mfma_f32_16x16x32_bf16 v[40:43], v[32:35], v[112:115], 0
    ds_read_b64_tr_b16 v[28:29], v12 offset:9216
    v_mfma_f32_16x16x32_bf16 v[44:47], v[32:35], v[116:119], 0
    ds_read_b64_tr_b16 v[30:31], v12 offset:13824
    v_mfma_f32_16x16x32_bf16 v[40:43], v[36:39], v[120:123], v[40:43]
    s_barrier
    ds_read_b64_tr_b16 v[32:33], v4 offset:18432
    v_mfma_f32_16x16x32_bf16 v[44:47], v[36:39], v[124:127], v[44:47]
    ds_read_b64_tr_b16 v[34:35], v4 offset:23040
    s_waitcnt lgkmcnt(7)
    v_mfma_f32_16x16x32_bf16 v[48:51], v[16:19], v[112:115], 0
    ds_read_b64_tr_b16 v[36:37], v4 offset:18440
    v_mfma_f32_16x16x32_bf16 v[52:55], v[16:19], v[116:119], 0
    ds_read_b64_tr_b16 v[38:39], v4 offset:23048
    v_mfma_f32_16x16x32_bf16 v[48:51], v[20:23], v[120:123], v[48:51]
    ds_read_b64_tr_b16 v[16:17], v4 offset:18448
    v_mfma_f32_16x16x32_bf16 v[52:55], v[20:23], v[124:127], v[52:55]
    ds_read_b64_tr_b16 v[18:19], v4 offset:23056
    s_waitcnt lgkmcnt(6)
    v_mfma_f32_16x16x32_bf16 v[56:59], v[24:27], v[112:115], 0
    ds_read_b64_tr_b16 v[20:21], v4 offset:18456
    v_mfma_f32_16x16x32_bf16 v[60:63], v[24:27], v[116:119], 0
    ds_read_b64_tr_b16 v[22:23], v4 offset:23064
    v_mfma_f32_16x16x32_bf16 v[56:59], v[28:31], v[120:123], v[56:59]
    ds_read_b64_tr_b16 v[24:25], v4 offset:18464
    v_mfma_f32_16x16x32_bf16 v[60:63], v[28:31], v[124:127], v[60:63]
    ds_read_b64_tr_b16 v[26:27], v4 offset:23072
    s_waitcnt lgkmcnt(6)
    v_mfma_f32_16x16x32_bf16 v[72:75], v[32:35], v[128:131], v[72:75]
    ds_read_b64_tr_b16 v[28:29], v5 offset:18624
    v_mfma_f32_16x16x32_bf16 v[76:79], v[32:35], v[132:135], v[76:79]
    ds_read_b64_tr_b16 v[30:31], v5 offset:23232
    v_mfma_f32_16x16x32_bf16 v[80:83], v[36:39], v[128:131], v[80:83]
    ds_read_b64_tr_b16 v[32:33], v5 offset:18672
    v_mfma_f32_16x16x32_bf16 v[84:87], v[36:39], v[132:135], v[84:87]
    ds_read_b64_tr_b16 v[34:35], v5 offset:23280
    s_waitcnt lgkmcnt(6)
    v_mfma_f32_16x16x32_bf16 v[88:91], v[16:19], v[128:131], v[88:91]
    ds_read_b64_tr_b16 v[36:37], v12 offset:18432
    v_mfma_f32_16x16x32_bf16 v[92:95], v[16:19], v[132:135], v[92:95]
    ds_read_b64_tr_b16 v[38:39], v12 offset:23040
    v_mfma_f32_16x16x32_bf16 v[96:99], v[20:23], v[128:131], v[96:99]
    ds_read_b64_tr_b16 v[16:17], v4 offset:27648
    v_mfma_f32_16x16x32_bf16 v[100:103], v[20:23], v[132:135], v[100:103]
    ds_read_b64_tr_b16 v[18:19], v4 offset:32256
    s_waitcnt lgkmcnt(6)
    v_mfma_f32_16x16x32_bf16 v[104:107], v[24:27], v[128:131], v[104:107]
    ds_read_b64_tr_b16 v[20:21], v4 offset:27656
    v_mfma_f32_16x16x32_bf16 v[108:111], v[24:27], v[132:135], v[108:111]
    ds_read_b64_tr_b16 v[22:23], v4 offset:32264
    v_mfma_f32_16x16x32_bf16 v[40:43], v[28:31], v[128:131], v[40:43]
    ds_read_b64_tr_b16 v[24:25], v4 offset:27664
    v_mfma_f32_16x16x32_bf16 v[44:47], v[28:31], v[132:135], v[44:47]
    ds_read_b64_tr_b16 v[26:27], v4 offset:32272
    s_waitcnt lgkmcnt(6)
    v_mfma_f32_16x16x32_bf16 v[48:51], v[32:35], v[128:131], v[48:51]
    ds_read_b64_tr_b16 v[28:29], v4 offset:27672
    v_mfma_f32_16x16x32_bf16 v[52:55], v[32:35], v[132:135], v[52:55]
    ds_read_b64_tr_b16 v[30:31], v4 offset:32280
    v_mfma_f32_16x16x32_bf16 v[56:59], v[36:39], v[128:131], v[56:59]
    ds_read_b64_tr_b16 v[32:33], v4 offset:27680
    v_mfma_f32_16x16x32_bf16 v[60:63], v[36:39], v[132:135], v[60:63]
    ds_read_b64_tr_b16 v[34:35], v4 offset:32288
    s_waitcnt lgkmcnt(6)
    v_mfma_f32_16x16x32_bf16 v[72:75], v[16:19], v[136:139], v[72:75]
    ds_read_b64_tr_b16 v[36:37], v5 offset:27840
    v_mfma_f32_16x16x32_bf16 v[76:79], v[16:19], v[140:143], v[76:79]
    ds_read_b64_tr_b16 v[38:39], v5 offset:32448
    v_mfma_f32_16x16x32_bf16 v[80:83], v[20:23], v[136:139], v[80:83]
    ds_read_b64_tr_b16 v[16:17], v5 offset:27888
    v_mfma_f32_16x16x32_bf16 v[84:87], v[20:23], v[140:143], v[84:87]
    ds_read_b64_tr_b16 v[18:19], v5 offset:32496
    s_waitcnt lgkmcnt(6)
    v_mfma_f32_16x16x32_bf16 v[88:91], v[24:27], v[136:139], v[88:91]
    ds_read_b64_tr_b16 v[20:21], v12 offset:27648
    v_mfma_f32_16x16x32_bf16 v[92:95], v[24:27], v[140:143], v[92:95]
    ds_read_b64_tr_b16 v[22:23], v12 offset:32256
    v_mfma_f32_16x16x32_bf16 v[96:99], v[28:31], v[136:139], v[96:99]
    s_barrier
    v_subrev_u32 v4, 55296, v4
    v_subrev_u32 v5, 55296, v5
    v_subrev_u32 v12, 55296, v12
    ds_read_b64_tr_b16 v[24:25], v4 offset:0
    v_mfma_f32_16x16x32_bf16 v[100:103], v[28:31], v[140:143], v[100:103]
    ds_read_b64_tr_b16 v[26:27], v4 offset:4608
    s_waitcnt lgkmcnt(6)
    v_mfma_f32_16x16x32_bf16 v[104:107], v[32:35], v[136:139], v[104:107]
    ds_read_b64_tr_b16 v[28:29], v4 offset:8
    v_mfma_f32_16x16x32_bf16 v[108:111], v[32:35], v[140:143], v[108:111]
    ds_read_b64_tr_b16 v[30:31], v4 offset:4616
    v_mfma_f32_16x16x32_bf16 v[40:43], v[36:39], v[136:139], v[40:43]
    ds_read_b64_tr_b16 v[32:33], v4 offset:16
    v_mfma_f32_16x16x32_bf16 v[44:47], v[36:39], v[140:143], v[44:47]
    ds_read_b64_tr_b16 v[34:35], v4 offset:4624
    s_waitcnt lgkmcnt(6)
    v_mfma_f32_16x16x32_bf16 v[48:51], v[16:19], v[136:139], v[48:51]
    ds_read_b64_tr_b16 v[36:37], v4 offset:24
    v_mfma_f32_16x16x32_bf16 v[52:55], v[16:19], v[140:143], v[52:55]
    ds_read_b64_tr_b16 v[38:39], v4 offset:4632
    v_mfma_f32_16x16x32_bf16 v[56:59], v[20:23], v[136:139], v[56:59]
    ds_read_b64_tr_b16 v[16:17], v4 offset:32
    v_mfma_f32_16x16x32_bf16 v[60:63], v[20:23], v[140:143], v[60:63]
    ds_read_b64_tr_b16 v[18:19], v4 offset:4640
    s_waitcnt lgkmcnt(6)
    v_mfma_f32_16x16x32_bf16 v[72:75], v[24:27], v[144:147], v[72:75]
    ds_read_b64_tr_b16 v[20:21], v5 offset:192
    v_mfma_f32_16x16x32_bf16 v[76:79], v[24:27], v[148:151], v[76:79]
    ds_read_b64_tr_b16 v[22:23], v5 offset:4800
    v_mfma_f32_16x16x32_bf16 v[80:83], v[28:31], v[144:147], v[80:83]
    ds_read_b64_tr_b16 v[24:25], v5 offset:240
    v_mfma_f32_16x16x32_bf16 v[84:87], v[28:31], v[148:151], v[84:87]
    ds_read_b64_tr_b16 v[26:27], v5 offset:4848
    s_waitcnt lgkmcnt(6)
    v_mfma_f32_16x16x32_bf16 v[88:91], v[32:35], v[144:147], v[88:91]
    ds_read_b64_tr_b16 v[28:29], v12 offset:0
    v_mfma_f32_16x16x32_bf16 v[92:95], v[32:35], v[148:151], v[92:95]
    ds_read_b64_tr_b16 v[30:31], v12 offset:4608
    v_mfma_f32_16x16x32_bf16 v[96:99], v[36:39], v[144:147], v[96:99]
    ds_read_b64_tr_b16 v[32:33], v4 offset:9216
    v_mfma_f32_16x16x32_bf16 v[100:103], v[36:39], v[148:151], v[100:103]
    ds_read_b64_tr_b16 v[34:35], v4 offset:13824
    s_waitcnt lgkmcnt(6)
    v_mfma_f32_16x16x32_bf16 v[104:107], v[16:19], v[144:147], v[104:107]
    ds_read_b64_tr_b16 v[36:37], v4 offset:9224
    v_mfma_f32_16x16x32_bf16 v[108:111], v[16:19], v[148:151], v[108:111]
    ds_read_b64_tr_b16 v[38:39], v4 offset:13832
    v_mfma_f32_16x16x32_bf16 v[40:43], v[20:23], v[144:147], v[40:43]
    ds_read_b64_tr_b16 v[16:17], v4 offset:9232
    v_mfma_f32_16x16x32_bf16 v[44:47], v[20:23], v[148:151], v[44:47]
    ds_read_b64_tr_b16 v[18:19], v4 offset:13840
    s_waitcnt lgkmcnt(6)
    v_mfma_f32_16x16x32_bf16 v[48:51], v[24:27], v[144:147], v[48:51]
    ds_read_b64_tr_b16 v[20:21], v4 offset:9240
    v_mfma_f32_16x16x32_bf16 v[52:55], v[24:27], v[148:151], v[52:55]
    ds_read_b64_tr_b16 v[22:23], v4 offset:13848
    v_mfma_f32_16x16x32_bf16 v[56:59], v[28:31], v[144:147], v[56:59]
    ds_read_b64_tr_b16 v[24:25], v4 offset:9248
    v_mfma_f32_16x16x32_bf16 v[60:63], v[28:31], v[148:151], v[60:63]
    ds_read_b64_tr_b16 v[26:27], v4 offset:13856
    s_waitcnt lgkmcnt(6)
    v_mfma_f32_16x16x32_bf16 v[72:75], v[32:35], v[152:155], v[72:75]
    ds_read_b64_tr_b16 v[28:29], v5 offset:9408
    v_mfma_f32_16x16x32_bf16 v[76:79], v[32:35], v[156:159], v[76:79]
    ds_read_b64_tr_b16 v[30:31], v5 offset:14016
    v_mfma_f32_16x16x32_bf16 v[80:83], v[36:39], v[152:155], v[80:83]
    ds_read_b64_tr_b16 v[32:33], v5 offset:9456
    v_mfma_f32_16x16x32_bf16 v[84:87], v[36:39], v[156:159], v[84:87]
    ds_read_b64_tr_b16 v[34:35], v5 offset:14064
    s_waitcnt lgkmcnt(6)
    v_mfma_f32_16x16x32_bf16 v[88:91], v[16:19], v[152:155], v[88:91]
    ds_read_b64_tr_b16 v[36:37], v12 offset:9216
    v_mfma_f32_16x16x32_bf16 v[92:95], v[16:19], v[156:159], v[92:95]
    ds_read_b64_tr_b16 v[38:39], v12 offset:13824
    v_mfma_f32_16x16x32_bf16 v[96:99], v[20:23], v[152:155], v[96:99]
    s_barrier
    ds_read_b64_tr_b16 v[16:17], v4 offset:18432
    v_mfma_f32_16x16x32_bf16 v[100:103], v[20:23], v[156:159], v[100:103]
    ds_read_b64_tr_b16 v[18:19], v4 offset:23040
    s_waitcnt lgkmcnt(6)
    v_mfma_f32_16x16x32_bf16 v[104:107], v[24:27], v[152:155], v[104:107]
    ds_read_b64_tr_b16 v[20:21], v4 offset:18440
    v_mfma_f32_16x16x32_bf16 v[108:111], v[24:27], v[156:159], v[108:111]
    ds_read_b64_tr_b16 v[22:23], v4 offset:23048
    v_mfma_f32_16x16x32_bf16 v[40:43], v[28:31], v[152:155], v[40:43]
    ds_read_b64_tr_b16 v[24:25], v4 offset:18448
    v_mfma_f32_16x16x32_bf16 v[44:47], v[28:31], v[156:159], v[44:47]
    ds_read_b64_tr_b16 v[26:27], v4 offset:23056
    s_waitcnt lgkmcnt(6)
    v_mfma_f32_16x16x32_bf16 v[48:51], v[32:35], v[152:155], v[48:51]
    ds_read_b64_tr_b16 v[28:29], v4 offset:18456
    v_mfma_f32_16x16x32_bf16 v[52:55], v[32:35], v[156:159], v[52:55]
    ds_read_b64_tr_b16 v[30:31], v4 offset:23064
    v_mfma_f32_16x16x32_bf16 v[56:59], v[36:39], v[152:155], v[56:59]
    ds_read_b64_tr_b16 v[32:33], v4 offset:18464
    v_mfma_f32_16x16x32_bf16 v[60:63], v[36:39], v[156:159], v[60:63]
    ds_read_b64_tr_b16 v[34:35], v4 offset:23072
    s_waitcnt lgkmcnt(6)
    v_mfma_f32_16x16x32_bf16 v[72:75], v[16:19], v[160:163], v[72:75]
    ds_read_b64_tr_b16 v[36:37], v5 offset:18624
    v_mfma_f32_16x16x32_bf16 v[76:79], v[16:19], v[164:167], v[76:79]
    ds_read_b64_tr_b16 v[38:39], v5 offset:23232
    v_mfma_f32_16x16x32_bf16 v[80:83], v[20:23], v[160:163], v[80:83]
    ds_read_b64_tr_b16 v[16:17], v5 offset:18672
    v_mfma_f32_16x16x32_bf16 v[84:87], v[20:23], v[164:167], v[84:87]
    ds_read_b64_tr_b16 v[18:19], v5 offset:23280
    s_waitcnt lgkmcnt(6)
    v_mfma_f32_16x16x32_bf16 v[88:91], v[24:27], v[160:163], v[88:91]
    ds_read_b64_tr_b16 v[20:21], v12 offset:18432
    v_mfma_f32_16x16x32_bf16 v[92:95], v[24:27], v[164:167], v[92:95]
    ds_read_b64_tr_b16 v[22:23], v12 offset:23040
    v_mfma_f32_16x16x32_bf16 v[96:99], v[28:31], v[160:163], v[96:99]
    ds_read_b64_tr_b16 v[24:25], v4 offset:27648
    v_mfma_f32_16x16x32_bf16 v[100:103], v[28:31], v[164:167], v[100:103]
    ds_read_b64_tr_b16 v[26:27], v4 offset:32256
    s_waitcnt lgkmcnt(6)
    v_mfma_f32_16x16x32_bf16 v[104:107], v[32:35], v[160:163], v[104:107]
    ds_read_b64_tr_b16 v[28:29], v4 offset:27656
    v_mfma_f32_16x16x32_bf16 v[108:111], v[32:35], v[164:167], v[108:111]
    ds_read_b64_tr_b16 v[30:31], v4 offset:32264
    v_mfma_f32_16x16x32_bf16 v[40:43], v[36:39], v[160:163], v[40:43]
    ds_read_b64_tr_b16 v[32:33], v4 offset:27664
    v_mfma_f32_16x16x32_bf16 v[44:47], v[36:39], v[164:167], v[44:47]
    ds_read_b64_tr_b16 v[34:35], v4 offset:32272
    s_waitcnt lgkmcnt(6)
    v_mfma_f32_16x16x32_bf16 v[48:51], v[16:19], v[160:163], v[48:51]
    ds_read_b64_tr_b16 v[36:37], v4 offset:27672
    v_mfma_f32_16x16x32_bf16 v[52:55], v[16:19], v[164:167], v[52:55]
    ds_read_b64_tr_b16 v[38:39], v4 offset:32280
    v_mfma_f32_16x16x32_bf16 v[56:59], v[20:23], v[160:163], v[56:59]
    ds_read_b64_tr_b16 v[16:17], v4 offset:27680
    v_mfma_f32_16x16x32_bf16 v[60:63], v[20:23], v[164:167], v[60:63]
    ds_read_b64_tr_b16 v[18:19], v4 offset:32288
    s_waitcnt lgkmcnt(6)
    v_mfma_f32_16x16x32_bf16 v[72:75], v[24:27], v[168:171], v[72:75]
    ds_read_b64_tr_b16 v[20:21], v5 offset:27840
    v_mfma_f32_16x16x32_bf16 v[76:79], v[24:27], v[172:175], v[76:79]
    ds_read_b64_tr_b16 v[22:23], v5 offset:32448
    v_mfma_f32_16x16x32_bf16 v[80:83], v[28:31], v[168:171], v[80:83]
    ds_read_b64_tr_b16 v[24:25], v5 offset:27888
    v_mfma_f32_16x16x32_bf16 v[84:87], v[28:31], v[172:175], v[84:87]
    ds_read_b64_tr_b16 v[26:27], v5 offset:32496
    s_waitcnt lgkmcnt(6)
    v_mfma_f32_16x16x32_bf16 v[88:91], v[32:35], v[168:171], v[88:91]
    ds_read_b64_tr_b16 v[28:29], v12 offset:27648
    v_mfma_f32_16x16x32_bf16 v[92:95], v[32:35], v[172:175], v[92:95]
    ds_read_b64_tr_b16 v[30:31], v12 offset:32256
    v_mfma_f32_16x16x32_bf16 v[96:99], v[36:39], v[168:171], v[96:99]
    s_barrier
    ds_read_b64_tr_b16 v[32:33], v4 offset:36864
    v_mfma_f32_16x16x32_bf16 v[100:103], v[36:39], v[172:175], v[100:103]
    ds_read_b64_tr_b16 v[34:35], v4 offset:41472
    s_waitcnt lgkmcnt(6)
    v_mfma_f32_16x16x32_bf16 v[104:107], v[16:19], v[168:171], v[104:107]
    ds_read_b64_tr_b16 v[36:37], v4 offset:36872
    v_mfma_f32_16x16x32_bf16 v[108:111], v[16:19], v[172:175], v[108:111]
    ds_read_b64_tr_b16 v[38:39], v4 offset:41480
    v_mfma_f32_16x16x32_bf16 v[40:43], v[20:23], v[168:171], v[40:43]
    ds_read_b64_tr_b16 v[16:17], v4 offset:36880
    v_mfma_f32_16x16x32_bf16 v[44:47], v[20:23], v[172:175], v[44:47]
    ds_read_b64_tr_b16 v[18:19], v4 offset:41488
    s_waitcnt lgkmcnt(6)
    v_mfma_f32_16x16x32_bf16 v[48:51], v[24:27], v[168:171], v[48:51]
    ds_read_b64_tr_b16 v[20:21], v4 offset:36888
    v_mfma_f32_16x16x32_bf16 v[52:55], v[24:27], v[172:175], v[52:55]
    ds_read_b64_tr_b16 v[22:23], v4 offset:41496
    v_mfma_f32_16x16x32_bf16 v[56:59], v[28:31], v[168:171], v[56:59]
    ds_read_b64_tr_b16 v[24:25], v4 offset:36896
    v_mfma_f32_16x16x32_bf16 v[60:63], v[28:31], v[172:175], v[60:63]
    ds_read_b64_tr_b16 v[26:27], v4 offset:41504
    s_waitcnt lgkmcnt(6)
    v_mfma_f32_16x16x32_bf16 v[72:75], v[32:35], v[176:179], v[72:75]
    ds_read_b64_tr_b16 v[28:29], v5 offset:37056
    v_mfma_f32_16x16x32_bf16 v[76:79], v[32:35], v[180:183], v[76:79]
    ds_read_b64_tr_b16 v[30:31], v5 offset:41664
    v_mfma_f32_16x16x32_bf16 v[80:83], v[36:39], v[176:179], v[80:83]
    ds_read_b64_tr_b16 v[32:33], v5 offset:37104
    v_mfma_f32_16x16x32_bf16 v[84:87], v[36:39], v[180:183], v[84:87]
    ds_read_b64_tr_b16 v[34:35], v5 offset:41712
    s_waitcnt lgkmcnt(6)
    v_mfma_f32_16x16x32_bf16 v[88:91], v[16:19], v[176:179], v[88:91]
    ds_read_b64_tr_b16 v[36:37], v12 offset:36864
    v_mfma_f32_16x16x32_bf16 v[92:95], v[16:19], v[180:183], v[92:95]
    ds_read_b64_tr_b16 v[38:39], v12 offset:41472
    v_mfma_f32_16x16x32_bf16 v[96:99], v[20:23], v[176:179], v[96:99]
    ds_read_b64_tr_b16 v[16:17], v4 offset:46080
    v_mfma_f32_16x16x32_bf16 v[100:103], v[20:23], v[180:183], v[100:103]
    ds_read_b64_tr_b16 v[18:19], v4 offset:50688
    s_waitcnt lgkmcnt(6)
    v_mfma_f32_16x16x32_bf16 v[104:107], v[24:27], v[176:179], v[104:107]
    ds_read_b64_tr_b16 v[20:21], v4 offset:46088
    v_mfma_f32_16x16x32_bf16 v[108:111], v[24:27], v[180:183], v[108:111]
    ds_read_b64_tr_b16 v[22:23], v4 offset:50696
    v_mfma_f32_16x16x32_bf16 v[40:43], v[28:31], v[176:179], v[40:43]
    ds_read_b64_tr_b16 v[24:25], v4 offset:46096
    v_mfma_f32_16x16x32_bf16 v[44:47], v[28:31], v[180:183], v[44:47]
    ds_read_b64_tr_b16 v[26:27], v4 offset:50704
    s_waitcnt lgkmcnt(6)
    v_mfma_f32_16x16x32_bf16 v[48:51], v[32:35], v[176:179], v[48:51]
    ds_read_b64_tr_b16 v[28:29], v4 offset:46104
    v_mfma_f32_16x16x32_bf16 v[52:55], v[32:35], v[180:183], v[52:55]
    ds_read_b64_tr_b16 v[30:31], v4 offset:50712
    v_mfma_f32_16x16x32_bf16 v[56:59], v[36:39], v[176:179], v[56:59]
    ds_read_b64_tr_b16 v[32:33], v4 offset:46112
    v_mfma_f32_16x16x32_bf16 v[60:63], v[36:39], v[180:183], v[60:63]
    ds_read_b64_tr_b16 v[34:35], v4 offset:50720
    s_waitcnt lgkmcnt(6)
    v_mfma_f32_16x16x32_bf16 v[72:75], v[16:19], v[184:187], v[72:75]
    ds_read_b64_tr_b16 v[36:37], v5 offset:46272
    v_mfma_f32_16x16x32_bf16 v[76:79], v[16:19], v[188:191], v[76:79]
    ds_read_b64_tr_b16 v[38:39], v5 offset:50880
    v_mfma_f32_16x16x32_bf16 v[80:83], v[20:23], v[184:187], v[80:83]
    ds_read_b64_tr_b16 v[16:17], v5 offset:46320
    v_mfma_f32_16x16x32_bf16 v[84:87], v[20:23], v[188:191], v[84:87]
    ds_read_b64_tr_b16 v[18:19], v5 offset:50928
    s_waitcnt lgkmcnt(6)
    v_mfma_f32_16x16x32_bf16 v[88:91], v[24:27], v[184:187], v[88:91]
    ds_read_b64_tr_b16 v[20:21], v12 offset:46080
    v_mfma_f32_16x16x32_bf16 v[92:95], v[24:27], v[188:191], v[92:95]
    ds_read_b64_tr_b16 v[22:23], v12 offset:50688
    v_mfma_f32_16x16x32_bf16 v[96:99], v[28:31], v[184:187], v[96:99]
    s_barrier
    ds_read_b64_tr_b16 v[24:25], v4 offset:55296
    v_mfma_f32_16x16x32_bf16 v[100:103], v[28:31], v[188:191], v[100:103]
    ds_read_b64_tr_b16 v[26:27], v4 offset:59904
    s_waitcnt lgkmcnt(6)
    v_mfma_f32_16x16x32_bf16 v[104:107], v[32:35], v[184:187], v[104:107]
    ds_read_b64_tr_b16 v[28:29], v4 offset:55304
    v_mfma_f32_16x16x32_bf16 v[108:111], v[32:35], v[188:191], v[108:111]
    ds_read_b64_tr_b16 v[30:31], v4 offset:59912
    v_mfma_f32_16x16x32_bf16 v[40:43], v[36:39], v[184:187], v[40:43]
    ds_read_b64_tr_b16 v[32:33], v4 offset:55312
    v_mfma_f32_16x16x32_bf16 v[44:47], v[36:39], v[188:191], v[44:47]
    ds_read_b64_tr_b16 v[34:35], v4 offset:59920
    s_waitcnt lgkmcnt(6)
    v_mfma_f32_16x16x32_bf16 v[48:51], v[16:19], v[184:187], v[48:51]
    ds_read_b64_tr_b16 v[36:37], v4 offset:55320
    v_mfma_f32_16x16x32_bf16 v[52:55], v[16:19], v[188:191], v[52:55]
    ds_read_b64_tr_b16 v[38:39], v4 offset:59928
    v_mfma_f32_16x16x32_bf16 v[56:59], v[20:23], v[184:187], v[56:59]
    ds_read_b64_tr_b16 v[16:17], v4 offset:55328
    v_mfma_f32_16x16x32_bf16 v[60:63], v[20:23], v[188:191], v[60:63]
    ds_read_b64_tr_b16 v[18:19], v4 offset:59936
    s_waitcnt lgkmcnt(6)
    v_mfma_f32_16x16x32_bf16 v[72:75], v[24:27], v[192:195], v[72:75]
    ds_read_b64_tr_b16 v[20:21], v5 offset:55488
    v_mfma_f32_16x16x32_bf16 v[76:79], v[24:27], v[196:199], v[76:79]
    ds_read_b64_tr_b16 v[22:23], v5 offset:60096
    v_mfma_f32_16x16x32_bf16 v[80:83], v[28:31], v[192:195], v[80:83]
    ds_read_b64_tr_b16 v[24:25], v5 offset:55536
    v_mfma_f32_16x16x32_bf16 v[84:87], v[28:31], v[196:199], v[84:87]
    ds_read_b64_tr_b16 v[26:27], v5 offset:60144
    s_waitcnt lgkmcnt(6)
    v_mfma_f32_16x16x32_bf16 v[88:91], v[32:35], v[192:195], v[88:91]
    ds_read_b64_tr_b16 v[28:29], v12 offset:55296
    v_mfma_f32_16x16x32_bf16 v[92:95], v[32:35], v[196:199], v[92:95]
    ds_read_b64_tr_b16 v[30:31], v12 offset:59904
    v_mfma_f32_16x16x32_bf16 v[96:99], v[36:39], v[192:195], v[96:99]
    ds_read_b64_tr_b16 v[32:33], v4 offset:64512
    v_mfma_f32_16x16x32_bf16 v[100:103], v[36:39], v[196:199], v[100:103]
    v_add_u32 v4, 55296, v4
    v_add_u32 v5, 55296, v5
    v_add_u32 v12, 55296, v12
    ds_read_b64_tr_b16 v[34:35], v4 offset:13824
    s_waitcnt lgkmcnt(6)
    v_mfma_f32_16x16x32_bf16 v[104:107], v[16:19], v[192:195], v[104:107]
    ds_read_b64_tr_b16 v[36:37], v4 offset:9224
    v_mfma_f32_16x16x32_bf16 v[108:111], v[16:19], v[196:199], v[108:111]
    ds_read_b64_tr_b16 v[38:39], v4 offset:13832
    v_mfma_f32_16x16x32_bf16 v[40:43], v[20:23], v[192:195], v[40:43]
    ds_read_b64_tr_b16 v[16:17], v4 offset:9232
    v_mfma_f32_16x16x32_bf16 v[44:47], v[20:23], v[196:199], v[44:47]
    ds_read_b64_tr_b16 v[18:19], v4 offset:13840
    s_waitcnt lgkmcnt(6)
    v_mfma_f32_16x16x32_bf16 v[48:51], v[24:27], v[192:195], v[48:51]
    ds_read_b64_tr_b16 v[20:21], v4 offset:9240
    v_mfma_f32_16x16x32_bf16 v[52:55], v[24:27], v[196:199], v[52:55]
    ds_read_b64_tr_b16 v[22:23], v4 offset:13848
    v_mfma_f32_16x16x32_bf16 v[56:59], v[28:31], v[192:195], v[56:59]
    ds_read_b64_tr_b16 v[24:25], v4 offset:9248
    v_mfma_f32_16x16x32_bf16 v[60:63], v[28:31], v[196:199], v[60:63]
    ds_read_b64_tr_b16 v[26:27], v4 offset:13856
    s_waitcnt lgkmcnt(6)
    v_mfma_f32_16x16x32_bf16 v[72:75], v[32:35], v[200:203], v[72:75]
    ds_read_b64_tr_b16 v[28:29], v5 offset:9408
    v_mfma_f32_16x16x32_bf16 v[76:79], v[32:35], v[204:207], v[76:79]
    ds_read_b64_tr_b16 v[30:31], v5 offset:14016
    v_mfma_f32_16x16x32_bf16 v[80:83], v[36:39], v[200:203], v[80:83]
    ds_read_b64_tr_b16 v[32:33], v5 offset:9456
    v_mfma_f32_16x16x32_bf16 v[84:87], v[36:39], v[204:207], v[84:87]
    ds_read_b64_tr_b16 v[34:35], v5 offset:14064
    s_waitcnt lgkmcnt(6)
    v_mfma_f32_16x16x32_bf16 v[88:91], v[16:19], v[200:203], v[88:91]
    ds_read_b64_tr_b16 v[36:37], v12 offset:9216
    v_mfma_f32_16x16x32_bf16 v[92:95], v[16:19], v[204:207], v[92:95]
    ds_read_b64_tr_b16 v[38:39], v12 offset:13824
    v_mfma_f32_16x16x32_bf16 v[96:99], v[20:23], v[200:203], v[96:99]
    s_barrier
    ds_read_b64_tr_b16 v[16:17], v4 offset:18432
    v_mfma_f32_16x16x32_bf16 v[100:103], v[20:23], v[204:207], v[100:103]
    ds_read_b64_tr_b16 v[18:19], v4 offset:23040
    s_waitcnt lgkmcnt(6)
    v_mfma_f32_16x16x32_bf16 v[104:107], v[24:27], v[200:203], v[104:107]
    ds_read_b64_tr_b16 v[20:21], v4 offset:18440
    v_mfma_f32_16x16x32_bf16 v[108:111], v[24:27], v[204:207], v[108:111]
    ds_read_b64_tr_b16 v[22:23], v4 offset:23048
    v_mfma_f32_16x16x32_bf16 v[40:43], v[28:31], v[200:203], v[40:43]
    ds_read_b64_tr_b16 v[24:25], v4 offset:18448
    v_mfma_f32_16x16x32_bf16 v[44:47], v[28:31], v[204:207], v[44:47]
    ds_read_b64_tr_b16 v[26:27], v4 offset:23056
    s_waitcnt lgkmcnt(6)
    v_mfma_f32_16x16x32_bf16 v[48:51], v[32:35], v[200:203], v[48:51]
    ds_read_b64_tr_b16 v[28:29], v4 offset:18456
    v_mfma_f32_16x16x32_bf16 v[52:55], v[32:35], v[204:207], v[52:55]
    ds_read_b64_tr_b16 v[30:31], v4 offset:23064
    v_mfma_f32_16x16x32_bf16 v[56:59], v[36:39], v[200:203], v[56:59]
    ds_read_b64_tr_b16 v[32:33], v4 offset:18464
    v_mfma_f32_16x16x32_bf16 v[60:63], v[36:39], v[204:207], v[60:63]
    ds_read_b64_tr_b16 v[34:35], v4 offset:23072
    s_waitcnt lgkmcnt(6)
    v_mfma_f32_16x16x32_bf16 v[72:75], v[16:19], v[208:211], v[72:75]
    ds_read_b64_tr_b16 v[36:37], v5 offset:18624
    v_mfma_f32_16x16x32_bf16 v[76:79], v[16:19], v[212:215], v[76:79]
    ds_read_b64_tr_b16 v[38:39], v5 offset:23232
    v_mfma_f32_16x16x32_bf16 v[80:83], v[20:23], v[208:211], v[80:83]
    ds_read_b64_tr_b16 v[16:17], v5 offset:18672
    v_mfma_f32_16x16x32_bf16 v[84:87], v[20:23], v[212:215], v[84:87]
    ds_read_b64_tr_b16 v[18:19], v5 offset:23280
    s_waitcnt lgkmcnt(6)
    v_mfma_f32_16x16x32_bf16 v[88:91], v[24:27], v[208:211], v[88:91]
    ds_read_b64_tr_b16 v[20:21], v12 offset:18432
    v_mfma_f32_16x16x32_bf16 v[92:95], v[24:27], v[212:215], v[92:95]
    ds_read_b64_tr_b16 v[22:23], v12 offset:23040
    v_mfma_f32_16x16x32_bf16 v[96:99], v[28:31], v[208:211], v[96:99]
    ds_read_b64_tr_b16 v[24:25], v4 offset:27648
    v_mfma_f32_16x16x32_bf16 v[100:103], v[28:31], v[212:215], v[100:103]
    ds_read_b64_tr_b16 v[26:27], v4 offset:32256
    s_waitcnt lgkmcnt(6)
    v_mfma_f32_16x16x32_bf16 v[104:107], v[32:35], v[208:211], v[104:107]
    ds_read_b64_tr_b16 v[28:29], v4 offset:27656
    v_mfma_f32_16x16x32_bf16 v[108:111], v[32:35], v[212:215], v[108:111]
    ds_read_b64_tr_b16 v[30:31], v4 offset:32264
    v_mfma_f32_16x16x32_bf16 v[40:43], v[36:39], v[208:211], v[40:43]
    ds_read_b64_tr_b16 v[32:33], v4 offset:27664
    v_mfma_f32_16x16x32_bf16 v[44:47], v[36:39], v[212:215], v[44:47]
    ds_read_b64_tr_b16 v[34:35], v4 offset:32272
    s_waitcnt lgkmcnt(6)
    v_mfma_f32_16x16x32_bf16 v[48:51], v[16:19], v[208:211], v[48:51]
    ds_read_b64_tr_b16 v[36:37], v4 offset:27672
    v_mfma_f32_16x16x32_bf16 v[52:55], v[16:19], v[212:215], v[52:55]
    ds_read_b64_tr_b16 v[38:39], v4 offset:32280
    v_mfma_f32_16x16x32_bf16 v[56:59], v[20:23], v[208:211], v[56:59]
    ds_read_b64_tr_b16 v[16:17], v4 offset:27680
    v_mfma_f32_16x16x32_bf16 v[60:63], v[20:23], v[212:215], v[60:63]
    ds_read_b64_tr_b16 v[18:19], v4 offset:32288
    s_waitcnt lgkmcnt(6)
    v_mfma_f32_16x16x32_bf16 v[72:75], v[24:27], v[216:219], v[72:75]
    ds_read_b64_tr_b16 v[20:21], v5 offset:27840
    v_mfma_f32_16x16x32_bf16 v[76:79], v[24:27], v[220:223], v[76:79]
    ds_read_b64_tr_b16 v[22:23], v5 offset:32448
    v_mfma_f32_16x16x32_bf16 v[80:83], v[28:31], v[216:219], v[80:83]
    ds_read_b64_tr_b16 v[24:25], v5 offset:27888
    v_mfma_f32_16x16x32_bf16 v[84:87], v[28:31], v[220:223], v[84:87]
    ds_read_b64_tr_b16 v[26:27], v5 offset:32496
    s_waitcnt lgkmcnt(6)
    v_mfma_f32_16x16x32_bf16 v[88:91], v[32:35], v[216:219], v[88:91]
    ds_read_b64_tr_b16 v[28:29], v12 offset:27648
    v_mfma_f32_16x16x32_bf16 v[92:95], v[32:35], v[220:223], v[92:95]
    ds_read_b64_tr_b16 v[30:31], v12 offset:32256
    v_mfma_f32_16x16x32_bf16 v[96:99], v[36:39], v[216:219], v[96:99]
    s_barrier
    v_subrev_u32 v4, 55296, v4
    v_subrev_u32 v5, 55296, v5
    v_subrev_u32 v12, 55296, v12
    ds_read_b64_tr_b16 v[32:33], v4 offset:0
    v_mfma_f32_16x16x32_bf16 v[100:103], v[36:39], v[220:223], v[100:103]
    ds_read_b64_tr_b16 v[34:35], v4 offset:4608
    s_waitcnt lgkmcnt(6)
    v_mfma_f32_16x16x32_bf16 v[104:107], v[16:19], v[216:219], v[104:107]
    ds_read_b64_tr_b16 v[36:37], v4 offset:8
    v_mfma_f32_16x16x32_bf16 v[108:111], v[16:19], v[220:223], v[108:111]
    ds_read_b64_tr_b16 v[38:39], v4 offset:4616
    v_mfma_f32_16x16x32_bf16 v[40:43], v[20:23], v[216:219], v[40:43]
    ds_read_b64_tr_b16 v[16:17], v4 offset:16
    v_mfma_f32_16x16x32_bf16 v[44:47], v[20:23], v[220:223], v[44:47]
    ds_read_b64_tr_b16 v[18:19], v4 offset:4624
    s_waitcnt lgkmcnt(6)
    v_mfma_f32_16x16x32_bf16 v[48:51], v[24:27], v[216:219], v[48:51]
    ds_read_b64_tr_b16 v[20:21], v4 offset:24
    v_mfma_f32_16x16x32_bf16 v[52:55], v[24:27], v[220:223], v[52:55]
    ds_read_b64_tr_b16 v[22:23], v4 offset:4632
    v_mfma_f32_16x16x32_bf16 v[56:59], v[28:31], v[216:219], v[56:59]
    ds_read_b64_tr_b16 v[24:25], v4 offset:32
    v_mfma_f32_16x16x32_bf16 v[60:63], v[28:31], v[220:223], v[60:63]
    ds_read_b64_tr_b16 v[26:27], v4 offset:4640
    s_waitcnt lgkmcnt(6)
    v_mfma_f32_16x16x32_bf16 v[72:75], v[32:35], v[224:227], v[72:75]
    ds_read_b64_tr_b16 v[28:29], v5 offset:192
    v_mfma_f32_16x16x32_bf16 v[76:79], v[32:35], v[228:231], v[76:79]
    ds_read_b64_tr_b16 v[30:31], v5 offset:4800
    v_mfma_f32_16x16x32_bf16 v[80:83], v[36:39], v[224:227], v[80:83]
    ds_read_b64_tr_b16 v[32:33], v5 offset:240
    v_mfma_f32_16x16x32_bf16 v[84:87], v[36:39], v[228:231], v[84:87]
    ds_read_b64_tr_b16 v[34:35], v5 offset:4848
    s_waitcnt lgkmcnt(6)
    v_mfma_f32_16x16x32_bf16 v[88:91], v[16:19], v[224:227], v[88:91]
    ds_read_b64_tr_b16 v[36:37], v12 offset:0
    v_mfma_f32_16x16x32_bf16 v[92:95], v[16:19], v[228:231], v[92:95]
    ds_read_b64_tr_b16 v[38:39], v12 offset:4608
    v_mfma_f32_16x16x32_bf16 v[96:99], v[20:23], v[224:227], v[96:99]
    ds_read_b64_tr_b16 v[16:17], v4 offset:9216
    v_mfma_f32_16x16x32_bf16 v[100:103], v[20:23], v[228:231], v[100:103]
    ds_read_b64_tr_b16 v[18:19], v4 offset:13824
    s_waitcnt lgkmcnt(6)
    v_mfma_f32_16x16x32_bf16 v[104:107], v[24:27], v[224:227], v[104:107]
    ds_read_b64_tr_b16 v[20:21], v4 offset:9224
    v_mfma_f32_16x16x32_bf16 v[108:111], v[24:27], v[228:231], v[108:111]
    ds_read_b64_tr_b16 v[22:23], v4 offset:13832
    v_mfma_f32_16x16x32_bf16 v[40:43], v[28:31], v[224:227], v[40:43]
    ds_read_b64_tr_b16 v[24:25], v4 offset:9232
    v_mfma_f32_16x16x32_bf16 v[44:47], v[28:31], v[228:231], v[44:47]
    ds_read_b64_tr_b16 v[26:27], v4 offset:13840
    s_waitcnt lgkmcnt(6)
    v_mfma_f32_16x16x32_bf16 v[48:51], v[32:35], v[224:227], v[48:51]
    ds_read_b64_tr_b16 v[28:29], v4 offset:9240
    v_mfma_f32_16x16x32_bf16 v[52:55], v[32:35], v[228:231], v[52:55]
    ds_read_b64_tr_b16 v[30:31], v4 offset:13848
    v_mfma_f32_16x16x32_bf16 v[56:59], v[36:39], v[224:227], v[56:59]
    ds_read_b64_tr_b16 v[32:33], v4 offset:9248
    v_mfma_f32_16x16x32_bf16 v[60:63], v[36:39], v[228:231], v[60:63]
    ds_read_b64_tr_b16 v[34:35], v4 offset:13856
    s_waitcnt lgkmcnt(6)
    v_mfma_f32_16x16x32_bf16 v[72:75], v[16:19], v[232:235], v[72:75]
    ds_read_b64_tr_b16 v[36:37], v5 offset:9408
    v_mfma_f32_16x16x32_bf16 v[76:79], v[16:19], v[236:239], v[76:79]
    ds_read_b64_tr_b16 v[38:39], v5 offset:14016
    v_mfma_f32_16x16x32_bf16 v[80:83], v[20:23], v[232:235], v[80:83]
    ds_read_b64_tr_b16 v[16:17], v5 offset:9456
    v_mfma_f32_16x16x32_bf16 v[84:87], v[20:23], v[236:239], v[84:87]
    ds_read_b64_tr_b16 v[18:19], v5 offset:14064
    s_waitcnt lgkmcnt(6)
    v_mfma_f32_16x16x32_bf16 v[88:91], v[24:27], v[232:235], v[88:91]
    ds_read_b64_tr_b16 v[20:21], v12 offset:9216
    v_mfma_f32_16x16x32_bf16 v[92:95], v[24:27], v[236:239], v[92:95]
    ds_read_b64_tr_b16 v[22:23], v12 offset:13824
    v_mfma_f32_16x16x32_bf16 v[96:99], v[28:31], v[232:235], v[96:99]
    s_barrier
    ds_read_b64_tr_b16 v[24:25], v4 offset:18432
    v_mfma_f32_16x16x32_bf16 v[100:103], v[28:31], v[236:239], v[100:103]
    ds_read_b64_tr_b16 v[26:27], v4 offset:23040
    s_waitcnt lgkmcnt(6)
    v_mfma_f32_16x16x32_bf16 v[104:107], v[32:35], v[232:235], v[104:107]
    ds_read_b64_tr_b16 v[28:29], v4 offset:18440
    v_mfma_f32_16x16x32_bf16 v[108:111], v[32:35], v[236:239], v[108:111]
    ds_read_b64_tr_b16 v[30:31], v4 offset:23048
    v_mfma_f32_16x16x32_bf16 v[40:43], v[36:39], v[232:235], v[40:43]
    ds_read_b64_tr_b16 v[32:33], v4 offset:18448
    v_mfma_f32_16x16x32_bf16 v[44:47], v[36:39], v[236:239], v[44:47]
    ds_read_b64_tr_b16 v[34:35], v4 offset:23056
    s_waitcnt lgkmcnt(6)
    v_mfma_f32_16x16x32_bf16 v[48:51], v[16:19], v[232:235], v[48:51]
    ds_read_b64_tr_b16 v[36:37], v4 offset:18456
    v_mfma_f32_16x16x32_bf16 v[52:55], v[16:19], v[236:239], v[52:55]
    ds_read_b64_tr_b16 v[38:39], v4 offset:23064
    v_mfma_f32_16x16x32_bf16 v[56:59], v[20:23], v[232:235], v[56:59]
    ds_read_b64_tr_b16 v[16:17], v4 offset:18464
    v_mfma_f32_16x16x32_bf16 v[60:63], v[20:23], v[236:239], v[60:63]
    ds_read_b64_tr_b16 v[18:19], v4 offset:23072
    s_waitcnt lgkmcnt(6)
    v_mfma_f32_16x16x32_bf16 v[72:75], v[24:27], v[240:243], v[72:75]
    ds_read_b64_tr_b16 v[20:21], v5 offset:18624
    v_mfma_f32_16x16x32_bf16 v[76:79], v[24:27], v[244:247], v[76:79]
    ds_read_b64_tr_b16 v[22:23], v5 offset:23232
    v_mfma_f32_16x16x32_bf16 v[80:83], v[28:31], v[240:243], v[80:83]
    ds_read_b64_tr_b16 v[24:25], v5 offset:18672
    v_mfma_f32_16x16x32_bf16 v[84:87], v[28:31], v[244:247], v[84:87]
    ds_read_b64_tr_b16 v[26:27], v5 offset:23280
    s_waitcnt lgkmcnt(6)
    v_mfma_f32_16x16x32_bf16 v[88:91], v[32:35], v[240:243], v[88:91]
    ds_read_b64_tr_b16 v[28:29], v12 offset:18432
    v_mfma_f32_16x16x32_bf16 v[92:95], v[32:35], v[244:247], v[92:95]
    ds_read_b64_tr_b16 v[30:31], v12 offset:23040
    v_mfma_f32_16x16x32_bf16 v[96:99], v[36:39], v[240:243], v[96:99]
    ds_read_b64_tr_b16 v[32:33], v4 offset:27648
    v_mfma_f32_16x16x32_bf16 v[100:103], v[36:39], v[244:247], v[100:103]
    ds_read_b64_tr_b16 v[34:35], v4 offset:32256
    s_waitcnt lgkmcnt(6)
    v_mfma_f32_16x16x32_bf16 v[104:107], v[16:19], v[240:243], v[104:107]
    ds_read_b64_tr_b16 v[36:37], v4 offset:27656
    v_mfma_f32_16x16x32_bf16 v[108:111], v[16:19], v[244:247], v[108:111]
    ds_read_b64_tr_b16 v[38:39], v4 offset:32264
    v_mfma_f32_16x16x32_bf16 v[40:43], v[20:23], v[240:243], v[40:43]
    ds_read_b64_tr_b16 v[16:17], v4 offset:27664
    v_mfma_f32_16x16x32_bf16 v[44:47], v[20:23], v[244:247], v[44:47]
    ds_read_b64_tr_b16 v[18:19], v4 offset:32272
    s_waitcnt lgkmcnt(6)
    v_mfma_f32_16x16x32_bf16 v[48:51], v[24:27], v[240:243], v[48:51]
    ds_read_b64_tr_b16 v[20:21], v4 offset:27672
    v_mfma_f32_16x16x32_bf16 v[52:55], v[24:27], v[244:247], v[52:55]
    ds_read_b64_tr_b16 v[22:23], v4 offset:32280
    v_mfma_f32_16x16x32_bf16 v[56:59], v[28:31], v[240:243], v[56:59]
    ds_read_b64_tr_b16 v[24:25], v4 offset:27680
    v_mfma_f32_16x16x32_bf16 v[60:63], v[28:31], v[244:247], v[60:63]
    ds_read_b64_tr_b16 v[26:27], v4 offset:32288
    s_waitcnt lgkmcnt(6)
    v_mfma_f32_16x16x32_bf16 v[72:75], v[32:35], v[248:251], v[72:75]
    ds_read_b64_tr_b16 v[28:29], v5 offset:27840
    v_mfma_f32_16x16x32_bf16 v[76:79], v[32:35], v[252:255], v[76:79]
    ds_read_b64_tr_b16 v[30:31], v5 offset:32448
    v_mfma_f32_16x16x32_bf16 v[80:83], v[36:39], v[248:251], v[80:83]
    ds_read_b64_tr_b16 v[32:33], v5 offset:27888
    v_mfma_f32_16x16x32_bf16 v[84:87], v[36:39], v[252:255], v[84:87]
    ds_read_b64_tr_b16 v[34:35], v5 offset:32496
    s_waitcnt lgkmcnt(6)
    v_mfma_f32_16x16x32_bf16 v[88:91], v[16:19], v[248:251], v[88:91]
    ds_read_b64_tr_b16 v[36:37], v12 offset:27648
    v_mfma_f32_16x16x32_bf16 v[92:95], v[16:19], v[252:255], v[92:95]
    ds_read_b64_tr_b16 v[38:39], v12 offset:32256
    v_mfma_f32_16x16x32_bf16 v[96:99], v[20:23], v[248:251], v[96:99]
    v_mfma_f32_16x16x32_bf16 v[100:103], v[20:23], v[252:255], v[100:103]
    s_waitcnt lgkmcnt(4)
    v_mfma_f32_16x16x32_bf16 v[104:107], v[24:27], v[248:251], v[104:107]
    v_mfma_f32_16x16x32_bf16 v[108:111], v[24:27], v[252:255], v[108:111]
    v_mfma_f32_16x16x32_bf16 v[40:43], v[28:31], v[248:251], v[40:43]
    v_mfma_f32_16x16x32_bf16 v[44:47], v[28:31], v[252:255], v[44:47]
    s_waitcnt lgkmcnt(0)
    v_mfma_f32_16x16x32_bf16 v[48:51], v[32:35], v[248:251], v[48:51]
    v_mfma_f32_16x16x32_bf16 v[52:55], v[32:35], v[252:255], v[52:55]
    v_mfma_f32_16x16x32_bf16 v[56:59], v[36:39], v[248:251], v[56:59]
    v_mfma_f32_16x16x32_bf16 v[60:63], v[36:39], v[252:255], v[60:63]
    v_lshl_add_u32 v1, v3, 4, v2
LA_p2:
    v_and_b32 v20, 7, v2
    v_xor_b32 v16, v3, v20
    v_lshlrev_b32 v16, 4, v16
    v_lshl_add_u32 v16, v2, 7, v16
    s_lshl_b32 s64, s63, 12
    v_add_u32 v16, s64, v16
    v_xor_b32 v17, 64, v16
    v_add_u32 v18, 71680, v16
    v_add_u32 v19, 71680, v17
    v_lshlrev_b32 v24, 4, v1
    v_lshlrev_b32 v25, 3, v1
    v_add_u32 v20, 16384, v24
    v_add_u32 v21, 71680, v20
    v_mov_b32 v36, 0xc0135761
    v_mov_b32 v37, 0xc0135761
    s_mov_b32 s74, 0xbdd2d3e8
    s_mov_b32 s75, 0xbdd2d3e8
    s_mov_b32 s76, 1.0
    s_mov_b32 s77, 1.0
    v_lshrrev_b32 v22, 2, v2
    v_and_b32 v23, 3, v2
    v_lshl_add_u32 v22, v22, 3, v23
    s_lshl_b32 s66, s60, 7
    s_lshl_b32 s67, s63, 5
    s_add_u32 s66, s66, s67
    v_add_u32 v22, s66, v22
    v_lshlrev_b32 v22, 1, v22
    s_mov_b32 s52, s18
    s_mov_b32 s53, s19
    s_mov_b32 s54, 4096
    s_mov_b32 s55, 0x20000
    buffer_load_ushort v26, v22, s[52:55], 0 offen
    buffer_load_ushort v27, v22, s[52:55], 0 offen offset:8
    s_and_b32 s64, s63, 1
    s_lshr_b32 s65, s63, 1
    s_lshl_b32 s66, s60, 1
    s_add_u32 s66, s66, s65
    s_mul_i32 s66, s66, 368640
    s_add_u32 s66, s66, 10485760
    s_lshl_b32 s67, s64, 11
    s_add_u32 s66, s66, s67
    s_lshl_b32 s67, s61, 14
    s_add_u32 s70, s66, s67
    s_add_u32 s70, s70, 73728
    s_lshr_b32 s67, s61, 1
    s_lshl_b32 s67, s67, 12
    s_add_u32 s71, s66, s67
    s_add_u32 s71, s71, 335872
    s_and_b32 s67, s61, 1
    s_lshl_b32 s67, s67, 9
    s_add_u32 s71, s71, s67
    s_lshl_b32 s67, s61, 12
    s_add_u32 s72, s66, s67
    s_lshr_b32 s67, s61, 3
    s_lshl_b32 s67, s67, 12
    s_add_u32 s73, s66, s67
    s_add_u32 s73, s73, 65536
    s_and_b32 s67, s61, 7
    s_lshl_b32 s67, s67, 7
    s_add_u32 s73, s73, s67
    s_lshl_b32 s64, s63, 4
    v_add_u32 v0, s64, v2
    v_mul_u32_u24 v0, 80, v0
    v_add_u32 v0, 141312, v0
    v_mul_u32_u24 v6, 40, v3
    v_add3_u32 v6, v6, v0, 32
    v_mov_b32 v5, 153600
    v_cmp_gt_u32 vcc, 2, v3
    s_nop 1
    v_cndmask_b32 v6, v5, v6, vcc
    v_lshl_add_u32 v0, v3, 3, v0
    v_cvt_pk_bf16_f32 v236, v72, v73
    v_cvt_pk_bf16_f32 v237, v74, v75
    v_cvt_pk_bf16_f32 v248, v76, v77
    v_cvt_pk_bf16_f32 v249, v78, v79
    v_cvt_pk_bf16_f32 v238, v80, v81
    v_cvt_pk_bf16_f32 v239, v82, v83
    v_cvt_pk_bf16_f32 v250, v84, v85
    v_cvt_pk_bf16_f32 v251, v86, v87
    v_cvt_pk_bf16_f32 v240, v88, v89
    v_cvt_pk_bf16_f32 v241, v90, v91
    v_cvt_pk_bf16_f32 v252, v92, v93
    v_cvt_pk_bf16_f32 v253, v94, v95
    v_cvt_pk_bf16_f32 v242, v96, v97
    v_cvt_pk_bf16_f32 v243, v98, v99
    v_cvt_pk_bf16_f32 v254, v100, v101
    v_cvt_pk_bf16_f32 v255, v102, v103
    v_cvt_pk_bf16_f32 v244, v104, v105
    v_cvt_pk_bf16_f32 v245, v106, v107
    v_cvt_pk_bf16_f32 v28, v108, v109
    v_cvt_pk_bf16_f32 v29, v110, v111
    v_mov_b32 v246, 0
    v_mov_b32 v247, 0
    v_mov_b32 v30, 0
    v_mov_b32 v31, 0
    v_cvt_pk_bf16_f32 v40, v40, v41
    v_cvt_pk_bf16_f32 v41, v42, v43
    ds_write_b64 v0, v[40:41] offset:0
    v_cvt_pk_bf16_f32 v44, v44, v45
    v_cvt_pk_bf16_f32 v45, v46, v47
    ds_write_b64 v0, v[44:45] offset:5120
    v_cvt_pk_bf16_f32 v48, v48, v49
    v_cvt_pk_bf16_f32 v49, v50, v51
    ds_write_b64 v0, v[48:49] offset:40
    v_cvt_pk_bf16_f32 v52, v52, v53
    v_cvt_pk_bf16_f32 v53, v54, v55
    ds_write_b64 v0, v[52:53] offset:5160
    v_cvt_pk_bf16_f32 v56, v56, v57
    v_mov_b32 v57, 0x3f80
    ds_write_b64 v6, v[56:57] offset:0
    v_cvt_pk_bf16_f32 v60, v60, v61
    v_mov_b32 v61, 0x3f80
    ds_write_b64 v6, v[60:61] offset:5120
    ds_read_b128 v[40:43], v13 offset:0
    ds_read_b128 v[44:47], v13 offset:1024
    ds_read_b128 v[48:51], v13 offset:2048
    ds_read_b128 v[52:55], v13 offset:3072
    ds_read_b128 v[56:59], v13 offset:4096
    ds_read_b128 v[60:63], v13 offset:5120
    ds_read_b128 v[64:67], v13 offset:6144
    ds_read_b128 v[68:71], v13 offset:7168
    ds_read_b128 v[72:75], v13 offset:8192
    s_waitcnt lgkmcnt(0)
    s_barrier
    v_and_b32 v12, 3, v2
    v_and_b32 v13, 1, v3
    v_mov_b32 v22, 2
    v_cmp_eq_u32 vcc, v12, v3
    s_nop 0
    s_nop 0
    v_cndmask_b32 v13, v22, v13, vcc
    v_mul_u32_u24 v13, 960, v13
    v_lshrrev_b32 v12, 2, v2
    v_mul_u32_u24 v12, 40, v12
    v_add_u32 v12, v12, v13
    v_add_u32 v38, 160768, v12
    v_lshl_add_u32 v12, s63, 4, v2
    v_mul_u32_u24 v12, 72, v12
    v_and_b32 v13, 1, v3
    v_mul_u32_u24 v13, 4608, v13
    v_add_u32 v12, 151552, v12
    v_add_u32 v12, v12, v13
    v_mul_u32_u24 v13, 56, v1
    v_add_u32 v13, 34816, v13
    v_cmp_lt_u32 vcc, 1, v3
    s_nop 0
    s_nop 0
    v_cndmask_b32 v39, v13, v12, vcc
    ds_read_b64_tr_b16 v[4:5], v38 offset:0
    ds_read_b64_tr_b16 v[6:7], v38 offset:160
    ds_read_b64_tr_b16 v[8:9], v38 offset:8
    ds_read_b64_tr_b16 v[10:11], v38 offset:168
    ds_read_b64_tr_b16 v[96:97], v38 offset:16
    ds_read_b64_tr_b16 v[98:99], v38 offset:176
    ds_read_b64_tr_b16 v[100:101], v38 offset:24
    ds_read_b64_tr_b16 v[102:103], v38 offset:184
    ds_read_b64_tr_b16 v[104:105], v38 offset:32
    ds_read_b64_tr_b16 v[106:107], v38 offset:192
    ds_read_b64_tr_b16 v[108:109], v38 offset:320
    ds_read_b64_tr_b16 v[110:111], v38 offset:480
    s_waitcnt lgkmcnt(10)
    v_mfma_f32_16x16x32_bf16 v[76:79], v[4:7], v[236:239], 0
    ds_read_b64_tr_b16 v[4:5], v38 offset:328
    ds_read_b64_tr_b16 v[6:7], v38 offset:488
    s_waitcnt lgkmcnt(10)
    v_mfma_f32_16x16x32_bf16 v[80:83], v[8:11], v[236:239], 0
    ds_read_b64_tr_b16 v[8:9], v38 offset:336
    ds_read_b64_tr_b16 v[10:11], v38 offset:496
    s_waitcnt lgkmcnt(10)
    v_mfma_f32_16x16x32_bf16 v[84:87], v[96:99], v[236:239], 0
    ds_read_b64_tr_b16 v[96:97], v38 offset:344
    ds_read_b64_tr_b16 v[98:99], v38 offset:504
    s_waitcnt lgkmcnt(10)
    v_mfma_f32_16x16x32_bf16 v[88:91], v[100:103], v[236:239], 0
    ds_read_b64_tr_b16 v[100:101], v38 offset:352
    ds_read_b64_tr_b16 v[102:103], v38 offset:512
    s_waitcnt lgkmcnt(10)
    v_mfma_f32_16x16x32_bf16 v[92:95], v[104:107], v[236:239], 0
    ds_read_b64_tr_b16 v[104:105], v38 offset:640
    ds_read_b64_tr_b16 v[106:107], v38 offset:800
    s_waitcnt lgkmcnt(10)
    v_mfma_f32_16x16x32_bf16 v[76:79], v[108:111], v[240:243], v[76:79]
    ds_read_b64_tr_b16 v[108:109], v38 offset:648
    ds_read_b64_tr_b16 v[110:111], v38 offset:808
    s_waitcnt lgkmcnt(10)
    v_mfma_f32_16x16x32_bf16 v[80:83], v[4:7], v[240:243], v[80:83]
    ds_read_b64_tr_b16 v[4:5], v38 offset:656
    ds_read_b64_tr_b16 v[6:7], v38 offset:816
    s_waitcnt lgkmcnt(10)
    v_mfma_f32_16x16x32_bf16 v[84:87], v[8:11], v[240:243], v[84:87]
    ds_read_b64_tr_b16 v[8:9], v38 offset:664
    ds_read_b64_tr_b16 v[10:11], v38 offset:824
    s_waitcnt lgkmcnt(10)
    v_mfma_f32_16x16x32_bf16 v[88:91], v[96:99], v[240:243], v[88:91]
    ds_read_b64_tr_b16 v[96:97], v38 offset:672
    ds_read_b64_tr_b16 v[98:99], v38 offset:832
    s_waitcnt lgkmcnt(10)
    v_mfma_f32_16x16x32_bf16 v[92:95], v[100:103], v[240:243], v[92:95]
    s_waitcnt lgkmcnt(8)
    v_mfma_f32_16x16x32_bf16 v[76:79], v[104:107], v[244:247], v[76:79]
    s_waitcnt lgkmcnt(6)
    v_mfma_f32_16x16x32_bf16 v[80:83], v[108:111], v[244:247], v[80:83]
    s_waitcnt lgkmcnt(4)
    v_mfma_f32_16x16x32_bf16 v[84:87], v[4:7], v[244:247], v[84:87]
    s_waitcnt lgkmcnt(2)
    v_mfma_f32_16x16x32_bf16 v[88:91], v[8:11], v[244:247], v[88:91]
    s_waitcnt lgkmcnt(0)
    v_mfma_f32_16x16x32_bf16 v[92:95], v[96:99], v[244:247], v[92:95]
    s_nop 1
    s_nop 1
    s_nop 1
    s_nop 1
    s_nop 1
    s_nop 1
    v_max3_f32 v12, v76, v77, v78
    v_max3_f32 v22, v79, v80, v81
    v_max3_f32 v12, v12, v82, v83
    v_max3_f32 v22, v22, v84, v85
    v_max3_f32 v12, v12, v86, v87
    v_max3_f32 v22, v22, v88, v89
    v_max3_f32 v12, v12, v90, v91
    v_max3_f32 v22, v22, v92, v93
    v_max_f32 v12, v12, v22
    v_min3_f32 v13, v76, v77, v78
    v_min3_f32 v23, v79, v80, v81
    v_min3_f32 v13, v13, v82, v83
    v_min3_f32 v23, v23, v84, v85
    v_min3_f32 v13, v13, v86, v87
    v_min3_f32 v23, v23, v88, v89
    v_min3_f32 v13, v13, v90, v91
    v_min3_f32 v23, v23, v92, v93
    v_min_f32 v13, v13, v23
    v_mul_f32 v12, s81, v12
    v_mul_f32 v13, s81, v13
    v_fma_f32 v96, -v76, s81, v13
    v_fma_f32 v97, -v77, s81, v13
    v_fma_f32 v98, -v78, s81, v13
    v_fma_f32 v99, -v79, s81, v13
    v_fma_f32 v100, -v80, s81, v13
    v_fma_f32 v101, -v81, s81, v13
    v_fma_f32 v102, -v82, s81, v13
    v_fma_f32 v103, -v83, s81, v13
    v_fma_f32 v104, -v84, s81, v13
    v_fma_f32 v105, -v85, s81, v13
    v_fma_f32 v106, -v86, s81, v13
    v_fma_f32 v107, -v87, s81, v13
    v_fma_f32 v108, -v88, s81, v13
    v_fma_f32 v109, -v89, s81, v13
    v_fma_f32 v110, -v90, s81, v13
    v_fma_f32 v111, -v91, s81, v13
    v_fma_f32 v32, -v92, s81, v13
    v_fma_f32 v33, -v93, s81, v13
    v_fma_f32 v76, v76, s81, -v12
    v_fma_f32 v77, v77, s81, -v12
    v_fma_f32 v78, v78, s81, -v12
    v_fma_f32 v79, v79, s81, -v12
    v_fma_f32 v80, v80, s81, -v12
    v_fma_f32 v81, v81, s81, -v12
    v_fma_f32 v82, v82, s81, -v12
    v_fma_f32 v83, v83, s81, -v12
    v_fma_f32 v84, v84, s81, -v12
    v_fma_f32 v85, v85, s81, -v12
    v_fma_f32 v86, v86, s81, -v12
    v_fma_f32 v87, v87, s81, -v12
    v_fma_f32 v88, v88, s81, -v12
    v_fma_f32 v89, v89, s81, -v12
    v_fma_f32 v90, v90, s81, -v12
    v_fma_f32 v91, v91, s81, -v12
    v_fma_f32 v92, v92, s81, -v12
    v_fma_f32 v93, v93, s81, -v12
    v_exp_f32 v96, v96
    v_exp_f32 v97, v97
    v_exp_f32 v98, v98
    v_exp_f32 v99, v99
    v_exp_f32 v100, v100
    v_exp_f32 v101, v101
    v_exp_f32 v102, v102
    v_exp_f32 v103, v103
    v_exp_f32 v104, v104
    v_exp_f32 v105, v105
    v_exp_f32 v106, v106
    v_exp_f32 v107, v107
    v_exp_f32 v108, v108
    v_exp_f32 v109, v109
    v_exp_f32 v110, v110
    v_exp_f32 v111, v111
    v_exp_f32 v32, v32
    v_exp_f32 v33, v33
    v_exp_f32 v76, v76
    v_exp_f32 v77, v77
    v_exp_f32 v78, v78
    v_exp_f32 v79, v79
    v_exp_f32 v80, v80
    v_exp_f32 v81, v81
    v_exp_f32 v82, v82
    v_exp_f32 v83, v83
    v_exp_f32 v84, v84
    v_exp_f32 v85, v85
    v_exp_f32 v86, v86
    v_exp_f32 v87, v87
    v_exp_f32 v88, v88
    v_exp_f32 v89, v89
    v_exp_f32 v90, v90
    v_exp_f32 v91, v91
    v_exp_f32 v92, v92
    v_exp_f32 v93, v93
    v_add_f32 v13, v96, v97
    v_add_f32 v23, v98, v99
    v_add_f32 v13, v13, v100
    v_add_f32 v23, v23, v101
    v_add_f32 v13, v13, v102
    v_add_f32 v23, v23, v103
    v_add_f32 v13, v13, v104
    v_add_f32 v23, v23, v105
    v_add_f32 v13, v13, v106
    v_add_f32 v23, v23, v107
    v_add_f32 v13, v13, v108
    v_add_f32 v23, v23, v109
    v_add_f32 v13, v13, v110
    v_add_f32 v23, v23, v111
    v_add_f32 v13, v13, v32
    v_add_f32 v23, v23, v33
    v_add_f32 v13, v13, v23
    v_add_f32 v12, v76, v77
    v_add_f32 v22, v78, v79
    v_add_f32 v12, v12, v80
    v_add_f32 v22, v22, v81
    v_add_f32 v12, v12, v82
    v_add_f32 v22, v22, v83
    v_add_f32 v12, v12, v84
    v_add_f32 v22, v22, v85
    v_add_f32 v12, v12, v86
    v_add_f32 v22, v22, v87
    v_add_f32 v12, v12, v88
    v_add_f32 v22, v22, v89
    v_add_f32 v12, v12, v90
    v_add_f32 v22, v22, v91
    v_add_f32 v12, v12, v92
    v_add_f32 v22, v22, v93
    v_add_f32 v12, v12, v22
    v_rcp_f32 v13, v13
    v_rcp_f32 v12, v12
    v_mul_f32 v96, v96, v13
    v_mul_f32 v97, v97, v13
    v_mul_f32 v98, v98, v13
    v_mul_f32 v99, v99, v13
    v_mul_f32 v100, v100, v13
    v_mul_f32 v101, v101, v13
    v_mul_f32 v102, v102, v13
    v_mul_f32 v103, v103, v13
    v_mul_f32 v104, v104, v13
    v_mul_f32 v105, v105, v13
    v_mul_f32 v106, v106, v13
    v_mul_f32 v107, v107, v13
    v_mul_f32 v108, v108, v13
    v_mul_f32 v109, v109, v13
    v_mul_f32 v110, v110, v13
    v_mul_f32 v111, v111, v13
    v_mul_f32 v32, v32, v13
    v_mul_f32 v33, v33, v13
    v_mul_f32 v76, v76, v12
    v_mul_f32 v77, v77, v12
    v_mul_f32 v78, v78, v12
    v_mul_f32 v79, v79, v12
    v_mul_f32 v80, v80, v12
    v_mul_f32 v81, v81, v12
    v_mul_f32 v82, v82, v12
    v_mul_f32 v83, v83, v12
    v_mul_f32 v84, v84, v12
    v_mul_f32 v85, v85, v12
    v_mul_f32 v86, v86, v12
    v_mul_f32 v87, v87, v12
    v_mul_f32 v88, v88, v12
    v_mul_f32 v89, v89, v12
    v_mul_f32 v90, v90, v12
    v_mul_f32 v91, v91, v12
    v_mul_f32 v92, v92, v12
    v_mul_f32 v93, v93, v12
    v_cvt_pk_bf16_f32 v76, v76, v77
    v_cvt_pk_bf16_f32 v77, v78, v79
    v_cvt_pk_bf16_f32 v78, v80, v81
    v_cvt_pk_bf16_f32 v79, v82, v83
    v_cvt_pk_bf16_f32 v80, v84, v85
    v_cvt_pk_bf16_f32 v81, v86, v87
    v_cvt_pk_bf16_f32 v82, v88, v89
    v_cvt_pk_bf16_f32 v83, v90, v91
    v_cvt_pk_bf16_f32 v84, v92, v93
    v_cvt_pk_bf16_f32 v85, v96, v97
    v_cvt_pk_bf16_f32 v86, v98, v99
    v_cvt_pk_bf16_f32 v87, v100, v101
    v_cvt_pk_bf16_f32 v88, v102, v103
    v_cvt_pk_bf16_f32 v89, v104, v105
    v_cvt_pk_bf16_f32 v90, v106, v107
    v_cvt_pk_bf16_f32 v91, v108, v109
    v_cvt_pk_bf16_f32 v92, v110, v111
    v_cvt_pk_bf16_f32 v93, v32, v33
    v_mov_b32 v94, 0
    v_mov_b32 v95, 0
    ds_write_b64 v39, v[76:77] offset:0
    ds_write_b64 v39, v[78:79] offset:8
    ds_write_b64 v39, v[80:81] offset:16
    ds_write_b64 v39, v[82:83] offset:24
    ds_write_b64 v39, v[84:85] offset:32
    ds_write_b64 v39, v[86:87] offset:40
    ds_write_b64 v39, v[88:89] offset:48
    ds_write_b64 v39, v[90:91] offset:56
    ds_write_b64 v39, v[92:93] offset:64
    s_waitcnt lgkmcnt(0)
    s_barrier
    s_waitcnt vmcnt(0)
    v_lshlrev_b32 v228, 16, v26
    v_lshlrev_b32 v229, 16, v26
    v_lshlrev_b32 v230, 16, v26
    v_lshlrev_b32 v231, 16, v26
    v_lshlrev_b32 v232, 16, v27
    v_lshlrev_b32 v233, 16, v27
    v_lshlrev_b32 v234, 16, v27
    v_lshlrev_b32 v235, 16, v27
    ds_read_b128 v[220:223], v16 offset:36864
    ds_read_b128 v[224:227], v16 offset:38912
    ds_read_b128 v[184:187], v20 offset:36864
    ds_read_b128 v[188:191], v20 offset:37888
    ds_read_b128 v[192:195], v20 offset:38912
    ds_read_b128 v[196:199], v20 offset:39936
    ds_read_b128 v[200:203], v20 offset:40960
    ds_read_b128 v[204:207], v20 offset:41984
    ds_read_b128 v[208:211], v20 offset:43008
    ds_read_b128 v[212:215], v20 offset:44032
    ds_read_b128 v[216:219], v20 offset:45056
    s_waitcnt lgkmcnt(6)
    v_mfma_f32_16x16x32_bf16 v[112:115], v[184:187], v[220:223], v[228:231]
    ds_read_b64_tr_b16 v[4:5], v38 offset:0
    ds_read_b64_tr_b16 v[6:7], v38 offset:160
    v_mfma_f32_16x16x32_bf16 v[116:119], v[184:187], v[224:227], v[232:235]
    ds_read_b128 v[184:187], v20 offset:46080
    ds_read_b64_tr_b16 v[8:9], v38 offset:8
    ds_read_b64_tr_b16 v[10:11], v38 offset:168
    v_mfma_f32_16x16x32_bf16 v[120:123], v[188:191], v[220:223], v[228:231]
    ds_read_b64_tr_b16 v[236:237], v38 offset:16
    ds_read_b64_tr_b16 v[238:239], v38 offset:176
    v_mfma_f32_16x16x32_bf16 v[124:127], v[188:191], v[224:227], v[232:235]
    ds_read_b128 v[188:191], v20 offset:47104
    ds_read_b64_tr_b16 v[240:241], v38 offset:24
    ds_read_b64_tr_b16 v[242:243], v38 offset:184
    v_mfma_f32_16x16x32_bf16 v[128:131], v[192:195], v[220:223], v[228:231]
    v_mfma_f32_16x16x32_bf16 v[132:135], v[192:195], v[224:227], v[232:235]
    ds_read_b128 v[192:195], v20 offset:48128
    s_waitcnt lgkmcnt(14)
    v_mfma_f32_16x16x32_bf16 v[136:139], v[196:199], v[220:223], v[228:231]
    v_mfma_f32_16x16x32_bf16 v[140:143], v[196:199], v[224:227], v[232:235]
    ds_read_b128 v[196:199], v20 offset:49152
    v_mfma_f32_16x16x32_bf16 v[144:147], v[200:203], v[220:223], v[228:231]
    ds_read_b64_tr_b16 v[244:245], v38 offset:32
    ds_read_b64_tr_b16 v[246:247], v38 offset:192
    v_mfma_f32_16x16x32_bf16 v[148:151], v[200:203], v[224:227], v[232:235]
    ds_read_b128 v[200:203], v20 offset:50176
    s_waitcnt lgkmcnt(13)
    v_mfma_f32_16x16x32_bf16 v[96:99], v[4:7], v[248:251], 0
    ds_read_b64_tr_b16 v[4:5], v38 offset:320
    v_mfma_f32_16x16x32_bf16 v[152:155], v[204:207], v[220:223], v[228:231]
    ds_read_b64_tr_b16 v[6:7], v38 offset:480
    s_waitcnt lgkmcnt(12)
    v_mfma_f32_16x16x32_bf16 v[100:103], v[8:11], v[248:251], 0
    v_mfma_f32_16x16x32_bf16 v[156:159], v[204:207], v[224:227], v[232:235]
    ds_read_b128 v[204:207], v20 offset:51200
    v_mfma_f32_16x16x32_bf16 v[160:163], v[208:211], v[220:223], v[228:231]
    ds_read_b64_tr_b16 v[8:9], v38 offset:328
    ds_read_b64_tr_b16 v[10:11], v38 offset:488
    v_mfma_f32_16x16x32_bf16 v[164:167], v[208:211], v[224:227], v[232:235]
    ds_read_b128 v[208:211], v20 offset:52224
    s_waitcnt lgkmcnt(14)
    v_mfma_f32_16x16x32_bf16 v[104:107], v[236:239], v[248:251], 0
    ds_read_b64_tr_b16 v[236:237], v38 offset:336
    v_mfma_f32_16x16x32_bf16 v[168:171], v[212:215], v[220:223], v[228:231]
    ds_read_b64_tr_b16 v[238:239], v38 offset:496
    s_waitcnt lgkmcnt(13)
    v_mfma_f32_16x16x32_bf16 v[108:111], v[240:243], v[248:251], 0
    v_mfma_f32_16x16x32_bf16 v[172:175], v[212:215], v[224:227], v[232:235]
    ds_read_b128 v[212:215], v20 offset:53248
    ds_read_b64_tr_b16 v[240:241], v38 offset:344
    ds_read_b64_tr_b16 v[242:243], v38 offset:504
    v_mfma_f32_16x16x32_bf16 v[176:179], v[216:219], v[220:223], v[228:231]
    s_waitcnt lgkmcnt(12)
    v_mfma_f32_16x16x32_bf16 v[32:35], v[244:247], v[248:251], 0
    ds_read_b64_tr_b16 v[244:245], v38 offset:352
    v_mfma_f32_16x16x32_bf16 v[180:183], v[216:219], v[224:227], v[232:235]
    ds_read_b128 v[216:219], v20 offset:54272
    ds_read_b128 v[228:231], v17 offset:36864
    ds_read_b128 v[232:235], v17 offset:38912
    s_waitcnt lgkmcnt(0)
    s_barrier
    v_mfma_f32_16x16x32_bf16 v[112:115], v[184:187], v[228:231], v[112:115]
    ds_read_b64_tr_b16 v[246:247], v38 offset:512
    v_mfma_f32_16x16x32_bf16 v[96:99], v[4:7], v[252:255], v[96:99]
    v_mfma_f32_16x16x32_bf16 v[116:119], v[184:187], v[232:235], v[116:119]
    ds_read_b128 v[184:187], v21 offset:0
    ds_read_b64_tr_b16 v[4:5], v38 offset:640
    ds_read_b64_tr_b16 v[6:7], v38 offset:800
    v_mfma_f32_16x16x32_bf16 v[120:123], v[188:191], v[228:231], v[120:123]
    ds_read_b128 v[220:223], v18 offset:0
    v_mfma_f32_16x16x32_bf16 v[100:103], v[8:11], v[252:255], v[100:103]
    ds_read_b64_tr_b16 v[8:9], v38 offset:648
    v_mfma_f32_16x16x32_bf16 v[124:127], v[188:191], v[232:235], v[124:127]
    ds_read_b128 v[188:191], v21 offset:1024
    ds_read_b64_tr_b16 v[10:11], v38 offset:808
    v_mfma_f32_16x16x32_bf16 v[104:107], v[236:239], v[252:255], v[104:107]
    v_mfma_f32_16x16x32_bf16 v[128:131], v[192:195], v[228:231], v[128:131]
    ds_read_b128 v[224:227], v18 offset:2048
    ds_read_b64_tr_b16 v[236:237], v38 offset:656
    ds_read_b64_tr_b16 v[238:239], v38 offset:816
    v_mfma_f32_16x16x32_bf16 v[132:135], v[192:195], v[232:235], v[132:135]
    ds_read_b128 v[192:195], v21 offset:2048
    v_mfma_f32_16x16x32_bf16 v[136:139], v[196:199], v[228:231], v[136:139]
    v_mfma_f32_16x16x32_bf16 v[108:111], v[240:243], v[252:255], v[108:111]
    ds_read_b64_tr_b16 v[240:241], v38 offset:664
    v_mfma_f32_16x16x32_bf16 v[140:143], v[196:199], v[232:235], v[140:143]
    ds_read_b128 v[196:199], v21 offset:3072
    ds_read_b64_tr_b16 v[242:243], v38 offset:824
    s_waitcnt lgkmcnt(14)
    v_mfma_f32_16x16x32_bf16 v[32:35], v[244:247], v[252:255], v[32:35]
    v_mfma_f32_16x16x32_bf16 v[144:147], v[200:203], v[228:231], v[144:147]
    ds_read_b64_tr_b16 v[244:245], v38 offset:672
    ds_read_b64_tr_b16 v[246:247], v38 offset:832
    v_mfma_f32_16x16x32_bf16 v[148:151], v[200:203], v[232:235], v[148:151]
    ds_read_b128 v[200:203], v21 offset:4096
    s_waitcnt lgkmcnt(14)
    v_mfma_f32_16x16x32_bf16 v[96:99], v[4:7], v[28:31], v[96:99]
    v_mfma_f32_16x16x32_bf16 v[152:155], v[204:207], v[228:231], v[152:155]
    s_waitcnt lgkmcnt(10)
    v_mfma_f32_16x16x32_bf16 v[100:103], v[8:11], v[28:31], v[100:103]
    v_mfma_f32_16x16x32_bf16 v[156:159], v[204:207], v[232:235], v[156:159]
    ds_read_b128 v[204:207], v21 offset:5120
    v_mfma_f32_16x16x32_bf16 v[160:163], v[208:211], v[228:231], v[160:163]
    s_waitcnt lgkmcnt(8)
    v_mfma_f32_16x16x32_bf16 v[104:107], v[236:239], v[28:31], v[104:107]
    v_mfma_f32_16x16x32_bf16 v[164:167], v[208:211], v[232:235], v[164:167]
    ds_read_b128 v[208:211], v21 offset:6144
    s_waitcnt lgkmcnt(5)
    v_mfma_f32_16x16x32_bf16 v[108:111], v[240:243], v[28:31], v[108:111]
    v_mfma_f32_16x16x32_bf16 v[168:171], v[212:215], v[228:231], v[168:171]
    s_waitcnt lgkmcnt(3)
    v_mfma_f32_16x16x32_bf16 v[32:35], v[244:247], v[28:31], v[32:35]
    s_nop 1
    v_mfma_f32_16x16x32_bf16 v[172:175], v[212:215], v[232:235], v[172:175]
    ds_read_b128 v[212:215], v21 offset:7168
    s_nop 1
    s_nop 1
    v_mfma_f32_16x16x32_bf16 v[176:179], v[216:219], v[228:231], v[176:179]
    s_nop 1
    s_nop 1
    v_mfma_f32_16x16x32_bf16 v[180:183], v[216:219], v[232:235], v[180:183]
    ds_read_b128 v[216:219], v21 offset:8192
    v_mfma_f32_16x16x32_bf16 v[112:115], v[184:187], v[220:223], v[112:115]
    s_nop 1
    v_max3_f32 v12, v96, v97, v98
    v_mfma_f32_16x16x32_bf16 v[116:119], v[184:187], v[224:227], v[116:119]
    ds_read_b128 v[184:187], v21 offset:9216
    v_max3_f32 v22, v99, v100, v101
    v_max3_f32 v12, v12, v102, v103
    v_mfma_f32_16x16x32_bf16 v[120:123], v[188:191], v[220:223], v[120:123]
    ds_read_b128 v[228:231], v19 offset:0
    v_max3_f32 v22, v22, v104, v105
    v_max3_f32 v12, v12, v106, v107
    v_mfma_f32_16x16x32_bf16 v[124:127], v[188:191], v[224:227], v[124:127]
    ds_read_b128 v[188:191], v21 offset:10240
    v_max3_f32 v22, v22, v108, v109
    v_max3_f32 v12, v12, v110, v111
    v_mfma_f32_16x16x32_bf16 v[128:131], v[192:195], v[220:223], v[128:131]
    ds_read_b128 v[232:235], v19 offset:2048
    v_max3_f32 v22, v22, v32, v33
    v_max_f32 v12, v12, v22
    v_mfma_f32_16x16x32_bf16 v[132:135], v[192:195], v[224:227], v[132:135]
    ds_read_b128 v[192:195], v21 offset:11264
    s_waitcnt lgkmcnt(8)
    v_mfma_f32_16x16x32_bf16 v[136:139], v[196:199], v[220:223], v[136:139]
    v_min3_f32 v13, v96, v97, v98
    v_min3_f32 v23, v99, v100, v101
    v_mfma_f32_16x16x32_bf16 v[140:143], v[196:199], v[224:227], v[140:143]
    ds_read_b128 v[196:199], v21 offset:12288
    v_min3_f32 v13, v13, v102, v103
    v_min3_f32 v23, v23, v104, v105
    v_mfma_f32_16x16x32_bf16 v[144:147], v[200:203], v[220:223], v[144:147]
    v_min3_f32 v13, v13, v106, v107
    v_min3_f32 v23, v23, v108, v109
    v_mfma_f32_16x16x32_bf16 v[148:151], v[200:203], v[224:227], v[148:151]
    ds_read_b128 v[200:203], v21 offset:13312
    v_min3_f32 v13, v13, v110, v111
    v_min3_f32 v23, v23, v32, v33
    v_mfma_f32_16x16x32_bf16 v[152:155], v[204:207], v[220:223], v[152:155]
    v_min_f32 v13, v13, v23
    v_mul_f32 v12, s81, v12
    v_mfma_f32_16x16x32_bf16 v[156:159], v[204:207], v[224:227], v[156:159]
    ds_read_b128 v[204:207], v21 offset:14336
    s_waitcnt lgkmcnt(8)
    v_mfma_f32_16x16x32_bf16 v[160:163], v[208:211], v[220:223], v[160:163]
    v_mul_f32 v13, s81, v13
    v_fma_f32 v236, -v96, s81, v13
    v_mfma_f32_16x16x32_bf16 v[164:167], v[208:211], v[224:227], v[164:167]
    ds_read_b128 v[208:211], v21 offset:15360
    v_fma_f32 v237, -v97, s81, v13
    v_fma_f32 v238, -v98, s81, v13
    v_mfma_f32_16x16x32_bf16 v[168:171], v[212:215], v[220:223], v[168:171]
    v_fma_f32 v239, -v99, s81, v13
    v_fma_f32 v240, -v100, s81, v13
    v_mfma_f32_16x16x32_bf16 v[172:175], v[212:215], v[224:227], v[172:175]
    ds_read_b128 v[212:215], v21 offset:16384
    v_fma_f32 v241, -v101, s81, v13
    v_fma_f32 v242, -v102, s81, v13
    v_mfma_f32_16x16x32_bf16 v[176:179], v[216:219], v[220:223], v[176:179]
    v_fma_f32 v243, -v103, s81, v13
    v_fma_f32 v244, -v104, s81, v13
    v_mfma_f32_16x16x32_bf16 v[180:183], v[216:219], v[224:227], v[180:183]
    ds_read_b128 v[216:219], v21 offset:17408
    s_waitcnt lgkmcnt(6)
    s_barrier
    v_mfma_f32_16x16x32_bf16 v[112:115], v[184:187], v[228:231], v[112:115]
    v_fma_f32 v245, -v105, s81, v13
    v_fma_f32 v246, -v106, s81, v13
    v_mfma_f32_16x16x32_bf16 v[116:119], v[184:187], v[232:235], v[116:119]
    ds_read_b128 v[184:187], v20 offset:0
    v_fma_f32 v247, -v107, s81, v13
    v_fma_f32 v248, -v108, s81, v13
    v_mfma_f32_16x16x32_bf16 v[120:123], v[188:191], v[228:231], v[120:123]
    ds_read_b128 v[220:223], v16 offset:0
    v_fma_f32 v249, -v109, s81, v13
    v_fma_f32 v250, -v110, s81, v13
    v_mfma_f32_16x16x32_bf16 v[124:127], v[188:191], v[232:235], v[124:127]
    ds_read_b128 v[188:191], v20 offset:1024
    v_fma_f32 v251, -v111, s81, v13
    v_fma_f32 v252, -v32, s81, v13
    v_mfma_f32_16x16x32_bf16 v[128:131], v[192:195], v[228:231], v[128:131]
    ds_read_b128 v[224:227], v16 offset:2048
    v_fma_f32 v253, -v33, s81, v13
    v_fma_f32 v96, v96, s81, -v12
    v_mfma_f32_16x16x32_bf16 v[132:135], v[192:195], v[232:235], v[132:135]
    ds_read_b128 v[192:195], v20 offset:2048
    s_waitcnt lgkmcnt(8)
    v_mfma_f32_16x16x32_bf16 v[136:139], v[196:199], v[228:231], v[136:139]
    v_fma_f32 v97, v97, s81, -v12
    v_fma_f32 v98, v98, s81, -v12
    v_mfma_f32_16x16x32_bf16 v[140:143], v[196:199], v[232:235], v[140:143]
    ds_read_b128 v[196:199], v20 offset:3072
    v_fma_f32 v99, v99, s81, -v12
    v_fma_f32 v100, v100, s81, -v12
    v_mfma_f32_16x16x32_bf16 v[144:147], v[200:203], v[228:231], v[144:147]
    v_fma_f32 v101, v101, s81, -v12
    v_fma_f32 v102, v102, s81, -v12
    v_mfma_f32_16x16x32_bf16 v[148:151], v[200:203], v[232:235], v[148:151]
    ds_read_b128 v[200:203], v20 offset:4096
    v_fma_f32 v103, v103, s81, -v12
    v_fma_f32 v104, v104, s81, -v12
    v_mfma_f32_16x16x32_bf16 v[152:155], v[204:207], v[228:231], v[152:155]
    v_fma_f32 v105, v105, s81, -v12
    v_fma_f32 v106, v106, s81, -v12
    v_mfma_f32_16x16x32_bf16 v[156:159], v[204:207], v[232:235], v[156:159]
    ds_read_b128 v[204:207], v20 offset:5120
    s_waitcnt lgkmcnt(8)
    v_mfma_f32_16x16x32_bf16 v[160:163], v[208:211], v[228:231], v[160:163]
    v_fma_f32 v107, v107, s81, -v12
    v_fma_f32 v108, v108, s81, -v12
    v_mfma_f32_16x16x32_bf16 v[164:167], v[208:211], v[232:235], v[164:167]
    ds_read_b128 v[208:211], v20 offset:6144
    v_fma_f32 v109, v109, s81, -v12
    v_fma_f32 v110, v110, s81, -v12
    v_mfma_f32_16x16x32_bf16 v[168:171], v[212:215], v[228:231], v[168:171]
    v_fma_f32 v111, v111, s81, -v12
    v_fma_f32 v32, v32, s81, -v12
    v_mfma_f32_16x16x32_bf16 v[172:175], v[212:215], v[232:235], v[172:175]
    ds_read_b128 v[212:215], v20 offset:7168
    v_fma_f32 v33, v33, s81, -v12
    v_mfma_f32_16x16x32_bf16 v[176:179], v[216:219], v[228:231], v[176:179]
    v_exp_f32 v236, v236
    v_mfma_f32_16x16x32_bf16 v[180:183], v[216:219], v[232:235], v[180:183]
    ds_read_b128 v[216:219], v20 offset:8192
    s_waitcnt lgkmcnt(6)
    v_mfma_f32_16x16x32_bf16 v[112:115], v[184:187], v[220:223], v[112:115]
    v_exp_f32 v237, v237
    v_mfma_f32_16x16x32_bf16 v[116:119], v[184:187], v[224:227], v[116:119]
    ds_read_b128 v[184:187], v20 offset:9216
    v_exp_f32 v238, v238
    v_mfma_f32_16x16x32_bf16 v[120:123], v[188:191], v[220:223], v[120:123]
    ds_read_b128 v[228:231], v17 offset:0
    v_exp_f32 v239, v239
    v_mfma_f32_16x16x32_bf16 v[124:127], v[188:191], v[224:227], v[124:127]
    ds_read_b128 v[188:191], v20 offset:10240
    v_exp_f32 v240, v240
    v_mfma_f32_16x16x32_bf16 v[128:131], v[192:195], v[220:223], v[128:131]
    ds_read_b128 v[232:235], v17 offset:2048
    v_exp_f32 v241, v241
    v_mfma_f32_16x16x32_bf16 v[132:135], v[192:195], v[224:227], v[132:135]
    ds_read_b128 v[192:195], v20 offset:11264
    s_waitcnt lgkmcnt(8)
    v_mfma_f32_16x16x32_bf16 v[136:139], v[196:199], v[220:223], v[136:139]
    v_exp_f32 v242, v242
    v_mfma_f32_16x16x32_bf16 v[140:143], v[196:199], v[224:227], v[140:143]
    ds_read_b128 v[196:199], v20 offset:12288
    v_exp_f32 v243, v243
    v_mfma_f32_16x16x32_bf16 v[144:147], v[200:203], v[220:223], v[144:147]
    v_exp_f32 v244, v244
    v_mfma_f32_16x16x32_bf16 v[148:151], v[200:203], v[224:227], v[148:151]
    ds_read_b128 v[200:203], v20 offset:13312
    v_exp_f32 v245, v245
    v_mfma_f32_16x16x32_bf16 v[152:155], v[204:207], v[220:223], v[152:155]
    v_exp_f32 v246, v246
    v_mfma_f32_16x16x32_bf16 v[156:159], v[204:207], v[224:227], v[156:159]
    ds_read_b128 v[204:207], v20 offset:14336
    s_waitcnt lgkmcnt(8)
    v_mfma_f32_16x16x32_bf16 v[160:163], v[208:211], v[220:223], v[160:163]
    v_exp_f32 v247, v247
    v_mfma_f32_16x16x32_bf16 v[164:167], v[208:211], v[224:227], v[164:167]
    ds_read_b128 v[208:211], v20 offset:15360
    v_exp_f32 v248, v248
    v_mfma_f32_16x16x32_bf16 v[168:171], v[212:215], v[220:223], v[168:171]
    v_exp_f32 v249, v249
    v_mfma_f32_16x16x32_bf16 v[172:175], v[212:215], v[224:227], v[172:175]
    ds_read_b128 v[212:215], v20 offset:16384
    v_exp_f32 v250, v250
    v_mfma_f32_16x16x32_bf16 v[176:179], v[216:219], v[220:223], v[176:179]
    v_exp_f32 v251, v251
    v_mfma_f32_16x16x32_bf16 v[180:183], v[216:219], v[224:227], v[180:183]
    ds_read_b128 v[216:219], v20 offset:17408
    s_waitcnt lgkmcnt(6)
    s_barrier
    v_mfma_f32_16x16x32_bf16 v[112:115], v[184:187], v[228:231], v[112:115]
    v_exp_f32 v252, v252
    v_mfma_f32_16x16x32_bf16 v[116:119], v[184:187], v[232:235], v[116:119]
    ds_read_b128 v[184:187], v21 offset:34816
    v_exp_f32 v253, v253
    v_mfma_f32_16x16x32_bf16 v[120:123], v[188:191], v[228:231], v[120:123]
    ds_read_b128 v[220:223], v18 offset:34816
    v_exp_f32 v96, v96
    v_mfma_f32_16x16x32_bf16 v[124:127], v[188:191], v[232:235], v[124:127]
    ds_read_b128 v[188:191], v21 offset:35840
    v_exp_f32 v97, v97
    v_mfma_f32_16x16x32_bf16 v[128:131], v[192:195], v[228:231], v[128:131]
    ds_read_b128 v[224:227], v18 offset:36864
    v_exp_f32 v98, v98
    v_mfma_f32_16x16x32_bf16 v[132:135], v[192:195], v[232:235], v[132:135]
    ds_read_b128 v[192:195], v21 offset:36864
    s_waitcnt lgkmcnt(8)
    v_mfma_f32_16x16x32_bf16 v[136:139], v[196:199], v[228:231], v[136:139]
    v_exp_f32 v99, v99
    v_mfma_f32_16x16x32_bf16 v[140:143], v[196:199], v[232:235], v[140:143]
    ds_read_b128 v[196:199], v21 offset:37888
    v_exp_f32 v100, v100
    v_mfma_f32_16x16x32_bf16 v[144:147], v[200:203], v[228:231], v[144:147]
    v_exp_f32 v101, v101
    v_mfma_f32_16x16x32_bf16 v[148:151], v[200:203], v[232:235], v[148:151]
    ds_read_b128 v[200:203], v21 offset:38912
    v_exp_f32 v102, v102
    v_mfma_f32_16x16x32_bf16 v[152:155], v[204:207], v[228:231], v[152:155]
    v_exp_f32 v103, v103
    v_mfma_f32_16x16x32_bf16 v[156:159], v[204:207], v[232:235], v[156:159]
    ds_read_b128 v[204:207], v21 offset:39936
    s_waitcnt lgkmcnt(8)
    v_mfma_f32_16x16x32_bf16 v[160:163], v[208:211], v[228:231], v[160:163]
    v_exp_f32 v104, v104
    v_mfma_f32_16x16x32_bf16 v[164:167], v[208:211], v[232:235], v[164:167]
    ds_read_b128 v[208:211], v21 offset:40960
    v_exp_f32 v105, v105
    v_mfma_f32_16x16x32_bf16 v[168:171], v[212:215], v[228:231], v[168:171]
    v_exp_f32 v106, v106
    v_mfma_f32_16x16x32_bf16 v[172:175], v[212:215], v[232:235], v[172:175]
    ds_read_b128 v[212:215], v21 offset:41984
    v_exp_f32 v107, v107
    v_mfma_f32_16x16x32_bf16 v[176:179], v[216:219], v[228:231], v[176:179]
    v_exp_f32 v108, v108
    v_mfma_f32_16x16x32_bf16 v[180:183], v[216:219], v[232:235], v[180:183]
    ds_read_b128 v[216:219], v21 offset:43008
    s_waitcnt lgkmcnt(6)
    v_mfma_f32_16x16x32_bf16 v[112:115], v[184:187], v[220:223], v[112:115]
    v_exp_f32 v109, v109
    v_mfma_f32_16x16x32_bf16 v[116:119], v[184:187], v[224:227], v[116:119]
    ds_read_b128 v[184:187], v21 offset:44032
    v_exp_f32 v110, v110
    v_mfma_f32_16x16x32_bf16 v[120:123], v[188:191], v[220:223], v[120:123]
    ds_read_b128 v[228:231], v19 offset:34816
    v_exp_f32 v111, v111
    v_mfma_f32_16x16x32_bf16 v[124:127], v[188:191], v[224:227], v[124:127]
    ds_read_b128 v[188:191], v21 offset:45056
    v_exp_f32 v32, v32
    v_mfma_f32_16x16x32_bf16 v[128:131], v[192:195], v[220:223], v[128:131]
    ds_read_b128 v[232:235], v19 offset:36864
    v_exp_f32 v33, v33
    v_mfma_f32_16x16x32_bf16 v[132:135], v[192:195], v[224:227], v[132:135]
    ds_read_b128 v[192:195], v21 offset:46080
    s_waitcnt lgkmcnt(8)
    v_mfma_f32_16x16x32_bf16 v[136:139], v[196:199], v[220:223], v[136:139]
    v_add_f32 v13, v236, v237
    v_add_f32 v23, v238, v239
    v_mfma_f32_16x16x32_bf16 v[140:143], v[196:199], v[224:227], v[140:143]
    ds_read_b128 v[196:199], v21 offset:47104
    v_add_f32 v13, v13, v240
    v_add_f32 v23, v23, v241
    v_mfma_f32_16x16x32_bf16 v[144:147], v[200:203], v[220:223], v[144:147]
    v_add_f32 v13, v13, v242
    v_add_f32 v23, v23, v243
    v_mfma_f32_16x16x32_bf16 v[148:151], v[200:203], v[224:227], v[148:151]
    ds_read_b128 v[200:203], v21 offset:48128
    v_add_f32 v13, v13, v244
    v_add_f32 v23, v23, v245
    v_mfma_f32_16x16x32_bf16 v[152:155], v[204:207], v[220:223], v[152:155]
    v_add_f32 v13, v13, v246
    v_add_f32 v23, v23, v247
    v_mfma_f32_16x16x32_bf16 v[156:159], v[204:207], v[224:227], v[156:159]
    ds_read_b128 v[204:207], v21 offset:49152
    s_waitcnt lgkmcnt(8)
    v_mfma_f32_16x16x32_bf16 v[160:163], v[208:211], v[220:223], v[160:163]
    v_add_f32 v13, v13, v248
    v_add_f32 v23, v23, v249
    v_mfma_f32_16x16x32_bf16 v[164:167], v[208:211], v[224:227], v[164:167]
    ds_read_b128 v[208:211], v21 offset:50176
    v_add_f32 v13, v13, v250
    v_add_f32 v23, v23, v251
    v_mfma_f32_16x16x32_bf16 v[168:171], v[212:215], v[220:223], v[168:171]
    v_add_f32 v13, v13, v252
    v_add_f32 v23, v23, v253
    v_mfma_f32_16x16x32_bf16 v[172:175], v[212:215], v[224:227], v[172:175]
    ds_read_b128 v[212:215], v21 offset:51200
    v_add_f32 v13, v13, v23
    v_add_f32 v12, v96, v97
    v_mfma_f32_16x16x32_bf16 v[176:179], v[216:219], v[220:223], v[176:179]
    v_add_f32 v22, v98, v99
    v_add_f32 v12, v12, v100
    v_mfma_f32_16x16x32_bf16 v[180:183], v[216:219], v[224:227], v[180:183]
    ds_read_b128 v[216:219], v21 offset:52224
    s_waitcnt lgkmcnt(6)
    s_barrier
    v_mfma_f32_16x16x32_bf16 v[112:115], v[184:187], v[228:231], v[112:115]
    v_add_f32 v22, v22, v101
    v_add_f32 v12, v12, v102
    v_mfma_f32_16x16x32_bf16 v[116:119], v[184:187], v[232:235], v[116:119]
    ds_read_b128 v[184:187], v20 offset:36864
    v_add_f32 v22, v22, v103
    v_add_f32 v12, v12, v104
    v_mfma_f32_16x16x32_bf16 v[120:123], v[188:191], v[228:231], v[120:123]
    ds_read_b128 v[220:223], v16 offset:36864
    v_add_f32 v22, v22, v105
    v_add_f32 v12, v12, v106
    v_mfma_f32_16x16x32_bf16 v[124:127], v[188:191], v[232:235], v[124:127]
    ds_read_b128 v[188:191], v20 offset:37888
    v_add_f32 v22, v22, v107
    v_add_f32 v12, v12, v108
    v_mfma_f32_16x16x32_bf16 v[128:131], v[192:195], v[228:231], v[128:131]
    ds_read_b128 v[224:227], v16 offset:38912
    v_add_f32 v22, v22, v109
    v_add_f32 v12, v12, v110
    v_mfma_f32_16x16x32_bf16 v[132:135], v[192:195], v[232:235], v[132:135]
    ds_read_b128 v[192:195], v20 offset:38912
    s_waitcnt lgkmcnt(8)
    v_mfma_f32_16x16x32_bf16 v[136:139], v[196:199], v[228:231], v[136:139]
    v_add_f32 v22, v22, v111
    v_add_f32 v12, v12, v32
    v_mfma_f32_16x16x32_bf16 v[140:143], v[196:199], v[232:235], v[140:143]
    ds_read_b128 v[196:199], v20 offset:39936
    v_add_f32 v22, v22, v33
    v_add_f32 v12, v12, v22
    v_mfma_f32_16x16x32_bf16 v[144:147], v[200:203], v[228:231], v[144:147]
    v_rcp_f32 v13, v13
    v_mfma_f32_16x16x32_bf16 v[148:151], v[200:203], v[232:235], v[148:151]
    ds_read_b128 v[200:203], v20 offset:40960
    v_rcp_f32 v12, v12
    v_mfma_f32_16x16x32_bf16 v[152:155], v[204:207], v[228:231], v[152:155]
    v_mul_f32 v236, v236, v13
    v_mul_f32 v237, v237, v13
    v_mfma_f32_16x16x32_bf16 v[156:159], v[204:207], v[232:235], v[156:159]
    ds_read_b128 v[204:207], v20 offset:41984
    s_waitcnt lgkmcnt(8)
    v_mfma_f32_16x16x32_bf16 v[160:163], v[208:211], v[228:231], v[160:163]
    v_mul_f32 v238, v238, v13
    v_mul_f32 v239, v239, v13
    v_mfma_f32_16x16x32_bf16 v[164:167], v[208:211], v[232:235], v[164:167]
    ds_read_b128 v[208:211], v20 offset:43008
    v_mul_f32 v240, v240, v13
    v_mul_f32 v241, v241, v13
    v_mfma_f32_16x16x32_bf16 v[168:171], v[212:215], v[228:231], v[168:171]
    v_mul_f32 v242, v242, v13
    v_mul_f32 v243, v243, v13
    v_mfma_f32_16x16x32_bf16 v[172:175], v[212:215], v[232:235], v[172:175]
    ds_read_b128 v[212:215], v20 offset:44032
    v_mul_f32 v244, v244, v13
    v_mul_f32 v245, v245, v13
    v_mfma_f32_16x16x32_bf16 v[176:179], v[216:219], v[228:231], v[176:179]
    v_mul_f32 v246, v246, v13
    v_mul_f32 v247, v247, v13
    v_mfma_f32_16x16x32_bf16 v[180:183], v[216:219], v[232:235], v[180:183]
    ds_read_b128 v[216:219], v20 offset:45056
    s_waitcnt lgkmcnt(6)
    v_mfma_f32_16x16x32_bf16 v[112:115], v[184:187], v[220:223], v[112:115]
    v_mul_f32 v248, v248, v13
    v_mul_f32 v249, v249, v13
    v_mfma_f32_16x16x32_bf16 v[116:119], v[184:187], v[224:227], v[116:119]
    ds_read_b128 v[184:187], v20 offset:46080
    v_mul_f32 v250, v250, v13
    v_mul_f32 v251, v251, v13
    v_mfma_f32_16x16x32_bf16 v[120:123], v[188:191], v[220:223], v[120:123]
    ds_read_b128 v[228:231], v17 offset:36864
    v_mul_f32 v252, v252, v13
    v_mul_f32 v253, v253, v13
    v_mfma_f32_16x16x32_bf16 v[124:127], v[188:191], v[224:227], v[124:127]
    ds_read_b128 v[188:191], v20 offset:47104
    v_mul_f32 v96, v96, v12
    v_mul_f32 v97, v97, v12
    v_mfma_f32_16x16x32_bf16 v[128:131], v[192:195], v[220:223], v[128:131]
    ds_read_b128 v[232:235], v17 offset:38912
    v_mul_f32 v98, v98, v12
    v_mul_f32 v99, v99, v12
    v_mfma_f32_16x16x32_bf16 v[132:135], v[192:195], v[224:227], v[132:135]
    ds_read_b128 v[192:195], v20 offset:48128
    s_waitcnt lgkmcnt(8)
    v_mfma_f32_16x16x32_bf16 v[136:139], v[196:199], v[220:223], v[136:139]
    v_mul_f32 v100, v100, v12
    v_mul_f32 v101, v101, v12
    v_mfma_f32_16x16x32_bf16 v[140:143], v[196:199], v[224:227], v[140:143]
    ds_read_b128 v[196:199], v20 offset:49152
    v_mul_f32 v102, v102, v12
    v_mul_f32 v103, v103, v12
    v_mfma_f32_16x16x32_bf16 v[144:147], v[200:203], v[220:223], v[144:147]
    v_mul_f32 v104, v104, v12
    v_mul_f32 v105, v105, v12
    v_mfma_f32_16x16x32_bf16 v[148:151], v[200:203], v[224:227], v[148:151]
    ds_read_b128 v[200:203], v20 offset:50176
    v_mul_f32 v106, v106, v12
    v_mul_f32 v107, v107, v12
    v_mfma_f32_16x16x32_bf16 v[152:155], v[204:207], v[220:223], v[152:155]
    v_mul_f32 v108, v108, v12
    v_mul_f32 v109, v109, v12
    v_mfma_f32_16x16x32_bf16 v[156:159], v[204:207], v[224:227], v[156:159]
    ds_read_b128 v[204:207], v20 offset:51200
    s_waitcnt lgkmcnt(8)
    v_mfma_f32_16x16x32_bf16 v[160:163], v[208:211], v[220:223], v[160:163]
    v_mul_f32 v110, v110, v12
    v_mul_f32 v111, v111, v12
    v_mfma_f32_16x16x32_bf16 v[164:167], v[208:211], v[224:227], v[164:167]
    ds_read_b128 v[208:211], v20 offset:52224
    v_mul_f32 v32, v32, v12
    v_mul_f32 v33, v33, v12
    v_mfma_f32_16x16x32_bf16 v[168:171], v[212:215], v[220:223], v[168:171]
    v_cvt_pk_bf16_f32 v96, v96, v97
    v_cvt_pk_bf16_f32 v97, v98, v99
    v_mfma_f32_16x16x32_bf16 v[172:175], v[212:215], v[224:227], v[172:175]
    ds_read_b128 v[212:215], v20 offset:53248
    v_cvt_pk_bf16_f32 v98, v100, v101
    v_cvt_pk_bf16_f32 v99, v102, v103
    v_mfma_f32_16x16x32_bf16 v[176:179], v[216:219], v[220:223], v[176:179]
    v_cvt_pk_bf16_f32 v100, v104, v105
    v_cvt_pk_bf16_f32 v101, v106, v107
    v_mfma_f32_16x16x32_bf16 v[180:183], v[216:219], v[224:227], v[180:183]
    ds_read_b128 v[216:219], v20 offset:54272
    s_waitcnt lgkmcnt(6)
    s_barrier
    v_mfma_f32_16x16x32_bf16 v[112:115], v[184:187], v[228:231], v[112:115]
    v_cvt_pk_bf16_f32 v102, v108, v109
    v_cvt_pk_bf16_f32 v103, v110, v111
    v_mfma_f32_16x16x32_bf16 v[116:119], v[184:187], v[232:235], v[116:119]
    ds_read_b128 v[184:187], v21 offset:0
    v_cvt_pk_bf16_f32 v104, v32, v33
    v_cvt_pk_bf16_f32 v105, v236, v237
    v_mfma_f32_16x16x32_bf16 v[120:123], v[188:191], v[228:231], v[120:123]
    ds_read_b128 v[220:223], v18 offset:0
    v_cvt_pk_bf16_f32 v106, v238, v239
    v_cvt_pk_bf16_f32 v107, v240, v241
    v_mfma_f32_16x16x32_bf16 v[124:127], v[188:191], v[232:235], v[124:127]
    ds_read_b128 v[188:191], v21 offset:1024
    v_cvt_pk_bf16_f32 v108, v242, v243
    v_cvt_pk_bf16_f32 v109, v244, v245
    v_mfma_f32_16x16x32_bf16 v[128:131], v[192:195], v[228:231], v[128:131]
    ds_read_b128 v[224:227], v18 offset:2048
    v_cvt_pk_bf16_f32 v110, v246, v247
    v_cvt_pk_bf16_f32 v111, v248, v249
    v_mfma_f32_16x16x32_bf16 v[132:135], v[192:195], v[232:235], v[132:135]
    ds_read_b128 v[192:195], v21 offset:2048
    s_waitcnt lgkmcnt(8)
    v_mfma_f32_16x16x32_bf16 v[136:139], v[196:199], v[228:231], v[136:139]
    v_cvt_pk_bf16_f32 v32, v250, v251
    v_cvt_pk_bf16_f32 v33, v252, v253
    v_mfma_f32_16x16x32_bf16 v[140:143], v[196:199], v[232:235], v[140:143]
    ds_read_b128 v[196:199], v21 offset:3072
    v_mov_b32 v34, 0
    v_mov_b32 v35, 0
    v_mfma_f32_16x16x32_bf16 v[144:147], v[200:203], v[228:231], v[144:147]
    v_lshlrev_b32 v236, 16, v40
    v_and_b32 v237, s83, v40
    v_mfma_f32_16x16x32_bf16 v[148:151], v[200:203], v[232:235], v[148:151]
    ds_read_b128 v[200:203], v21 offset:4096
    v_lshlrev_b32 v238, 16, v41
    v_and_b32 v239, s83, v41
    v_mfma_f32_16x16x32_bf16 v[152:155], v[204:207], v[228:231], v[152:155]
    ds_write_b64 v39, v[96:97] offset:0
    v_lshlrev_b32 v240, 16, v42
    v_mfma_f32_16x16x32_bf16 v[156:159], v[204:207], v[232:235], v[156:159]
    ds_read_b128 v[204:207], v21 offset:5120
    s_waitcnt lgkmcnt(9)
    v_mfma_f32_16x16x32_bf16 v[160:163], v[208:211], v[228:231], v[160:163]
    v_and_b32 v241, s83, v42
    v_lshlrev_b32 v242, 16, v43
    v_mfma_f32_16x16x32_bf16 v[164:167], v[208:211], v[232:235], v[164:167]
    ds_read_b128 v[208:211], v21 offset:6144
    v_and_b32 v243, s83, v43
    v_pk_mul_f32 v[244:245], v[236:237], v[236:237]
    v_mfma_f32_16x16x32_bf16 v[168:171], v[212:215], v[228:231], v[168:171]
    ds_write_b64 v39, v[98:99] offset:8
    v_pk_mul_f32 v[246:247], v[238:239], v[238:239]
    v_mfma_f32_16x16x32_bf16 v[172:175], v[212:215], v[232:235], v[172:175]
    ds_read_b128 v[212:215], v21 offset:7168
    v_pk_mul_f32 v[248:249], v[240:241], v[240:241]
    v_pk_mul_f32 v[250:251], v[242:243], v[242:243]
    v_mfma_f32_16x16x32_bf16 v[176:179], v[216:219], v[228:231], v[176:179]
    v_pk_fma_f32 v[244:245], v[244:245], s[74:75], v[36:37]
    v_pk_fma_f32 v[246:247], v[246:247], s[74:75], v[36:37]
    v_mfma_f32_16x16x32_bf16 v[180:183], v[216:219], v[232:235], v[180:183]
    ds_read_b128 v[216:219], v21 offset:8192
    s_waitcnt lgkmcnt(8)
    v_mfma_f32_16x16x32_bf16 v[112:115], v[184:187], v[220:223], v[112:115]
    ds_write_b64 v39, v[100:101] offset:16
    v_pk_fma_f32 v[248:249], v[248:249], s[74:75], v[36:37]
    v_mfma_f32_16x16x32_bf16 v[116:119], v[184:187], v[224:227], v[116:119]
    ds_read_b128 v[184:187], v21 offset:9216
    v_pk_fma_f32 v[250:251], v[250:251], s[74:75], v[36:37]
    v_pk_mul_f32 v[244:245], v[244:245], v[236:237]
    v_mfma_f32_16x16x32_bf16 v[120:123], v[188:191], v[220:223], v[120:123]
    ds_read_b128 v[228:231], v19 offset:0
    v_pk_mul_f32 v[246:247], v[246:247], v[238:239]
    v_pk_mul_f32 v[248:249], v[248:249], v[240:241]
    v_mfma_f32_16x16x32_bf16 v[124:127], v[188:191], v[224:227], v[124:127]
    ds_read_b128 v[188:191], v21 offset:10240
    ds_write_b64 v39, v[102:103] offset:24
    v_pk_mul_f32 v[250:251], v[250:251], v[242:243]
    v_mfma_f32_16x16x32_bf16 v[128:131], v[192:195], v[220:223], v[128:131]
    ds_read_b128 v[232:235], v19 offset:2048
    v_exp_f32 v244, v244
    v_mfma_f32_16x16x32_bf16 v[132:135], v[192:195], v[224:227], v[132:135]
    ds_read_b128 v[192:195], v21 offset:11264
    s_waitcnt lgkmcnt(11)
    v_mfma_f32_16x16x32_bf16 v[136:139], v[196:199], v[220:223], v[136:139]
    v_exp_f32 v245, v245
    v_mfma_f32_16x16x32_bf16 v[140:143], v[196:199], v[224:227], v[140:143]
    ds_read_b128 v[196:199], v21 offset:12288
    ds_write_b64 v39, v[104:105] offset:32
    v_mfma_f32_16x16x32_bf16 v[144:147], v[200:203], v[220:223], v[144:147]
    v_exp_f32 v246, v246
    v_mfma_f32_16x16x32_bf16 v[148:151], v[200:203], v[224:227], v[148:151]
    ds_read_b128 v[200:203], v21 offset:13312
    v_exp_f32 v247, v247
    v_mfma_f32_16x16x32_bf16 v[152:155], v[204:207], v[220:223], v[152:155]
    ds_write_b64 v39, v[106:107] offset:40
    v_mfma_f32_16x16x32_bf16 v[156:159], v[204:207], v[224:227], v[156:159]
    ds_read_b128 v[204:207], v21 offset:14336
    s_waitcnt lgkmcnt(12)
    v_mfma_f32_16x16x32_bf16 v[160:163], v[208:211], v[220:223], v[160:163]
    v_exp_f32 v248, v248
    v_mfma_f32_16x16x32_bf16 v[164:167], v[208:211], v[224:227], v[164:167]
    ds_read_b128 v[208:211], v21 offset:15360
    v_exp_f32 v249, v249
    v_mfma_f32_16x16x32_bf16 v[168:171], v[212:215], v[220:223], v[168:171]
    ds_write_b64 v39, v[108:109] offset:48
    v_mfma_f32_16x16x32_bf16 v[172:175], v[212:215], v[224:227], v[172:175]
    ds_read_b128 v[212:215], v21 offset:16384
    v_exp_f32 v250, v250
    v_mfma_f32_16x16x32_bf16 v[176:179], v[216:219], v[220:223], v[176:179]
    v_exp_f32 v251, v251
    v_mfma_f32_16x16x32_bf16 v[180:183], v[216:219], v[224:227], v[180:183]
    ds_read_b128 v[216:219], v21 offset:17408
    s_waitcnt lgkmcnt(9)
    s_waitcnt lgkmcnt(2)
    s_barrier
    v_mfma_f32_16x16x32_bf16 v[112:115], v[184:187], v[228:231], v[112:115]
    ds_write_b64 v39, v[110:111] offset:56
    v_pk_add_f32 v[244:245], v[244:245], s[76:77]
    v_mfma_f32_16x16x32_bf16 v[116:119], v[184:187], v[232:235], v[116:119]
    ds_read_b128 v[184:187], v20 offset:0
    v_pk_add_f32 v[246:247], v[246:247], s[76:77]
    v_pk_add_f32 v[248:249], v[248:249], s[76:77]
    v_mfma_f32_16x16x32_bf16 v[120:123], v[188:191], v[228:231], v[120:123]
    ds_read_b128 v[220:223], v16 offset:0
    v_pk_add_f32 v[250:251], v[250:251], s[76:77]
    v_mfma_f32_16x16x32_bf16 v[124:127], v[188:191], v[232:235], v[124:127]
    ds_read_b128 v[188:191], v20 offset:1024
    ds_write_b64 v39, v[32:33] offset:64
    v_mfma_f32_16x16x32_bf16 v[128:131], v[192:195], v[228:231], v[128:131]
    ds_read_b128 v[224:227], v16 offset:2048
    v_rcp_f32 v244, v244
    v_mfma_f32_16x16x32_bf16 v[132:135], v[192:195], v[232:235], v[132:135]
    ds_read_b128 v[192:195], v20 offset:2048
    v_mfma_f32_16x16x32_bf16 v[136:139], v[196:199], v[228:231], v[136:139]
    v_rcp_f32 v245, v245
    v_mfma_f32_16x16x32_bf16 v[140:143], v[196:199], v[232:235], v[140:143]
    ds_read_b128 v[196:199], v20 offset:3072
    v_rcp_f32 v246, v246
    v_mfma_f32_16x16x32_bf16 v[144:147], v[200:203], v[228:231], v[144:147]
    v_rcp_f32 v247, v247
    v_mfma_f32_16x16x32_bf16 v[148:151], v[200:203], v[232:235], v[148:151]
    ds_read_b128 v[200:203], v20 offset:4096
    v_rcp_f32 v248, v248
    v_mfma_f32_16x16x32_bf16 v[152:155], v[204:207], v[228:231], v[152:155]
    v_rcp_f32 v249, v249
    v_mfma_f32_16x16x32_bf16 v[156:159], v[204:207], v[232:235], v[156:159]
    ds_read_b128 v[204:207], v20 offset:5120
    s_waitcnt lgkmcnt(10)
    v_mfma_f32_16x16x32_bf16 v[160:163], v[208:211], v[228:231], v[160:163]
    v_rcp_f32 v250, v250
    v_mfma_f32_16x16x32_bf16 v[164:167], v[208:211], v[232:235], v[164:167]
    ds_read_b128 v[208:211], v20 offset:6144
    v_rcp_f32 v251, v251
    v_mfma_f32_16x16x32_bf16 v[168:171], v[212:215], v[228:231], v[168:171]
    v_pk_mul_f32 v[236:237], v[236:237], v[244:245]
    v_pk_mul_f32 v[238:239], v[238:239], v[246:247]
    v_mfma_f32_16x16x32_bf16 v[172:175], v[212:215], v[232:235], v[172:175]
    ds_read_b128 v[212:215], v20 offset:7168
    v_pk_mul_f32 v[240:241], v[240:241], v[248:249]
    v_pk_mul_f32 v[242:243], v[242:243], v[250:251]
    v_mfma_f32_16x16x32_bf16 v[176:179], v[216:219], v[228:231], v[176:179]
    v_cvt_pk_bf16_f32 v40, v236, v237
    v_cvt_pk_bf16_f32 v41, v238, v239
    v_mfma_f32_16x16x32_bf16 v[180:183], v[216:219], v[232:235], v[180:183]
    ds_read_b128 v[216:219], v20 offset:8192
    s_waitcnt lgkmcnt(6)
    v_mfma_f32_16x16x32_bf16 v[112:115], v[184:187], v[220:223], v[112:115]
    v_cvt_pk_bf16_f32 v42, v240, v241
    v_cvt_pk_bf16_f32 v43, v242, v243
    v_mfma_f32_16x16x32_bf16 v[116:119], v[184:187], v[224:227], v[116:119]
    ds_read_b128 v[184:187], v20 offset:9216
    v_lshlrev_b32 v236, 16, v44
    v_and_b32 v237, s83, v44
    v_mfma_f32_16x16x32_bf16 v[120:123], v[188:191], v[220:223], v[120:123]
    ds_read_b128 v[228:231], v17 offset:0
    v_lshlrev_b32 v238, 16, v45
    v_and_b32 v239, s83, v45
    v_mfma_f32_16x16x32_bf16 v[124:127], v[188:191], v[224:227], v[124:127]
    ds_read_b128 v[188:191], v20 offset:10240
    v_lshlrev_b32 v240, 16, v46
    v_and_b32 v241, s83, v46
    v_mfma_f32_16x16x32_bf16 v[128:131], v[192:195], v[220:223], v[128:131]
    ds_read_b128 v[232:235], v17 offset:2048
    v_lshlrev_b32 v242, 16, v47
    v_and_b32 v243, s83, v47
    v_mfma_f32_16x16x32_bf16 v[132:135], v[192:195], v[224:227], v[132:135]
    ds_read_b128 v[192:195], v20 offset:11264
    s_waitcnt lgkmcnt(8)
    v_mfma_f32_16x16x32_bf16 v[136:139], v[196:199], v[220:223], v[136:139]
    v_pk_mul_f32 v[244:245], v[236:237], v[236:237]
    v_pk_mul_f32 v[246:247], v[238:239], v[238:239]
    v_mfma_f32_16x16x32_bf16 v[140:143], v[196:199], v[224:227], v[140:143]
    ds_read_b128 v[196:199], v20 offset:12288
    v_pk_mul_f32 v[248:249], v[240:241], v[240:241]
    v_pk_mul_f32 v[250:251], v[242:243], v[242:243]
    v_mfma_f32_16x16x32_bf16 v[144:147], v[200:203], v[220:223], v[144:147]
    v_pk_fma_f32 v[244:245], v[244:245], s[74:75], v[36:37]
    v_pk_fma_f32 v[246:247], v[246:247], s[74:75], v[36:37]
    v_mfma_f32_16x16x32_bf16 v[148:151], v[200:203], v[224:227], v[148:151]
    ds_read_b128 v[200:203], v20 offset:13312
    v_pk_fma_f32 v[248:249], v[248:249], s[74:75], v[36:37]
    v_pk_fma_f32 v[250:251], v[250:251], s[74:75], v[36:37]
    v_mfma_f32_16x16x32_bf16 v[152:155], v[204:207], v[220:223], v[152:155]
    v_pk_mul_f32 v[244:245], v[244:245], v[236:237]
    v_pk_mul_f32 v[246:247], v[246:247], v[238:239]
    v_mfma_f32_16x16x32_bf16 v[156:159], v[204:207], v[224:227], v[156:159]
    ds_read_b128 v[204:207], v20 offset:14336
    s_waitcnt lgkmcnt(8)
    v_mfma_f32_16x16x32_bf16 v[160:163], v[208:211], v[220:223], v[160:163]
    v_pk_mul_f32 v[248:249], v[248:249], v[240:241]
    v_pk_mul_f32 v[250:251], v[250:251], v[242:243]
    v_mfma_f32_16x16x32_bf16 v[164:167], v[208:211], v[224:227], v[164:167]
    ds_read_b128 v[208:211], v20 offset:15360
    v_exp_f32 v244, v244
    v_mfma_f32_16x16x32_bf16 v[168:171], v[212:215], v[220:223], v[168:171]
    v_exp_f32 v245, v245
    v_mfma_f32_16x16x32_bf16 v[172:175], v[212:215], v[224:227], v[172:175]
    ds_read_b128 v[212:215], v20 offset:16384
    v_exp_f32 v246, v246
    v_mfma_f32_16x16x32_bf16 v[176:179], v[216:219], v[220:223], v[176:179]
    v_exp_f32 v247, v247
    v_mfma_f32_16x16x32_bf16 v[180:183], v[216:219], v[224:227], v[180:183]
    ds_read_b128 v[216:219], v20 offset:17408
    s_waitcnt lgkmcnt(6)
    s_barrier
    v_mfma_f32_16x16x32_bf16 v[112:115], v[184:187], v[228:231], v[112:115]
    v_exp_f32 v248, v248
    v_mfma_f32_16x16x32_bf16 v[116:119], v[184:187], v[232:235], v[116:119]
    ds_read_b128 v[184:187], v21 offset:34816
    v_exp_f32 v249, v249
    v_mfma_f32_16x16x32_bf16 v[120:123], v[188:191], v[228:231], v[120:123]
    ds_read_b128 v[220:223], v18 offset:34816
    v_exp_f32 v250, v250
    v_mfma_f32_16x16x32_bf16 v[124:127], v[188:191], v[232:235], v[124:127]
    ds_read_b128 v[188:191], v21 offset:35840
    v_exp_f32 v251, v251
    v_mfma_f32_16x16x32_bf16 v[128:131], v[192:195], v[228:231], v[128:131]
    ds_read_b128 v[224:227], v18 offset:36864
    v_pk_add_f32 v[244:245], v[244:245], s[76:77]
    v_pk_add_f32 v[246:247], v[246:247], s[76:77]
    v_mfma_f32_16x16x32_bf16 v[132:135], v[192:195], v[232:235], v[132:135]
    ds_read_b128 v[192:195], v21 offset:36864
    s_waitcnt lgkmcnt(8)
    v_mfma_f32_16x16x32_bf16 v[136:139], v[196:199], v[228:231], v[136:139]
    v_pk_add_f32 v[248:249], v[248:249], s[76:77]
    v_pk_add_f32 v[250:251], v[250:251], s[76:77]
    v_mfma_f32_16x16x32_bf16 v[140:143], v[196:199], v[232:235], v[140:143]
    ds_read_b128 v[196:199], v21 offset:37888
    v_rcp_f32 v244, v244
    v_mfma_f32_16x16x32_bf16 v[144:147], v[200:203], v[228:231], v[144:147]
    v_rcp_f32 v245, v245
    v_mfma_f32_16x16x32_bf16 v[148:151], v[200:203], v[232:235], v[148:151]
    ds_read_b128 v[200:203], v21 offset:38912
    v_rcp_f32 v246, v246
    v_mfma_f32_16x16x32_bf16 v[152:155], v[204:207], v[228:231], v[152:155]
    v_rcp_f32 v247, v247
    v_mfma_f32_16x16x32_bf16 v[156:159], v[204:207], v[232:235], v[156:159]
    ds_read_b128 v[204:207], v21 offset:39936
    s_waitcnt lgkmcnt(8)
    v_mfma_f32_16x16x32_bf16 v[160:163], v[208:211], v[228:231], v[160:163]
    v_rcp_f32 v248, v248
    v_mfma_f32_16x16x32_bf16 v[164:167], v[208:211], v[232:235], v[164:167]
    ds_read_b128 v[208:211], v21 offset:40960
    v_rcp_f32 v249, v249
    v_mfma_f32_16x16x32_bf16 v[168:171], v[212:215], v[228:231], v[168:171]
    v_rcp_f32 v250, v250
    v_mfma_f32_16x16x32_bf16 v[172:175], v[212:215], v[232:235], v[172:175]
    ds_read_b128 v[212:215], v21 offset:41984
    v_rcp_f32 v251, v251
    v_mfma_f32_16x16x32_bf16 v[176:179], v[216:219], v[228:231], v[176:179]
    v_pk_mul_f32 v[236:237], v[236:237], v[244:245]
    v_pk_mul_f32 v[238:239], v[238:239], v[246:247]
    v_mfma_f32_16x16x32_bf16 v[180:183], v[216:219], v[232:235], v[180:183]
    ds_read_b128 v[216:219], v21 offset:43008
    s_waitcnt lgkmcnt(6)
    v_mfma_f32_16x16x32_bf16 v[112:115], v[184:187], v[220:223], v[112:115]
    v_pk_mul_f32 v[240:241], v[240:241], v[248:249]
    v_pk_mul_f32 v[242:243], v[242:243], v[250:251]
    v_mfma_f32_16x16x32_bf16 v[116:119], v[184:187], v[224:227], v[116:119]
    ds_read_b128 v[184:187], v21 offset:44032
    v_cvt_pk_bf16_f32 v44, v236, v237
    v_cvt_pk_bf16_f32 v45, v238, v239
    v_mfma_f32_16x16x32_bf16 v[120:123], v[188:191], v[220:223], v[120:123]
    ds_read_b128 v[228:231], v19 offset:34816
    v_cvt_pk_bf16_f32 v46, v240, v241
    v_cvt_pk_bf16_f32 v47, v242, v243
    v_mfma_f32_16x16x32_bf16 v[124:127], v[188:191], v[224:227], v[124:127]
    ds_read_b128 v[188:191], v21 offset:45056
    v_lshlrev_b32 v236, 16, v48
    v_and_b32 v237, s83, v48
    v_mfma_f32_16x16x32_bf16 v[128:131], v[192:195], v[220:223], v[128:131]
    ds_read_b128 v[232:235], v19 offset:36864
    v_lshlrev_b32 v238, 16, v49
    v_and_b32 v239, s83, v49
    v_mfma_f32_16x16x32_bf16 v[132:135], v[192:195], v[224:227], v[132:135]
    ds_read_b128 v[192:195], v21 offset:46080
    s_waitcnt lgkmcnt(8)
    v_mfma_f32_16x16x32_bf16 v[136:139], v[196:199], v[220:223], v[136:139]
    v_lshlrev_b32 v240, 16, v50
    v_and_b32 v241, s83, v50
    v_mfma_f32_16x16x32_bf16 v[140:143], v[196:199], v[224:227], v[140:143]
    ds_read_b128 v[196:199], v21 offset:47104
    v_lshlrev_b32 v242, 16, v51
    v_and_b32 v243, s83, v51
    v_mfma_f32_16x16x32_bf16 v[144:147], v[200:203], v[220:223], v[144:147]
    v_pk_mul_f32 v[244:245], v[236:237], v[236:237]
    v_pk_mul_f32 v[246:247], v[238:239], v[238:239]
    v_mfma_f32_16x16x32_bf16 v[148:151], v[200:203], v[224:227], v[148:151]
    ds_read_b128 v[200:203], v21 offset:48128
    v_pk_mul_f32 v[248:249], v[240:241], v[240:241]
    v_pk_mul_f32 v[250:251], v[242:243], v[242:243]
    v_mfma_f32_16x16x32_bf16 v[152:155], v[204:207], v[220:223], v[152:155]
    v_pk_fma_f32 v[244:245], v[244:245], s[74:75], v[36:37]
    v_pk_fma_f32 v[246:247], v[246:247], s[74:75], v[36:37]
    v_mfma_f32_16x16x32_bf16 v[156:159], v[204:207], v[224:227], v[156:159]
    ds_read_b128 v[204:207], v21 offset:49152
    s_waitcnt lgkmcnt(8)
    v_mfma_f32_16x16x32_bf16 v[160:163], v[208:211], v[220:223], v[160:163]
    v_pk_fma_f32 v[248:249], v[248:249], s[74:75], v[36:37]
    v_pk_fma_f32 v[250:251], v[250:251], s[74:75], v[36:37]
    v_mfma_f32_16x16x32_bf16 v[164:167], v[208:211], v[224:227], v[164:167]
    ds_read_b128 v[208:211], v21 offset:50176
    v_pk_mul_f32 v[244:245], v[244:245], v[236:237]
    v_pk_mul_f32 v[246:247], v[246:247], v[238:239]
    v_mfma_f32_16x16x32_bf16 v[168:171], v[212:215], v[220:223], v[168:171]
    v_pk_mul_f32 v[248:249], v[248:249], v[240:241]
    v_pk_mul_f32 v[250:251], v[250:251], v[242:243]
    v_mfma_f32_16x16x32_bf16 v[172:175], v[212:215], v[224:227], v[172:175]
    ds_read_b128 v[212:215], v21 offset:51200
    v_exp_f32 v244, v244
    v_mfma_f32_16x16x32_bf16 v[176:179], v[216:219], v[220:223], v[176:179]
    v_exp_f32 v245, v245
    v_mfma_f32_16x16x32_bf16 v[180:183], v[216:219], v[224:227], v[180:183]
    ds_read_b128 v[216:219], v21 offset:52224
    s_waitcnt lgkmcnt(6)
    s_barrier
    v_mfma_f32_16x16x32_bf16 v[112:115], v[184:187], v[228:231], v[112:115]
    v_exp_f32 v246, v246
    v_mfma_f32_16x16x32_bf16 v[116:119], v[184:187], v[232:235], v[116:119]
    ds_read_b128 v[184:187], v20 offset:36864
    v_exp_f32 v247, v247
    v_mfma_f32_16x16x32_bf16 v[120:123], v[188:191], v[228:231], v[120:123]
    ds_read_b128 v[220:223], v16 offset:36864
    v_exp_f32 v248, v248
    v_mfma_f32_16x16x32_bf16 v[124:127], v[188:191], v[232:235], v[124:127]
    ds_read_b128 v[188:191], v20 offset:37888
    v_exp_f32 v249, v249
    v_mfma_f32_16x16x32_bf16 v[128:131], v[192:195], v[228:231], v[128:131]
    ds_read_b128 v[224:227], v16 offset:38912
    v_exp_f32 v250, v250
    v_mfma_f32_16x16x32_bf16 v[132:135], v[192:195], v[232:235], v[132:135]
    ds_read_b128 v[192:195], v20 offset:38912
    s_waitcnt lgkmcnt(8)
    v_mfma_f32_16x16x32_bf16 v[136:139], v[196:199], v[228:231], v[136:139]
    v_exp_f32 v251, v251
    v_mfma_f32_16x16x32_bf16 v[140:143], v[196:199], v[232:235], v[140:143]
    ds_read_b128 v[196:199], v20 offset:39936
    v_pk_add_f32 v[244:245], v[244:245], s[76:77]
    v_pk_add_f32 v[246:247], v[246:247], s[76:77]
    v_mfma_f32_16x16x32_bf16 v[144:147], v[200:203], v[228:231], v[144:147]
    v_pk_add_f32 v[248:249], v[248:249], s[76:77]
    v_pk_add_f32 v[250:251], v[250:251], s[76:77]
    v_mfma_f32_16x16x32_bf16 v[148:151], v[200:203], v[232:235], v[148:151]
    ds_read_b128 v[200:203], v20 offset:40960
    v_rcp_f32 v244, v244
    v_mfma_f32_16x16x32_bf16 v[152:155], v[204:207], v[228:231], v[152:155]
    v_rcp_f32 v245, v245
    v_mfma_f32_16x16x32_bf16 v[156:159], v[204:207], v[232:235], v[156:159]
    ds_read_b128 v[204:207], v20 offset:41984
    s_waitcnt lgkmcnt(8)
    v_mfma_f32_16x16x32_bf16 v[160:163], v[208:211], v[228:231], v[160:163]
    v_rcp_f32 v246, v246
    v_mfma_f32_16x16x32_bf16 v[164:167], v[208:211], v[232:235], v[164:167]
    ds_read_b128 v[208:211], v20 offset:43008
    v_rcp_f32 v247, v247
    v_mfma_f32_16x16x32_bf16 v[168:171], v[212:215], v[228:231], v[168:171]
    v_rcp_f32 v248, v248
    v_mfma_f32_16x16x32_bf16 v[172:175], v[212:215], v[232:235], v[172:175]
    ds_read_b128 v[212:215], v20 offset:44032
    v_rcp_f32 v249, v249
    v_mfma_f32_16x16x32_bf16 v[176:179], v[216:219], v[228:231], v[176:179]
    v_rcp_f32 v250, v250
    v_mfma_f32_16x16x32_bf16 v[180:183], v[216:219], v[232:235], v[180:183]
    ds_read_b128 v[216:219], v20 offset:45056
    s_waitcnt lgkmcnt(6)
    v_mfma_f32_16x16x32_bf16 v[112:115], v[184:187], v[220:223], v[112:115]
    v_rcp_f32 v251, v251
    v_mfma_f32_16x16x32_bf16 v[116:119], v[184:187], v[224:227], v[116:119]
    ds_read_b128 v[184:187], v20 offset:46080
    v_pk_mul_f32 v[236:237], v[236:237], v[244:245]
    v_pk_mul_f32 v[238:239], v[238:239], v[246:247]
    v_mfma_f32_16x16x32_bf16 v[120:123], v[188:191], v[220:223], v[120:123]
    ds_read_b128 v[228:231], v17 offset:36864
    v_pk_mul_f32 v[240:241], v[240:241], v[248:249]
    v_pk_mul_f32 v[242:243], v[242:243], v[250:251]
    v_mfma_f32_16x16x32_bf16 v[124:127], v[188:191], v[224:227], v[124:127]
    ds_read_b128 v[188:191], v20 offset:47104
    v_cvt_pk_bf16_f32 v48, v236, v237
    v_cvt_pk_bf16_f32 v49, v238, v239
    v_mfma_f32_16x16x32_bf16 v[128:131], v[192:195], v[220:223], v[128:131]
    ds_read_b128 v[232:235], v17 offset:38912
    v_cvt_pk_bf16_f32 v50, v240, v241
    v_cvt_pk_bf16_f32 v51, v242, v243
    v_mfma_f32_16x16x32_bf16 v[132:135], v[192:195], v[224:227], v[132:135]
    ds_read_b128 v[192:195], v20 offset:48128
    s_waitcnt lgkmcnt(8)
    v_mfma_f32_16x16x32_bf16 v[136:139], v[196:199], v[220:223], v[136:139]
    v_lshlrev_b32 v236, 16, v52
    v_and_b32 v237, s83, v52
    v_mfma_f32_16x16x32_bf16 v[140:143], v[196:199], v[224:227], v[140:143]
    ds_read_b128 v[196:199], v20 offset:49152
    v_lshlrev_b32 v238, 16, v53
    v_and_b32 v239, s83, v53
    v_mfma_f32_16x16x32_bf16 v[144:147], v[200:203], v[220:223], v[144:147]
    v_lshlrev_b32 v240, 16, v54
    v_and_b32 v241, s83, v54
    v_mfma_f32_16x16x32_bf16 v[148:151], v[200:203], v[224:227], v[148:151]
    ds_read_b128 v[200:203], v20 offset:50176
    v_lshlrev_b32 v242, 16, v55
    v_and_b32 v243, s83, v55
    v_mfma_f32_16x16x32_bf16 v[152:155], v[204:207], v[220:223], v[152:155]
    v_pk_mul_f32 v[244:245], v[236:237], v[236:237]
    v_pk_mul_f32 v[246:247], v[238:239], v[238:239]
    v_mfma_f32_16x16x32_bf16 v[156:159], v[204:207], v[224:227], v[156:159]
    ds_read_b128 v[204:207], v20 offset:51200
    s_waitcnt lgkmcnt(8)
    v_mfma_f32_16x16x32_bf16 v[160:163], v[208:211], v[220:223], v[160:163]
    v_pk_mul_f32 v[248:249], v[240:241], v[240:241]
    v_pk_mul_f32 v[250:251], v[242:243], v[242:243]
    v_mfma_f32_16x16x32_bf16 v[164:167], v[208:211], v[224:227], v[164:167]
    ds_read_b128 v[208:211], v20 offset:52224
    v_pk_fma_f32 v[244:245], v[244:245], s[74:75], v[36:37]
    v_pk_fma_f32 v[246:247], v[246:247], s[74:75], v[36:37]
    v_mfma_f32_16x16x32_bf16 v[168:171], v[212:215], v[220:223], v[168:171]
    v_pk_fma_f32 v[248:249], v[248:249], s[74:75], v[36:37]
    v_pk_fma_f32 v[250:251], v[250:251], s[74:75], v[36:37]
    v_mfma_f32_16x16x32_bf16 v[172:175], v[212:215], v[224:227], v[172:175]
    ds_read_b128 v[212:215], v20 offset:53248
    v_pk_mul_f32 v[244:245], v[244:245], v[236:237]
    v_pk_mul_f32 v[246:247], v[246:247], v[238:239]
    v_mfma_f32_16x16x32_bf16 v[176:179], v[216:219], v[220:223], v[176:179]
    v_pk_mul_f32 v[248:249], v[248:249], v[240:241]
    v_pk_mul_f32 v[250:251], v[250:251], v[242:243]
    v_mfma_f32_16x16x32_bf16 v[180:183], v[216:219], v[224:227], v[180:183]
    ds_read_b128 v[216:219], v20 offset:54272
    s_waitcnt lgkmcnt(6)
    s_barrier
    v_mfma_f32_16x16x32_bf16 v[112:115], v[184:187], v[228:231], v[112:115]
    v_exp_f32 v244, v244
    v_mfma_f32_16x16x32_bf16 v[116:119], v[184:187], v[232:235], v[116:119]
    ds_read_b128 v[184:187], v21 offset:0
    v_exp_f32 v245, v245
    v_mfma_f32_16x16x32_bf16 v[120:123], v[188:191], v[228:231], v[120:123]
    ds_read_b128 v[220:223], v18 offset:0
    v_exp_f32 v246, v246
    v_mfma_f32_16x16x32_bf16 v[124:127], v[188:191], v[232:235], v[124:127]
    ds_read_b128 v[188:191], v21 offset:1024
    v_exp_f32 v247, v247
    v_mfma_f32_16x16x32_bf16 v[128:131], v[192:195], v[228:231], v[128:131]
    ds_read_b128 v[224:227], v18 offset:2048
    v_exp_f32 v248, v248
    v_mfma_f32_16x16x32_bf16 v[132:135], v[192:195], v[232:235], v[132:135]
    ds_read_b128 v[192:195], v21 offset:2048
    s_waitcnt lgkmcnt(8)
    v_mfma_f32_16x16x32_bf16 v[136:139], v[196:199], v[228:231], v[136:139]
    v_exp_f32 v249, v249
    v_mfma_f32_16x16x32_bf16 v[140:143], v[196:199], v[232:235], v[140:143]
    ds_read_b128 v[196:199], v21 offset:3072
    v_exp_f32 v250, v250
    v_mfma_f32_16x16x32_bf16 v[144:147], v[200:203], v[228:231], v[144:147]
    v_exp_f32 v251, v251
    v_mfma_f32_16x16x32_bf16 v[148:151], v[200:203], v[232:235], v[148:151]
    ds_read_b128 v[200:203], v21 offset:4096
    v_pk_add_f32 v[244:245], v[244:245], s[76:77]
    v_pk_add_f32 v[246:247], v[246:247], s[76:77]
    v_mfma_f32_16x16x32_bf16 v[152:155], v[204:207], v[228:231], v[152:155]
    v_pk_add_f32 v[248:249], v[248:249], s[76:77]
    v_pk_add_f32 v[250:251], v[250:251], s[76:77]
    v_mfma_f32_16x16x32_bf16 v[156:159], v[204:207], v[232:235], v[156:159]
    ds_read_b128 v[204:207], v21 offset:5120
    s_waitcnt lgkmcnt(8)
    v_mfma_f32_16x16x32_bf16 v[160:163], v[208:211], v[228:231], v[160:163]
    v_rcp_f32 v244, v244
    v_mfma_f32_16x16x32_bf16 v[164:167], v[208:211], v[232:235], v[164:167]
    ds_read_b128 v[208:211], v21 offset:6144
    v_rcp_f32 v245, v245
    v_mfma_f32_16x16x32_bf16 v[168:171], v[212:215], v[228:231], v[168:171]
    v_rcp_f32 v246, v246
    v_mfma_f32_16x16x32_bf16 v[172:175], v[212:215], v[232:235], v[172:175]
    ds_read_b128 v[212:215], v21 offset:7168
    v_rcp_f32 v247, v247
    v_mfma_f32_16x16x32_bf16 v[176:179], v[216:219], v[228:231], v[176:179]
    v_rcp_f32 v248, v248
    v_mfma_f32_16x16x32_bf16 v[180:183], v[216:219], v[232:235], v[180:183]
    ds_read_b128 v[216:219], v21 offset:8192
    s_waitcnt lgkmcnt(6)
    v_mfma_f32_16x16x32_bf16 v[112:115], v[184:187], v[220:223], v[112:115]
    v_rcp_f32 v249, v249
    v_mfma_f32_16x16x32_bf16 v[116:119], v[184:187], v[224:227], v[116:119]
    ds_read_b128 v[184:187], v21 offset:9216
    v_rcp_f32 v250, v250
    v_mfma_f32_16x16x32_bf16 v[120:123], v[188:191], v[220:223], v[120:123]
    ds_read_b128 v[228:231], v19 offset:0
    v_rcp_f32 v251, v251
    v_mfma_f32_16x16x32_bf16 v[124:127], v[188:191], v[224:227], v[124:127]
    ds_read_b128 v[188:191], v21 offset:10240
    v_pk_mul_f32 v[236:237], v[236:237], v[244:245]
    v_pk_mul_f32 v[238:239], v[238:239], v[246:247]
    v_mfma_f32_16x16x32_bf16 v[128:131], v[192:195], v[220:223], v[128:131]
    ds_read_b128 v[232:235], v19 offset:2048
    v_pk_mul_f32 v[240:241], v[240:241], v[248:249]
    v_pk_mul_f32 v[242:243], v[242:243], v[250:251]
    v_mfma_f32_16x16x32_bf16 v[132:135], v[192:195], v[224:227], v[132:135]
    ds_read_b128 v[192:195], v21 offset:11264
    s_waitcnt lgkmcnt(8)
    v_mfma_f32_16x16x32_bf16 v[136:139], v[196:199], v[220:223], v[136:139]
    v_cvt_pk_bf16_f32 v52, v236, v237
    v_cvt_pk_bf16_f32 v53, v238, v239
    v_mfma_f32_16x16x32_bf16 v[140:143], v[196:199], v[224:227], v[140:143]
    ds_read_b128 v[196:199], v21 offset:12288
    v_cvt_pk_bf16_f32 v54, v240, v241
    v_cvt_pk_bf16_f32 v55, v242, v243
    v_mfma_f32_16x16x32_bf16 v[144:147], v[200:203], v[220:223], v[144:147]
    v_lshlrev_b32 v236, 16, v56
    v_and_b32 v237, s83, v56
    v_mfma_f32_16x16x32_bf16 v[148:151], v[200:203], v[224:227], v[148:151]
    ds_read_b128 v[200:203], v21 offset:13312
    v_lshlrev_b32 v238, 16, v57
    v_and_b32 v239, s83, v57
    v_mfma_f32_16x16x32_bf16 v[152:155], v[204:207], v[220:223], v[152:155]
    v_lshlrev_b32 v240, 16, v58
    v_and_b32 v241, s83, v58
    v_mfma_f32_16x16x32_bf16 v[156:159], v[204:207], v[224:227], v[156:159]
    ds_read_b128 v[204:207], v21 offset:14336
    s_waitcnt lgkmcnt(8)
    v_mfma_f32_16x16x32_bf16 v[160:163], v[208:211], v[220:223], v[160:163]
    v_lshlrev_b32 v242, 16, v59
    v_and_b32 v243, s83, v59
    v_mfma_f32_16x16x32_bf16 v[164:167], v[208:211], v[224:227], v[164:167]
    ds_read_b128 v[208:211], v21 offset:15360
    v_pk_mul_f32 v[244:245], v[236:237], v[236:237]
    v_pk_mul_f32 v[246:247], v[238:239], v[238:239]
    v_mfma_f32_16x16x32_bf16 v[168:171], v[212:215], v[220:223], v[168:171]
    v_pk_mul_f32 v[248:249], v[240:241], v[240:241]
    v_pk_mul_f32 v[250:251], v[242:243], v[242:243]
    v_mfma_f32_16x16x32_bf16 v[172:175], v[212:215], v[224:227], v[172:175]
    ds_read_b128 v[212:215], v21 offset:16384
    v_pk_fma_f32 v[244:245], v[244:245], s[74:75], v[36:37]
    v_pk_fma_f32 v[246:247], v[246:247], s[74:75], v[36:37]
    v_mfma_f32_16x16x32_bf16 v[176:179], v[216:219], v[220:223], v[176:179]
    v_pk_fma_f32 v[248:249], v[248:249], s[74:75], v[36:37]
    v_pk_fma_f32 v[250:251], v[250:251], s[74:75], v[36:37]
    v_mfma_f32_16x16x32_bf16 v[180:183], v[216:219], v[224:227], v[180:183]
    ds_read_b128 v[216:219], v21 offset:17408
    s_waitcnt lgkmcnt(6)
    s_barrier
    v_mfma_f32_16x16x32_bf16 v[112:115], v[184:187], v[228:231], v[112:115]
    v_pk_mul_f32 v[244:245], v[244:245], v[236:237]
    v_pk_mul_f32 v[246:247], v[246:247], v[238:239]
    v_mfma_f32_16x16x32_bf16 v[116:119], v[184:187], v[232:235], v[116:119]
    ds_read_b128 v[184:187], v20 offset:0
    v_pk_mul_f32 v[248:249], v[248:249], v[240:241]
    v_pk_mul_f32 v[250:251], v[250:251], v[242:243]
    v_mfma_f32_16x16x32_bf16 v[120:123], v[188:191], v[228:231], v[120:123]
    ds_read_b128 v[220:223], v16 offset:0
    v_exp_f32 v244, v244
    v_mfma_f32_16x16x32_bf16 v[124:127], v[188:191], v[232:235], v[124:127]
    ds_read_b128 v[188:191], v20 offset:1024
    v_exp_f32 v245, v245
    v_mfma_f32_16x16x32_bf16 v[128:131], v[192:195], v[228:231], v[128:131]
    ds_read_b128 v[224:227], v16 offset:2048
    v_exp_f32 v246, v246
    v_mfma_f32_16x16x32_bf16 v[132:135], v[192:195], v[232:235], v[132:135]
    ds_read_b128 v[192:195], v20 offset:2048
    s_waitcnt lgkmcnt(8)
    v_mfma_f32_16x16x32_bf16 v[136:139], v[196:199], v[228:231], v[136:139]
    v_exp_f32 v247, v247
    v_mfma_f32_16x16x32_bf16 v[140:143], v[196:199], v[232:235], v[140:143]
    ds_read_b128 v[196:199], v20 offset:3072
    v_exp_f32 v248, v248
    v_mfma_f32_16x16x32_bf16 v[144:147], v[200:203], v[228:231], v[144:147]
    v_exp_f32 v249, v249
    v_mfma_f32_16x16x32_bf16 v[148:151], v[200:203], v[232:235], v[148:151]
    ds_read_b128 v[200:203], v20 offset:4096
    v_exp_f32 v250, v250
    v_mfma_f32_16x16x32_bf16 v[152:155], v[204:207], v[228:231], v[152:155]
    v_exp_f32 v251, v251
    v_mfma_f32_16x16x32_bf16 v[156:159], v[204:207], v[232:235], v[156:159]
    ds_read_b128 v[204:207], v20 offset:5120
    s_waitcnt lgkmcnt(8)
    v_mfma_f32_16x16x32_bf16 v[160:163], v[208:211], v[228:231], v[160:163]
    v_pk_add_f32 v[244:245], v[244:245], s[76:77]
    v_pk_add_f32 v[246:247], v[246:247], s[76:77]
    v_mfma_f32_16x16x32_bf16 v[164:167], v[208:211], v[232:235], v[164:167]
    ds_read_b128 v[208:211], v20 offset:6144
    v_pk_add_f32 v[248:249], v[248:249], s[76:77]
    v_pk_add_f32 v[250:251], v[250:251], s[76:77]
    v_mfma_f32_16x16x32_bf16 v[168:171], v[212:215], v[228:231], v[168:171]
    v_rcp_f32 v244, v244
    v_mfma_f32_16x16x32_bf16 v[172:175], v[212:215], v[232:235], v[172:175]
    ds_read_b128 v[212:215], v20 offset:7168
    v_rcp_f32 v245, v245
    v_mfma_f32_16x16x32_bf16 v[176:179], v[216:219], v[228:231], v[176:179]
    v_rcp_f32 v246, v246
    v_mfma_f32_16x16x32_bf16 v[180:183], v[216:219], v[232:235], v[180:183]
    ds_read_b128 v[216:219], v20 offset:8192
    s_waitcnt lgkmcnt(6)
    v_mfma_f32_16x16x32_bf16 v[112:115], v[184:187], v[220:223], v[112:115]
    v_rcp_f32 v247, v247
    v_mfma_f32_16x16x32_bf16 v[116:119], v[184:187], v[224:227], v[116:119]
    ds_read_b128 v[184:187], v20 offset:9216
    v_rcp_f32 v248, v248
    v_mfma_f32_16x16x32_bf16 v[120:123], v[188:191], v[220:223], v[120:123]
    ds_read_b128 v[228:231], v17 offset:0
    v_rcp_f32 v249, v249
    v_mfma_f32_16x16x32_bf16 v[124:127], v[188:191], v[224:227], v[124:127]
    ds_read_b128 v[188:191], v20 offset:10240
    v_rcp_f32 v250, v250
    v_mfma_f32_16x16x32_bf16 v[128:131], v[192:195], v[220:223], v[128:131]
    ds_read_b128 v[232:235], v17 offset:2048
    v_rcp_f32 v251, v251
    v_mfma_f32_16x16x32_bf16 v[132:135], v[192:195], v[224:227], v[132:135]
    ds_read_b128 v[192:195], v20 offset:11264
    s_waitcnt lgkmcnt(8)
    v_mfma_f32_16x16x32_bf16 v[136:139], v[196:199], v[220:223], v[136:139]
    v_pk_mul_f32 v[236:237], v[236:237], v[244:245]
    v_pk_mul_f32 v[238:239], v[238:239], v[246:247]
    v_mfma_f32_16x16x32_bf16 v[140:143], v[196:199], v[224:227], v[140:143]
    ds_read_b128 v[196:199], v20 offset:12288
    v_pk_mul_f32 v[240:241], v[240:241], v[248:249]
    v_pk_mul_f32 v[242:243], v[242:243], v[250:251]
    v_mfma_f32_16x16x32_bf16 v[144:147], v[200:203], v[220:223], v[144:147]
    v_cvt_pk_bf16_f32 v56, v236, v237
    v_cvt_pk_bf16_f32 v57, v238, v239
    v_mfma_f32_16x16x32_bf16 v[148:151], v[200:203], v[224:227], v[148:151]
    ds_read_b128 v[200:203], v20 offset:13312
    v_cvt_pk_bf16_f32 v58, v240, v241
    v_cvt_pk_bf16_f32 v59, v242, v243
    v_mfma_f32_16x16x32_bf16 v[152:155], v[204:207], v[220:223], v[152:155]
    v_lshlrev_b32 v236, 16, v60
    v_and_b32 v237, s83, v60
    v_mfma_f32_16x16x32_bf16 v[156:159], v[204:207], v[224:227], v[156:159]
    ds_read_b128 v[204:207], v20 offset:14336
    s_waitcnt lgkmcnt(8)
    v_mfma_f32_16x16x32_bf16 v[160:163], v[208:211], v[220:223], v[160:163]
    v_lshlrev_b32 v238, 16, v61
    v_and_b32 v239, s83, v61
    v_mfma_f32_16x16x32_bf16 v[164:167], v[208:211], v[224:227], v[164:167]
    ds_read_b128 v[208:211], v20 offset:15360
    v_lshlrev_b32 v240, 16, v62
    v_and_b32 v241, s83, v62
    v_mfma_f32_16x16x32_bf16 v[168:171], v[212:215], v[220:223], v[168:171]
    v_lshlrev_b32 v242, 16, v63
    v_and_b32 v243, s83, v63
    v_mfma_f32_16x16x32_bf16 v[172:175], v[212:215], v[224:227], v[172:175]
    ds_read_b128 v[212:215], v20 offset:16384
    v_pk_mul_f32 v[244:245], v[236:237], v[236:237]
    v_pk_mul_f32 v[246:247], v[238:239], v[238:239]
    v_mfma_f32_16x16x32_bf16 v[176:179], v[216:219], v[220:223], v[176:179]
    v_pk_mul_f32 v[248:249], v[240:241], v[240:241]
    v_pk_mul_f32 v[250:251], v[242:243], v[242:243]
    v_mfma_f32_16x16x32_bf16 v[180:183], v[216:219], v[224:227], v[180:183]
    ds_read_b128 v[216:219], v20 offset:17408
    s_waitcnt lgkmcnt(6)
    s_barrier
    v_mfma_f32_16x16x32_bf16 v[112:115], v[184:187], v[228:231], v[112:115]
    v_pk_fma_f32 v[244:245], v[244:245], s[74:75], v[36:37]
    v_pk_fma_f32 v[246:247], v[246:247], s[74:75], v[36:37]
    v_mfma_f32_16x16x32_bf16 v[116:119], v[184:187], v[232:235], v[116:119]
    ds_read_b128 v[184:187], v21 offset:34816
    v_pk_fma_f32 v[248:249], v[248:249], s[74:75], v[36:37]
    v_pk_fma_f32 v[250:251], v[250:251], s[74:75], v[36:37]
    v_mfma_f32_16x16x32_bf16 v[120:123], v[188:191], v[228:231], v[120:123]
    ds_read_b128 v[220:223], v18 offset:34816
    v_pk_mul_f32 v[244:245], v[244:245], v[236:237]
    v_pk_mul_f32 v[246:247], v[246:247], v[238:239]
    v_mfma_f32_16x16x32_bf16 v[124:127], v[188:191], v[232:235], v[124:127]
    ds_read_b128 v[188:191], v21 offset:35840
    v_pk_mul_f32 v[248:249], v[248:249], v[240:241]
    v_pk_mul_f32 v[250:251], v[250:251], v[242:243]
    v_mfma_f32_16x16x32_bf16 v[128:131], v[192:195], v[228:231], v[128:131]
    ds_read_b128 v[224:227], v18 offset:36864
    v_exp_f32 v244, v244
    v_mfma_f32_16x16x32_bf16 v[132:135], v[192:195], v[232:235], v[132:135]
    ds_read_b128 v[192:195], v21 offset:36864
    s_waitcnt lgkmcnt(8)
    v_mfma_f32_16x16x32_bf16 v[136:139], v[196:199], v[228:231], v[136:139]
    v_exp_f32 v245, v245
    v_mfma_f32_16x16x32_bf16 v[140:143], v[196:199], v[232:235], v[140:143]
    ds_read_b128 v[196:199], v21 offset:37888
    v_exp_f32 v246, v246
    v_mfma_f32_16x16x32_bf16 v[144:147], v[200:203], v[228:231], v[144:147]
    v_exp_f32 v247, v247
    v_mfma_f32_16x16x32_bf16 v[148:151], v[200:203], v[232:235], v[148:151]
    ds_read_b128 v[200:203], v21 offset:38912
    v_exp_f32 v248, v248
    v_mfma_f32_16x16x32_bf16 v[152:155], v[204:207], v[228:231], v[152:155]
    v_exp_f32 v249, v249
    v_mfma_f32_16x16x32_bf16 v[156:159], v[204:207], v[232:235], v[156:159]
    ds_read_b128 v[204:207], v21 offset:39936
    s_waitcnt lgkmcnt(8)
    v_mfma_f32_16x16x32_bf16 v[160:163], v[208:211], v[228:231], v[160:163]
    v_exp_f32 v250, v250
    v_mfma_f32_16x16x32_bf16 v[164:167], v[208:211], v[232:235], v[164:167]
    ds_read_b128 v[208:211], v21 offset:40960
    v_exp_f32 v251, v251
    v_mfma_f32_16x16x32_bf16 v[168:171], v[212:215], v[228:231], v[168:171]
    v_pk_add_f32 v[244:245], v[244:245], s[76:77]
    v_pk_add_f32 v[246:247], v[246:247], s[76:77]
    v_mfma_f32_16x16x32_bf16 v[172:175], v[212:215], v[232:235], v[172:175]
    ds_read_b128 v[212:215], v21 offset:41984
    v_pk_add_f32 v[248:249], v[248:249], s[76:77]
    v_pk_add_f32 v[250:251], v[250:251], s[76:77]
    v_mfma_f32_16x16x32_bf16 v[176:179], v[216:219], v[228:231], v[176:179]
    v_rcp_f32 v244, v244
    v_mfma_f32_16x16x32_bf16 v[180:183], v[216:219], v[232:235], v[180:183]
    ds_read_b128 v[216:219], v21 offset:43008
    s_waitcnt lgkmcnt(6)
    v_mfma_f32_16x16x32_bf16 v[112:115], v[184:187], v[220:223], v[112:115]
    v_rcp_f32 v245, v245
    v_mfma_f32_16x16x32_bf16 v[116:119], v[184:187], v[224:227], v[116:119]
    ds_read_b128 v[184:187], v21 offset:44032
    v_rcp_f32 v246, v246
    v_mfma_f32_16x16x32_bf16 v[120:123], v[188:191], v[220:223], v[120:123]
    ds_read_b128 v[228:231], v19 offset:34816
    v_rcp_f32 v247, v247
    v_mfma_f32_16x16x32_bf16 v[124:127], v[188:191], v[224:227], v[124:127]
    ds_read_b128 v[188:191], v21 offset:45056
    v_rcp_f32 v248, v248
    v_mfma_f32_16x16x32_bf16 v[128:131], v[192:195], v[220:223], v[128:131]
    ds_read_b128 v[232:235], v19 offset:36864
    v_rcp_f32 v249, v249
    v_mfma_f32_16x16x32_bf16 v[132:135], v[192:195], v[224:227], v[132:135]
    ds_read_b128 v[192:195], v21 offset:46080
    s_waitcnt lgkmcnt(8)
    v_mfma_f32_16x16x32_bf16 v[136:139], v[196:199], v[220:223], v[136:139]
    v_rcp_f32 v250, v250
    v_mfma_f32_16x16x32_bf16 v[140:143], v[196:199], v[224:227], v[140:143]
    ds_read_b128 v[196:199], v21 offset:47104
    v_rcp_f32 v251, v251
    v_mfma_f32_16x16x32_bf16 v[144:147], v[200:203], v[220:223], v[144:147]
    v_pk_mul_f32 v[236:237], v[236:237], v[244:245]
    v_pk_mul_f32 v[238:239], v[238:239], v[246:247]
    v_mfma_f32_16x16x32_bf16 v[148:151], v[200:203], v[224:227], v[148:151]
    ds_read_b128 v[200:203], v21 offset:48128
    v_pk_mul_f32 v[240:241], v[240:241], v[248:249]
    v_pk_mul_f32 v[242:243], v[242:243], v[250:251]
    v_mfma_f32_16x16x32_bf16 v[152:155], v[204:207], v[220:223], v[152:155]
    v_cvt_pk_bf16_f32 v60, v236, v237
    v_cvt_pk_bf16_f32 v61, v238, v239
    v_mfma_f32_16x16x32_bf16 v[156:159], v[204:207], v[224:227], v[156:159]
    ds_read_b128 v[204:207], v21 offset:49152
    s_waitcnt lgkmcnt(8)
    v_mfma_f32_16x16x32_bf16 v[160:163], v[208:211], v[220:223], v[160:163]
    v_cvt_pk_bf16_f32 v62, v240, v241
    v_cvt_pk_bf16_f32 v63, v242, v243
    v_mfma_f32_16x16x32_bf16 v[164:167], v[208:211], v[224:227], v[164:167]
    ds_read_b128 v[208:211], v21 offset:50176
    v_lshlrev_b32 v236, 16, v64
    v_and_b32 v237, s83, v64
    v_mfma_f32_16x16x32_bf16 v[168:171], v[212:215], v[220:223], v[168:171]
    v_lshlrev_b32 v238, 16, v65
    v_and_b32 v239, s83, v65
    v_mfma_f32_16x16x32_bf16 v[172:175], v[212:215], v[224:227], v[172:175]
    ds_read_b128 v[212:215], v21 offset:51200
    v_lshlrev_b32 v240, 16, v66
    v_and_b32 v241, s83, v66
    v_mfma_f32_16x16x32_bf16 v[176:179], v[216:219], v[220:223], v[176:179]
    v_lshlrev_b32 v242, 16, v67
    v_and_b32 v243, s83, v67
    v_mfma_f32_16x16x32_bf16 v[180:183], v[216:219], v[224:227], v[180:183]
    ds_read_b128 v[216:219], v21 offset:52224
    s_waitcnt lgkmcnt(6)
    s_barrier
    v_mfma_f32_16x16x32_bf16 v[112:115], v[184:187], v[228:231], v[112:115]
    v_pk_mul_f32 v[244:245], v[236:237], v[236:237]
    v_pk_mul_f32 v[246:247], v[238:239], v[238:239]
    v_mfma_f32_16x16x32_bf16 v[116:119], v[184:187], v[232:235], v[116:119]
    ds_read_b128 v[184:187], v20 offset:36864
    v_pk_mul_f32 v[248:249], v[240:241], v[240:241]
    v_pk_mul_f32 v[250:251], v[242:243], v[242:243]
    v_mfma_f32_16x16x32_bf16 v[120:123], v[188:191], v[228:231], v[120:123]
    ds_read_b128 v[220:223], v16 offset:36864
    v_pk_fma_f32 v[244:245], v[244:245], s[74:75], v[36:37]
    v_pk_fma_f32 v[246:247], v[246:247], s[74:75], v[36:37]
    v_mfma_f32_16x16x32_bf16 v[124:127], v[188:191], v[232:235], v[124:127]
    ds_read_b128 v[188:191], v20 offset:37888
    v_pk_fma_f32 v[248:249], v[248:249], s[74:75], v[36:37]
    v_pk_fma_f32 v[250:251], v[250:251], s[74:75], v[36:37]
    v_mfma_f32_16x16x32_bf16 v[128:131], v[192:195], v[228:231], v[128:131]
    ds_read_b128 v[224:227], v16 offset:38912
    v_pk_mul_f32 v[244:245], v[244:245], v[236:237]
    v_pk_mul_f32 v[246:247], v[246:247], v[238:239]
    v_mfma_f32_16x16x32_bf16 v[132:135], v[192:195], v[232:235], v[132:135]
    ds_read_b128 v[192:195], v20 offset:38912
    s_waitcnt lgkmcnt(8)
    v_mfma_f32_16x16x32_bf16 v[136:139], v[196:199], v[228:231], v[136:139]
    v_pk_mul_f32 v[248:249], v[248:249], v[240:241]
    v_pk_mul_f32 v[250:251], v[250:251], v[242:243]
    v_mfma_f32_16x16x32_bf16 v[140:143], v[196:199], v[232:235], v[140:143]
    ds_read_b128 v[196:199], v20 offset:39936
    v_exp_f32 v244, v244
    v_mfma_f32_16x16x32_bf16 v[144:147], v[200:203], v[228:231], v[144:147]
    v_exp_f32 v245, v245
    v_mfma_f32_16x16x32_bf16 v[148:151], v[200:203], v[232:235], v[148:151]
    ds_read_b128 v[200:203], v20 offset:40960
    v_exp_f32 v246, v246
    v_mfma_f32_16x16x32_bf16 v[152:155], v[204:207], v[228:231], v[152:155]
    v_exp_f32 v247, v247
    v_mfma_f32_16x16x32_bf16 v[156:159], v[204:207], v[232:235], v[156:159]
    ds_read_b128 v[204:207], v20 offset:41984
    s_waitcnt lgkmcnt(8)
    v_mfma_f32_16x16x32_bf16 v[160:163], v[208:211], v[228:231], v[160:163]
    v_exp_f32 v248, v248
    v_mfma_f32_16x16x32_bf16 v[164:167], v[208:211], v[232:235], v[164:167]
    ds_read_b128 v[208:211], v20 offset:43008
    v_exp_f32 v249, v249
    v_mfma_f32_16x16x32_bf16 v[168:171], v[212:215], v[228:231], v[168:171]
    v_exp_f32 v250, v250
    v_mfma_f32_16x16x32_bf16 v[172:175], v[212:215], v[232:235], v[172:175]
    ds_read_b128 v[212:215], v20 offset:44032
    v_exp_f32 v251, v251
    v_mfma_f32_16x16x32_bf16 v[176:179], v[216:219], v[228:231], v[176:179]
    v_pk_add_f32 v[244:245], v[244:245], s[76:77]
    v_pk_add_f32 v[246:247], v[246:247], s[76:77]
    v_mfma_f32_16x16x32_bf16 v[180:183], v[216:219], v[232:235], v[180:183]
    ds_read_b128 v[216:219], v20 offset:45056
    s_waitcnt lgkmcnt(6)
    v_mfma_f32_16x16x32_bf16 v[112:115], v[184:187], v[220:223], v[112:115]
    v_pk_add_f32 v[248:249], v[248:249], s[76:77]
    v_pk_add_f32 v[250:251], v[250:251], s[76:77]
    v_mfma_f32_16x16x32_bf16 v[116:119], v[184:187], v[224:227], v[116:119]
    ds_read_b128 v[184:187], v20 offset:46080
    v_rcp_f32 v244, v244
    v_mfma_f32_16x16x32_bf16 v[120:123], v[188:191], v[220:223], v[120:123]
    ds_read_b128 v[228:231], v17 offset:36864
    v_rcp_f32 v245, v245
    v_mfma_f32_16x16x32_bf16 v[124:127], v[188:191], v[224:227], v[124:127]
    ds_read_b128 v[188:191], v20 offset:47104
    v_rcp_f32 v246, v246
    v_mfma_f32_16x16x32_bf16 v[128:131], v[192:195], v[220:223], v[128:131]
    ds_read_b128 v[232:235], v17 offset:38912
    v_rcp_f32 v247, v247
    v_mfma_f32_16x16x32_bf16 v[132:135], v[192:195], v[224:227], v[132:135]
    ds_read_b128 v[192:195], v20 offset:48128
    s_waitcnt lgkmcnt(8)
    v_mfma_f32_16x16x32_bf16 v[136:139], v[196:199], v[220:223], v[136:139]
    v_rcp_f32 v248, v248
    v_mfma_f32_16x16x32_bf16 v[140:143], v[196:199], v[224:227], v[140:143]
    ds_read_b128 v[196:199], v20 offset:49152
    v_rcp_f32 v249, v249
    v_mfma_f32_16x16x32_bf16 v[144:147], v[200:203], v[220:223], v[144:147]
    v_rcp_f32 v250, v250
    v_mfma_f32_16x16x32_bf16 v[148:151], v[200:203], v[224:227], v[148:151]
    ds_read_b128 v[200:203], v20 offset:50176
    v_rcp_f32 v251, v251
    v_mfma_f32_16x16x32_bf16 v[152:155], v[204:207], v[220:223], v[152:155]
    v_pk_mul_f32 v[236:237], v[236:237], v[244:245]
    v_pk_mul_f32 v[238:239], v[238:239], v[246:247]
    v_mfma_f32_16x16x32_bf16 v[156:159], v[204:207], v[224:227], v[156:159]
    ds_read_b128 v[204:207], v20 offset:51200
    s_waitcnt lgkmcnt(8)
    v_mfma_f32_16x16x32_bf16 v[160:163], v[208:211], v[220:223], v[160:163]
    v_pk_mul_f32 v[240:241], v[240:241], v[248:249]
    v_pk_mul_f32 v[242:243], v[242:243], v[250:251]
    v_mfma_f32_16x16x32_bf16 v[164:167], v[208:211], v[224:227], v[164:167]
    ds_read_b128 v[208:211], v20 offset:52224
    v_cvt_pk_bf16_f32 v64, v236, v237
    v_cvt_pk_bf16_f32 v65, v238, v239
    v_mfma_f32_16x16x32_bf16 v[168:171], v[212:215], v[220:223], v[168:171]
    v_cvt_pk_bf16_f32 v66, v240, v241
    v_cvt_pk_bf16_f32 v67, v242, v243
    v_mfma_f32_16x16x32_bf16 v[172:175], v[212:215], v[224:227], v[172:175]
    ds_read_b128 v[212:215], v20 offset:53248
    v_lshlrev_b32 v236, 16, v68
    v_and_b32 v237, s83, v68
    v_mfma_f32_16x16x32_bf16 v[176:179], v[216:219], v[220:223], v[176:179]
    v_lshlrev_b32 v238, 16, v69
    v_and_b32 v239, s83, v69
    v_mfma_f32_16x16x32_bf16 v[180:183], v[216:219], v[224:227], v[180:183]
    ds_read_b128 v[216:219], v20 offset:54272
    s_waitcnt lgkmcnt(6)
    s_barrier
    v_mfma_f32_16x16x32_bf16 v[112:115], v[184:187], v[228:231], v[112:115]
    v_lshlrev_b32 v240, 16, v70
    v_and_b32 v241, s83, v70
    v_mfma_f32_16x16x32_bf16 v[116:119], v[184:187], v[232:235], v[116:119]
    ds_read_b128 v[184:187], v21 offset:0
    v_lshlrev_b32 v242, 16, v71
    v_and_b32 v243, s83, v71
    v_mfma_f32_16x16x32_bf16 v[120:123], v[188:191], v[228:231], v[120:123]
    ds_read_b128 v[220:223], v18 offset:0
    v_pk_mul_f32 v[244:245], v[236:237], v[236:237]
    v_pk_mul_f32 v[246:247], v[238:239], v[238:239]
    v_mfma_f32_16x16x32_bf16 v[124:127], v[188:191], v[232:235], v[124:127]
    ds_read_b128 v[188:191], v21 offset:1024
    v_pk_mul_f32 v[248:249], v[240:241], v[240:241]
    v_pk_mul_f32 v[250:251], v[242:243], v[242:243]
    v_mfma_f32_16x16x32_bf16 v[128:131], v[192:195], v[228:231], v[128:131]
    ds_read_b128 v[224:227], v18 offset:2048
    v_pk_fma_f32 v[244:245], v[244:245], s[74:75], v[36:37]
    v_pk_fma_f32 v[246:247], v[246:247], s[74:75], v[36:37]
    v_mfma_f32_16x16x32_bf16 v[132:135], v[192:195], v[232:235], v[132:135]
    ds_read_b128 v[192:195], v21 offset:2048
    s_waitcnt lgkmcnt(8)
    v_mfma_f32_16x16x32_bf16 v[136:139], v[196:199], v[228:231], v[136:139]
    v_pk_fma_f32 v[248:249], v[248:249], s[74:75], v[36:37]
    v_pk_fma_f32 v[250:251], v[250:251], s[74:75], v[36:37]
    v_mfma_f32_16x16x32_bf16 v[140:143], v[196:199], v[232:235], v[140:143]
    ds_read_b128 v[196:199], v21 offset:3072
    v_pk_mul_f32 v[244:245], v[244:245], v[236:237]
    v_pk_mul_f32 v[246:247], v[246:247], v[238:239]
    v_mfma_f32_16x16x32_bf16 v[144:147], v[200:203], v[228:231], v[144:147]
    v_pk_mul_f32 v[248:249], v[248:249], v[240:241]
    v_pk_mul_f32 v[250:251], v[250:251], v[242:243]
    v_mfma_f32_16x16x32_bf16 v[148:151], v[200:203], v[232:235], v[148:151]
    ds_read_b128 v[200:203], v21 offset:4096
    v_exp_f32 v244, v244
    v_mfma_f32_16x16x32_bf16 v[152:155], v[204:207], v[228:231], v[152:155]
    v_exp_f32 v245, v245
    v_mfma_f32_16x16x32_bf16 v[156:159], v[204:207], v[232:235], v[156:159]
    ds_read_b128 v[204:207], v21 offset:5120
    s_waitcnt lgkmcnt(8)
    v_mfma_f32_16x16x32_bf16 v[160:163], v[208:211], v[228:231], v[160:163]
    v_exp_f32 v246, v246
    v_mfma_f32_16x16x32_bf16 v[164:167], v[208:211], v[232:235], v[164:167]
    ds_read_b128 v[208:211], v21 offset:6144
    v_exp_f32 v247, v247
    v_mfma_f32_16x16x32_bf16 v[168:171], v[212:215], v[228:231], v[168:171]
    v_exp_f32 v248, v248
    v_mfma_f32_16x16x32_bf16 v[172:175], v[212:215], v[232:235], v[172:175]
    ds_read_b128 v[212:215], v21 offset:7168
    v_exp_f32 v249, v249
    v_mfma_f32_16x16x32_bf16 v[176:179], v[216:219], v[228:231], v[176:179]
    v_exp_f32 v250, v250
    v_mfma_f32_16x16x32_bf16 v[180:183], v[216:219], v[232:235], v[180:183]
    ds_read_b128 v[216:219], v21 offset:8192
    s_waitcnt lgkmcnt(6)
    v_mfma_f32_16x16x32_bf16 v[112:115], v[184:187], v[220:223], v[112:115]
    v_exp_f32 v251, v251
    v_mfma_f32_16x16x32_bf16 v[116:119], v[184:187], v[224:227], v[116:119]
    ds_read_b128 v[184:187], v21 offset:9216
    v_pk_add_f32 v[244:245], v[244:245], s[76:77]
    v_pk_add_f32 v[246:247], v[246:247], s[76:77]
    v_mfma_f32_16x16x32_bf16 v[120:123], v[188:191], v[220:223], v[120:123]
    ds_read_b128 v[228:231], v19 offset:0
    v_pk_add_f32 v[248:249], v[248:249], s[76:77]
    v_pk_add_f32 v[250:251], v[250:251], s[76:77]
    v_mfma_f32_16x16x32_bf16 v[124:127], v[188:191], v[224:227], v[124:127]
    ds_read_b128 v[188:191], v21 offset:10240
    v_rcp_f32 v244, v244
    v_mfma_f32_16x16x32_bf16 v[128:131], v[192:195], v[220:223], v[128:131]
    ds_read_b128 v[232:235], v19 offset:2048
    v_rcp_f32 v245, v245
    v_mfma_f32_16x16x32_bf16 v[132:135], v[192:195], v[224:227], v[132:135]
    ds_read_b128 v[192:195], v21 offset:11264
    s_waitcnt lgkmcnt(8)
    v_mfma_f32_16x16x32_bf16 v[136:139], v[196:199], v[220:223], v[136:139]
    v_rcp_f32 v246, v246
    v_mfma_f32_16x16x32_bf16 v[140:143], v[196:199], v[224:227], v[140:143]
    ds_read_b128 v[196:199], v21 offset:12288
    v_rcp_f32 v247, v247
    v_mfma_f32_16x16x32_bf16 v[144:147], v[200:203], v[220:223], v[144:147]
    v_rcp_f32 v248, v248
    v_mfma_f32_16x16x32_bf16 v[148:151], v[200:203], v[224:227], v[148:151]
    ds_read_b128 v[200:203], v21 offset:13312
    v_rcp_f32 v249, v249
    v_mfma_f32_16x16x32_bf16 v[152:155], v[204:207], v[220:223], v[152:155]
    v_rcp_f32 v250, v250
    v_mfma_f32_16x16x32_bf16 v[156:159], v[204:207], v[224:227], v[156:159]
    ds_read_b128 v[204:207], v21 offset:14336
    s_waitcnt lgkmcnt(8)
    v_mfma_f32_16x16x32_bf16 v[160:163], v[208:211], v[220:223], v[160:163]
    v_rcp_f32 v251, v251
    v_mfma_f32_16x16x32_bf16 v[164:167], v[208:211], v[224:227], v[164:167]
    ds_read_b128 v[208:211], v21 offset:15360
    v_pk_mul_f32 v[236:237], v[236:237], v[244:245]
    v_pk_mul_f32 v[238:239], v[238:239], v[246:247]
    v_mfma_f32_16x16x32_bf16 v[168:171], v[212:215], v[220:223], v[168:171]
    v_pk_mul_f32 v[240:241], v[240:241], v[248:249]
    v_pk_mul_f32 v[242:243], v[242:243], v[250:251]
    v_mfma_f32_16x16x32_bf16 v[172:175], v[212:215], v[224:227], v[172:175]
    ds_read_b128 v[212:215], v21 offset:16384
    v_cvt_pk_bf16_f32 v68, v236, v237
    v_cvt_pk_bf16_f32 v69, v238, v239
    v_mfma_f32_16x16x32_bf16 v[176:179], v[216:219], v[220:223], v[176:179]
    v_cvt_pk_bf16_f32 v70, v240, v241
    v_cvt_pk_bf16_f32 v71, v242, v243
    v_mfma_f32_16x16x32_bf16 v[180:183], v[216:219], v[224:227], v[180:183]
    ds_read_b128 v[216:219], v21 offset:17408
    s_waitcnt lgkmcnt(6)
    s_barrier
    v_mfma_f32_16x16x32_bf16 v[112:115], v[184:187], v[228:231], v[112:115]
    v_lshlrev_b32 v236, 16, v72
    v_and_b32 v237, s83, v72
    v_mfma_f32_16x16x32_bf16 v[116:119], v[184:187], v[232:235], v[116:119]
    ds_read_b128 v[184:187], v20 offset:0
    v_lshlrev_b32 v238, 16, v73
    v_and_b32 v239, s83, v73
    v_mfma_f32_16x16x32_bf16 v[120:123], v[188:191], v[228:231], v[120:123]
    ds_read_b128 v[220:223], v16 offset:0
    v_lshlrev_b32 v240, 16, v74
    v_and_b32 v241, s83, v74
    v_mfma_f32_16x16x32_bf16 v[124:127], v[188:191], v[232:235], v[124:127]
    ds_read_b128 v[188:191], v20 offset:1024
    v_lshlrev_b32 v242, 16, v75
    v_and_b32 v243, s83, v75
    v_mfma_f32_16x16x32_bf16 v[128:131], v[192:195], v[228:231], v[128:131]
    ds_read_b128 v[224:227], v16 offset:2048
    v_pk_mul_f32 v[244:245], v[236:237], v[236:237]
    v_pk_mul_f32 v[246:247], v[238:239], v[238:239]
    v_mfma_f32_16x16x32_bf16 v[132:135], v[192:195], v[232:235], v[132:135]
    ds_read_b128 v[192:195], v20 offset:2048
    s_waitcnt lgkmcnt(8)
    v_mfma_f32_16x16x32_bf16 v[136:139], v[196:199], v[228:231], v[136:139]
    v_pk_mul_f32 v[248:249], v[240:241], v[240:241]
    v_pk_mul_f32 v[250:251], v[242:243], v[242:243]
    v_mfma_f32_16x16x32_bf16 v[140:143], v[196:199], v[232:235], v[140:143]
    ds_read_b128 v[196:199], v20 offset:3072
    v_pk_fma_f32 v[244:245], v[244:245], s[74:75], v[36:37]
    v_pk_fma_f32 v[246:247], v[246:247], s[74:75], v[36:37]
    v_mfma_f32_16x16x32_bf16 v[144:147], v[200:203], v[228:231], v[144:147]
    v_pk_fma_f32 v[248:249], v[248:249], s[74:75], v[36:37]
    v_pk_fma_f32 v[250:251], v[250:251], s[74:75], v[36:37]
    v_mfma_f32_16x16x32_bf16 v[148:151], v[200:203], v[232:235], v[148:151]
    ds_read_b128 v[200:203], v20 offset:4096
    v_pk_mul_f32 v[244:245], v[244:245], v[236:237]
    v_pk_mul_f32 v[246:247], v[246:247], v[238:239]
    v_mfma_f32_16x16x32_bf16 v[152:155], v[204:207], v[228:231], v[152:155]
    v_pk_mul_f32 v[248:249], v[248:249], v[240:241]
    v_pk_mul_f32 v[250:251], v[250:251], v[242:243]
    v_mfma_f32_16x16x32_bf16 v[156:159], v[204:207], v[232:235], v[156:159]
    ds_read_b128 v[204:207], v20 offset:5120
    s_waitcnt lgkmcnt(8)
    v_mfma_f32_16x16x32_bf16 v[160:163], v[208:211], v[228:231], v[160:163]
    v_exp_f32 v244, v244
    v_mfma_f32_16x16x32_bf16 v[164:167], v[208:211], v[232:235], v[164:167]
    ds_read_b128 v[208:211], v20 offset:6144
    v_exp_f32 v245, v245
    v_mfma_f32_16x16x32_bf16 v[168:171], v[212:215], v[228:231], v[168:171]
    v_exp_f32 v246, v246
    v_mfma_f32_16x16x32_bf16 v[172:175], v[212:215], v[232:235], v[172:175]
    ds_read_b128 v[212:215], v20 offset:7168
    v_exp_f32 v247, v247
    v_mfma_f32_16x16x32_bf16 v[176:179], v[216:219], v[228:231], v[176:179]
    v_exp_f32 v248, v248
    v_mfma_f32_16x16x32_bf16 v[180:183], v[216:219], v[232:235], v[180:183]
    ds_read_b128 v[216:219], v20 offset:8192
    s_waitcnt lgkmcnt(6)
    v_mfma_f32_16x16x32_bf16 v[112:115], v[184:187], v[220:223], v[112:115]
    v_exp_f32 v249, v249
    v_mfma_f32_16x16x32_bf16 v[116:119], v[184:187], v[224:227], v[116:119]
    ds_read_b128 v[184:187], v20 offset:9216
    v_exp_f32 v250, v250
    v_mfma_f32_16x16x32_bf16 v[120:123], v[188:191], v[220:223], v[120:123]
    ds_read_b128 v[228:231], v17 offset:0
    v_exp_f32 v251, v251
    v_mfma_f32_16x16x32_bf16 v[124:127], v[188:191], v[224:227], v[124:127]
    ds_read_b128 v[188:191], v20 offset:10240
    v_pk_add_f32 v[244:245], v[244:245], s[76:77]
    v_pk_add_f32 v[246:247], v[246:247], s[76:77]
    v_mfma_f32_16x16x32_bf16 v[128:131], v[192:195], v[220:223], v[128:131]
    ds_read_b128 v[232:235], v17 offset:2048
    v_pk_add_f32 v[248:249], v[248:249], s[76:77]
    v_pk_add_f32 v[250:251], v[250:251], s[76:77]
    v_mfma_f32_16x16x32_bf16 v[132:135], v[192:195], v[224:227], v[132:135]
    ds_read_b128 v[192:195], v20 offset:11264
    s_waitcnt lgkmcnt(8)
    v_mfma_f32_16x16x32_bf16 v[136:139], v[196:199], v[220:223], v[136:139]
    v_rcp_f32 v244, v244
    v_mfma_f32_16x16x32_bf16 v[140:143], v[196:199], v[224:227], v[140:143]
    ds_read_b128 v[196:199], v20 offset:12288
    v_rcp_f32 v245, v245
    v_mfma_f32_16x16x32_bf16 v[144:147], v[200:203], v[220:223], v[144:147]
    v_rcp_f32 v246, v246
    v_mfma_f32_16x16x32_bf16 v[148:151], v[200:203], v[224:227], v[148:151]
    ds_read_b128 v[200:203], v20 offset:13312
    v_rcp_f32 v247, v247
    v_mfma_f32_16x16x32_bf16 v[152:155], v[204:207], v[220:223], v[152:155]
    v_rcp_f32 v248, v248
    v_mfma_f32_16x16x32_bf16 v[156:159], v[204:207], v[224:227], v[156:159]
    ds_read_b128 v[204:207], v20 offset:14336
    s_waitcnt lgkmcnt(8)
    v_mfma_f32_16x16x32_bf16 v[160:163], v[208:211], v[220:223], v[160:163]
    v_rcp_f32 v249, v249
    v_mfma_f32_16x16x32_bf16 v[164:167], v[208:211], v[224:227], v[164:167]
    ds_read_b128 v[208:211], v20 offset:15360
    v_rcp_f32 v250, v250
    v_mfma_f32_16x16x32_bf16 v[168:171], v[212:215], v[220:223], v[168:171]
    v_rcp_f32 v251, v251
    v_mfma_f32_16x16x32_bf16 v[172:175], v[212:215], v[224:227], v[172:175]
    ds_read_b128 v[212:215], v20 offset:16384
    v_pk_mul_f32 v[236:237], v[236:237], v[244:245]
    v_pk_mul_f32 v[238:239], v[238:239], v[246:247]
    v_mfma_f32_16x16x32_bf16 v[176:179], v[216:219], v[220:223], v[176:179]
    v_pk_mul_f32 v[240:241], v[240:241], v[248:249]
    v_pk_mul_f32 v[242:243], v[242:243], v[250:251]
    v_mfma_f32_16x16x32_bf16 v[180:183], v[216:219], v[224:227], v[180:183]
    ds_read_b128 v[216:219], v20 offset:17408
    s_waitcnt lgkmcnt(6)
    s_barrier
    v_mfma_f32_16x16x32_bf16 v[112:115], v[184:187], v[228:231], v[112:115]
    v_cvt_pk_bf16_f32 v72, v236, v237
    v_cvt_pk_bf16_f32 v73, v238, v239
    v_mfma_f32_16x16x32_bf16 v[116:119], v[184:187], v[232:235], v[116:119]
    ds_read_b128 v[184:187], v21 offset:34816
    v_cvt_pk_bf16_f32 v74, v240, v241
    v_cvt_pk_bf16_f32 v75, v242, v243
    v_mfma_f32_16x16x32_bf16 v[120:123], v[188:191], v[228:231], v[120:123]
    ds_read_b128 v[220:223], v18 offset:34816
    v_mfma_f32_16x16x32_bf16 v[124:127], v[188:191], v[232:235], v[124:127]
    ds_read_b128 v[188:191], v21 offset:35840
    v_mfma_f32_16x16x32_bf16 v[128:131], v[192:195], v[228:231], v[128:131]
    ds_read_b128 v[224:227], v18 offset:36864
    v_mfma_f32_16x16x32_bf16 v[132:135], v[192:195], v[232:235], v[132:135]
    ds_read_b128 v[192:195], v21 offset:36864
    s_waitcnt lgkmcnt(8)
    v_mfma_f32_16x16x32_bf16 v[136:139], v[196:199], v[228:231], v[136:139]
    v_mfma_f32_16x16x32_bf16 v[140:143], v[196:199], v[232:235], v[140:143]
    ds_read_b128 v[196:199], v21 offset:37888
    v_mfma_f32_16x16x32_bf16 v[144:147], v[200:203], v[228:231], v[144:147]
    v_mfma_f32_16x16x32_bf16 v[148:151], v[200:203], v[232:235], v[148:151]
    ds_read_b128 v[200:203], v21 offset:38912
    v_mfma_f32_16x16x32_bf16 v[152:155], v[204:207], v[228:231], v[152:155]
    v_mfma_f32_16x16x32_bf16 v[156:159], v[204:207], v[232:235], v[156:159]
    ds_read_b128 v[204:207], v21 offset:39936
    s_waitcnt lgkmcnt(8)
    v_mfma_f32_16x16x32_bf16 v[160:163], v[208:211], v[228:231], v[160:163]
    v_mfma_f32_16x16x32_bf16 v[164:167], v[208:211], v[232:235], v[164:167]
    ds_read_b128 v[208:211], v21 offset:40960
    v_mfma_f32_16x16x32_bf16 v[168:171], v[212:215], v[228:231], v[168:171]
    v_mfma_f32_16x16x32_bf16 v[172:175], v[212:215], v[232:235], v[172:175]
    ds_read_b128 v[212:215], v21 offset:41984
    v_mfma_f32_16x16x32_bf16 v[176:179], v[216:219], v[228:231], v[176:179]
    v_mfma_f32_16x16x32_bf16 v[180:183], v[216:219], v[232:235], v[180:183]
    ds_read_b128 v[216:219], v21 offset:43008
    s_waitcnt lgkmcnt(6)
    v_mfma_f32_16x16x32_bf16 v[112:115], v[184:187], v[220:223], v[112:115]
    v_mfma_f32_16x16x32_bf16 v[116:119], v[184:187], v[224:227], v[116:119]
    ds_read_b128 v[184:187], v21 offset:44032
    v_mfma_f32_16x16x32_bf16 v[120:123], v[188:191], v[220:223], v[120:123]
    ds_read_b128 v[228:231], v19 offset:34816
    v_mfma_f32_16x16x32_bf16 v[124:127], v[188:191], v[224:227], v[124:127]
    ds_read_b128 v[188:191], v21 offset:45056
    v_mfma_f32_16x16x32_bf16 v[128:131], v[192:195], v[220:223], v[128:131]
    ds_read_b128 v[232:235], v19 offset:36864
    v_mfma_f32_16x16x32_bf16 v[132:135], v[192:195], v[224:227], v[132:135]
    ds_read_b128 v[192:195], v21 offset:46080
    s_waitcnt lgkmcnt(8)
    v_mfma_f32_16x16x32_bf16 v[136:139], v[196:199], v[220:223], v[136:139]
    v_mfma_f32_16x16x32_bf16 v[140:143], v[196:199], v[224:227], v[140:143]
    ds_read_b128 v[196:199], v21 offset:47104
    v_mfma_f32_16x16x32_bf16 v[144:147], v[200:203], v[220:223], v[144:147]
    v_mfma_f32_16x16x32_bf16 v[148:151], v[200:203], v[224:227], v[148:151]
    ds_read_b128 v[200:203], v21 offset:48128
    v_mfma_f32_16x16x32_bf16 v[152:155], v[204:207], v[220:223], v[152:155]
    v_mfma_f32_16x16x32_bf16 v[156:159], v[204:207], v[224:227], v[156:159]
    ds_read_b128 v[204:207], v21 offset:49152
    s_waitcnt lgkmcnt(8)
    v_mfma_f32_16x16x32_bf16 v[160:163], v[208:211], v[220:223], v[160:163]
    v_mfma_f32_16x16x32_bf16 v[164:167], v[208:211], v[224:227], v[164:167]
    ds_read_b128 v[208:211], v21 offset:50176
    v_mfma_f32_16x16x32_bf16 v[168:171], v[212:215], v[220:223], v[168:171]
    v_mfma_f32_16x16x32_bf16 v[172:175], v[212:215], v[224:227], v[172:175]
    ds_read_b128 v[212:215], v21 offset:51200
    v_mfma_f32_16x16x32_bf16 v[176:179], v[216:219], v[220:223], v[176:179]
    v_mfma_f32_16x16x32_bf16 v[180:183], v[216:219], v[224:227], v[180:183]
    ds_read_b128 v[216:219], v21 offset:52224
    s_waitcnt lgkmcnt(6)
    s_barrier
    v_mfma_f32_16x16x32_bf16 v[112:115], v[184:187], v[228:231], v[112:115]
    v_mfma_f32_16x16x32_bf16 v[116:119], v[184:187], v[232:235], v[116:119]
    ds_read_b128 v[184:187], v20 offset:36864
    v_mfma_f32_16x16x32_bf16 v[120:123], v[188:191], v[228:231], v[120:123]
    ds_read_b128 v[220:223], v16 offset:36864
    v_mfma_f32_16x16x32_bf16 v[124:127], v[188:191], v[232:235], v[124:127]
    ds_read_b128 v[188:191], v20 offset:37888
    v_mfma_f32_16x16x32_bf16 v[128:131], v[192:195], v[228:231], v[128:131]
    ds_read_b128 v[224:227], v16 offset:38912
    v_mfma_f32_16x16x32_bf16 v[132:135], v[192:195], v[232:235], v[132:135]
    ds_read_b128 v[192:195], v20 offset:38912
    s_waitcnt lgkmcnt(8)
    v_mfma_f32_16x16x32_bf16 v[136:139], v[196:199], v[228:231], v[136:139]
    v_mfma_f32_16x16x32_bf16 v[140:143], v[196:199], v[232:235], v[140:143]
    ds_read_b128 v[196:199], v20 offset:39936
    v_mfma_f32_16x16x32_bf16 v[144:147], v[200:203], v[228:231], v[144:147]
    v_mfma_f32_16x16x32_bf16 v[148:151], v[200:203], v[232:235], v[148:151]
    ds_read_b128 v[200:203], v20 offset:40960
    v_mfma_f32_16x16x32_bf16 v[152:155], v[204:207], v[228:231], v[152:155]
    v_mfma_f32_16x16x32_bf16 v[156:159], v[204:207], v[232:235], v[156:159]
    ds_read_b128 v[204:207], v20 offset:41984
    s_waitcnt lgkmcnt(8)
    v_mfma_f32_16x16x32_bf16 v[160:163], v[208:211], v[228:231], v[160:163]
    v_mfma_f32_16x16x32_bf16 v[164:167], v[208:211], v[232:235], v[164:167]
    ds_read_b128 v[208:211], v20 offset:43008
    v_mfma_f32_16x16x32_bf16 v[168:171], v[212:215], v[228:231], v[168:171]
    v_mfma_f32_16x16x32_bf16 v[172:175], v[212:215], v[232:235], v[172:175]
    ds_read_b128 v[212:215], v20 offset:44032
    v_mfma_f32_16x16x32_bf16 v[176:179], v[216:219], v[228:231], v[176:179]
    v_mfma_f32_16x16x32_bf16 v[180:183], v[216:219], v[232:235], v[180:183]
    ds_read_b128 v[216:219], v20 offset:45056
LA_p2b:
    s_waitcnt lgkmcnt(6)
    v_mfma_f32_16x16x32_bf16 v[112:115], v[184:187], v[220:223], v[112:115]
    v_mfma_f32_16x16x32_bf16 v[116:119], v[184:187], v[224:227], v[116:119]
    ds_read_b128 v[184:187], v20 offset:46080
    v_mfma_f32_16x16x32_bf16 v[120:123], v[188:191], v[220:223], v[120:123]
    ds_read_b128 v[228:231], v17 offset:36864
    v_mfma_f32_16x16x32_bf16 v[124:127], v[188:191], v[224:227], v[124:127]
    ds_read_b128 v[188:191], v20 offset:47104
    v_mfma_f32_16x16x32_bf16 v[128:131], v[192:195], v[220:223], v[128:131]
    ds_read_b128 v[232:235], v17 offset:38912
    v_mfma_f32_16x16x32_bf16 v[132:135], v[192:195], v[224:227], v[132:135]
    ds_read_b128 v[192:195], v20 offset:48128
    s_waitcnt lgkmcnt(8)
    v_mfma_f32_16x16x32_bf16 v[136:139], v[196:199], v[220:223], v[136:139]
    v_mfma_f32_16x16x32_bf16 v[140:143], v[196:199], v[224:227], v[140:143]
    ds_read_b128 v[196:199], v20 offset:49152
    v_mfma_f32_16x16x32_bf16 v[144:147], v[200:203], v[220:223], v[144:147]
    v_mfma_f32_16x16x32_bf16 v[148:151], v[200:203], v[224:227], v[148:151]
    ds_read_b128 v[200:203], v20 offset:50176
    v_mfma_f32_16x16x32_bf16 v[152:155], v[204:207], v[220:223], v[152:155]
    v_mfma_f32_16x16x32_bf16 v[156:159], v[204:207], v[224:227], v[156:159]
    ds_read_b128 v[204:207], v20 offset:51200
    s_waitcnt lgkmcnt(8)
    v_mfma_f32_16x16x32_bf16 v[160:163], v[208:211], v[220:223], v[160:163]
    v_mfma_f32_16x16x32_bf16 v[164:167], v[208:211], v[224:227], v[164:167]
    ds_read_b128 v[208:211], v20 offset:52224
    v_mfma_f32_16x16x32_bf16 v[168:171], v[212:215], v[220:223], v[168:171]
    v_mfma_f32_16x16x32_bf16 v[172:175], v[212:215], v[224:227], v[172:175]
    ds_read_b128 v[212:215], v20 offset:53248
    v_mfma_f32_16x16x32_bf16 v[176:179], v[216:219], v[220:223], v[176:179]
    v_mfma_f32_16x16x32_bf16 v[180:183], v[216:219], v[224:227], v[180:183]
    ds_read_b128 v[216:219], v20 offset:54272
    s_waitcnt lgkmcnt(6)
    s_barrier
    v_mfma_f32_16x16x32_bf16 v[112:115], v[184:187], v[228:231], v[112:115]
    v_mfma_f32_16x16x32_bf16 v[116:119], v[184:187], v[232:235], v[116:119]
    ds_read_b128 v[184:187], v21 offset:0
    v_mfma_f32_16x16x32_bf16 v[120:123], v[188:191], v[228:231], v[120:123]
    ds_read_b128 v[220:223], v18 offset:0
    v_mfma_f32_16x16x32_bf16 v[124:127], v[188:191], v[232:235], v[124:127]
    ds_read_b128 v[188:191], v21 offset:1024
    v_mfma_f32_16x16x32_bf16 v[128:131], v[192:195], v[228:231], v[128:131]
    ds_read_b128 v[224:227], v18 offset:2048
    v_mfma_f32_16x16x32_bf16 v[132:135], v[192:195], v[232:235], v[132:135]
    ds_read_b128 v[192:195], v21 offset:2048
    s_waitcnt lgkmcnt(8)
    v_mfma_f32_16x16x32_bf16 v[136:139], v[196:199], v[228:231], v[136:139]
    v_mfma_f32_16x16x32_bf16 v[140:143], v[196:199], v[232:235], v[140:143]
    ds_read_b128 v[196:199], v21 offset:3072
    v_mfma_f32_16x16x32_bf16 v[144:147], v[200:203], v[228:231], v[144:147]
    v_mfma_f32_16x16x32_bf16 v[148:151], v[200:203], v[232:235], v[148:151]
    ds_read_b128 v[200:203], v21 offset:4096
    v_mfma_f32_16x16x32_bf16 v[152:155], v[204:207], v[228:231], v[152:155]
    v_mfma_f32_16x16x32_bf16 v[156:159], v[204:207], v[232:235], v[156:159]
    ds_read_b128 v[204:207], v21 offset:5120
    s_waitcnt lgkmcnt(8)
    v_mfma_f32_16x16x32_bf16 v[160:163], v[208:211], v[228:231], v[160:163]
    v_mfma_f32_16x16x32_bf16 v[164:167], v[208:211], v[232:235], v[164:167]
    ds_read_b128 v[208:211], v21 offset:6144
    v_mfma_f32_16x16x32_bf16 v[168:171], v[212:215], v[228:231], v[168:171]
    v_mfma_f32_16x16x32_bf16 v[172:175], v[212:215], v[232:235], v[172:175]
    ds_read_b128 v[212:215], v21 offset:7168
    v_mfma_f32_16x16x32_bf16 v[176:179], v[216:219], v[228:231], v[176:179]
    v_mfma_f32_16x16x32_bf16 v[180:183], v[216:219], v[232:235], v[180:183]
    ds_read_b128 v[216:219], v21 offset:8192
    s_waitcnt lgkmcnt(6)
    v_mfma_f32_16x16x32_bf16 v[112:115], v[184:187], v[220:223], v[112:115]
    v_mfma_f32_16x16x32_bf16 v[116:119], v[184:187], v[224:227], v[116:119]
    ds_read_b128 v[184:187], v21 offset:9216
    v_mfma_f32_16x16x32_bf16 v[120:123], v[188:191], v[220:223], v[120:123]
    ds_read_b128 v[228:231], v19 offset:0
    v_mfma_f32_16x16x32_bf16 v[124:127], v[188:191], v[224:227], v[124:127]
    ds_read_b128 v[188:191], v21 offset:10240
    v_mfma_f32_16x16x32_bf16 v[128:131], v[192:195], v[220:223], v[128:131]
    ds_read_b128 v[232:235], v19 offset:2048
    v_mfma_f32_16x16x32_bf16 v[132:135], v[192:195], v[224:227], v[132:135]
    ds_read_b128 v[192:195], v21 offset:11264
    s_waitcnt lgkmcnt(8)
    v_mfma_f32_16x16x32_bf16 v[136:139], v[196:199], v[220:223], v[136:139]
    v_mfma_f32_16x16x32_bf16 v[140:143], v[196:199], v[224:227], v[140:143]
    ds_read_b128 v[196:199], v21 offset:12288
    v_mfma_f32_16x16x32_bf16 v[144:147], v[200:203], v[220:223], v[144:147]
    v_mfma_f32_16x16x32_bf16 v[148:151], v[200:203], v[224:227], v[148:151]
    ds_read_b128 v[200:203], v21 offset:13312
    v_mfma_f32_16x16x32_bf16 v[152:155], v[204:207], v[220:223], v[152:155]
    v_mfma_f32_16x16x32_bf16 v[156:159], v[204:207], v[224:227], v[156:159]
    ds_read_b128 v[204:207], v21 offset:14336
    s_waitcnt lgkmcnt(8)
    v_mfma_f32_16x16x32_bf16 v[160:163], v[208:211], v[220:223], v[160:163]
    v_mfma_f32_16x16x32_bf16 v[164:167], v[208:211], v[224:227], v[164:167]
    ds_read_b128 v[208:211], v21 offset:15360
    v_mfma_f32_16x16x32_bf16 v[168:171], v[212:215], v[220:223], v[168:171]
    v_mfma_f32_16x16x32_bf16 v[172:175], v[212:215], v[224:227], v[172:175]
    ds_read_b128 v[212:215], v21 offset:16384
    v_mfma_f32_16x16x32_bf16 v[176:179], v[216:219], v[220:223], v[176:179]
    v_mfma_f32_16x16x32_bf16 v[180:183], v[216:219], v[224:227], v[180:183]
    ds_read_b128 v[216:219], v21 offset:17408
    s_waitcnt lgkmcnt(6)
    s_barrier
    v_mfma_f32_16x16x32_bf16 v[112:115], v[184:187], v[228:231], v[112:115]
    v_bfe_u32 v12, v2, 1, 1
    v_mov_b32 v22, 2
    v_mfma_f32_16x16x32_bf16 v[116:119], v[184:187], v[232:235], v[116:119]
    ds_read_b128 v[184:187], v20 offset:0
    v_cmp_eq_u32 vcc, v12, v3
    v_lshrrev_b32 v12, 2, v2
    v_mfma_f32_16x16x32_bf16 v[120:123], v[188:191], v[228:231], v[120:123]
    ds_read_b128 v[220:223], v16 offset:0
    v_mul_u32_u24 v12, 48, v12
    v_cndmask_b32 v13, v22, v3, vcc
    v_mfma_f32_16x16x32_bf16 v[124:127], v[188:191], v[232:235], v[124:127]
    ds_read_b128 v[188:191], v20 offset:1024
    v_mul_u32_u24 v13, 1920, v13
    v_add_u32 v13, v13, v12
    v_mfma_f32_16x16x32_bf16 v[128:131], v[192:195], v[228:231], v[128:131]
    ds_read_b128 v[224:227], v16 offset:2048
    v_and_b32 v12, 1, v2
    v_mul_u32_u24 v12, 24, v12
    v_mfma_f32_16x16x32_bf16 v[132:135], v[192:195], v[232:235], v[132:135]
    ds_read_b128 v[192:195], v20 offset:2048
    s_waitcnt lgkmcnt(8)
    v_mfma_f32_16x16x32_bf16 v[136:139], v[196:199], v[228:231], v[136:139]
    v_add_u32 v12, v12, v13
    v_add_u32 v38, 141312, v12
    v_mfma_f32_16x16x32_bf16 v[140:143], v[196:199], v[232:235], v[140:143]
    ds_read_b128 v[196:199], v20 offset:3072
    v_lshlrev_b32 v39, 1, v1
    ds_read_b64_tr_b16 v[4:5], v38 offset:0
    v_mfma_f32_16x16x32_bf16 v[144:147], v[200:203], v[228:231], v[144:147]
    ds_read_b64_tr_b16 v[6:7], v38 offset:192
    ds_read_b64_tr_b16 v[8:9], v38 offset:8
    v_mfma_f32_16x16x32_bf16 v[148:151], v[200:203], v[232:235], v[148:151]
    ds_read_b128 v[200:203], v20 offset:4096
    ds_read_b64_tr_b16 v[10:11], v38 offset:200
    v_mfma_f32_16x16x32_bf16 v[152:155], v[204:207], v[228:231], v[152:155]
    v_mfma_f32_16x16x32_bf16 v[156:159], v[204:207], v[232:235], v[156:159]
    ds_read_b128 v[204:207], v20 offset:5120
    s_waitcnt lgkmcnt(12)
    v_mfma_f32_16x16x32_bf16 v[160:163], v[208:211], v[228:231], v[160:163]
    v_mfma_f32_16x16x32_bf16 v[164:167], v[208:211], v[232:235], v[164:167]
    ds_read_b128 v[208:211], v20 offset:6144
    v_mfma_f32_16x16x32_bf16 v[168:171], v[212:215], v[228:231], v[168:171]
    s_waitcnt lgkmcnt(5)
    v_mfma_f32_16x16x32_bf16 v[236:239], v[4:7], v[76:79], 0
    v_mfma_f32_16x16x32_bf16 v[248:251], v[4:7], v[96:99], 0
    v_mfma_f32_16x16x32_bf16 v[172:175], v[212:215], v[232:235], v[172:175]
    ds_read_b128 v[212:215], v20 offset:7168
    ds_read_b64_tr_b16 v[4:5], v38 offset:16
    ds_read_b64_tr_b16 v[6:7], v38 offset:208
    v_mfma_f32_16x16x32_bf16 v[176:179], v[216:219], v[228:231], v[176:179]
    v_mfma_f32_16x16x32_bf16 v[180:183], v[216:219], v[232:235], v[180:183]
    ds_read_b128 v[216:219], v20 offset:8192
    v_mfma_f32_16x16x32_bf16 v[112:115], v[184:187], v[220:223], v[112:115]
    v_mfma_f32_16x16x32_bf16 v[116:119], v[184:187], v[224:227], v[116:119]
    ds_read_b128 v[184:187], v20 offset:9216
    v_mfma_f32_16x16x32_bf16 v[120:123], v[188:191], v[220:223], v[120:123]
    ds_read_b128 v[228:231], v17 offset:0
    s_waitcnt lgkmcnt(8)
    v_mfma_f32_16x16x32_bf16 v[240:243], v[8:11], v[76:79], 0
    v_mfma_f32_16x16x32_bf16 v[252:255], v[8:11], v[96:99], 0
    v_mfma_f32_16x16x32_bf16 v[124:127], v[188:191], v[224:227], v[124:127]
    ds_read_b128 v[188:191], v20 offset:10240
    ds_read_b64_tr_b16 v[8:9], v38 offset:384
    ds_read_b64_tr_b16 v[10:11], v38 offset:576
    v_mfma_f32_16x16x32_bf16 v[128:131], v[192:195], v[220:223], v[128:131]
    ds_read_b128 v[232:235], v17 offset:2048
    v_mfma_f32_16x16x32_bf16 v[132:135], v[192:195], v[224:227], v[132:135]
    ds_read_b128 v[192:195], v20 offset:11264
    s_waitcnt lgkmcnt(12)
    v_mfma_f32_16x16x32_bf16 v[136:139], v[196:199], v[220:223], v[136:139]
    v_mfma_f32_16x16x32_bf16 v[140:143], v[196:199], v[224:227], v[140:143]
    ds_read_b128 v[196:199], v20 offset:12288
    v_mfma_f32_16x16x32_bf16 v[144:147], v[200:203], v[220:223], v[144:147]
    s_waitcnt lgkmcnt(9)
    v_mfma_f32_16x16x32_bf16 v[244:247], v[4:7], v[76:79], 0
    v_mfma_f32_16x16x32_bf16 v[28:31], v[4:7], v[96:99], 0
    v_mfma_f32_16x16x32_bf16 v[148:151], v[200:203], v[224:227], v[148:151]
    ds_read_b128 v[200:203], v20 offset:13312
    ds_read_b64_tr_b16 v[4:5], v38 offset:392
    ds_read_b64_tr_b16 v[6:7], v38 offset:584
    v_mfma_f32_16x16x32_bf16 v[152:155], v[204:207], v[220:223], v[152:155]
    v_mfma_f32_16x16x32_bf16 v[156:159], v[204:207], v[224:227], v[156:159]
    ds_read_b128 v[204:207], v20 offset:14336
    s_waitcnt lgkmcnt(12)
    v_mfma_f32_16x16x32_bf16 v[160:163], v[208:211], v[220:223], v[160:163]
    v_mfma_f32_16x16x32_bf16 v[164:167], v[208:211], v[224:227], v[164:167]
    ds_read_b128 v[208:211], v20 offset:15360
    v_mfma_f32_16x16x32_bf16 v[168:171], v[212:215], v[220:223], v[168:171]
    s_waitcnt lgkmcnt(8)
    v_mfma_f32_16x16x32_bf16 v[236:239], v[8:11], v[80:83], v[236:239]
    v_mfma_f32_16x16x32_bf16 v[248:251], v[8:11], v[100:103], v[248:251]
    v_mfma_f32_16x16x32_bf16 v[172:175], v[212:215], v[224:227], v[172:175]
    ds_read_b128 v[212:215], v20 offset:16384
    ds_read_b64_tr_b16 v[8:9], v38 offset:400
    ds_read_b64_tr_b16 v[10:11], v38 offset:592
    v_mfma_f32_16x16x32_bf16 v[176:179], v[216:219], v[220:223], v[176:179]
    v_mfma_f32_16x16x32_bf16 v[180:183], v[216:219], v[224:227], v[180:183]
    ds_read_b128 v[216:219], v20 offset:17408
    s_waitcnt lgkmcnt(10)
    s_barrier
    v_mfma_f32_16x16x32_bf16 v[112:115], v[184:187], v[228:231], v[112:115]
    v_mfma_f32_16x16x32_bf16 v[116:119], v[184:187], v[232:235], v[116:119]
    ds_read_b128 v[184:187], v21 offset:34816
    v_mfma_f32_16x16x32_bf16 v[120:123], v[188:191], v[228:231], v[120:123]
    ds_read_b128 v[220:223], v18 offset:34816
    s_waitcnt lgkmcnt(8)
    v_mfma_f32_16x16x32_bf16 v[240:243], v[4:7], v[80:83], v[240:243]
    v_mfma_f32_16x16x32_bf16 v[252:255], v[4:7], v[100:103], v[252:255]
    v_mfma_f32_16x16x32_bf16 v[124:127], v[188:191], v[232:235], v[124:127]
    ds_read_b128 v[188:191], v21 offset:35840
    ds_read_b64_tr_b16 v[4:5], v38 offset:768
    ds_read_b64_tr_b16 v[6:7], v38 offset:960
    v_mfma_f32_16x16x32_bf16 v[128:131], v[192:195], v[228:231], v[128:131]
    ds_read_b128 v[224:227], v18 offset:36864
    v_mfma_f32_16x16x32_bf16 v[132:135], v[192:195], v[232:235], v[132:135]
    ds_read_b128 v[192:195], v21 offset:36864
    s_waitcnt lgkmcnt(12)
    v_mfma_f32_16x16x32_bf16 v[136:139], v[196:199], v[228:231], v[136:139]
    v_mfma_f32_16x16x32_bf16 v[140:143], v[196:199], v[232:235], v[140:143]
    ds_read_b128 v[196:199], v21 offset:37888
    v_mfma_f32_16x16x32_bf16 v[144:147], v[200:203], v[228:231], v[144:147]
    s_waitcnt lgkmcnt(9)
    v_mfma_f32_16x16x32_bf16 v[244:247], v[8:11], v[80:83], v[244:247]
    v_mfma_f32_16x16x32_bf16 v[28:31], v[8:11], v[100:103], v[28:31]
    v_mfma_f32_16x16x32_bf16 v[148:151], v[200:203], v[232:235], v[148:151]
    ds_read_b128 v[200:203], v21 offset:38912
    ds_read_b64_tr_b16 v[8:9], v38 offset:776
    ds_read_b64_tr_b16 v[10:11], v38 offset:968
    v_mfma_f32_16x16x32_bf16 v[152:155], v[204:207], v[228:231], v[152:155]
    v_mfma_f32_16x16x32_bf16 v[156:159], v[204:207], v[232:235], v[156:159]
    ds_read_b128 v[204:207], v21 offset:39936
    s_waitcnt lgkmcnt(12)
    v_mfma_f32_16x16x32_bf16 v[160:163], v[208:211], v[228:231], v[160:163]
    v_mfma_f32_16x16x32_bf16 v[164:167], v[208:211], v[232:235], v[164:167]
    ds_read_b128 v[208:211], v21 offset:40960
    v_mfma_f32_16x16x32_bf16 v[168:171], v[212:215], v[228:231], v[168:171]
    s_waitcnt lgkmcnt(8)
    v_mfma_f32_16x16x32_bf16 v[236:239], v[4:7], v[84:87], v[236:239]
    v_mfma_f32_16x16x32_bf16 v[248:251], v[4:7], v[104:107], v[248:251]
    v_mfma_f32_16x16x32_bf16 v[172:175], v[212:215], v[232:235], v[172:175]
    ds_read_b128 v[212:215], v21 offset:41984
    ds_read_b64_tr_b16 v[4:5], v38 offset:784
    ds_read_b64_tr_b16 v[6:7], v38 offset:976
    v_mfma_f32_16x16x32_bf16 v[176:179], v[216:219], v[228:231], v[176:179]
    v_mfma_f32_16x16x32_bf16 v[180:183], v[216:219], v[232:235], v[180:183]
    ds_read_b128 v[216:219], v21 offset:43008
    s_waitcnt lgkmcnt(10)
    v_mfma_f32_16x16x32_bf16 v[112:115], v[184:187], v[220:223], v[112:115]
    v_mfma_f32_16x16x32_bf16 v[116:119], v[184:187], v[224:227], v[116:119]
    ds_read_b128 v[184:187], v21 offset:44032
    v_mfma_f32_16x16x32_bf16 v[120:123], v[188:191], v[220:223], v[120:123]
    ds_read_b128 v[228:231], v19 offset:34816
    s_waitcnt lgkmcnt(8)
    v_mfma_f32_16x16x32_bf16 v[240:243], v[8:11], v[84:87], v[240:243]
    v_mfma_f32_16x16x32_bf16 v[252:255], v[8:11], v[104:107], v[252:255]
    v_mfma_f32_16x16x32_bf16 v[124:127], v[188:191], v[224:227], v[124:127]
    ds_read_b128 v[188:191], v21 offset:45056
    ds_read_b64_tr_b16 v[8:9], v38 offset:1152
    ds_read_b64_tr_b16 v[10:11], v38 offset:1344
    v_mfma_f32_16x16x32_bf16 v[128:131], v[192:195], v[220:223], v[128:131]
    ds_read_b128 v[232:235], v19 offset:36864
    v_mfma_f32_16x16x32_bf16 v[132:135], v[192:195], v[224:227], v[132:135]
    ds_read_b128 v[192:195], v21 offset:46080
    s_waitcnt lgkmcnt(12)
    v_mfma_f32_16x16x32_bf16 v[136:139], v[196:199], v[220:223], v[136:139]
    v_mfma_f32_16x16x32_bf16 v[140:143], v[196:199], v[224:227], v[140:143]
    ds_read_b128 v[196:199], v21 offset:47104
    v_mfma_f32_16x16x32_bf16 v[144:147], v[200:203], v[220:223], v[144:147]
    s_waitcnt lgkmcnt(9)
    v_mfma_f32_16x16x32_bf16 v[244:247], v[4:7], v[84:87], v[244:247]
    v_mfma_f32_16x16x32_bf16 v[28:31], v[4:7], v[104:107], v[28:31]
    v_mfma_f32_16x16x32_bf16 v[148:151], v[200:203], v[224:227], v[148:151]
    ds_read_b128 v[200:203], v21 offset:48128
    ds_read_b64_tr_b16 v[4:5], v38 offset:1160
    ds_read_b64_tr_b16 v[6:7], v38 offset:1352
    v_mfma_f32_16x16x32_bf16 v[152:155], v[204:207], v[220:223], v[152:155]
    v_mfma_f32_16x16x32_bf16 v[156:159], v[204:207], v[224:227], v[156:159]
    ds_read_b128 v[204:207], v21 offset:49152
    s_waitcnt lgkmcnt(12)
    v_mfma_f32_16x16x32_bf16 v[160:163], v[208:211], v[220:223], v[160:163]
    v_mfma_f32_16x16x32_bf16 v[164:167], v[208:211], v[224:227], v[164:167]
    ds_read_b128 v[208:211], v21 offset:50176
    v_mfma_f32_16x16x32_bf16 v[168:171], v[212:215], v[220:223], v[168:171]
    s_waitcnt lgkmcnt(8)
    v_mfma_f32_16x16x32_bf16 v[236:239], v[8:11], v[88:91], v[236:239]
    v_mfma_f32_16x16x32_bf16 v[248:251], v[8:11], v[108:111], v[248:251]
    v_mfma_f32_16x16x32_bf16 v[172:175], v[212:215], v[224:227], v[172:175]
    ds_read_b128 v[212:215], v21 offset:51200
    ds_read_b64_tr_b16 v[8:9], v38 offset:1168
    ds_read_b64_tr_b16 v[10:11], v38 offset:1360
    v_mfma_f32_16x16x32_bf16 v[176:179], v[216:219], v[220:223], v[176:179]
    v_mfma_f32_16x16x32_bf16 v[180:183], v[216:219], v[224:227], v[180:183]
    ds_read_b128 v[216:219], v21 offset:52224
    s_waitcnt lgkmcnt(10)
    s_barrier
    v_mfma_f32_16x16x32_bf16 v[112:115], v[184:187], v[228:231], v[112:115]
    v_mfma_f32_16x16x32_bf16 v[116:119], v[184:187], v[232:235], v[116:119]
    ds_read_b128 v[184:187], v20 offset:36864
    v_mfma_f32_16x16x32_bf16 v[120:123], v[188:191], v[228:231], v[120:123]
    ds_read_b128 v[220:223], v16 offset:36864
    s_waitcnt lgkmcnt(8)
    v_mfma_f32_16x16x32_bf16 v[240:243], v[4:7], v[88:91], v[240:243]
    v_mfma_f32_16x16x32_bf16 v[252:255], v[4:7], v[108:111], v[252:255]
    v_mfma_f32_16x16x32_bf16 v[124:127], v[188:191], v[232:235], v[124:127]
    ds_read_b128 v[188:191], v20 offset:37888
    ds_read_b64_tr_b16 v[4:5], v38 offset:1536
    ds_read_b64_tr_b16 v[6:7], v38 offset:1728
    v_mfma_f32_16x16x32_bf16 v[128:131], v[192:195], v[228:231], v[128:131]
    ds_read_b128 v[224:227], v16 offset:38912
    v_mfma_f32_16x16x32_bf16 v[132:135], v[192:195], v[232:235], v[132:135]
    ds_read_b128 v[192:195], v20 offset:38912
    s_waitcnt lgkmcnt(12)
    v_mfma_f32_16x16x32_bf16 v[136:139], v[196:199], v[228:231], v[136:139]
    v_mfma_f32_16x16x32_bf16 v[140:143], v[196:199], v[232:235], v[140:143]
    ds_read_b128 v[196:199], v20 offset:39936
    v_mfma_f32_16x16x32_bf16 v[144:147], v[200:203], v[228:231], v[144:147]
    s_waitcnt lgkmcnt(9)
    v_mfma_f32_16x16x32_bf16 v[244:247], v[8:11], v[88:91], v[244:247]
    v_mfma_f32_16x16x32_bf16 v[28:31], v[8:11], v[108:111], v[28:31]
    v_mfma_f32_16x16x32_bf16 v[148:151], v[200:203], v[232:235], v[148:151]
    ds_read_b128 v[200:203], v20 offset:40960
    ds_read_b64_tr_b16 v[8:9], v38 offset:1544
    ds_read_b64_tr_b16 v[10:11], v38 offset:1736
    v_mfma_f32_16x16x32_bf16 v[152:155], v[204:207], v[228:231], v[152:155]
    v_mfma_f32_16x16x32_bf16 v[156:159], v[204:207], v[232:235], v[156:159]
    ds_read_b128 v[204:207], v20 offset:41984
    s_waitcnt lgkmcnt(12)
    v_mfma_f32_16x16x32_bf16 v[160:163], v[208:211], v[228:231], v[160:163]
    v_mfma_f32_16x16x32_bf16 v[164:167], v[208:211], v[232:235], v[164:167]
    ds_read_b128 v[208:211], v20 offset:43008
    v_mfma_f32_16x16x32_bf16 v[168:171], v[212:215], v[228:231], v[168:171]
    s_waitcnt lgkmcnt(8)
    v_mfma_f32_16x16x32_bf16 v[236:239], v[4:7], v[92:95], v[236:239]
    v_mfma_f32_16x16x32_bf16 v[248:251], v[4:7], v[32:35], v[248:251]
    v_mfma_f32_16x16x32_bf16 v[172:175], v[212:215], v[232:235], v[172:175]
    ds_read_b128 v[212:215], v20 offset:44032
    ds_read_b64_tr_b16 v[4:5], v38 offset:1552
    ds_read_b64_tr_b16 v[6:7], v38 offset:1744
    v_mfma_f32_16x16x32_bf16 v[176:179], v[216:219], v[228:231], v[176:179]
    v_mfma_f32_16x16x32_bf16 v[180:183], v[216:219], v[232:235], v[180:183]
    ds_read_b128 v[216:219], v20 offset:45056
    s_waitcnt lgkmcnt(10)
    v_mfma_f32_16x16x32_bf16 v[112:115], v[184:187], v[220:223], v[112:115]
    v_mfma_f32_16x16x32_bf16 v[116:119], v[184:187], v[224:227], v[116:119]
    ds_read_b128 v[184:187], v20 offset:46080
    v_mfma_f32_16x16x32_bf16 v[120:123], v[188:191], v[220:223], v[120:123]
    ds_read_b128 v[228:231], v17 offset:36864
    s_waitcnt lgkmcnt(8)
    v_mfma_f32_16x16x32_bf16 v[240:243], v[8:11], v[92:95], v[240:243]
    v_mfma_f32_16x16x32_bf16 v[252:255], v[8:11], v[32:35], v[252:255]
    v_mfma_f32_16x16x32_bf16 v[124:127], v[188:191], v[224:227], v[124:127]
    ds_read_b128 v[188:191], v20 offset:47104
    v_mfma_f32_16x16x32_bf16 v[128:131], v[192:195], v[220:223], v[128:131]
    ds_read_b128 v[232:235], v17 offset:38912
    v_mfma_f32_16x16x32_bf16 v[132:135], v[192:195], v[224:227], v[132:135]
    ds_read_b128 v[192:195], v20 offset:48128
    s_waitcnt lgkmcnt(10)
    v_mfma_f32_16x16x32_bf16 v[136:139], v[196:199], v[220:223], v[136:139]
    v_mfma_f32_16x16x32_bf16 v[140:143], v[196:199], v[224:227], v[140:143]
    ds_read_b128 v[196:199], v20 offset:49152
    s_waitcnt lgkmcnt(7)
    v_mfma_f32_16x16x32_bf16 v[244:247], v[4:7], v[92:95], v[244:247]
    v_mfma_f32_16x16x32_bf16 v[28:31], v[4:7], v[32:35], v[28:31]
    v_mfma_f32_16x16x32_bf16 v[144:147], v[200:203], v[220:223], v[144:147]
    s_mul_i32 s64, s63, 2304
    s_add_u32 s64, s64, 151552
    v_mfma_f32_16x16x32_bf16 v[148:151], v[200:203], v[224:227], v[148:151]
    ds_read_b128 v[200:203], v20 offset:50176
    v_add_u32 v38, s64, v24
    v_add_u32 v39, s64, v39
    v_mfma_f32_16x16x32_bf16 v[152:155], v[204:207], v[220:223], v[152:155]
    s_nop 1
    s_nop 1
    v_mfma_f32_16x16x32_bf16 v[156:159], v[204:207], v[224:227], v[156:159]
    ds_read_b128 v[204:207], v20 offset:51200
    s_waitcnt lgkmcnt(8)
    v_mfma_f32_16x16x32_bf16 v[160:163], v[208:211], v[220:223], v[160:163]
    v_add_f32 v245, 0x358637bd, v245
    v_mfma_f32_16x16x32_bf16 v[164:167], v[208:211], v[224:227], v[164:167]
    ds_read_b128 v[208:211], v20 offset:52224
    v_rcp_f32 v245, v245
    v_mfma_f32_16x16x32_bf16 v[168:171], v[212:215], v[220:223], v[168:171]
    s_nop 0
    v_mul_f32 v236, v236, v245
    v_mfma_f32_16x16x32_bf16 v[172:175], v[212:215], v[224:227], v[172:175]
    ds_read_b128 v[212:215], v20 offset:53248
    v_mul_f32 v237, v237, v245
    v_mul_f32 v238, v238, v245
    v_mfma_f32_16x16x32_bf16 v[176:179], v[216:219], v[220:223], v[176:179]
    v_mul_f32 v239, v239, v245
    v_mul_f32 v240, v240, v245
    v_mfma_f32_16x16x32_bf16 v[180:183], v[216:219], v[224:227], v[180:183]
    ds_read_b128 v[216:219], v20 offset:54272
    s_waitcnt lgkmcnt(6)
    s_barrier
    v_mfma_f32_16x16x32_bf16 v[112:115], v[184:187], v[228:231], v[112:115]
    v_mul_f32 v241, v241, v245
    v_mul_f32 v242, v242, v245
    v_mfma_f32_16x16x32_bf16 v[116:119], v[184:187], v[232:235], v[116:119]
    ds_read_b128 v[184:187], v21 offset:0
    v_mul_f32 v243, v243, v245
    v_mul_f32 v244, v244, v245
    v_mfma_f32_16x16x32_bf16 v[120:123], v[188:191], v[228:231], v[120:123]
    ds_read_b128 v[220:223], v18 offset:0
    v_cvt_pk_bf16_f32 v236, v236, v237
    v_cvt_pk_bf16_f32 v237, v238, v239
    v_mfma_f32_16x16x32_bf16 v[124:127], v[188:191], v[232:235], v[124:127]
    ds_read_b128 v[188:191], v21 offset:1024
    v_cvt_pk_bf16_f32 v238, v240, v241
    v_cvt_pk_bf16_f32 v239, v242, v243
    v_mfma_f32_16x16x32_bf16 v[128:131], v[192:195], v[228:231], v[128:131]
    ds_read_b128 v[224:227], v18 offset:2048
    v_cvt_pk_bf16_f32 v244, v244, v244
    v_mfma_f32_16x16x32_bf16 v[132:135], v[192:195], v[232:235], v[132:135]
    ds_read_b128 v[192:195], v21 offset:2048
    s_waitcnt lgkmcnt(8)
    v_mfma_f32_16x16x32_bf16 v[136:139], v[196:199], v[228:231], v[136:139]
    ds_write_b128 v38, v[236:239] offset:0
    v_mfma_f32_16x16x32_bf16 v[140:143], v[196:199], v[232:235], v[140:143]
    ds_read_b128 v[196:199], v21 offset:3072
    ds_write_b16 v39, v244 offset:2048
    v_mfma_f32_16x16x32_bf16 v[144:147], v[200:203], v[228:231], v[144:147]
    v_add_f32 v29, 0x358637bd, v29
    v_mfma_f32_16x16x32_bf16 v[148:151], v[200:203], v[232:235], v[148:151]
    ds_read_b128 v[200:203], v21 offset:4096
    v_rcp_f32 v29, v29
    v_mfma_f32_16x16x32_bf16 v[152:155], v[204:207], v[228:231], v[152:155]
    s_nop 0
    v_mul_f32 v248, v248, v29
    v_mfma_f32_16x16x32_bf16 v[156:159], v[204:207], v[232:235], v[156:159]
    ds_read_b128 v[204:207], v21 offset:5120
    s_waitcnt lgkmcnt(10)
    v_mfma_f32_16x16x32_bf16 v[160:163], v[208:211], v[228:231], v[160:163]
    v_mul_f32 v249, v249, v29
    v_mul_f32 v250, v250, v29
    v_mfma_f32_16x16x32_bf16 v[164:167], v[208:211], v[232:235], v[164:167]
    ds_read_b128 v[208:211], v21 offset:6144
    v_mul_f32 v251, v251, v29
    v_mul_f32 v252, v252, v29
    v_mfma_f32_16x16x32_bf16 v[168:171], v[212:215], v[228:231], v[168:171]
    v_mul_f32 v253, v253, v29
    v_mul_f32 v254, v254, v29
    v_mfma_f32_16x16x32_bf16 v[172:175], v[212:215], v[232:235], v[172:175]
    ds_read_b128 v[212:215], v21 offset:7168
    v_mul_f32 v255, v255, v29
    v_mul_f32 v28, v28, v29
    v_mfma_f32_16x16x32_bf16 v[176:179], v[216:219], v[228:231], v[176:179]
    v_cvt_pk_bf16_f32 v248, v248, v249
    v_cvt_pk_bf16_f32 v249, v250, v251
    v_mfma_f32_16x16x32_bf16 v[180:183], v[216:219], v[232:235], v[180:183]
    ds_read_b128 v[216:219], v21 offset:8192
    s_waitcnt lgkmcnt(8)
    v_mfma_f32_16x16x32_bf16 v[112:115], v[184:187], v[220:223], v[112:115]
    v_cvt_pk_bf16_f32 v250, v252, v253
    v_cvt_pk_bf16_f32 v251, v254, v255
    v_mfma_f32_16x16x32_bf16 v[116:119], v[184:187], v[224:227], v[116:119]
    ds_read_b128 v[184:187], v21 offset:9216
    v_cvt_pk_bf16_f32 v28, v28, v28
    v_mfma_f32_16x16x32_bf16 v[120:123], v[188:191], v[220:223], v[120:123]
    ds_read_b128 v[228:231], v19 offset:0
    ds_write_b128 v38, v[248:251] offset:1024
    v_mfma_f32_16x16x32_bf16 v[124:127], v[188:191], v[224:227], v[124:127]
    ds_read_b128 v[188:191], v21 offset:10240
    ds_write_b16 v39, v28 offset:2176
    v_mfma_f32_16x16x32_bf16 v[128:131], v[192:195], v[220:223], v[128:131]
    ds_read_b128 v[232:235], v19 offset:2048
    v_lshlrev_b32 v76, 16, v40
    v_and_b32 v77, s83, v40
    v_mfma_f32_16x16x32_bf16 v[132:135], v[192:195], v[224:227], v[132:135]
    ds_read_b128 v[192:195], v21 offset:11264
    s_waitcnt lgkmcnt(10)
    v_mfma_f32_16x16x32_bf16 v[136:139], v[196:199], v[220:223], v[136:139]
    v_lshlrev_b32 v78, 16, v41
    v_and_b32 v79, s83, v41
    v_mfma_f32_16x16x32_bf16 v[140:143], v[196:199], v[224:227], v[140:143]
    ds_read_b128 v[196:199], v21 offset:12288
    v_lshlrev_b32 v80, 16, v42
    v_and_b32 v81, s83, v42
    v_mfma_f32_16x16x32_bf16 v[144:147], v[200:203], v[220:223], v[144:147]
    v_lshlrev_b32 v82, 16, v43
    v_and_b32 v83, s83, v43
    v_mfma_f32_16x16x32_bf16 v[148:151], v[200:203], v[224:227], v[148:151]
    ds_read_b128 v[200:203], v21 offset:13312
    v_lshlrev_b32 v84, 16, v44
    v_and_b32 v85, s83, v44
    v_mfma_f32_16x16x32_bf16 v[152:155], v[204:207], v[220:223], v[152:155]
    v_lshlrev_b32 v86, 16, v45
    v_and_b32 v87, s83, v45
    v_mfma_f32_16x16x32_bf16 v[156:159], v[204:207], v[224:227], v[156:159]
    ds_read_b128 v[204:207], v21 offset:14336
    s_waitcnt lgkmcnt(10)
    v_mfma_f32_16x16x32_bf16 v[160:163], v[208:211], v[220:223], v[160:163]
    v_lshlrev_b32 v88, 16, v46
    v_and_b32 v89, s83, v46
    v_mfma_f32_16x16x32_bf16 v[164:167], v[208:211], v[224:227], v[164:167]
    ds_read_b128 v[208:211], v21 offset:15360
    v_lshlrev_b32 v90, 16, v47
    v_and_b32 v91, s83, v47
    v_mfma_f32_16x16x32_bf16 v[168:171], v[212:215], v[220:223], v[168:171]
    v_lshlrev_b32 v92, 16, v48
    v_and_b32 v93, s83, v48
    v_mfma_f32_16x16x32_bf16 v[172:175], v[212:215], v[224:227], v[172:175]
    ds_read_b128 v[212:215], v21 offset:16384
    v_lshlrev_b32 v94, 16, v49
    v_and_b32 v95, s83, v49
    v_mfma_f32_16x16x32_bf16 v[176:179], v[216:219], v[220:223], v[176:179]
    v_lshlrev_b32 v96, 16, v50
    v_and_b32 v97, s83, v50
    v_mfma_f32_16x16x32_bf16 v[180:183], v[216:219], v[224:227], v[180:183]
    ds_read_b128 v[216:219], v21 offset:17408
    s_waitcnt lgkmcnt(6)
    s_barrier
    v_mfma_f32_16x16x32_bf16 v[112:115], v[184:187], v[228:231], v[112:115]
    v_lshlrev_b32 v98, 16, v51
    v_and_b32 v99, s83, v51
    v_mfma_f32_16x16x32_bf16 v[116:119], v[184:187], v[232:235], v[116:119]
    ds_read_b128 v[184:187], v20 offset:0
    v_lshlrev_b32 v100, 16, v52
    v_and_b32 v101, s83, v52
    v_mfma_f32_16x16x32_bf16 v[120:123], v[188:191], v[228:231], v[120:123]
    ds_read_b128 v[220:223], v16 offset:0
    v_lshlrev_b32 v102, 16, v53
    v_and_b32 v103, s83, v53
    v_mfma_f32_16x16x32_bf16 v[124:127], v[188:191], v[232:235], v[124:127]
    ds_read_b128 v[188:191], v20 offset:1024
    v_lshlrev_b32 v104, 16, v54
    v_and_b32 v105, s83, v54
    v_mfma_f32_16x16x32_bf16 v[128:131], v[192:195], v[228:231], v[128:131]
    ds_read_b128 v[224:227], v16 offset:2048
    v_lshlrev_b32 v106, 16, v55
    v_and_b32 v107, s83, v55
    v_mfma_f32_16x16x32_bf16 v[132:135], v[192:195], v[232:235], v[132:135]
    ds_read_b128 v[192:195], v20 offset:2048
    s_waitcnt lgkmcnt(8)
    v_mfma_f32_16x16x32_bf16 v[136:139], v[196:199], v[228:231], v[136:139]
    v_lshlrev_b32 v108, 16, v56
    v_and_b32 v109, s83, v56
    v_mfma_f32_16x16x32_bf16 v[140:143], v[196:199], v[232:235], v[140:143]
    ds_read_b128 v[196:199], v20 offset:3072
    v_lshlrev_b32 v110, 16, v57
    v_and_b32 v111, s83, v57
    v_mfma_f32_16x16x32_bf16 v[144:147], v[200:203], v[228:231], v[144:147]
    v_lshlrev_b32 v236, 16, v58
    v_and_b32 v237, s83, v58
    v_mfma_f32_16x16x32_bf16 v[148:151], v[200:203], v[232:235], v[148:151]
    ds_read_b128 v[200:203], v20 offset:4096
    v_lshlrev_b32 v238, 16, v59
    v_and_b32 v239, s83, v59
    v_mfma_f32_16x16x32_bf16 v[152:155], v[204:207], v[228:231], v[152:155]
    v_lshlrev_b32 v240, 16, v60
    v_and_b32 v241, s83, v60
    v_mfma_f32_16x16x32_bf16 v[156:159], v[204:207], v[232:235], v[156:159]
    ds_read_b128 v[204:207], v20 offset:5120
    s_waitcnt lgkmcnt(8)
    v_mfma_f32_16x16x32_bf16 v[160:163], v[208:211], v[228:231], v[160:163]
    v_lshlrev_b32 v242, 16, v61
    v_and_b32 v243, s83, v61
    v_mfma_f32_16x16x32_bf16 v[164:167], v[208:211], v[232:235], v[164:167]
    ds_read_b128 v[208:211], v20 offset:6144
    v_lshlrev_b32 v244, 16, v62
    v_and_b32 v245, s83, v62
    v_mfma_f32_16x16x32_bf16 v[168:171], v[212:215], v[228:231], v[168:171]
    v_lshlrev_b32 v246, 16, v63
    v_and_b32 v247, s83, v63
    v_mfma_f32_16x16x32_bf16 v[172:175], v[212:215], v[232:235], v[172:175]
    ds_read_b128 v[212:215], v20 offset:7168
    v_lshlrev_b32 v248, 16, v64
    v_and_b32 v249, s83, v64
    v_mfma_f32_16x16x32_bf16 v[176:179], v[216:219], v[228:231], v[176:179]
    v_lshlrev_b32 v250, 16, v65
    v_and_b32 v251, s83, v65
    v_mfma_f32_16x16x32_bf16 v[180:183], v[216:219], v[232:235], v[180:183]
    ds_read_b128 v[216:219], v20 offset:8192
    s_waitcnt lgkmcnt(6)
    v_mfma_f32_16x16x32_bf16 v[112:115], v[184:187], v[220:223], v[112:115]
    v_lshlrev_b32 v252, 16, v66
    v_and_b32 v253, s83, v66
    v_mfma_f32_16x16x32_bf16 v[116:119], v[184:187], v[224:227], v[116:119]
    ds_read_b128 v[184:187], v20 offset:9216
    v_lshlrev_b32 v254, 16, v67
    v_and_b32 v255, s83, v67
    v_mfma_f32_16x16x32_bf16 v[120:123], v[188:191], v[220:223], v[120:123]
    ds_read_b128 v[228:231], v17 offset:0
    v_lshlrev_b32 v28, 16, v68
    v_and_b32 v29, s83, v68
    v_mfma_f32_16x16x32_bf16 v[124:127], v[188:191], v[224:227], v[124:127]
    ds_read_b128 v[188:191], v20 offset:10240
    v_lshlrev_b32 v30, 16, v69
    v_and_b32 v31, s83, v69
    v_mfma_f32_16x16x32_bf16 v[128:131], v[192:195], v[220:223], v[128:131]
    ds_read_b128 v[232:235], v17 offset:2048
    v_lshlrev_b32 v32, 16, v70
    v_and_b32 v33, s83, v70
    v_mfma_f32_16x16x32_bf16 v[132:135], v[192:195], v[224:227], v[132:135]
    ds_read_b128 v[192:195], v20 offset:11264
    s_waitcnt lgkmcnt(8)
    v_mfma_f32_16x16x32_bf16 v[136:139], v[196:199], v[220:223], v[136:139]
    v_lshlrev_b32 v34, 16, v71
    v_and_b32 v35, s83, v71
    v_mfma_f32_16x16x32_bf16 v[140:143], v[196:199], v[224:227], v[140:143]
    ds_read_b128 v[196:199], v20 offset:12288
    v_lshlrev_b32 v4, 16, v72
    v_and_b32 v5, s83, v72
    v_mfma_f32_16x16x32_bf16 v[144:147], v[200:203], v[220:223], v[144:147]
    v_lshlrev_b32 v6, 16, v73
    v_and_b32 v7, s83, v73
    v_mfma_f32_16x16x32_bf16 v[148:151], v[200:203], v[224:227], v[148:151]
    ds_read_b128 v[200:203], v20 offset:13312
    v_lshlrev_b32 v8, 16, v74
    v_and_b32 v9, s83, v74
    v_mfma_f32_16x16x32_bf16 v[152:155], v[204:207], v[220:223], v[152:155]
    v_lshlrev_b32 v10, 16, v75
    v_and_b32 v11, s83, v75
    v_mfma_f32_16x16x32_bf16 v[156:159], v[204:207], v[224:227], v[156:159]
    ds_read_b128 v[204:207], v20 offset:14336
    s_waitcnt lgkmcnt(8)
    v_mfma_f32_16x16x32_bf16 v[160:163], v[208:211], v[220:223], v[160:163]
    v_mfma_f32_16x16x32_bf16 v[164:167], v[208:211], v[224:227], v[164:167]
    ds_read_b128 v[208:211], v20 offset:15360
    v_mfma_f32_16x16x32_bf16 v[168:171], v[212:215], v[220:223], v[168:171]
    v_mfma_f32_16x16x32_bf16 v[172:175], v[212:215], v[224:227], v[172:175]
    ds_read_b128 v[212:215], v20 offset:16384
    v_mfma_f32_16x16x32_bf16 v[176:179], v[216:219], v[220:223], v[176:179]
    v_mfma_f32_16x16x32_bf16 v[180:183], v[216:219], v[224:227], v[180:183]
    ds_read_b128 v[216:219], v20 offset:17408
    s_waitcnt lgkmcnt(6)
    s_barrier
    v_mfma_f32_16x16x32_bf16 v[112:115], v[184:187], v[228:231], v[112:115]
    v_mfma_f32_16x16x32_bf16 v[116:119], v[184:187], v[232:235], v[116:119]
    ds_read_b128 v[184:187], v21 offset:34816
    v_mfma_f32_16x16x32_bf16 v[120:123], v[188:191], v[228:231], v[120:123]
    ds_read_b128 v[220:223], v18 offset:34816
    v_mfma_f32_16x16x32_bf16 v[124:127], v[188:191], v[232:235], v[124:127]
    ds_read_b128 v[188:191], v21 offset:35840
    v_mfma_f32_16x16x32_bf16 v[128:131], v[192:195], v[228:231], v[128:131]
    ds_read_b128 v[224:227], v18 offset:36864
    v_mfma_f32_16x16x32_bf16 v[132:135], v[192:195], v[232:235], v[132:135]
    ds_read_b128 v[192:195], v21 offset:36864
    s_waitcnt lgkmcnt(8)
    v_mfma_f32_16x16x32_bf16 v[136:139], v[196:199], v[228:231], v[136:139]
    v_mfma_f32_16x16x32_bf16 v[140:143], v[196:199], v[232:235], v[140:143]
    ds_read_b128 v[196:199], v21 offset:37888
    v_mfma_f32_16x16x32_bf16 v[144:147], v[200:203], v[228:231], v[144:147]
    v_mfma_f32_16x16x32_bf16 v[148:151], v[200:203], v[232:235], v[148:151]
    ds_read_b128 v[200:203], v21 offset:38912
    v_mfma_f32_16x16x32_bf16 v[152:155], v[204:207], v[228:231], v[152:155]
    v_mfma_f32_16x16x32_bf16 v[156:159], v[204:207], v[232:235], v[156:159]
    ds_read_b128 v[204:207], v21 offset:39936
    s_waitcnt lgkmcnt(8)
    v_mfma_f32_16x16x32_bf16 v[160:163], v[208:211], v[228:231], v[160:163]
    v_mfma_f32_16x16x32_bf16 v[164:167], v[208:211], v[232:235], v[164:167]
    ds_read_b128 v[208:211], v21 offset:40960
    v_mfma_f32_16x16x32_bf16 v[168:171], v[212:215], v[228:231], v[168:171]
    v_mfma_f32_16x16x32_bf16 v[172:175], v[212:215], v[232:235], v[172:175]
    ds_read_b128 v[212:215], v21 offset:41984
    v_mfma_f32_16x16x32_bf16 v[176:179], v[216:219], v[228:231], v[176:179]
    v_mfma_f32_16x16x32_bf16 v[180:183], v[216:219], v[232:235], v[180:183]
    ds_read_b128 v[216:219], v21 offset:43008
    s_waitcnt lgkmcnt(6)
    v_mfma_f32_16x16x32_bf16 v[112:115], v[184:187], v[220:223], v[112:115]
    v_mfma_f32_16x16x32_bf16 v[116:119], v[184:187], v[224:227], v[116:119]
    ds_read_b128 v[184:187], v21 offset:44032
    v_mfma_f32_16x16x32_bf16 v[120:123], v[188:191], v[220:223], v[120:123]
    ds_read_b128 v[228:231], v19 offset:34816
    v_mfma_f32_16x16x32_bf16 v[124:127], v[188:191], v[224:227], v[124:127]
    ds_read_b128 v[188:191], v21 offset:45056
    v_mfma_f32_16x16x32_bf16 v[128:131], v[192:195], v[220:223], v[128:131]
    ds_read_b128 v[232:235], v19 offset:36864
    v_mfma_f32_16x16x32_bf16 v[132:135], v[192:195], v[224:227], v[132:135]
    ds_read_b128 v[192:195], v21 offset:46080
    s_waitcnt lgkmcnt(8)
    v_mfma_f32_16x16x32_bf16 v[136:139], v[196:199], v[220:223], v[136:139]
    v_mfma_f32_16x16x32_bf16 v[140:143], v[196:199], v[224:227], v[140:143]
    ds_read_b128 v[196:199], v21 offset:47104
    v_mfma_f32_16x16x32_bf16 v[144:147], v[200:203], v[220:223], v[144:147]
    v_mfma_f32_16x16x32_bf16 v[148:151], v[200:203], v[224:227], v[148:151]
    ds_read_b128 v[200:203], v21 offset:48128
    v_mfma_f32_16x16x32_bf16 v[152:155], v[204:207], v[220:223], v[152:155]
    v_mfma_f32_16x16x32_bf16 v[156:159], v[204:207], v[224:227], v[156:159]
    ds_read_b128 v[204:207], v21 offset:49152
    s_waitcnt lgkmcnt(8)
    v_mfma_f32_16x16x32_bf16 v[160:163], v[208:211], v[220:223], v[160:163]
    v_mfma_f32_16x16x32_bf16 v[164:167], v[208:211], v[224:227], v[164:167]
    ds_read_b128 v[208:211], v21 offset:50176
    v_mfma_f32_16x16x32_bf16 v[168:171], v[212:215], v[220:223], v[168:171]
    v_mfma_f32_16x16x32_bf16 v[172:175], v[212:215], v[224:227], v[172:175]
    ds_read_b128 v[212:215], v21 offset:51200
    v_mfma_f32_16x16x32_bf16 v[176:179], v[216:219], v[220:223], v[176:179]
    v_mfma_f32_16x16x32_bf16 v[180:183], v[216:219], v[224:227], v[180:183]
    ds_read_b128 v[216:219], v21 offset:52224
    s_waitcnt lgkmcnt(6)
    s_barrier
    v_mfma_f32_16x16x32_bf16 v[112:115], v[184:187], v[228:231], v[112:115]
    v_mfma_f32_16x16x32_bf16 v[116:119], v[184:187], v[232:235], v[116:119]
    ds_read_b128 v[184:187], v20 offset:36864
    v_mfma_f32_16x16x32_bf16 v[120:123], v[188:191], v[228:231], v[120:123]
    ds_read_b128 v[220:223], v16 offset:36864
    v_mfma_f32_16x16x32_bf16 v[124:127], v[188:191], v[232:235], v[124:127]
    ds_read_b128 v[188:191], v20 offset:37888
    v_mfma_f32_16x16x32_bf16 v[128:131], v[192:195], v[228:231], v[128:131]
    ds_read_b128 v[224:227], v16 offset:38912
    v_mfma_f32_16x16x32_bf16 v[132:135], v[192:195], v[232:235], v[132:135]
    ds_read_b128 v[192:195], v20 offset:38912
    s_waitcnt lgkmcnt(8)
    v_mfma_f32_16x16x32_bf16 v[136:139], v[196:199], v[228:231], v[136:139]
    v_mfma_f32_16x16x32_bf16 v[140:143], v[196:199], v[232:235], v[140:143]
    ds_read_b128 v[196:199], v20 offset:39936
    v_mfma_f32_16x16x32_bf16 v[144:147], v[200:203], v[228:231], v[144:147]
    v_mfma_f32_16x16x32_bf16 v[148:151], v[200:203], v[232:235], v[148:151]
    ds_read_b128 v[200:203], v20 offset:40960
    v_mfma_f32_16x16x32_bf16 v[152:155], v[204:207], v[228:231], v[152:155]
    v_mfma_f32_16x16x32_bf16 v[156:159], v[204:207], v[232:235], v[156:159]
    ds_read_b128 v[204:207], v20 offset:41984
    s_waitcnt lgkmcnt(8)
    v_mfma_f32_16x16x32_bf16 v[160:163], v[208:211], v[228:231], v[160:163]
    v_mfma_f32_16x16x32_bf16 v[164:167], v[208:211], v[232:235], v[164:167]
    ds_read_b128 v[208:211], v20 offset:43008
    v_mfma_f32_16x16x32_bf16 v[168:171], v[212:215], v[228:231], v[168:171]
    v_mfma_f32_16x16x32_bf16 v[172:175], v[212:215], v[232:235], v[172:175]
    ds_read_b128 v[212:215], v20 offset:44032
    v_mfma_f32_16x16x32_bf16 v[176:179], v[216:219], v[228:231], v[176:179]
    v_mfma_f32_16x16x32_bf16 v[180:183], v[216:219], v[232:235], v[180:183]
    ds_read_b128 v[216:219], v20 offset:45056
    s_waitcnt lgkmcnt(6)
    v_mfma_f32_16x16x32_bf16 v[112:115], v[184:187], v[220:223], v[112:115]
    v_mfma_f32_16x16x32_bf16 v[116:119], v[184:187], v[224:227], v[116:119]
    ds_read_b128 v[184:187], v20 offset:46080
    v_mfma_f32_16x16x32_bf16 v[120:123], v[188:191], v[220:223], v[120:123]
    ds_read_b128 v[228:231], v17 offset:36864
    v_mfma_f32_16x16x32_bf16 v[124:127], v[188:191], v[224:227], v[124:127]
    ds_read_b128 v[188:191], v20 offset:47104
    v_mfma_f32_16x16x32_bf16 v[128:131], v[192:195], v[220:223], v[128:131]
    ds_read_b128 v[232:235], v17 offset:38912
    v_mfma_f32_16x16x32_bf16 v[132:135], v[192:195], v[224:227], v[132:135]
    ds_read_b128 v[192:195], v20 offset:48128
    s_waitcnt lgkmcnt(8)
    v_mfma_f32_16x16x32_bf16 v[136:139], v[196:199], v[220:223], v[136:139]
    v_mfma_f32_16x16x32_bf16 v[140:143], v[196:199], v[224:227], v[140:143]
    ds_read_b128 v[196:199], v20 offset:49152
    v_mfma_f32_16x16x32_bf16 v[144:147], v[200:203], v[220:223], v[144:147]
    v_mfma_f32_16x16x32_bf16 v[148:151], v[200:203], v[224:227], v[148:151]
    ds_read_b128 v[200:203], v20 offset:50176
    v_mfma_f32_16x16x32_bf16 v[152:155], v[204:207], v[220:223], v[152:155]
    v_mfma_f32_16x16x32_bf16 v[156:159], v[204:207], v[224:227], v[156:159]
    ds_read_b128 v[204:207], v20 offset:51200
    s_waitcnt lgkmcnt(8)
    v_mfma_f32_16x16x32_bf16 v[160:163], v[208:211], v[220:223], v[160:163]
    v_mfma_f32_16x16x32_bf16 v[164:167], v[208:211], v[224:227], v[164:167]
    ds_read_b128 v[208:211], v20 offset:52224
    v_mfma_f32_16x16x32_bf16 v[168:171], v[212:215], v[220:223], v[168:171]
    v_mfma_f32_16x16x32_bf16 v[172:175], v[212:215], v[224:227], v[172:175]
    ds_read_b128 v[212:215], v20 offset:53248
    v_mfma_f32_16x16x32_bf16 v[176:179], v[216:219], v[220:223], v[176:179]
    v_mfma_f32_16x16x32_bf16 v[180:183], v[216:219], v[224:227], v[180:183]
    ds_read_b128 v[216:219], v20 offset:54272
    s_waitcnt lgkmcnt(6)
    s_barrier
    v_mfma_f32_16x16x32_bf16 v[112:115], v[184:187], v[228:231], v[112:115]
    v_mfma_f32_16x16x32_bf16 v[116:119], v[184:187], v[232:235], v[116:119]
    ds_read_b128 v[184:187], v21 offset:0
    v_mfma_f32_16x16x32_bf16 v[120:123], v[188:191], v[228:231], v[120:123]
    ds_read_b128 v[220:223], v18 offset:0
    v_mfma_f32_16x16x32_bf16 v[124:127], v[188:191], v[232:235], v[124:127]
    ds_read_b128 v[188:191], v21 offset:1024
    v_mfma_f32_16x16x32_bf16 v[128:131], v[192:195], v[228:231], v[128:131]
    ds_read_b128 v[224:227], v18 offset:2048
    v_mfma_f32_16x16x32_bf16 v[132:135], v[192:195], v[232:235], v[132:135]
    ds_read_b128 v[192:195], v21 offset:2048
    s_waitcnt lgkmcnt(8)
    v_mfma_f32_16x16x32_bf16 v[136:139], v[196:199], v[228:231], v[136:139]
    v_mfma_f32_16x16x32_bf16 v[140:143], v[196:199], v[232:235], v[140:143]
    ds_read_b128 v[196:199], v21 offset:3072
    v_mfma_f32_16x16x32_bf16 v[144:147], v[200:203], v[228:231], v[144:147]
    v_mfma_f32_16x16x32_bf16 v[148:151], v[200:203], v[232:235], v[148:151]
    ds_read_b128 v[200:203], v21 offset:4096
    v_mfma_f32_16x16x32_bf16 v[152:155], v[204:207], v[228:231], v[152:155]
    v_mfma_f32_16x16x32_bf16 v[156:159], v[204:207], v[232:235], v[156:159]
    ds_read_b128 v[204:207], v21 offset:5120
    s_waitcnt lgkmcnt(8)
    v_mfma_f32_16x16x32_bf16 v[160:163], v[208:211], v[228:231], v[160:163]
    v_mfma_f32_16x16x32_bf16 v[164:167], v[208:211], v[232:235], v[164:167]
    ds_read_b128 v[208:211], v21 offset:6144
    v_mfma_f32_16x16x32_bf16 v[168:171], v[212:215], v[228:231], v[168:171]
    v_mfma_f32_16x16x32_bf16 v[172:175], v[212:215], v[232:235], v[172:175]
    ds_read_b128 v[212:215], v21 offset:7168
    v_mfma_f32_16x16x32_bf16 v[176:179], v[216:219], v[228:231], v[176:179]
    v_mfma_f32_16x16x32_bf16 v[180:183], v[216:219], v[232:235], v[180:183]
    ds_read_b128 v[216:219], v21 offset:8192
    s_waitcnt lgkmcnt(6)
    v_mfma_f32_16x16x32_bf16 v[112:115], v[184:187], v[220:223], v[112:115]
    v_mfma_f32_16x16x32_bf16 v[116:119], v[184:187], v[224:227], v[116:119]
    ds_read_b128 v[184:187], v21 offset:9216
    v_mfma_f32_16x16x32_bf16 v[120:123], v[188:191], v[220:223], v[120:123]
    ds_read_b128 v[228:231], v19 offset:0
    v_mfma_f32_16x16x32_bf16 v[124:127], v[188:191], v[224:227], v[124:127]
    ds_read_b128 v[188:191], v21 offset:10240
    v_mfma_f32_16x16x32_bf16 v[128:131], v[192:195], v[220:223], v[128:131]
    ds_read_b128 v[232:235], v19 offset:2048
    v_mfma_f32_16x16x32_bf16 v[132:135], v[192:195], v[224:227], v[132:135]
    ds_read_b128 v[192:195], v21 offset:11264
    s_waitcnt lgkmcnt(8)
    v_mfma_f32_16x16x32_bf16 v[136:139], v[196:199], v[220:223], v[136:139]
    v_mfma_f32_16x16x32_bf16 v[140:143], v[196:199], v[224:227], v[140:143]
    ds_read_b128 v[196:199], v21 offset:12288
    v_mfma_f32_16x16x32_bf16 v[144:147], v[200:203], v[220:223], v[144:147]
    v_mfma_f32_16x16x32_bf16 v[148:151], v[200:203], v[224:227], v[148:151]
    ds_read_b128 v[200:203], v21 offset:13312
    v_mfma_f32_16x16x32_bf16 v[152:155], v[204:207], v[220:223], v[152:155]
    v_mfma_f32_16x16x32_bf16 v[156:159], v[204:207], v[224:227], v[156:159]
    ds_read_b128 v[204:207], v21 offset:14336
    s_waitcnt lgkmcnt(8)
    v_mfma_f32_16x16x32_bf16 v[160:163], v[208:211], v[220:223], v[160:163]
    v_mfma_f32_16x16x32_bf16 v[164:167], v[208:211], v[224:227], v[164:167]
    ds_read_b128 v[208:211], v21 offset:15360
    v_mfma_f32_16x16x32_bf16 v[168:171], v[212:215], v[220:223], v[168:171]
    v_mfma_f32_16x16x32_bf16 v[172:175], v[212:215], v[224:227], v[172:175]
    ds_read_b128 v[212:215], v21 offset:16384
    v_mfma_f32_16x16x32_bf16 v[176:179], v[216:219], v[220:223], v[176:179]
    v_mfma_f32_16x16x32_bf16 v[180:183], v[216:219], v[224:227], v[180:183]
    ds_read_b128 v[216:219], v21 offset:17408
    s_waitcnt lgkmcnt(6)
    s_barrier
    v_mfma_f32_16x16x32_bf16 v[112:115], v[184:187], v[228:231], v[112:115]
    v_mfma_f32_16x16x32_bf16 v[116:119], v[184:187], v[232:235], v[116:119]
    ds_read_b128 v[184:187], v20 offset:0
    v_mfma_f32_16x16x32_bf16 v[120:123], v[188:191], v[228:231], v[120:123]
    ds_read_b128 v[220:223], v16 offset:0
    v_mfma_f32_16x16x32_bf16 v[124:127], v[188:191], v[232:235], v[124:127]
    ds_read_b128 v[188:191], v20 offset:1024
    v_mfma_f32_16x16x32_bf16 v[128:131], v[192:195], v[228:231], v[128:131]
    ds_read_b128 v[224:227], v16 offset:2048
    v_mfma_f32_16x16x32_bf16 v[132:135], v[192:195], v[232:235], v[132:135]
    ds_read_b128 v[192:195], v20 offset:2048
    s_waitcnt lgkmcnt(8)
    v_mfma_f32_16x16x32_bf16 v[136:139], v[196:199], v[228:231], v[136:139]
    v_mfma_f32_16x16x32_bf16 v[140:143], v[196:199], v[232:235], v[140:143]
    ds_read_b128 v[196:199], v20 offset:3072
    v_mfma_f32_16x16x32_bf16 v[144:147], v[200:203], v[228:231], v[144:147]
    v_mfma_f32_16x16x32_bf16 v[148:151], v[200:203], v[232:235], v[148:151]
    ds_read_b128 v[200:203], v20 offset:4096
    v_mfma_f32_16x16x32_bf16 v[152:155], v[204:207], v[228:231], v[152:155]
    v_mfma_f32_16x16x32_bf16 v[156:159], v[204:207], v[232:235], v[156:159]
    ds_read_b128 v[204:207], v20 offset:5120
    s_waitcnt lgkmcnt(8)
    v_mfma_f32_16x16x32_bf16 v[160:163], v[208:211], v[228:231], v[160:163]
    v_mfma_f32_16x16x32_bf16 v[164:167], v[208:211], v[232:235], v[164:167]
    ds_read_b128 v[208:211], v20 offset:6144
    v_mfma_f32_16x16x32_bf16 v[168:171], v[212:215], v[228:231], v[168:171]
    v_mfma_f32_16x16x32_bf16 v[172:175], v[212:215], v[232:235], v[172:175]
    ds_read_b128 v[212:215], v20 offset:7168
    v_mfma_f32_16x16x32_bf16 v[176:179], v[216:219], v[228:231], v[176:179]
    v_mfma_f32_16x16x32_bf16 v[180:183], v[216:219], v[232:235], v[180:183]
    ds_read_b128 v[216:219], v20 offset:8192
    s_waitcnt lgkmcnt(6)
    v_mfma_f32_16x16x32_bf16 v[112:115], v[184:187], v[220:223], v[112:115]
    v_mfma_f32_16x16x32_bf16 v[116:119], v[184:187], v[224:227], v[116:119]
    ds_read_b128 v[184:187], v20 offset:9216
    v_mfma_f32_16x16x32_bf16 v[120:123], v[188:191], v[220:223], v[120:123]
    ds_read_b128 v[228:231], v17 offset:0
    v_mfma_f32_16x16x32_bf16 v[124:127], v[188:191], v[224:227], v[124:127]
    ds_read_b128 v[188:191], v20 offset:10240
    v_mfma_f32_16x16x32_bf16 v[128:131], v[192:195], v[220:223], v[128:131]
    ds_read_b128 v[232:235], v17 offset:2048
    v_mfma_f32_16x16x32_bf16 v[132:135], v[192:195], v[224:227], v[132:135]
    ds_read_b128 v[192:195], v20 offset:11264
    s_waitcnt lgkmcnt(8)
    v_mfma_f32_16x16x32_bf16 v[136:139], v[196:199], v[220:223], v[136:139]
    v_mfma_f32_16x16x32_bf16 v[140:143], v[196:199], v[224:227], v[140:143]
    ds_read_b128 v[196:199], v20 offset:12288
    v_mfma_f32_16x16x32_bf16 v[144:147], v[200:203], v[220:223], v[144:147]
    v_mfma_f32_16x16x32_bf16 v[148:151], v[200:203], v[224:227], v[148:151]
    ds_read_b128 v[200:203], v20 offset:13312
    v_mfma_f32_16x16x32_bf16 v[152:155], v[204:207], v[220:223], v[152:155]
    v_mfma_f32_16x16x32_bf16 v[156:159], v[204:207], v[224:227], v[156:159]
    ds_read_b128 v[204:207], v20 offset:14336
    s_waitcnt lgkmcnt(8)
    v_mfma_f32_16x16x32_bf16 v[160:163], v[208:211], v[220:223], v[160:163]
    v_mfma_f32_16x16x32_bf16 v[164:167], v[208:211], v[224:227], v[164:167]
    ds_read_b128 v[208:211], v20 offset:15360
    v_mfma_f32_16x16x32_bf16 v[168:171], v[212:215], v[220:223], v[168:171]
    v_mfma_f32_16x16x32_bf16 v[172:175], v[212:215], v[224:227], v[172:175]
    ds_read_b128 v[212:215], v20 offset:16384
    v_mfma_f32_16x16x32_bf16 v[176:179], v[216:219], v[220:223], v[176:179]
    v_mfma_f32_16x16x32_bf16 v[180:183], v[216:219], v[224:227], v[180:183]
    ds_read_b128 v[216:219], v20 offset:17408
    s_waitcnt lgkmcnt(6)
    s_barrier
    v_mfma_f32_16x16x32_bf16 v[112:115], v[184:187], v[228:231], v[112:115]
    v_mfma_f32_16x16x32_bf16 v[116:119], v[184:187], v[232:235], v[116:119]
    ds_read_b128 v[184:187], v21 offset:34816
    v_mfma_f32_16x16x32_bf16 v[120:123], v[188:191], v[228:231], v[120:123]
    ds_read_b128 v[220:223], v18 offset:34816
    v_mfma_f32_16x16x32_bf16 v[124:127], v[188:191], v[232:235], v[124:127]
    ds_read_b128 v[188:191], v21 offset:35840
    v_mfma_f32_16x16x32_bf16 v[128:131], v[192:195], v[228:231], v[128:131]
    ds_read_b128 v[224:227], v18 offset:36864
    v_mfma_f32_16x16x32_bf16 v[132:135], v[192:195], v[232:235], v[132:135]
    ds_read_b128 v[192:195], v21 offset:36864
    s_waitcnt lgkmcnt(8)
    v_mfma_f32_16x16x32_bf16 v[136:139], v[196:199], v[228:231], v[136:139]
    v_mfma_f32_16x16x32_bf16 v[140:143], v[196:199], v[232:235], v[140:143]
    ds_read_b128 v[196:199], v21 offset:37888
    v_mfma_f32_16x16x32_bf16 v[144:147], v[200:203], v[228:231], v[144:147]
    v_mfma_f32_16x16x32_bf16 v[148:151], v[200:203], v[232:235], v[148:151]
    ds_read_b128 v[200:203], v21 offset:38912
    v_mfma_f32_16x16x32_bf16 v[152:155], v[204:207], v[228:231], v[152:155]
    v_mfma_f32_16x16x32_bf16 v[156:159], v[204:207], v[232:235], v[156:159]
    ds_read_b128 v[204:207], v21 offset:39936
    s_waitcnt lgkmcnt(8)
    v_mfma_f32_16x16x32_bf16 v[160:163], v[208:211], v[228:231], v[160:163]
    v_mfma_f32_16x16x32_bf16 v[164:167], v[208:211], v[232:235], v[164:167]
    ds_read_b128 v[208:211], v21 offset:40960
    v_mfma_f32_16x16x32_bf16 v[168:171], v[212:215], v[228:231], v[168:171]
    v_mfma_f32_16x16x32_bf16 v[172:175], v[212:215], v[232:235], v[172:175]
    ds_read_b128 v[212:215], v21 offset:41984
    v_mfma_f32_16x16x32_bf16 v[176:179], v[216:219], v[228:231], v[176:179]
    v_mfma_f32_16x16x32_bf16 v[180:183], v[216:219], v[232:235], v[180:183]
    ds_read_b128 v[216:219], v21 offset:43008
    s_waitcnt lgkmcnt(6)
    v_mfma_f32_16x16x32_bf16 v[112:115], v[184:187], v[220:223], v[112:115]
    v_mfma_f32_16x16x32_bf16 v[116:119], v[184:187], v[224:227], v[116:119]
    ds_read_b128 v[184:187], v21 offset:44032
    v_mfma_f32_16x16x32_bf16 v[120:123], v[188:191], v[220:223], v[120:123]
    ds_read_b128 v[228:231], v19 offset:34816
    v_mfma_f32_16x16x32_bf16 v[124:127], v[188:191], v[224:227], v[124:127]
    ds_read_b128 v[188:191], v21 offset:45056
    v_mfma_f32_16x16x32_bf16 v[128:131], v[192:195], v[220:223], v[128:131]
    ds_read_b128 v[232:235], v19 offset:36864
    v_mfma_f32_16x16x32_bf16 v[132:135], v[192:195], v[224:227], v[132:135]
    ds_read_b128 v[192:195], v21 offset:46080
    s_waitcnt lgkmcnt(8)
    v_mfma_f32_16x16x32_bf16 v[136:139], v[196:199], v[220:223], v[136:139]
    v_mfma_f32_16x16x32_bf16 v[140:143], v[196:199], v[224:227], v[140:143]
    ds_read_b128 v[196:199], v21 offset:47104
    v_mfma_f32_16x16x32_bf16 v[144:147], v[200:203], v[220:223], v[144:147]
    v_mfma_f32_16x16x32_bf16 v[148:151], v[200:203], v[224:227], v[148:151]
    ds_read_b128 v[200:203], v21 offset:48128
    v_mfma_f32_16x16x32_bf16 v[152:155], v[204:207], v[220:223], v[152:155]
    v_mfma_f32_16x16x32_bf16 v[156:159], v[204:207], v[224:227], v[156:159]
    ds_read_b128 v[204:207], v21 offset:49152
    s_waitcnt lgkmcnt(8)
    v_mfma_f32_16x16x32_bf16 v[160:163], v[208:211], v[220:223], v[160:163]
    v_mfma_f32_16x16x32_bf16 v[164:167], v[208:211], v[224:227], v[164:167]
    ds_read_b128 v[208:211], v21 offset:50176
    v_mfma_f32_16x16x32_bf16 v[168:171], v[212:215], v[220:223], v[168:171]
    v_mfma_f32_16x16x32_bf16 v[172:175], v[212:215], v[224:227], v[172:175]
    ds_read_b128 v[212:215], v21 offset:51200
    v_mfma_f32_16x16x32_bf16 v[176:179], v[216:219], v[220:223], v[176:179]
    v_mfma_f32_16x16x32_bf16 v[180:183], v[216:219], v[224:227], v[180:183]
    ds_read_b128 v[216:219], v21 offset:52224
    s_waitcnt lgkmcnt(6)
    s_barrier
    v_mfma_f32_16x16x32_bf16 v[112:115], v[184:187], v[228:231], v[112:115]
    v_mfma_f32_16x16x32_bf16 v[116:119], v[184:187], v[232:235], v[116:119]
    ds_read_b128 v[184:187], v20 offset:36864
    v_mfma_f32_16x16x32_bf16 v[120:123], v[188:191], v[228:231], v[120:123]
    ds_read_b128 v[220:223], v16 offset:36864
    v_mfma_f32_16x16x32_bf16 v[124:127], v[188:191], v[232:235], v[124:127]
    ds_read_b128 v[188:191], v20 offset:37888
    v_mfma_f32_16x16x32_bf16 v[128:131], v[192:195], v[228:231], v[128:131]
    ds_read_b128 v[224:227], v16 offset:38912
    v_mfma_f32_16x16x32_bf16 v[132:135], v[192:195], v[232:235], v[132:135]
    ds_read_b128 v[192:195], v20 offset:38912
    s_waitcnt lgkmcnt(8)
    v_mfma_f32_16x16x32_bf16 v[136:139], v[196:199], v[228:231], v[136:139]
    v_mfma_f32_16x16x32_bf16 v[140:143], v[196:199], v[232:235], v[140:143]
    ds_read_b128 v[196:199], v20 offset:39936
    v_mfma_f32_16x16x32_bf16 v[144:147], v[200:203], v[228:231], v[144:147]
    v_mfma_f32_16x16x32_bf16 v[148:151], v[200:203], v[232:235], v[148:151]
    ds_read_b128 v[200:203], v20 offset:40960
    v_mfma_f32_16x16x32_bf16 v[152:155], v[204:207], v[228:231], v[152:155]
    v_mfma_f32_16x16x32_bf16 v[156:159], v[204:207], v[232:235], v[156:159]
    ds_read_b128 v[204:207], v20 offset:41984
    s_waitcnt lgkmcnt(8)
    v_mfma_f32_16x16x32_bf16 v[160:163], v[208:211], v[228:231], v[160:163]
    v_mfma_f32_16x16x32_bf16 v[164:167], v[208:211], v[232:235], v[164:167]
    ds_read_b128 v[208:211], v20 offset:43008
    v_mfma_f32_16x16x32_bf16 v[168:171], v[212:215], v[228:231], v[168:171]
    v_mfma_f32_16x16x32_bf16 v[172:175], v[212:215], v[232:235], v[172:175]
    ds_read_b128 v[212:215], v20 offset:44032
    v_mfma_f32_16x16x32_bf16 v[176:179], v[216:219], v[228:231], v[176:179]
    v_mfma_f32_16x16x32_bf16 v[180:183], v[216:219], v[232:235], v[180:183]
    ds_read_b128 v[216:219], v20 offset:45056
    s_waitcnt lgkmcnt(6)
    v_mfma_f32_16x16x32_bf16 v[112:115], v[184:187], v[220:223], v[112:115]
    v_mfma_f32_16x16x32_bf16 v[116:119], v[184:187], v[224:227], v[116:119]
    ds_read_b128 v[184:187], v20 offset:46080
    v_mfma_f32_16x16x32_bf16 v[120:123], v[188:191], v[220:223], v[120:123]
    ds_read_b128 v[228:231], v17 offset:36864
    v_mfma_f32_16x16x32_bf16 v[124:127], v[188:191], v[224:227], v[124:127]
    ds_read_b128 v[188:191], v20 offset:47104
    v_mfma_f32_16x16x32_bf16 v[128:131], v[192:195], v[220:223], v[128:131]
    ds_read_b128 v[232:235], v17 offset:38912
    v_mfma_f32_16x16x32_bf16 v[132:135], v[192:195], v[224:227], v[132:135]
    ds_read_b128 v[192:195], v20 offset:48128
    s_waitcnt lgkmcnt(8)
    v_mfma_f32_16x16x32_bf16 v[136:139], v[196:199], v[220:223], v[136:139]
    v_mfma_f32_16x16x32_bf16 v[140:143], v[196:199], v[224:227], v[140:143]
    ds_read_b128 v[196:199], v20 offset:49152
    v_mfma_f32_16x16x32_bf16 v[144:147], v[200:203], v[220:223], v[144:147]
    v_mfma_f32_16x16x32_bf16 v[148:151], v[200:203], v[224:227], v[148:151]
    ds_read_b128 v[200:203], v20 offset:50176
    v_mfma_f32_16x16x32_bf16 v[152:155], v[204:207], v[220:223], v[152:155]
    v_mfma_f32_16x16x32_bf16 v[156:159], v[204:207], v[224:227], v[156:159]
    ds_read_b128 v[204:207], v20 offset:51200
    s_waitcnt lgkmcnt(8)
    v_mfma_f32_16x16x32_bf16 v[160:163], v[208:211], v[220:223], v[160:163]
    v_mfma_f32_16x16x32_bf16 v[164:167], v[208:211], v[224:227], v[164:167]
    ds_read_b128 v[208:211], v20 offset:52224
    v_mfma_f32_16x16x32_bf16 v[168:171], v[212:215], v[220:223], v[168:171]
    v_mfma_f32_16x16x32_bf16 v[172:175], v[212:215], v[224:227], v[172:175]
    ds_read_b128 v[212:215], v20 offset:53248
    v_mfma_f32_16x16x32_bf16 v[176:179], v[216:219], v[220:223], v[176:179]
    v_mfma_f32_16x16x32_bf16 v[180:183], v[216:219], v[224:227], v[180:183]
    ds_read_b128 v[216:219], v20 offset:54272
    s_waitcnt lgkmcnt(6)
    s_barrier
    v_mfma_f32_16x16x32_bf16 v[112:115], v[184:187], v[228:231], v[112:115]
    v_mfma_f32_16x16x32_bf16 v[116:119], v[184:187], v[232:235], v[116:119]
    ds_read_b128 v[184:187], v21 offset:0
    v_mfma_f32_16x16x32_bf16 v[120:123], v[188:191], v[228:231], v[120:123]
    ds_read_b128 v[220:223], v18 offset:0
    v_mfma_f32_16x16x32_bf16 v[124:127], v[188:191], v[232:235], v[124:127]
    ds_read_b128 v[188:191], v21 offset:1024
    v_mfma_f32_16x16x32_bf16 v[128:131], v[192:195], v[228:231], v[128:131]
    ds_read_b128 v[224:227], v18 offset:2048
    v_mfma_f32_16x16x32_bf16 v[132:135], v[192:195], v[232:235], v[132:135]
    ds_read_b128 v[192:195], v21 offset:2048
    s_waitcnt lgkmcnt(8)
    v_mfma_f32_16x16x32_bf16 v[136:139], v[196:199], v[228:231], v[136:139]
    v_mfma_f32_16x16x32_bf16 v[140:143], v[196:199], v[232:235], v[140:143]
    ds_read_b128 v[196:199], v21 offset:3072
    v_mfma_f32_16x16x32_bf16 v[144:147], v[200:203], v[228:231], v[144:147]
    v_mfma_f32_16x16x32_bf16 v[148:151], v[200:203], v[232:235], v[148:151]
    ds_read_b128 v[200:203], v21 offset:4096
    v_mfma_f32_16x16x32_bf16 v[152:155], v[204:207], v[228:231], v[152:155]
    v_mfma_f32_16x16x32_bf16 v[156:159], v[204:207], v[232:235], v[156:159]
    ds_read_b128 v[204:207], v21 offset:5120
    s_waitcnt lgkmcnt(8)
    v_mfma_f32_16x16x32_bf16 v[160:163], v[208:211], v[228:231], v[160:163]
    v_mfma_f32_16x16x32_bf16 v[164:167], v[208:211], v[232:235], v[164:167]
    ds_read_b128 v[208:211], v21 offset:6144
    v_mfma_f32_16x16x32_bf16 v[168:171], v[212:215], v[228:231], v[168:171]
    v_mfma_f32_16x16x32_bf16 v[172:175], v[212:215], v[232:235], v[172:175]
    ds_read_b128 v[212:215], v21 offset:7168
    v_mfma_f32_16x16x32_bf16 v[176:179], v[216:219], v[228:231], v[176:179]
    v_mfma_f32_16x16x32_bf16 v[180:183], v[216:219], v[232:235], v[180:183]
    ds_read_b128 v[216:219], v21 offset:8192
    s_waitcnt lgkmcnt(6)
    v_mfma_f32_16x16x32_bf16 v[112:115], v[184:187], v[220:223], v[112:115]
    v_mfma_f32_16x16x32_bf16 v[116:119], v[184:187], v[224:227], v[116:119]
    ds_read_b128 v[184:187], v21 offset:9216
    v_mfma_f32_16x16x32_bf16 v[120:123], v[188:191], v[220:223], v[120:123]
    ds_read_b128 v[228:231], v19 offset:0
    v_mfma_f32_16x16x32_bf16 v[124:127], v[188:191], v[224:227], v[124:127]
    ds_read_b128 v[188:191], v21 offset:10240
    v_mfma_f32_16x16x32_bf16 v[128:131], v[192:195], v[220:223], v[128:131]
    ds_read_b128 v[232:235], v19 offset:2048
    v_mfma_f32_16x16x32_bf16 v[132:135], v[192:195], v[224:227], v[132:135]
    ds_read_b128 v[192:195], v21 offset:11264
    s_waitcnt lgkmcnt(8)
    v_mfma_f32_16x16x32_bf16 v[136:139], v[196:199], v[220:223], v[136:139]
    v_mfma_f32_16x16x32_bf16 v[140:143], v[196:199], v[224:227], v[140:143]
    ds_read_b128 v[196:199], v21 offset:12288
    v_mfma_f32_16x16x32_bf16 v[144:147], v[200:203], v[220:223], v[144:147]
    v_mfma_f32_16x16x32_bf16 v[148:151], v[200:203], v[224:227], v[148:151]
    ds_read_b128 v[200:203], v21 offset:13312
    v_mfma_f32_16x16x32_bf16 v[152:155], v[204:207], v[220:223], v[152:155]
    v_mfma_f32_16x16x32_bf16 v[156:159], v[204:207], v[224:227], v[156:159]
    ds_read_b128 v[204:207], v21 offset:14336
    s_waitcnt lgkmcnt(8)
    v_mfma_f32_16x16x32_bf16 v[160:163], v[208:211], v[220:223], v[160:163]
    v_mfma_f32_16x16x32_bf16 v[164:167], v[208:211], v[224:227], v[164:167]
    ds_read_b128 v[208:211], v21 offset:15360
    v_mfma_f32_16x16x32_bf16 v[168:171], v[212:215], v[220:223], v[168:171]
    v_mfma_f32_16x16x32_bf16 v[172:175], v[212:215], v[224:227], v[172:175]
    ds_read_b128 v[212:215], v21 offset:16384
    v_mfma_f32_16x16x32_bf16 v[176:179], v[216:219], v[220:223], v[176:179]
    v_mfma_f32_16x16x32_bf16 v[180:183], v[216:219], v[224:227], v[180:183]
    ds_read_b128 v[216:219], v21 offset:17408
    s_waitcnt lgkmcnt(6)
    s_barrier
    v_mfma_f32_16x16x32_bf16 v[112:115], v[184:187], v[228:231], v[112:115]
    v_mfma_f32_16x16x32_bf16 v[116:119], v[184:187], v[232:235], v[116:119]
    ds_read_b128 v[184:187], v20 offset:0
    v_mfma_f32_16x16x32_bf16 v[120:123], v[188:191], v[228:231], v[120:123]
    ds_read_b128 v[220:223], v16 offset:0
    v_mfma_f32_16x16x32_bf16 v[124:127], v[188:191], v[232:235], v[124:127]
    ds_read_b128 v[188:191], v20 offset:1024
    v_mfma_f32_16x16x32_bf16 v[128:131], v[192:195], v[228:231], v[128:131]
    ds_read_b128 v[224:227], v16 offset:2048
    v_mfma_f32_16x16x32_bf16 v[132:135], v[192:195], v[232:235], v[132:135]
    ds_read_b128 v[192:195], v20 offset:2048
    s_waitcnt lgkmcnt(8)
    v_mfma_f32_16x16x32_bf16 v[136:139], v[196:199], v[228:231], v[136:139]
    v_mfma_f32_16x16x32_bf16 v[140:143], v[196:199], v[232:235], v[140:143]
    ds_read_b128 v[196:199], v20 offset:3072
    v_mfma_f32_16x16x32_bf16 v[144:147], v[200:203], v[228:231], v[144:147]
    v_mfma_f32_16x16x32_bf16 v[148:151], v[200:203], v[232:235], v[148:151]
    ds_read_b128 v[200:203], v20 offset:4096
    v_mfma_f32_16x16x32_bf16 v[152:155], v[204:207], v[228:231], v[152:155]
    v_mfma_f32_16x16x32_bf16 v[156:159], v[204:207], v[232:235], v[156:159]
    ds_read_b128 v[204:207], v20 offset:5120
    s_waitcnt lgkmcnt(8)
    v_mfma_f32_16x16x32_bf16 v[160:163], v[208:211], v[228:231], v[160:163]
    v_mfma_f32_16x16x32_bf16 v[164:167], v[208:211], v[232:235], v[164:167]
    ds_read_b128 v[208:211], v20 offset:6144
    v_mfma_f32_16x16x32_bf16 v[168:171], v[212:215], v[228:231], v[168:171]
    v_mfma_f32_16x16x32_bf16 v[172:175], v[212:215], v[232:235], v[172:175]
    ds_read_b128 v[212:215], v20 offset:7168
    v_mfma_f32_16x16x32_bf16 v[176:179], v[216:219], v[228:231], v[176:179]
    v_mfma_f32_16x16x32_bf16 v[180:183], v[216:219], v[232:235], v[180:183]
    ds_read_b128 v[216:219], v20 offset:8192
    s_waitcnt lgkmcnt(6)
    v_mfma_f32_16x16x32_bf16 v[112:115], v[184:187], v[220:223], v[112:115]
    v_mfma_f32_16x16x32_bf16 v[116:119], v[184:187], v[224:227], v[116:119]
    ds_read_b128 v[184:187], v20 offset:9216
    v_mfma_f32_16x16x32_bf16 v[120:123], v[188:191], v[220:223], v[120:123]
    ds_read_b128 v[228:231], v17 offset:0
    v_mfma_f32_16x16x32_bf16 v[124:127], v[188:191], v[224:227], v[124:127]
    ds_read_b128 v[188:191], v20 offset:10240
    v_mfma_f32_16x16x32_bf16 v[128:131], v[192:195], v[220:223], v[128:131]
    ds_read_b128 v[232:235], v17 offset:2048
    v_mfma_f32_16x16x32_bf16 v[132:135], v[192:195], v[224:227], v[132:135]
    ds_read_b128 v[192:195], v20 offset:11264
    s_waitcnt lgkmcnt(8)
    v_mfma_f32_16x16x32_bf16 v[136:139], v[196:199], v[220:223], v[136:139]
    v_mfma_f32_16x16x32_bf16 v[140:143], v[196:199], v[224:227], v[140:143]
    ds_read_b128 v[196:199], v20 offset:12288
    v_mfma_f32_16x16x32_bf16 v[144:147], v[200:203], v[220:223], v[144:147]
    v_mfma_f32_16x16x32_bf16 v[148:151], v[200:203], v[224:227], v[148:151]
    ds_read_b128 v[200:203], v20 offset:13312
    v_mfma_f32_16x16x32_bf16 v[152:155], v[204:207], v[220:223], v[152:155]
    v_mfma_f32_16x16x32_bf16 v[156:159], v[204:207], v[224:227], v[156:159]
    ds_read_b128 v[204:207], v20 offset:14336
    s_waitcnt lgkmcnt(8)
    v_mfma_f32_16x16x32_bf16 v[160:163], v[208:211], v[220:223], v[160:163]
    v_mfma_f32_16x16x32_bf16 v[164:167], v[208:211], v[224:227], v[164:167]
    ds_read_b128 v[208:211], v20 offset:15360
    v_mfma_f32_16x16x32_bf16 v[168:171], v[212:215], v[220:223], v[168:171]
    v_mfma_f32_16x16x32_bf16 v[172:175], v[212:215], v[224:227], v[172:175]
    ds_read_b128 v[212:215], v20 offset:16384
    v_mfma_f32_16x16x32_bf16 v[176:179], v[216:219], v[220:223], v[176:179]
    v_mfma_f32_16x16x32_bf16 v[180:183], v[216:219], v[224:227], v[180:183]
    ds_read_b128 v[216:219], v20 offset:17408
    s_waitcnt lgkmcnt(6)
    s_barrier
    v_mfma_f32_16x16x32_bf16 v[112:115], v[184:187], v[228:231], v[112:115]
    v_mfma_f32_16x16x32_bf16 v[116:119], v[184:187], v[232:235], v[116:119]
    ds_read_b128 v[184:187], v21 offset:34816
    v_mfma_f32_16x16x32_bf16 v[120:123], v[188:191], v[228:231], v[120:123]
    ds_read_b128 v[220:223], v18 offset:34816
    v_mfma_f32_16x16x32_bf16 v[124:127], v[188:191], v[232:235], v[124:127]
    ds_read_b128 v[188:191], v21 offset:35840
    v_mfma_f32_16x16x32_bf16 v[128:131], v[192:195], v[228:231], v[128:131]
    ds_read_b128 v[224:227], v18 offset:36864
    v_mfma_f32_16x16x32_bf16 v[132:135], v[192:195], v[232:235], v[132:135]
    ds_read_b128 v[192:195], v21 offset:36864
    s_waitcnt lgkmcnt(8)
    v_mfma_f32_16x16x32_bf16 v[136:139], v[196:199], v[228:231], v[136:139]
    v_mfma_f32_16x16x32_bf16 v[140:143], v[196:199], v[232:235], v[140:143]
    ds_read_b128 v[196:199], v21 offset:37888
    v_mfma_f32_16x16x32_bf16 v[144:147], v[200:203], v[228:231], v[144:147]
    v_mfma_f32_16x16x32_bf16 v[148:151], v[200:203], v[232:235], v[148:151]
    ds_read_b128 v[200:203], v21 offset:38912
    v_mfma_f32_16x16x32_bf16 v[152:155], v[204:207], v[228:231], v[152:155]
    v_mfma_f32_16x16x32_bf16 v[156:159], v[204:207], v[232:235], v[156:159]
    ds_read_b128 v[204:207], v21 offset:39936
    s_waitcnt lgkmcnt(8)
    v_mfma_f32_16x16x32_bf16 v[160:163], v[208:211], v[228:231], v[160:163]
    v_mfma_f32_16x16x32_bf16 v[164:167], v[208:211], v[232:235], v[164:167]
    ds_read_b128 v[208:211], v21 offset:40960
    v_mfma_f32_16x16x32_bf16 v[168:171], v[212:215], v[228:231], v[168:171]
    v_mfma_f32_16x16x32_bf16 v[172:175], v[212:215], v[232:235], v[172:175]
    ds_read_b128 v[212:215], v21 offset:41984
    v_mfma_f32_16x16x32_bf16 v[176:179], v[216:219], v[228:231], v[176:179]
    v_mfma_f32_16x16x32_bf16 v[180:183], v[216:219], v[232:235], v[180:183]
    ds_read_b128 v[216:219], v21 offset:43008
    s_waitcnt lgkmcnt(6)
    v_mfma_f32_16x16x32_bf16 v[112:115], v[184:187], v[220:223], v[112:115]
    ds_read_b128 v[228:231], v19 offset:34816
    v_mfma_f32_16x16x32_bf16 v[116:119], v[184:187], v[224:227], v[116:119]
    ds_read_b128 v[184:187], v21 offset:44032
    v_mfma_f32_16x16x32_bf16 v[120:123], v[188:191], v[220:223], v[120:123]
    ds_read_b128 v[232:235], v19 offset:36864
    v_mfma_f32_16x16x32_bf16 v[124:127], v[188:191], v[224:227], v[124:127]
    ds_read_b128 v[188:191], v21 offset:45056
    v_mfma_f32_16x16x32_bf16 v[128:131], v[192:195], v[220:223], v[128:131]
    v_mfma_f32_16x16x32_bf16 v[132:135], v[192:195], v[224:227], v[132:135]
    ds_read_b128 v[192:195], v21 offset:46080
    s_waitcnt lgkmcnt(2)
    s_barrier
    v_mfma_f32_16x16x32_bf16 v[112:115], v[184:187], v[228:231], v[112:115]
    v_mfma_f32_16x16x32_bf16 v[116:119], v[184:187], v[232:235], v[116:119]
    v_mfma_f32_16x16x32_bf16 v[136:139], v[196:199], v[220:223], v[136:139]
    v_mfma_f32_16x16x32_bf16 v[140:143], v[196:199], v[224:227], v[140:143]
    ds_read_b128 v[196:199], v21 offset:47104
    s_waitcnt lgkmcnt(2)
    v_mfma_f32_16x16x32_bf16 v[120:123], v[188:191], v[228:231], v[120:123]
    v_mfma_f32_16x16x32_bf16 v[124:127], v[188:191], v[232:235], v[124:127]
    v_mfma_f32_16x16x32_bf16 v[144:147], v[200:203], v[220:223], v[144:147]
    v_pk_mul_f32 v[112:113], v[112:113], v[76:77]
    v_pk_mul_f32 v[114:115], v[114:115], v[78:79]
    v_mfma_f32_16x16x32_bf16 v[148:151], v[200:203], v[224:227], v[148:151]
    ds_read_b128 v[200:203], v21 offset:48128
    v_cvt_pk_bf16_f32 v112, v112, v113
    v_cvt_pk_bf16_f32 v113, v114, v115
    s_waitcnt lgkmcnt(2)
    v_mfma_f32_16x16x32_bf16 v[128:131], v[192:195], v[228:231], v[128:131]
    v_pk_mul_f32 v[116:117], v[116:117], v[80:81]
    v_pk_mul_f32 v[118:119], v[118:119], v[82:83]
    v_mfma_f32_16x16x32_bf16 v[132:135], v[192:195], v[232:235], v[132:135]
    v_cvt_pk_bf16_f32 v116, v116, v117
    v_cvt_pk_bf16_f32 v117, v118, v119
    v_mfma_f32_16x16x32_bf16 v[152:155], v[204:207], v[220:223], v[152:155]
    v_pk_mul_f32 v[120:121], v[120:121], v[84:85]
    v_pk_mul_f32 v[122:123], v[122:123], v[86:87]
    v_mfma_f32_16x16x32_bf16 v[156:159], v[204:207], v[224:227], v[156:159]
    ds_read_b128 v[204:207], v21 offset:49152
    v_cvt_pk_bf16_f32 v114, v120, v121
    v_cvt_pk_bf16_f32 v115, v122, v123
    s_waitcnt lgkmcnt(2)
    v_mfma_f32_16x16x32_bf16 v[136:139], v[196:199], v[228:231], v[136:139]
    v_pk_mul_f32 v[124:125], v[124:125], v[88:89]
    v_pk_mul_f32 v[126:127], v[126:127], v[90:91]
    v_mfma_f32_16x16x32_bf16 v[140:143], v[196:199], v[232:235], v[140:143]
    v_cvt_pk_bf16_f32 v118, v124, v125
    v_cvt_pk_bf16_f32 v119, v126, v127
    v_mfma_f32_16x16x32_bf16 v[160:163], v[208:211], v[220:223], v[160:163]
    buffer_store_dwordx4 v[112:115], v24, s[36:39], s70 offen offset:0 sc1
    buffer_store_dwordx4 v[116:119], v24, s[36:39], s70 offen offset:1024 sc1
    v_mfma_f32_16x16x32_bf16 v[164:167], v[208:211], v[224:227], v[164:167]
    ds_read_b128 v[208:211], v21 offset:50176
    v_pk_mul_f32 v[128:129], v[128:129], v[92:93]
    v_pk_mul_f32 v[130:131], v[130:131], v[94:95]
    s_waitcnt lgkmcnt(2)
    v_mfma_f32_16x16x32_bf16 v[144:147], v[200:203], v[228:231], v[144:147]
    v_cvt_pk_bf16_f32 v128, v128, v129
    v_cvt_pk_bf16_f32 v129, v130, v131
    v_mfma_f32_16x16x32_bf16 v[148:151], v[200:203], v[232:235], v[148:151]
    v_pk_mul_f32 v[132:133], v[132:133], v[96:97]
    v_pk_mul_f32 v[134:135], v[134:135], v[98:99]
    v_mfma_f32_16x16x32_bf16 v[168:171], v[212:215], v[220:223], v[168:171]
    v_cvt_pk_bf16_f32 v132, v132, v133
    v_cvt_pk_bf16_f32 v133, v134, v135
    v_mfma_f32_16x16x32_bf16 v[172:175], v[212:215], v[224:227], v[172:175]
    ds_read_b128 v[212:215], v21 offset:51200
    v_pk_mul_f32 v[136:137], v[136:137], v[100:101]
    v_pk_mul_f32 v[138:139], v[138:139], v[102:103]
    s_waitcnt lgkmcnt(2)
    v_mfma_f32_16x16x32_bf16 v[152:155], v[204:207], v[228:231], v[152:155]
    v_cvt_pk_bf16_f32 v130, v136, v137
    v_cvt_pk_bf16_f32 v131, v138, v139
    v_mfma_f32_16x16x32_bf16 v[156:159], v[204:207], v[232:235], v[156:159]
    v_pk_mul_f32 v[140:141], v[140:141], v[104:105]
    v_pk_mul_f32 v[142:143], v[142:143], v[106:107]
    v_mfma_f32_16x16x32_bf16 v[176:179], v[216:219], v[220:223], v[176:179]
    v_cvt_pk_bf16_f32 v134, v140, v141
    v_cvt_pk_bf16_f32 v135, v142, v143
    v_mfma_f32_16x16x32_bf16 v[180:183], v[216:219], v[224:227], v[180:183]
    ds_read_b128 v[216:219], v21 offset:52224
    s_add_u32 s70, s70, 4096
    buffer_store_dwordx4 v[128:131], v24, s[36:39], s70 offen offset:0 sc1
    s_waitcnt lgkmcnt(2)
    v_mfma_f32_16x16x32_bf16 v[160:163], v[208:211], v[228:231], v[160:163]
    buffer_store_dwordx4 v[132:135], v24, s[36:39], s70 offen offset:1024 sc1
    v_pk_mul_f32 v[144:145], v[144:145], v[108:109]
    v_mfma_f32_16x16x32_bf16 v[164:167], v[208:211], v[232:235], v[164:167]
    v_pk_mul_f32 v[146:147], v[146:147], v[110:111]
    v_cvt_pk_bf16_f32 v144, v144, v145
    s_waitcnt lgkmcnt(1)
    v_mfma_f32_16x16x32_bf16 v[168:171], v[212:215], v[228:231], v[168:171]
    v_cvt_pk_bf16_f32 v145, v146, v147
    v_pk_mul_f32 v[148:149], v[148:149], v[236:237]
    v_mfma_f32_16x16x32_bf16 v[172:175], v[212:215], v[232:235], v[172:175]
    v_pk_mul_f32 v[150:151], v[150:151], v[238:239]
    v_cvt_pk_bf16_f32 v148, v148, v149
    s_waitcnt lgkmcnt(0)
    v_mfma_f32_16x16x32_bf16 v[176:179], v[216:219], v[228:231], v[176:179]
    v_cvt_pk_bf16_f32 v149, v150, v151
    v_pk_mul_f32 v[152:153], v[152:153], v[240:241]
    v_mfma_f32_16x16x32_bf16 v[180:183], v[216:219], v[232:235], v[180:183]
    v_pk_mul_f32 v[154:155], v[154:155], v[242:243]
    v_cvt_pk_bf16_f32 v146, v152, v153
    v_cvt_pk_bf16_f32 v147, v154, v155
    v_pk_mul_f32 v[156:157], v[156:157], v[244:245]
    v_pk_mul_f32 v[158:159], v[158:159], v[246:247]
    v_cvt_pk_bf16_f32 v150, v156, v157
    v_cvt_pk_bf16_f32 v151, v158, v159
    s_add_u32 s70, s70, 4096
    buffer_store_dwordx4 v[144:147], v24, s[36:39], s70 offen offset:0 sc1
    buffer_store_dwordx4 v[148:151], v24, s[36:39], s70 offen offset:1024 sc1
    v_pk_mul_f32 v[160:161], v[160:161], v[248:249]
    v_pk_mul_f32 v[162:163], v[162:163], v[250:251]
    v_cvt_pk_bf16_f32 v160, v160, v161
    v_cvt_pk_bf16_f32 v161, v162, v163
    v_pk_mul_f32 v[164:165], v[164:165], v[252:253]
    v_pk_mul_f32 v[166:167], v[166:167], v[254:255]
    v_cvt_pk_bf16_f32 v164, v164, v165
    v_cvt_pk_bf16_f32 v165, v166, v167
    v_pk_mul_f32 v[168:169], v[168:169], v[28:29]
    v_pk_mul_f32 v[170:171], v[170:171], v[30:31]
    v_cvt_pk_bf16_f32 v162, v168, v169
    v_cvt_pk_bf16_f32 v163, v170, v171
    v_pk_mul_f32 v[172:173], v[172:173], v[32:33]
    v_pk_mul_f32 v[174:175], v[174:175], v[34:35]
    v_cvt_pk_bf16_f32 v166, v172, v173
    v_cvt_pk_bf16_f32 v167, v174, v175
    s_add_u32 s70, s70, 4096
    buffer_store_dwordx4 v[160:163], v24, s[36:39], s70 offen offset:0 sc1
    buffer_store_dwordx4 v[164:167], v24, s[36:39], s70 offen offset:1024 sc1
    v_pk_mul_f32 v[176:177], v[176:177], v[4:5]
    v_pk_mul_f32 v[178:179], v[178:179], v[6:7]
    v_cvt_pk_bf16_f32 v176, v176, v177
    v_cvt_pk_bf16_f32 v177, v178, v179
    v_pk_mul_f32 v[180:181], v[180:181], v[8:9]
    v_pk_mul_f32 v[182:183], v[182:183], v[10:11]
    v_cvt_pk_bf16_f32 v180, v180, v181
    v_cvt_pk_bf16_f32 v181, v182, v183
    buffer_store_dwordx2 v[176:177], v25, s[36:39], s71 offen offset:0 sc1
    buffer_store_dwordx2 v[180:181], v25, s[36:39], s71 offen offset:1024 sc1
LA_p3:
    s_and_b32 s64, s63, 1
    s_lshr_b32 s65, s63, 1
    s_lshl_b32 s66, s64, 12
    s_lshl_b32 s67, s65, 11
    s_add_u32 s69, s66, s67
    v_add_u32 v4, s69, v24
    v_lshrrev_b32 v5, 2, v2
    v_lshl_add_u32 v5, v3, 2, v5
    s_lshl_b32 s66, s64, 5
    v_add_u32 v5, s66, v5
    v_mul_u32_u24 v5, 144, v5
    v_and_b32 v6, 3, v2
    v_lshl_add_u32 v5, v6, 3, v5
    v_add_u32 v5, 8192, v5
    v_add_u32 v6, 54272, v4
    v_add_u32 v7, 106496, v4
    v_add_u32 v8, 54272, v5
    v_add_u32 v9, 106496, v5
    v_lshrrev_b32 v10, 2, v2
    v_and_b32 v11, 3, v2
    v_lshl_add_u32 v10, v10, 3, v11
    s_and_b32 s66, s61, 1
    s_lshl_b32 s66, s66, 6
    s_lshl_b32 s67, s65, 5
    s_add_u32 s66, s66, s67
    s_lshl_b32 s67, s64, 2
    s_add_u32 s66, s66, s67
    v_add_u32 v10, s66, v10
    v_mul_u32_u24 v10, 1152, v10
    s_lshr_b32 s66, s61, 1
    s_mul_i32 s66, s66, 144
    v_lshl_add_u32 v10, v3, 3, v10
    v_add_u32 v10, s66, v10
    s_mul_i32 s66, s60, 147456
    s_add_u32 s48, s22, s66
    s_addc_u32 s49, s23, 0
    s_mov_b32 s50, 147456
    s_mov_b32 s51, 0x20000
    buffer_load_dwordx2 v[236:237], v10, s[28:31], 0 offen offset:0
    buffer_load_dwordx2 v[238:239], v10, s[28:31], 0 offen offset:32
    buffer_load_dwordx2 v[240:241], v10, s[28:31], 0 offen offset:64
    buffer_load_dwordx2 v[242:243], v10, s[28:31], 0 offen offset:96
    buffer_load_dwordx2 v[244:245], v10, s[28:31], 0 offen offset:128
    s_waitcnt vmcnt(5)
    s_lshl_b32 s64, s60, 2
    s_add_u32 s64, s64, s63
    s_mul_i32 s64, s64, 4352
    s_add_u32 s64, s64, 24952832
    s_mov_b64 exec, 1
    v_mov_b32 v12, 0
    v_mov_b32 v13, 1
    buffer_atomic_add v13, v12, s[36:39], s64 offen sc1
    s_mov_b64 exec, -1
    s_barrier
    ds_read_b128 v[112:115], v7 offset:34816
    ds_read_b128 v[116:119], v7 offset:35840
    ds_read_b64_tr_b16 v[120:121], v9 offset:34816
    ds_read_b64_tr_b16 v[122:123], v9 offset:37120
    ds_read_b64_tr_b16 v[124:125], v9 offset:34848
    ds_read_b64_tr_b16 v[126:127], v9 offset:37152
    ds_read_b64_tr_b16 v[128:129], v9 offset:34880
    ds_read_b64_tr_b16 v[130:131], v9 offset:37184
    ds_read_b64_tr_b16 v[132:133], v9 offset:34912
    ds_read_b64_tr_b16 v[134:135], v9 offset:37216
    ds_read_b64_tr_b16 v[136:137], v9 offset:34944
    ds_read_b64_tr_b16 v[138:139], v9 offset:37248
    s_barrier
    s_waitcnt lgkmcnt(0)
    ds_read_b128 v[140:143], v4 offset:36864
    ds_read_b128 v[144:147], v4 offset:37888
    v_mfma_f32_16x16x32_bf16 v[40:43], v[120:123], v[112:115], 0
    ds_read_b64_tr_b16 v[148:149], v5 offset:36864
    v_mfma_f32_16x16x32_bf16 v[44:47], v[120:123], v[116:119], 0
    ds_read_b64_tr_b16 v[150:151], v5 offset:39168
    v_mfma_f32_16x16x32_bf16 v[48:51], v[124:127], v[112:115], 0
    ds_read_b64_tr_b16 v[152:153], v5 offset:36896
    v_mfma_f32_16x16x32_bf16 v[52:55], v[124:127], v[116:119], 0
    ds_read_b64_tr_b16 v[154:155], v5 offset:39200
    v_mfma_f32_16x16x32_bf16 v[56:59], v[128:131], v[112:115], 0
    ds_read_b64_tr_b16 v[156:157], v5 offset:36928
    v_mfma_f32_16x16x32_bf16 v[60:63], v[128:131], v[116:119], 0
    ds_read_b64_tr_b16 v[158:159], v5 offset:39232
    v_mfma_f32_16x16x32_bf16 v[64:67], v[132:135], v[112:115], 0
    ds_read_b64_tr_b16 v[160:161], v5 offset:36960
    v_mfma_f32_16x16x32_bf16 v[68:71], v[132:135], v[116:119], 0
    ds_read_b64_tr_b16 v[162:163], v5 offset:39264
    v_mfma_f32_16x16x32_bf16 v[72:75], v[136:139], v[112:115], 0
    ds_read_b64_tr_b16 v[164:165], v5 offset:36992
    v_mfma_f32_16x16x32_bf16 v[76:79], v[136:139], v[116:119], 0
    ds_read_b64_tr_b16 v[166:167], v5 offset:39296
    s_barrier
    s_waitcnt lgkmcnt(0)
    ds_read_b128 v[112:115], v6 offset:0
    ds_read_b128 v[116:119], v6 offset:1024
    v_mfma_f32_16x16x32_bf16 v[40:43], v[148:151], v[140:143], v[40:43]
    ds_read_b64_tr_b16 v[120:121], v8 offset:0
    v_mfma_f32_16x16x32_bf16 v[44:47], v[148:151], v[144:147], v[44:47]
    ds_read_b64_tr_b16 v[122:123], v8 offset:2304
    v_mfma_f32_16x16x32_bf16 v[48:51], v[152:155], v[140:143], v[48:51]
    ds_read_b64_tr_b16 v[124:125], v8 offset:32
    v_mfma_f32_16x16x32_bf16 v[52:55], v[152:155], v[144:147], v[52:55]
    ds_read_b64_tr_b16 v[126:127], v8 offset:2336
    v_mfma_f32_16x16x32_bf16 v[56:59], v[156:159], v[140:143], v[56:59]
    ds_read_b64_tr_b16 v[128:129], v8 offset:64
    v_mfma_f32_16x16x32_bf16 v[60:63], v[156:159], v[144:147], v[60:63]
    ds_read_b64_tr_b16 v[130:131], v8 offset:2368
    v_mfma_f32_16x16x32_bf16 v[64:67], v[160:163], v[140:143], v[64:67]
    ds_read_b64_tr_b16 v[132:133], v8 offset:96
    v_mfma_f32_16x16x32_bf16 v[68:71], v[160:163], v[144:147], v[68:71]
    ds_read_b64_tr_b16 v[134:135], v8 offset:2400
    v_mfma_f32_16x16x32_bf16 v[72:75], v[164:167], v[140:143], v[72:75]
    ds_read_b64_tr_b16 v[136:137], v8 offset:128
    v_mfma_f32_16x16x32_bf16 v[76:79], v[164:167], v[144:147], v[76:79]
    ds_read_b64_tr_b16 v[138:139], v8 offset:2432
    s_barrier
    s_waitcnt lgkmcnt(0)
    ds_read_b128 v[140:143], v6 offset:17408
    ds_read_b128 v[144:147], v6 offset:18432
    v_mfma_f32_16x16x32_bf16 v[40:43], v[120:123], v[112:115], v[40:43]
    ds_read_b64_tr_b16 v[148:149], v8 offset:17408
    v_mfma_f32_16x16x32_bf16 v[44:47], v[120:123], v[116:119], v[44:47]
    ds_read_b64_tr_b16 v[150:151], v8 offset:19712
    v_mfma_f32_16x16x32_bf16 v[48:51], v[124:127], v[112:115], v[48:51]
    ds_read_b64_tr_b16 v[152:153], v8 offset:17440
    v_mfma_f32_16x16x32_bf16 v[52:55], v[124:127], v[116:119], v[52:55]
    ds_read_b64_tr_b16 v[154:155], v8 offset:19744
    v_mfma_f32_16x16x32_bf16 v[56:59], v[128:131], v[112:115], v[56:59]
    ds_read_b64_tr_b16 v[156:157], v8 offset:17472
    v_mfma_f32_16x16x32_bf16 v[60:63], v[128:131], v[116:119], v[60:63]
    ds_read_b64_tr_b16 v[158:159], v8 offset:19776
    v_mfma_f32_16x16x32_bf16 v[64:67], v[132:135], v[112:115], v[64:67]
    ds_read_b64_tr_b16 v[160:161], v8 offset:17504
    v_mfma_f32_16x16x32_bf16 v[68:71], v[132:135], v[116:119], v[68:71]
    ds_read_b64_tr_b16 v[162:163], v8 offset:19808
    v_mfma_f32_16x16x32_bf16 v[72:75], v[136:139], v[112:115], v[72:75]
    ds_read_b64_tr_b16 v[164:165], v8 offset:17536
    v_mfma_f32_16x16x32_bf16 v[76:79], v[136:139], v[116:119], v[76:79]
    ds_read_b64_tr_b16 v[166:167], v8 offset:19840
    s_barrier
    s_waitcnt lgkmcnt(0)
    ds_read_b128 v[112:115], v6 offset:34816
    ds_read_b128 v[116:119], v6 offset:35840
    v_mfma_f32_16x16x32_bf16 v[40:43], v[148:151], v[140:143], v[40:43]
    ds_read_b64_tr_b16 v[120:121], v8 offset:34816
    v_mfma_f32_16x16x32_bf16 v[44:47], v[148:151], v[144:147], v[44:47]
    ds_read_b64_tr_b16 v[122:123], v8 offset:37120
    v_mfma_f32_16x16x32_bf16 v[48:51], v[152:155], v[140:143], v[48:51]
    ds_read_b64_tr_b16 v[124:125], v8 offset:34848
    v_mfma_f32_16x16x32_bf16 v[52:55], v[152:155], v[144:147], v[52:55]
    ds_read_b64_tr_b16 v[126:127], v8 offset:37152
    v_mfma_f32_16x16x32_bf16 v[56:59], v[156:159], v[140:143], v[56:59]
    ds_read_b64_tr_b16 v[128:129], v8 offset:34880
    v_mfma_f32_16x16x32_bf16 v[60:63], v[156:159], v[144:147], v[60:63]
    ds_read_b64_tr_b16 v[130:131], v8 offset:37184
    v_mfma_f32_16x16x32_bf16 v[64:67], v[160:163], v[140:143], v[64:67]
    ds_read_b64_tr_b16 v[132:133], v8 offset:34912
    v_mfma_f32_16x16x32_bf16 v[68:71], v[160:163], v[144:147], v[68:71]
    ds_read_b64_tr_b16 v[134:135], v8 offset:37216
    v_mfma_f32_16x16x32_bf16 v[72:75], v[164:167], v[140:143], v[72:75]
    ds_read_b64_tr_b16 v[136:137], v8 offset:34944
    v_mfma_f32_16x16x32_bf16 v[76:79], v[164:167], v[144:147], v[76:79]
    ds_read_b64_tr_b16 v[138:139], v8 offset:37248
    s_barrier
    s_waitcnt lgkmcnt(0)
    ds_read_b128 v[140:143], v4 offset:0
    ds_read_b128 v[144:147], v4 offset:1024
    v_mfma_f32_16x16x32_bf16 v[40:43], v[120:123], v[112:115], v[40:43]
    ds_read_b64_tr_b16 v[148:149], v5 offset:0
    v_mfma_f32_16x16x32_bf16 v[44:47], v[120:123], v[116:119], v[44:47]
    ds_read_b64_tr_b16 v[150:151], v5 offset:2304
    v_mfma_f32_16x16x32_bf16 v[48:51], v[124:127], v[112:115], v[48:51]
    ds_read_b64_tr_b16 v[152:153], v5 offset:32
    v_mfma_f32_16x16x32_bf16 v[52:55], v[124:127], v[116:119], v[52:55]
    ds_read_b64_tr_b16 v[154:155], v5 offset:2336
    v_mfma_f32_16x16x32_bf16 v[56:59], v[128:131], v[112:115], v[56:59]
    ds_read_b64_tr_b16 v[156:157], v5 offset:64
    v_mfma_f32_16x16x32_bf16 v[60:63], v[128:131], v[116:119], v[60:63]
    ds_read_b64_tr_b16 v[158:159], v5 offset:2368
    v_mfma_f32_16x16x32_bf16 v[64:67], v[132:135], v[112:115], v[64:67]
    ds_read_b64_tr_b16 v[160:161], v5 offset:96
    v_mfma_f32_16x16x32_bf16 v[68:71], v[132:135], v[116:119], v[68:71]
    ds_read_b64_tr_b16 v[162:163], v5 offset:2400
    v_mfma_f32_16x16x32_bf16 v[72:75], v[136:139], v[112:115], v[72:75]
    ds_read_b64_tr_b16 v[164:165], v5 offset:128
    v_mfma_f32_16x16x32_bf16 v[76:79], v[136:139], v[116:119], v[76:79]
    ds_read_b64_tr_b16 v[166:167], v5 offset:2432
    s_barrier
    s_waitcnt lgkmcnt(0)
    ds_read_b128 v[112:115], v4 offset:17408
    ds_read_b128 v[116:119], v4 offset:18432
    v_mfma_f32_16x16x32_bf16 v[40:43], v[148:151], v[140:143], v[40:43]
    ds_read_b64_tr_b16 v[120:121], v5 offset:17408
    v_mfma_f32_16x16x32_bf16 v[44:47], v[148:151], v[144:147], v[44:47]
    ds_read_b64_tr_b16 v[122:123], v5 offset:19712
    v_mfma_f32_16x16x32_bf16 v[48:51], v[152:155], v[140:143], v[48:51]
    ds_read_b64_tr_b16 v[124:125], v5 offset:17440
    v_mfma_f32_16x16x32_bf16 v[52:55], v[152:155], v[144:147], v[52:55]
    ds_read_b64_tr_b16 v[126:127], v5 offset:19744
    v_mfma_f32_16x16x32_bf16 v[56:59], v[156:159], v[140:143], v[56:59]
    ds_read_b64_tr_b16 v[128:129], v5 offset:17472
    v_mfma_f32_16x16x32_bf16 v[60:63], v[156:159], v[144:147], v[60:63]
    ds_read_b64_tr_b16 v[130:131], v5 offset:19776
    v_mfma_f32_16x16x32_bf16 v[64:67], v[160:163], v[140:143], v[64:67]
    ds_read_b64_tr_b16 v[132:133], v5 offset:17504
    v_mfma_f32_16x16x32_bf16 v[68:71], v[160:163], v[144:147], v[68:71]
    ds_read_b64_tr_b16 v[134:135], v5 offset:19808
    v_mfma_f32_16x16x32_bf16 v[72:75], v[164:167], v[140:143], v[72:75]
    ds_read_b64_tr_b16 v[136:137], v5 offset:17536
    v_mfma_f32_16x16x32_bf16 v[76:79], v[164:167], v[144:147], v[76:79]
    ds_read_b64_tr_b16 v[138:139], v5 offset:19840
    s_barrier
    s_waitcnt lgkmcnt(0)
    ds_read_b128 v[140:143], v7 offset:0
    ds_read_b128 v[144:147], v7 offset:1024
    v_mfma_f32_16x16x32_bf16 v[40:43], v[120:123], v[112:115], v[40:43]
    ds_read_b64_tr_b16 v[148:149], v9 offset:0
    v_mfma_f32_16x16x32_bf16 v[44:47], v[120:123], v[116:119], v[44:47]
    ds_read_b64_tr_b16 v[150:151], v9 offset:2304
    v_mfma_f32_16x16x32_bf16 v[48:51], v[124:127], v[112:115], v[48:51]
    ds_read_b64_tr_b16 v[152:153], v9 offset:32
    v_mfma_f32_16x16x32_bf16 v[52:55], v[124:127], v[116:119], v[52:55]
    ds_read_b64_tr_b16 v[154:155], v9 offset:2336
    v_mfma_f32_16x16x32_bf16 v[56:59], v[128:131], v[112:115], v[56:59]
    ds_read_b64_tr_b16 v[156:157], v9 offset:64
    v_mfma_f32_16x16x32_bf16 v[60:63], v[128:131], v[116:119], v[60:63]
    ds_read_b64_tr_b16 v[158:159], v9 offset:2368
    v_mfma_f32_16x16x32_bf16 v[64:67], v[132:135], v[112:115], v[64:67]
    ds_read_b64_tr_b16 v[160:161], v9 offset:96
    v_mfma_f32_16x16x32_bf16 v[68:71], v[132:135], v[116:119], v[68:71]
    ds_read_b64_tr_b16 v[162:163], v9 offset:2400
    v_mfma_f32_16x16x32_bf16 v[72:75], v[136:139], v[112:115], v[72:75]
    ds_read_b64_tr_b16 v[164:165], v9 offset:128
    v_mfma_f32_16x16x32_bf16 v[76:79], v[136:139], v[116:119], v[76:79]
    ds_read_b64_tr_b16 v[166:167], v9 offset:2432
    s_barrier
    s_waitcnt lgkmcnt(0)
    s_add_u32 s66, s69, 123904
    v_lshlrev_b32 v11, 1, v1
    v_add_u32 v11, s66, v11
    ds_read_u16 v168, v11 offset:0
    ds_read_u16 v169, v11 offset:128
    ds_read_u16 v170, v11 offset:256
    ds_read_u16 v171, v11 offset:384
    ds_read_u16 v172, v11 offset:512
    ds_read_u16 v173, v11 offset:640
    ds_read_u16 v174, v11 offset:768
    ds_read_u16 v175, v11 offset:896
    ds_read_u16 v176, v11 offset:1024
    ds_read_u16 v177, v11 offset:1152
    ds_read_u16 v178, v11 offset:1280
    ds_read_u16 v179, v11 offset:1408
    ds_read_u16 v180, v11 offset:1536
    ds_read_u16 v181, v11 offset:1664
    ds_read_u16 v182, v11 offset:1792
    ds_read_u16 v183, v11 offset:1920
    v_mfma_f32_16x16x32_bf16 v[40:43], v[148:151], v[140:143], v[40:43]
    ds_read_b64_tr_b16 v[120:121], v9 offset:17408
    v_mfma_f32_16x16x32_bf16 v[44:47], v[148:151], v[144:147], v[44:47]
    ds_read_b64_tr_b16 v[122:123], v9 offset:19712
    v_mfma_f32_16x16x32_bf16 v[48:51], v[152:155], v[140:143], v[48:51]
    ds_read_b64_tr_b16 v[124:125], v9 offset:17440
    v_mfma_f32_16x16x32_bf16 v[52:55], v[152:155], v[144:147], v[52:55]
    ds_read_b64_tr_b16 v[126:127], v9 offset:19744
    v_mfma_f32_16x16x32_bf16 v[56:59], v[156:159], v[140:143], v[56:59]
    ds_read_b64_tr_b16 v[128:129], v9 offset:17472
    v_mfma_f32_16x16x32_bf16 v[60:63], v[156:159], v[144:147], v[60:63]
    ds_read_b64_tr_b16 v[130:131], v9 offset:19776
    v_mfma_f32_16x16x32_bf16 v[64:67], v[160:163], v[140:143], v[64:67]
    ds_read_b64_tr_b16 v[132:133], v9 offset:17504
    v_mfma_f32_16x16x32_bf16 v[68:71], v[160:163], v[144:147], v[68:71]
    ds_read_b64_tr_b16 v[134:135], v9 offset:19808
    v_mfma_f32_16x16x32_bf16 v[72:75], v[164:167], v[140:143], v[72:75]
    ds_read_b64_tr_b16 v[136:137], v9 offset:17536
    v_mfma_f32_16x16x32_bf16 v[76:79], v[164:167], v[144:147], v[76:79]
    ds_read_b64_tr_b16 v[138:139], v9 offset:19840
    s_barrier
    s_barrier
    s_waitcnt lgkmcnt(0)
    v_lshl_or_b32 v112, v169, 16, v168
    v_lshl_or_b32 v113, v171, 16, v170
    v_lshl_or_b32 v114, v173, 16, v172
    v_lshl_or_b32 v115, v175, 16, v174
    v_lshl_or_b32 v116, v177, 16, v176
    v_lshl_or_b32 v117, v179, 16, v178
    v_lshl_or_b32 v118, v181, 16, v180
    v_lshl_or_b32 v119, v183, 16, v182
    ds_read_b128 v[140:143], v7 offset:34816
    ds_read_b128 v[144:147], v7 offset:35840
    v_mfma_f32_16x16x32_bf16 v[40:43], v[120:123], v[112:115], v[40:43]
    ds_read_b64_tr_b16 v[148:149], v9 offset:34816
    v_mfma_f32_16x16x32_bf16 v[44:47], v[120:123], v[116:119], v[44:47]
    ds_read_b64_tr_b16 v[150:151], v9 offset:37120
    v_mfma_f32_16x16x32_bf16 v[48:51], v[124:127], v[112:115], v[48:51]
    ds_read_b64_tr_b16 v[152:153], v9 offset:34848
    v_mfma_f32_16x16x32_bf16 v[52:55], v[124:127], v[116:119], v[52:55]
    ds_read_b64_tr_b16 v[154:155], v9 offset:37152
    v_mfma_f32_16x16x32_bf16 v[56:59], v[128:131], v[112:115], v[56:59]
    ds_read_b64_tr_b16 v[156:157], v9 offset:34880
    v_mfma_f32_16x16x32_bf16 v[60:63], v[128:131], v[116:119], v[60:63]
    ds_read_b64_tr_b16 v[158:159], v9 offset:37184
    v_mfma_f32_16x16x32_bf16 v[64:67], v[132:135], v[112:115], v[64:67]
    ds_read_b64_tr_b16 v[160:161], v9 offset:34912
    v_mfma_f32_16x16x32_bf16 v[68:71], v[132:135], v[116:119], v[68:71]
    ds_read_b64_tr_b16 v[162:163], v9 offset:37216
    v_mfma_f32_16x16x32_bf16 v[72:75], v[136:139], v[112:115], v[72:75]
    ds_read_b64_tr_b16 v[164:165], v9 offset:34944
    v_mfma_f32_16x16x32_bf16 v[76:79], v[136:139], v[116:119], v[76:79]
    ds_read_b64_tr_b16 v[166:167], v9 offset:37248
    s_barrier
    s_waitcnt lgkmcnt(0)
    ds_read_b128 v[112:115], v4 offset:36864
    ds_read_b128 v[116:119], v4 offset:37888
    v_mfma_f32_16x16x32_bf16 v[40:43], v[148:151], v[140:143], v[40:43]
    ds_read_b64_tr_b16 v[120:121], v5 offset:36864
    v_mfma_f32_16x16x32_bf16 v[44:47], v[148:151], v[144:147], v[44:47]
    ds_read_b64_tr_b16 v[122:123], v5 offset:39168
    v_mfma_f32_16x16x32_bf16 v[48:51], v[152:155], v[140:143], v[48:51]
    ds_read_b64_tr_b16 v[124:125], v5 offset:36896
    v_mfma_f32_16x16x32_bf16 v[52:55], v[152:155], v[144:147], v[52:55]
    ds_read_b64_tr_b16 v[126:127], v5 offset:39200
    v_mfma_f32_16x16x32_bf16 v[56:59], v[156:159], v[140:143], v[56:59]
    ds_read_b64_tr_b16 v[128:129], v5 offset:36928
    v_mfma_f32_16x16x32_bf16 v[60:63], v[156:159], v[144:147], v[60:63]
    ds_read_b64_tr_b16 v[130:131], v5 offset:39232
    v_mfma_f32_16x16x32_bf16 v[64:67], v[160:163], v[140:143], v[64:67]
    ds_read_b64_tr_b16 v[132:133], v5 offset:36960
    v_mfma_f32_16x16x32_bf16 v[68:71], v[160:163], v[144:147], v[68:71]
    ds_read_b64_tr_b16 v[134:135], v5 offset:39264
    v_mfma_f32_16x16x32_bf16 v[72:75], v[164:167], v[140:143], v[72:75]
    ds_read_b64_tr_b16 v[136:137], v5 offset:36992
    v_mfma_f32_16x16x32_bf16 v[76:79], v[164:167], v[144:147], v[76:79]
    ds_read_b64_tr_b16 v[138:139], v5 offset:39296
    s_barrier
    s_waitcnt lgkmcnt(0)
    ds_read_b128 v[140:143], v6 offset:0
    ds_read_b128 v[144:147], v6 offset:1024
    v_mfma_f32_16x16x32_bf16 v[40:43], v[120:123], v[112:115], v[40:43]
    ds_read_b64_tr_b16 v[148:149], v8 offset:0
    v_mfma_f32_16x16x32_bf16 v[44:47], v[120:123], v[116:119], v[44:47]
    ds_read_b64_tr_b16 v[150:151], v8 offset:2304
    v_mfma_f32_16x16x32_bf16 v[48:51], v[124:127], v[112:115], v[48:51]
    ds_read_b64_tr_b16 v[152:153], v8 offset:32
    v_mfma_f32_16x16x32_bf16 v[52:55], v[124:127], v[116:119], v[52:55]
    ds_read_b64_tr_b16 v[154:155], v8 offset:2336
    v_mfma_f32_16x16x32_bf16 v[56:59], v[128:131], v[112:115], v[56:59]
    ds_read_b64_tr_b16 v[156:157], v8 offset:64
    v_mfma_f32_16x16x32_bf16 v[60:63], v[128:131], v[116:119], v[60:63]
    ds_read_b64_tr_b16 v[158:159], v8 offset:2368
    v_mfma_f32_16x16x32_bf16 v[64:67], v[132:135], v[112:115], v[64:67]
    ds_read_b64_tr_b16 v[160:161], v8 offset:96
    v_mfma_f32_16x16x32_bf16 v[68:71], v[132:135], v[116:119], v[68:71]
    ds_read_b64_tr_b16 v[162:163], v8 offset:2400
    v_mfma_f32_16x16x32_bf16 v[72:75], v[136:139], v[112:115], v[72:75]
    ds_read_b64_tr_b16 v[164:165], v8 offset:128
    v_mfma_f32_16x16x32_bf16 v[76:79], v[136:139], v[116:119], v[76:79]
    ds_read_b64_tr_b16 v[166:167], v8 offset:2432
    s_barrier
    s_waitcnt lgkmcnt(0)
    ds_read_b128 v[112:115], v6 offset:17408
    ds_read_b128 v[116:119], v6 offset:18432
    v_mfma_f32_16x16x32_bf16 v[40:43], v[148:151], v[140:143], v[40:43]
    ds_read_b64_tr_b16 v[120:121], v8 offset:17408
    v_mfma_f32_16x16x32_bf16 v[44:47], v[148:151], v[144:147], v[44:47]
    ds_read_b64_tr_b16 v[122:123], v8 offset:19712
    v_mfma_f32_16x16x32_bf16 v[48:51], v[152:155], v[140:143], v[48:51]
    ds_read_b64_tr_b16 v[124:125], v8 offset:17440
    v_mfma_f32_16x16x32_bf16 v[52:55], v[152:155], v[144:147], v[52:55]
    ds_read_b64_tr_b16 v[126:127], v8 offset:19744
    v_mfma_f32_16x16x32_bf16 v[56:59], v[156:159], v[140:143], v[56:59]
    ds_read_b64_tr_b16 v[128:129], v8 offset:17472
    v_mfma_f32_16x16x32_bf16 v[60:63], v[156:159], v[144:147], v[60:63]
    ds_read_b64_tr_b16 v[130:131], v8 offset:19776
    v_mfma_f32_16x16x32_bf16 v[64:67], v[160:163], v[140:143], v[64:67]
    ds_read_b64_tr_b16 v[132:133], v8 offset:17504
    v_mfma_f32_16x16x32_bf16 v[68:71], v[160:163], v[144:147], v[68:71]
    ds_read_b64_tr_b16 v[134:135], v8 offset:19808
    v_mfma_f32_16x16x32_bf16 v[72:75], v[164:167], v[140:143], v[72:75]
    ds_read_b64_tr_b16 v[136:137], v8 offset:17536
    v_mfma_f32_16x16x32_bf16 v[76:79], v[164:167], v[144:147], v[76:79]
    ds_read_b64_tr_b16 v[138:139], v8 offset:19840
    s_barrier
    s_waitcnt lgkmcnt(0)
    ds_read_b128 v[140:143], v6 offset:34816
    ds_read_b128 v[144:147], v6 offset:35840
    v_mfma_f32_16x16x32_bf16 v[40:43], v[120:123], v[112:115], v[40:43]
    ds_read_b64_tr_b16 v[148:149], v8 offset:34816
    v_mfma_f32_16x16x32_bf16 v[44:47], v[120:123], v[116:119], v[44:47]
    ds_read_b64_tr_b16 v[150:151], v8 offset:37120
    v_mfma_f32_16x16x32_bf16 v[48:51], v[124:127], v[112:115], v[48:51]
    ds_read_b64_tr_b16 v[152:153], v8 offset:34848
    v_mfma_f32_16x16x32_bf16 v[52:55], v[124:127], v[116:119], v[52:55]
    ds_read_b64_tr_b16 v[154:155], v8 offset:37152
    v_mfma_f32_16x16x32_bf16 v[56:59], v[128:131], v[112:115], v[56:59]
    ds_read_b64_tr_b16 v[156:157], v8 offset:34880
    v_mfma_f32_16x16x32_bf16 v[60:63], v[128:131], v[116:119], v[60:63]
    ds_read_b64_tr_b16 v[158:159], v8 offset:37184
    v_mfma_f32_16x16x32_bf16 v[64:67], v[132:135], v[112:115], v[64:67]
    ds_read_b64_tr_b16 v[160:161], v8 offset:34912
    v_mfma_f32_16x16x32_bf16 v[68:71], v[132:135], v[116:119], v[68:71]
    ds_read_b64_tr_b16 v[162:163], v8 offset:37216
    v_mfma_f32_16x16x32_bf16 v[72:75], v[136:139], v[112:115], v[72:75]
    ds_read_b64_tr_b16 v[164:165], v8 offset:34944
    v_mfma_f32_16x16x32_bf16 v[76:79], v[136:139], v[116:119], v[76:79]
    ds_read_b64_tr_b16 v[166:167], v8 offset:37248
    s_barrier
    s_waitcnt lgkmcnt(0)
    ds_read_b128 v[112:115], v4 offset:0
    ds_read_b128 v[116:119], v4 offset:1024
    v_mfma_f32_16x16x32_bf16 v[40:43], v[148:151], v[140:143], v[40:43]
    ds_read_b64_tr_b16 v[120:121], v5 offset:0
    v_mfma_f32_16x16x32_bf16 v[44:47], v[148:151], v[144:147], v[44:47]
    ds_read_b64_tr_b16 v[122:123], v5 offset:2304
    v_mfma_f32_16x16x32_bf16 v[48:51], v[152:155], v[140:143], v[48:51]
    ds_read_b64_tr_b16 v[124:125], v5 offset:32
    v_mfma_f32_16x16x32_bf16 v[52:55], v[152:155], v[144:147], v[52:55]
    ds_read_b64_tr_b16 v[126:127], v5 offset:2336
    v_mfma_f32_16x16x32_bf16 v[56:59], v[156:159], v[140:143], v[56:59]
    ds_read_b64_tr_b16 v[128:129], v5 offset:64
    v_mfma_f32_16x16x32_bf16 v[60:63], v[156:159], v[144:147], v[60:63]
    ds_read_b64_tr_b16 v[130:131], v5 offset:2368
    v_mfma_f32_16x16x32_bf16 v[64:67], v[160:163], v[140:143], v[64:67]
    ds_read_b64_tr_b16 v[132:133], v5 offset:96
    v_mfma_f32_16x16x32_bf16 v[68:71], v[160:163], v[144:147], v[68:71]
    ds_read_b64_tr_b16 v[134:135], v5 offset:2400
    v_mfma_f32_16x16x32_bf16 v[72:75], v[164:167], v[140:143], v[72:75]
    ds_read_b64_tr_b16 v[136:137], v5 offset:128
    v_mfma_f32_16x16x32_bf16 v[76:79], v[164:167], v[144:147], v[76:79]
    ds_read_b64_tr_b16 v[138:139], v5 offset:2432
    s_barrier
    s_waitcnt lgkmcnt(0)
    ds_read_b128 v[140:143], v4 offset:17408
    ds_read_b128 v[144:147], v4 offset:18432
    v_mfma_f32_16x16x32_bf16 v[40:43], v[120:123], v[112:115], v[40:43]
    ds_read_b64_tr_b16 v[148:149], v5 offset:17408
    v_mfma_f32_16x16x32_bf16 v[44:47], v[120:123], v[116:119], v[44:47]
    ds_read_b64_tr_b16 v[150:151], v5 offset:19712
    v_mfma_f32_16x16x32_bf16 v[48:51], v[124:127], v[112:115], v[48:51]
    ds_read_b64_tr_b16 v[152:153], v5 offset:17440
    v_mfma_f32_16x16x32_bf16 v[52:55], v[124:127], v[116:119], v[52:55]
    ds_read_b64_tr_b16 v[154:155], v5 offset:19744
    v_mfma_f32_16x16x32_bf16 v[56:59], v[128:131], v[112:115], v[56:59]
    ds_read_b64_tr_b16 v[156:157], v5 offset:17472
    v_mfma_f32_16x16x32_bf16 v[60:63], v[128:131], v[116:119], v[60:63]
    ds_read_b64_tr_b16 v[158:159], v5 offset:19776
    v_mfma_f32_16x16x32_bf16 v[64:67], v[132:135], v[112:115], v[64:67]
    ds_read_b64_tr_b16 v[160:161], v5 offset:17504
    v_mfma_f32_16x16x32_bf16 v[68:71], v[132:135], v[116:119], v[68:71]
    ds_read_b64_tr_b16 v[162:163], v5 offset:19808
    v_mfma_f32_16x16x32_bf16 v[72:75], v[136:139], v[112:115], v[72:75]
    ds_read_b64_tr_b16 v[164:165], v5 offset:17536
    v_mfma_f32_16x16x32_bf16 v[76:79], v[136:139], v[116:119], v[76:79]
    ds_read_b64_tr_b16 v[166:167], v5 offset:19840
    s_barrier
    s_waitcnt lgkmcnt(0)
    ds_read_b128 v[112:115], v7 offset:0
    ds_read_b128 v[116:119], v7 offset:1024
    v_mfma_f32_16x16x32_bf16 v[40:43], v[148:151], v[140:143], v[40:43]
    ds_read_b64_tr_b16 v[120:121], v9 offset:0
    v_mfma_f32_16x16x32_bf16 v[44:47], v[148:151], v[144:147], v[44:47]
    ds_read_b64_tr_b16 v[122:123], v9 offset:2304
    v_mfma_f32_16x16x32_bf16 v[48:51], v[152:155], v[140:143], v[48:51]
    ds_read_b64_tr_b16 v[124:125], v9 offset:32
    v_mfma_f32_16x16x32_bf16 v[52:55], v[152:155], v[144:147], v[52:55]
    ds_read_b64_tr_b16 v[126:127], v9 offset:2336
    v_mfma_f32_16x16x32_bf16 v[56:59], v[156:159], v[140:143], v[56:59]
    ds_read_b64_tr_b16 v[128:129], v9 offset:64
    v_mfma_f32_16x16x32_bf16 v[60:63], v[156:159], v[144:147], v[60:63]
    ds_read_b64_tr_b16 v[130:131], v9 offset:2368
    v_mfma_f32_16x16x32_bf16 v[64:67], v[160:163], v[140:143], v[64:67]
    ds_read_b64_tr_b16 v[132:133], v9 offset:96
    v_mfma_f32_16x16x32_bf16 v[68:71], v[160:163], v[144:147], v[68:71]
    ds_read_b64_tr_b16 v[134:135], v9 offset:2400
    v_mfma_f32_16x16x32_bf16 v[72:75], v[164:167], v[140:143], v[72:75]
    ds_read_b64_tr_b16 v[136:137], v9 offset:128
    v_mfma_f32_16x16x32_bf16 v[76:79], v[164:167], v[144:147], v[76:79]
    ds_read_b64_tr_b16 v[138:139], v9 offset:2432
    s_barrier
    s_waitcnt lgkmcnt(0)
    ds_read_b128 v[140:143], v7 offset:17408
    ds_read_b128 v[144:147], v7 offset:18432
    v_mfma_f32_16x16x32_bf16 v[40:43], v[120:123], v[112:115], v[40:43]
    ds_read_b64_tr_b16 v[148:149], v9 offset:17408
    v_mfma_f32_16x16x32_bf16 v[44:47], v[120:123], v[116:119], v[44:47]
    ds_read_b64_tr_b16 v[150:151], v9 offset:19712
    v_mfma_f32_16x16x32_bf16 v[48:51], v[124:127], v[112:115], v[48:51]
    ds_read_b64_tr_b16 v[152:153], v9 offset:17440
    v_mfma_f32_16x16x32_bf16 v[52:55], v[124:127], v[116:119], v[52:55]
    ds_read_b64_tr_b16 v[154:155], v9 offset:19744
    v_mfma_f32_16x16x32_bf16 v[56:59], v[128:131], v[112:115], v[56:59]
    ds_read_b64_tr_b16 v[156:157], v9 offset:17472
    v_mfma_f32_16x16x32_bf16 v[60:63], v[128:131], v[116:119], v[60:63]
    ds_read_b64_tr_b16 v[158:159], v9 offset:19776
    v_mfma_f32_16x16x32_bf16 v[64:67], v[132:135], v[112:115], v[64:67]
    ds_read_b64_tr_b16 v[160:161], v9 offset:17504
    v_mfma_f32_16x16x32_bf16 v[68:71], v[132:135], v[116:119], v[68:71]
    ds_read_b64_tr_b16 v[162:163], v9 offset:19808
    v_mfma_f32_16x16x32_bf16 v[72:75], v[136:139], v[112:115], v[72:75]
    ds_read_b64_tr_b16 v[164:165], v9 offset:17536
    v_mfma_f32_16x16x32_bf16 v[76:79], v[136:139], v[116:119], v[76:79]
    ds_read_b64_tr_b16 v[166:167], v9 offset:19840
    s_barrier
    s_waitcnt lgkmcnt(0)
    ds_read_b128 v[112:115], v7 offset:34816
    ds_read_b128 v[116:119], v7 offset:35840
    v_mfma_f32_16x16x32_bf16 v[40:43], v[148:151], v[140:143], v[40:43]
    ds_read_b64_tr_b16 v[120:121], v9 offset:34816
    v_mfma_f32_16x16x32_bf16 v[44:47], v[148:151], v[144:147], v[44:47]
    ds_read_b64_tr_b16 v[122:123], v9 offset:37120
    v_mfma_f32_16x16x32_bf16 v[48:51], v[152:155], v[140:143], v[48:51]
    ds_read_b64_tr_b16 v[124:125], v9 offset:34848
    v_mfma_f32_16x16x32_bf16 v[52:55], v[152:155], v[144:147], v[52:55]
    ds_read_b64_tr_b16 v[126:127], v9 offset:37152
    v_mfma_f32_16x16x32_bf16 v[56:59], v[156:159], v[140:143], v[56:59]
    ds_read_b64_tr_b16 v[128:129], v9 offset:34880
    v_mfma_f32_16x16x32_bf16 v[60:63], v[156:159], v[144:147], v[60:63]
    ds_read_b64_tr_b16 v[130:131], v9 offset:37184
    v_mfma_f32_16x16x32_bf16 v[64:67], v[160:163], v[140:143], v[64:67]
    ds_read_b64_tr_b16 v[132:133], v9 offset:34912
    v_mfma_f32_16x16x32_bf16 v[68:71], v[160:163], v[144:147], v[68:71]
    ds_read_b64_tr_b16 v[134:135], v9 offset:37216
    v_mfma_f32_16x16x32_bf16 v[72:75], v[164:167], v[140:143], v[72:75]
    ds_read_b64_tr_b16 v[136:137], v9 offset:34944
    v_mfma_f32_16x16x32_bf16 v[76:79], v[164:167], v[144:147], v[76:79]
    ds_read_b64_tr_b16 v[138:139], v9 offset:37248
    s_barrier
    s_waitcnt lgkmcnt(0)
    ds_read_b128 v[140:143], v4 offset:36864
    ds_read_b128 v[144:147], v4 offset:37888
    v_mfma_f32_16x16x32_bf16 v[40:43], v[120:123], v[112:115], v[40:43]
    ds_read_b64_tr_b16 v[148:149], v5 offset:36864
    v_mfma_f32_16x16x32_bf16 v[44:47], v[120:123], v[116:119], v[44:47]
    ds_read_b64_tr_b16 v[150:151], v5 offset:39168
    v_mfma_f32_16x16x32_bf16 v[48:51], v[124:127], v[112:115], v[48:51]
    ds_read_b64_tr_b16 v[152:153], v5 offset:36896
    v_mfma_f32_16x16x32_bf16 v[52:55], v[124:127], v[116:119], v[52:55]
    ds_read_b64_tr_b16 v[154:155], v5 offset:39200
    v_mfma_f32_16x16x32_bf16 v[56:59], v[128:131], v[112:115], v[56:59]
    ds_read_b64_tr_b16 v[156:157], v5 offset:36928
    v_mfma_f32_16x16x32_bf16 v[60:63], v[128:131], v[116:119], v[60:63]
    ds_read_b64_tr_b16 v[158:159], v5 offset:39232
    v_mfma_f32_16x16x32_bf16 v[64:67], v[132:135], v[112:115], v[64:67]
    ds_read_b64_tr_b16 v[160:161], v5 offset:36960
    v_mfma_f32_16x16x32_bf16 v[68:71], v[132:135], v[116:119], v[68:71]
    ds_read_b64_tr_b16 v[162:163], v5 offset:39264
    v_mfma_f32_16x16x32_bf16 v[72:75], v[136:139], v[112:115], v[72:75]
    ds_read_b64_tr_b16 v[164:165], v5 offset:36992
    v_mfma_f32_16x16x32_bf16 v[76:79], v[136:139], v[116:119], v[76:79]
    ds_read_b64_tr_b16 v[166:167], v5 offset:39296
    s_barrier
    s_waitcnt lgkmcnt(0)
    ds_read_b128 v[112:115], v6 offset:0
    ds_read_b128 v[116:119], v6 offset:1024
    v_mfma_f32_16x16x32_bf16 v[40:43], v[148:151], v[140:143], v[40:43]
    ds_read_b64_tr_b16 v[120:121], v8 offset:0
    v_mfma_f32_16x16x32_bf16 v[44:47], v[148:151], v[144:147], v[44:47]
    ds_read_b64_tr_b16 v[122:123], v8 offset:2304
    v_mfma_f32_16x16x32_bf16 v[48:51], v[152:155], v[140:143], v[48:51]
    ds_read_b64_tr_b16 v[124:125], v8 offset:32
    v_mfma_f32_16x16x32_bf16 v[52:55], v[152:155], v[144:147], v[52:55]
    ds_read_b64_tr_b16 v[126:127], v8 offset:2336
    v_mfma_f32_16x16x32_bf16 v[56:59], v[156:159], v[140:143], v[56:59]
    ds_read_b64_tr_b16 v[128:129], v8 offset:64
    v_mfma_f32_16x16x32_bf16 v[60:63], v[156:159], v[144:147], v[60:63]
    ds_read_b64_tr_b16 v[130:131], v8 offset:2368
    v_mfma_f32_16x16x32_bf16 v[64:67], v[160:163], v[140:143], v[64:67]
    ds_read_b64_tr_b16 v[132:133], v8 offset:96
    v_mfma_f32_16x16x32_bf16 v[68:71], v[160:163], v[144:147], v[68:71]
    ds_read_b64_tr_b16 v[134:135], v8 offset:2400
    v_mfma_f32_16x16x32_bf16 v[72:75], v[164:167], v[140:143], v[72:75]
    ds_read_b64_tr_b16 v[136:137], v8 offset:128
    v_mfma_f32_16x16x32_bf16 v[76:79], v[164:167], v[144:147], v[76:79]
    ds_read_b64_tr_b16 v[138:139], v8 offset:2432
    s_barrier
    s_waitcnt lgkmcnt(0)
    ds_read_b128 v[140:143], v6 offset:17408
    ds_read_b128 v[144:147], v6 offset:18432
    v_mfma_f32_16x16x32_bf16 v[40:43], v[120:123], v[112:115], v[40:43]
    ds_read_b64_tr_b16 v[148:149], v8 offset:17408
    v_mfma_f32_16x16x32_bf16 v[44:47], v[120:123], v[116:119], v[44:47]
    ds_read_b64_tr_b16 v[150:151], v8 offset:19712
    v_mfma_f32_16x16x32_bf16 v[48:51], v[124:127], v[112:115], v[48:51]
    ds_read_b64_tr_b16 v[152:153], v8 offset:17440
    v_mfma_f32_16x16x32_bf16 v[52:55], v[124:127], v[116:119], v[52:55]
    ds_read_b64_tr_b16 v[154:155], v8 offset:19744
    v_mfma_f32_16x16x32_bf16 v[56:59], v[128:131], v[112:115], v[56:59]
    ds_read_b64_tr_b16 v[156:157], v8 offset:17472
    v_mfma_f32_16x16x32_bf16 v[60:63], v[128:131], v[116:119], v[60:63]
    ds_read_b64_tr_b16 v[158:159], v8 offset:19776
    v_mfma_f32_16x16x32_bf16 v[64:67], v[132:135], v[112:115], v[64:67]
    ds_read_b64_tr_b16 v[160:161], v8 offset:17504
    v_mfma_f32_16x16x32_bf16 v[68:71], v[132:135], v[116:119], v[68:71]
    ds_read_b64_tr_b16 v[162:163], v8 offset:19808
    v_mfma_f32_16x16x32_bf16 v[72:75], v[136:139], v[112:115], v[72:75]
    ds_read_b64_tr_b16 v[164:165], v8 offset:17536
    v_mfma_f32_16x16x32_bf16 v[76:79], v[136:139], v[116:119], v[76:79]
    ds_read_b64_tr_b16 v[166:167], v8 offset:19840
    s_barrier
    s_waitcnt lgkmcnt(0)
    ds_read_b128 v[112:115], v6 offset:34816
    ds_read_b128 v[116:119], v6 offset:35840
    v_mfma_f32_16x16x32_bf16 v[40:43], v[148:151], v[140:143], v[40:43]
    ds_read_b64_tr_b16 v[120:121], v8 offset:34816
    v_mfma_f32_16x16x32_bf16 v[44:47], v[148:151], v[144:147], v[44:47]
    ds_read_b64_tr_b16 v[122:123], v8 offset:37120
    v_mfma_f32_16x16x32_bf16 v[48:51], v[152:155], v[140:143], v[48:51]
    ds_read_b64_tr_b16 v[124:125], v8 offset:34848
    v_mfma_f32_16x16x32_bf16 v[52:55], v[152:155], v[144:147], v[52:55]
    ds_read_b64_tr_b16 v[126:127], v8 offset:37152
    v_mfma_f32_16x16x32_bf16 v[56:59], v[156:159], v[140:143], v[56:59]
    ds_read_b64_tr_b16 v[128:129], v8 offset:34880
    v_mfma_f32_16x16x32_bf16 v[60:63], v[156:159], v[144:147], v[60:63]
    ds_read_b64_tr_b16 v[130:131], v8 offset:37184
    v_mfma_f32_16x16x32_bf16 v[64:67], v[160:163], v[140:143], v[64:67]
    ds_read_b64_tr_b16 v[132:133], v8 offset:34912
    v_mfma_f32_16x16x32_bf16 v[68:71], v[160:163], v[144:147], v[68:71]
    ds_read_b64_tr_b16 v[134:135], v8 offset:37216
    v_mfma_f32_16x16x32_bf16 v[72:75], v[164:167], v[140:143], v[72:75]
    ds_read_b64_tr_b16 v[136:137], v8 offset:34944
    v_mfma_f32_16x16x32_bf16 v[76:79], v[164:167], v[144:147], v[76:79]
    ds_read_b64_tr_b16 v[138:139], v8 offset:37248
    s_barrier
    s_waitcnt lgkmcnt(0)
    ds_read_b128 v[140:143], v4 offset:0
    ds_read_b128 v[144:147], v4 offset:1024
    v_mfma_f32_16x16x32_bf16 v[40:43], v[120:123], v[112:115], v[40:43]
    ds_read_b64_tr_b16 v[148:149], v5 offset:0
    v_mfma_f32_16x16x32_bf16 v[44:47], v[120:123], v[116:119], v[44:47]
    ds_read_b64_tr_b16 v[150:151], v5 offset:2304
    v_mfma_f32_16x16x32_bf16 v[48:51], v[124:127], v[112:115], v[48:51]
    ds_read_b64_tr_b16 v[152:153], v5 offset:32
    v_mfma_f32_16x16x32_bf16 v[52:55], v[124:127], v[116:119], v[52:55]
    ds_read_b64_tr_b16 v[154:155], v5 offset:2336
    v_mfma_f32_16x16x32_bf16 v[56:59], v[128:131], v[112:115], v[56:59]
    ds_read_b64_tr_b16 v[156:157], v5 offset:64
    v_mfma_f32_16x16x32_bf16 v[60:63], v[128:131], v[116:119], v[60:63]
    ds_read_b64_tr_b16 v[158:159], v5 offset:2368
    v_mfma_f32_16x16x32_bf16 v[64:67], v[132:135], v[112:115], v[64:67]
    ds_read_b64_tr_b16 v[160:161], v5 offset:96
    v_mfma_f32_16x16x32_bf16 v[68:71], v[132:135], v[116:119], v[68:71]
    ds_read_b64_tr_b16 v[162:163], v5 offset:2400
    v_mfma_f32_16x16x32_bf16 v[72:75], v[136:139], v[112:115], v[72:75]
    ds_read_b64_tr_b16 v[164:165], v5 offset:128
    v_mfma_f32_16x16x32_bf16 v[76:79], v[136:139], v[116:119], v[76:79]
    ds_read_b64_tr_b16 v[166:167], v5 offset:2432
    s_barrier
    s_waitcnt lgkmcnt(0)
    ds_read_b128 v[112:115], v4 offset:17408
    ds_read_b128 v[116:119], v4 offset:18432
    v_mfma_f32_16x16x32_bf16 v[40:43], v[148:151], v[140:143], v[40:43]
    ds_read_b64_tr_b16 v[120:121], v5 offset:17408
    v_mfma_f32_16x16x32_bf16 v[44:47], v[148:151], v[144:147], v[44:47]
    ds_read_b64_tr_b16 v[122:123], v5 offset:19712
    v_mfma_f32_16x16x32_bf16 v[48:51], v[152:155], v[140:143], v[48:51]
    ds_read_b64_tr_b16 v[124:125], v5 offset:17440
    v_mfma_f32_16x16x32_bf16 v[52:55], v[152:155], v[144:147], v[52:55]
    ds_read_b64_tr_b16 v[126:127], v5 offset:19744
    v_mfma_f32_16x16x32_bf16 v[56:59], v[156:159], v[140:143], v[56:59]
    ds_read_b64_tr_b16 v[128:129], v5 offset:17472
    v_mfma_f32_16x16x32_bf16 v[60:63], v[156:159], v[144:147], v[60:63]
    ds_read_b64_tr_b16 v[130:131], v5 offset:19776
    v_mfma_f32_16x16x32_bf16 v[64:67], v[160:163], v[140:143], v[64:67]
    ds_read_b64_tr_b16 v[132:133], v5 offset:17504
    v_mfma_f32_16x16x32_bf16 v[68:71], v[160:163], v[144:147], v[68:71]
    ds_read_b64_tr_b16 v[134:135], v5 offset:19808
    v_mfma_f32_16x16x32_bf16 v[72:75], v[164:167], v[140:143], v[72:75]
    ds_read_b64_tr_b16 v[136:137], v5 offset:17536
    v_mfma_f32_16x16x32_bf16 v[76:79], v[164:167], v[144:147], v[76:79]
    ds_read_b64_tr_b16 v[138:139], v5 offset:19840
    s_barrier
    s_waitcnt lgkmcnt(0)
    ds_read_b128 v[140:143], v7 offset:0
    ds_read_b128 v[144:147], v7 offset:1024
    v_mfma_f32_16x16x32_bf16 v[40:43], v[120:123], v[112:115], v[40:43]
    ds_read_b64_tr_b16 v[148:149], v9 offset:0
    v_mfma_f32_16x16x32_bf16 v[44:47], v[120:123], v[116:119], v[44:47]
    ds_read_b64_tr_b16 v[150:151], v9 offset:2304
    v_mfma_f32_16x16x32_bf16 v[48:51], v[124:127], v[112:115], v[48:51]
    ds_read_b64_tr_b16 v[152:153], v9 offset:32
    v_mfma_f32_16x16x32_bf16 v[52:55], v[124:127], v[116:119], v[52:55]
    ds_read_b64_tr_b16 v[154:155], v9 offset:2336
    v_mfma_f32_16x16x32_bf16 v[56:59], v[128:131], v[112:115], v[56:59]
    ds_read_b64_tr_b16 v[156:157], v9 offset:64
    v_mfma_f32_16x16x32_bf16 v[60:63], v[128:131], v[116:119], v[60:63]
    ds_read_b64_tr_b16 v[158:159], v9 offset:2368
    v_mfma_f32_16x16x32_bf16 v[64:67], v[132:135], v[112:115], v[64:67]
    ds_read_b64_tr_b16 v[160:161], v9 offset:96
    v_mfma_f32_16x16x32_bf16 v[68:71], v[132:135], v[116:119], v[68:71]
    ds_read_b64_tr_b16 v[162:163], v9 offset:2400
    v_mfma_f32_16x16x32_bf16 v[72:75], v[136:139], v[112:115], v[72:75]
    ds_read_b64_tr_b16 v[164:165], v9 offset:128
    v_mfma_f32_16x16x32_bf16 v[76:79], v[136:139], v[116:119], v[76:79]
    ds_read_b64_tr_b16 v[166:167], v9 offset:2432
    s_barrier
    s_waitcnt lgkmcnt(0)
    ds_read_b128 v[112:115], v7 offset:17408
    ds_read_b128 v[116:119], v7 offset:18432
    v_mfma_f32_16x16x32_bf16 v[40:43], v[148:151], v[140:143], v[40:43]
    ds_read_b64_tr_b16 v[120:121], v9 offset:17408
    v_mfma_f32_16x16x32_bf16 v[44:47], v[148:151], v[144:147], v[44:47]
    ds_read_b64_tr_b16 v[122:123], v9 offset:19712
    v_mfma_f32_16x16x32_bf16 v[48:51], v[152:155], v[140:143], v[48:51]
    ds_read_b64_tr_b16 v[124:125], v9 offset:17440
    v_mfma_f32_16x16x32_bf16 v[52:55], v[152:155], v[144:147], v[52:55]
    ds_read_b64_tr_b16 v[126:127], v9 offset:19744
    v_mfma_f32_16x16x32_bf16 v[56:59], v[156:159], v[140:143], v[56:59]
    ds_read_b64_tr_b16 v[128:129], v9 offset:17472
    v_mfma_f32_16x16x32_bf16 v[60:63], v[156:159], v[144:147], v[60:63]
    ds_read_b64_tr_b16 v[130:131], v9 offset:19776
    v_mfma_f32_16x16x32_bf16 v[64:67], v[160:163], v[140:143], v[64:67]
    ds_read_b64_tr_b16 v[132:133], v9 offset:17504
    v_mfma_f32_16x16x32_bf16 v[68:71], v[160:163], v[144:147], v[68:71]
    ds_read_b64_tr_b16 v[134:135], v9 offset:19808
    v_mfma_f32_16x16x32_bf16 v[72:75], v[164:167], v[140:143], v[72:75]
    ds_read_b64_tr_b16 v[136:137], v9 offset:17536
    v_mfma_f32_16x16x32_bf16 v[76:79], v[164:167], v[144:147], v[76:79]
    ds_read_b64_tr_b16 v[138:139], v9 offset:19840
    s_barrier
    s_waitcnt lgkmcnt(0)
    ds_read_b128 v[140:143], v7 offset:34816
    ds_read_b128 v[144:147], v7 offset:35840
    v_mfma_f32_16x16x32_bf16 v[40:43], v[120:123], v[112:115], v[40:43]
    ds_read_b64_tr_b16 v[148:149], v9 offset:34816
    v_mfma_f32_16x16x32_bf16 v[44:47], v[120:123], v[116:119], v[44:47]
    ds_read_b64_tr_b16 v[150:151], v9 offset:37120
    v_mfma_f32_16x16x32_bf16 v[48:51], v[124:127], v[112:115], v[48:51]
    ds_read_b64_tr_b16 v[152:153], v9 offset:34848
    v_mfma_f32_16x16x32_bf16 v[52:55], v[124:127], v[116:119], v[52:55]
    ds_read_b64_tr_b16 v[154:155], v9 offset:37152
    v_mfma_f32_16x16x32_bf16 v[56:59], v[128:131], v[112:115], v[56:59]
    ds_read_b64_tr_b16 v[156:157], v9 offset:34880
    v_mfma_f32_16x16x32_bf16 v[60:63], v[128:131], v[116:119], v[60:63]
    ds_read_b64_tr_b16 v[158:159], v9 offset:37184
    v_mfma_f32_16x16x32_bf16 v[64:67], v[132:135], v[112:115], v[64:67]
    ds_read_b64_tr_b16 v[160:161], v9 offset:34912
    v_mfma_f32_16x16x32_bf16 v[68:71], v[132:135], v[116:119], v[68:71]
    ds_read_b64_tr_b16 v[162:163], v9 offset:37216
    v_mfma_f32_16x16x32_bf16 v[72:75], v[136:139], v[112:115], v[72:75]
    ds_read_b64_tr_b16 v[164:165], v9 offset:34944
    v_mfma_f32_16x16x32_bf16 v[76:79], v[136:139], v[116:119], v[76:79]
    ds_read_b64_tr_b16 v[166:167], v9 offset:37248
    s_barrier
    s_waitcnt lgkmcnt(0)
    ds_read_b128 v[112:115], v4 offset:36864
    ds_read_b128 v[116:119], v4 offset:37888
    v_mfma_f32_16x16x32_bf16 v[40:43], v[148:151], v[140:143], v[40:43]
    ds_read_b64_tr_b16 v[120:121], v5 offset:36864
    v_mfma_f32_16x16x32_bf16 v[44:47], v[148:151], v[144:147], v[44:47]
    ds_read_b64_tr_b16 v[122:123], v5 offset:39168
    v_mfma_f32_16x16x32_bf16 v[48:51], v[152:155], v[140:143], v[48:51]
    ds_read_b64_tr_b16 v[124:125], v5 offset:36896
    v_mfma_f32_16x16x32_bf16 v[52:55], v[152:155], v[144:147], v[52:55]
    ds_read_b64_tr_b16 v[126:127], v5 offset:39200
    v_mfma_f32_16x16x32_bf16 v[56:59], v[156:159], v[140:143], v[56:59]
    ds_read_b64_tr_b16 v[128:129], v5 offset:36928
    v_mfma_f32_16x16x32_bf16 v[60:63], v[156:159], v[144:147], v[60:63]
    ds_read_b64_tr_b16 v[130:131], v5 offset:39232
    v_mfma_f32_16x16x32_bf16 v[64:67], v[160:163], v[140:143], v[64:67]
    ds_read_b64_tr_b16 v[132:133], v5 offset:36960
    v_mfma_f32_16x16x32_bf16 v[68:71], v[160:163], v[144:147], v[68:71]
    ds_read_b64_tr_b16 v[134:135], v5 offset:39264
    v_mfma_f32_16x16x32_bf16 v[72:75], v[164:167], v[140:143], v[72:75]
    ds_read_b64_tr_b16 v[136:137], v5 offset:36992
    v_mfma_f32_16x16x32_bf16 v[76:79], v[164:167], v[144:147], v[76:79]
    ds_read_b64_tr_b16 v[138:139], v5 offset:39296
    s_barrier
    s_waitcnt lgkmcnt(0)
    ds_read_b128 v[140:143], v6 offset:0
    ds_read_b128 v[144:147], v6 offset:1024
    v_mfma_f32_16x16x32_bf16 v[40:43], v[120:123], v[112:115], v[40:43]
    ds_read_b64_tr_b16 v[148:149], v8 offset:0
    v_mfma_f32_16x16x32_bf16 v[44:47], v[120:123], v[116:119], v[44:47]
    ds_read_b64_tr_b16 v[150:151], v8 offset:2304
    v_mfma_f32_16x16x32_bf16 v[48:51], v[124:127], v[112:115], v[48:51]
    ds_read_b64_tr_b16 v[152:153], v8 offset:32
    v_mfma_f32_16x16x32_bf16 v[52:55], v[124:127], v[116:119], v[52:55]
    ds_read_b64_tr_b16 v[154:155], v8 offset:2336
    v_mfma_f32_16x16x32_bf16 v[56:59], v[128:131], v[112:115], v[56:59]
    ds_read_b64_tr_b16 v[156:157], v8 offset:64
    v_mfma_f32_16x16x32_bf16 v[60:63], v[128:131], v[116:119], v[60:63]
    ds_read_b64_tr_b16 v[158:159], v8 offset:2368
    v_mfma_f32_16x16x32_bf16 v[64:67], v[132:135], v[112:115], v[64:67]
    ds_read_b64_tr_b16 v[160:161], v8 offset:96
    v_mfma_f32_16x16x32_bf16 v[68:71], v[132:135], v[116:119], v[68:71]
    ds_read_b64_tr_b16 v[162:163], v8 offset:2400
    v_mfma_f32_16x16x32_bf16 v[72:75], v[136:139], v[112:115], v[72:75]
    ds_read_b64_tr_b16 v[164:165], v8 offset:128
    v_mfma_f32_16x16x32_bf16 v[76:79], v[136:139], v[116:119], v[76:79]
    ds_read_b64_tr_b16 v[166:167], v8 offset:2432
    s_barrier
    s_waitcnt lgkmcnt(0)
    ds_read_b128 v[112:115], v6 offset:17408
    ds_read_b128 v[116:119], v6 offset:18432
    v_mfma_f32_16x16x32_bf16 v[40:43], v[148:151], v[140:143], v[40:43]
    ds_read_b64_tr_b16 v[120:121], v8 offset:17408
    v_mfma_f32_16x16x32_bf16 v[44:47], v[148:151], v[144:147], v[44:47]
    ds_read_b64_tr_b16 v[122:123], v8 offset:19712
    v_mfma_f32_16x16x32_bf16 v[48:51], v[152:155], v[140:143], v[48:51]
    ds_read_b64_tr_b16 v[124:125], v8 offset:17440
    v_mfma_f32_16x16x32_bf16 v[52:55], v[152:155], v[144:147], v[52:55]
    ds_read_b64_tr_b16 v[126:127], v8 offset:19744
    v_mfma_f32_16x16x32_bf16 v[56:59], v[156:159], v[140:143], v[56:59]
    ds_read_b64_tr_b16 v[128:129], v8 offset:17472
    v_mfma_f32_16x16x32_bf16 v[60:63], v[156:159], v[144:147], v[60:63]
    ds_read_b64_tr_b16 v[130:131], v8 offset:19776
    v_mfma_f32_16x16x32_bf16 v[64:67], v[160:163], v[140:143], v[64:67]
    ds_read_b64_tr_b16 v[132:133], v8 offset:17504
    v_mfma_f32_16x16x32_bf16 v[68:71], v[160:163], v[144:147], v[68:71]
    ds_read_b64_tr_b16 v[134:135], v8 offset:19808
    v_mfma_f32_16x16x32_bf16 v[72:75], v[164:167], v[140:143], v[72:75]
    ds_read_b64_tr_b16 v[136:137], v8 offset:17536
    v_mfma_f32_16x16x32_bf16 v[76:79], v[164:167], v[144:147], v[76:79]
    ds_read_b64_tr_b16 v[138:139], v8 offset:19840
    s_barrier
    s_waitcnt lgkmcnt(0)
    ds_read_b128 v[140:143], v6 offset:34816
    ds_read_b128 v[144:147], v6 offset:35840
    v_mfma_f32_16x16x32_bf16 v[40:43], v[120:123], v[112:115], v[40:43]
    ds_read_b64_tr_b16 v[148:149], v8 offset:34816
    v_mfma_f32_16x16x32_bf16 v[44:47], v[120:123], v[116:119], v[44:47]
    ds_read_b64_tr_b16 v[150:151], v8 offset:37120
    v_mfma_f32_16x16x32_bf16 v[48:51], v[124:127], v[112:115], v[48:51]
    ds_read_b64_tr_b16 v[152:153], v8 offset:34848
    v_mfma_f32_16x16x32_bf16 v[52:55], v[124:127], v[116:119], v[52:55]
    ds_read_b64_tr_b16 v[154:155], v8 offset:37152
    v_mfma_f32_16x16x32_bf16 v[56:59], v[128:131], v[112:115], v[56:59]
    ds_read_b64_tr_b16 v[156:157], v8 offset:34880
    v_mfma_f32_16x16x32_bf16 v[60:63], v[128:131], v[116:119], v[60:63]
    ds_read_b64_tr_b16 v[158:159], v8 offset:37184
    v_mfma_f32_16x16x32_bf16 v[64:67], v[132:135], v[112:115], v[64:67]
    ds_read_b64_tr_b16 v[160:161], v8 offset:34912
    v_mfma_f32_16x16x32_bf16 v[68:71], v[132:135], v[116:119], v[68:71]
    ds_read_b64_tr_b16 v[162:163], v8 offset:37216
    v_mfma_f32_16x16x32_bf16 v[72:75], v[136:139], v[112:115], v[72:75]
    ds_read_b64_tr_b16 v[164:165], v8 offset:34944
    v_mfma_f32_16x16x32_bf16 v[76:79], v[136:139], v[116:119], v[76:79]
    ds_read_b64_tr_b16 v[166:167], v8 offset:37248
    s_barrier
    s_waitcnt lgkmcnt(0)
    ds_read_b128 v[112:115], v4 offset:0
    ds_read_b128 v[116:119], v4 offset:1024
    v_mfma_f32_16x16x32_bf16 v[40:43], v[148:151], v[140:143], v[40:43]
    ds_read_b64_tr_b16 v[120:121], v5 offset:0
    v_mfma_f32_16x16x32_bf16 v[44:47], v[148:151], v[144:147], v[44:47]
    ds_read_b64_tr_b16 v[122:123], v5 offset:2304
    v_mfma_f32_16x16x32_bf16 v[48:51], v[152:155], v[140:143], v[48:51]
    ds_read_b64_tr_b16 v[124:125], v5 offset:32
    v_mfma_f32_16x16x32_bf16 v[52:55], v[152:155], v[144:147], v[52:55]
    ds_read_b64_tr_b16 v[126:127], v5 offset:2336
    v_mfma_f32_16x16x32_bf16 v[56:59], v[156:159], v[140:143], v[56:59]
    ds_read_b64_tr_b16 v[128:129], v5 offset:64
    v_mfma_f32_16x16x32_bf16 v[60:63], v[156:159], v[144:147], v[60:63]
    ds_read_b64_tr_b16 v[130:131], v5 offset:2368
    v_mfma_f32_16x16x32_bf16 v[64:67], v[160:163], v[140:143], v[64:67]
    ds_read_b64_tr_b16 v[132:133], v5 offset:96
    v_mfma_f32_16x16x32_bf16 v[68:71], v[160:163], v[144:147], v[68:71]
    ds_read_b64_tr_b16 v[134:135], v5 offset:2400
    v_mfma_f32_16x16x32_bf16 v[72:75], v[164:167], v[140:143], v[72:75]
    ds_read_b64_tr_b16 v[136:137], v5 offset:128
    v_mfma_f32_16x16x32_bf16 v[76:79], v[164:167], v[144:147], v[76:79]
    ds_read_b64_tr_b16 v[138:139], v5 offset:2432
    s_barrier
    s_waitcnt lgkmcnt(0)
    ds_read_b128 v[140:143], v4 offset:17408
    ds_read_b128 v[144:147], v4 offset:18432
    v_mfma_f32_16x16x32_bf16 v[40:43], v[120:123], v[112:115], v[40:43]
    ds_read_b64_tr_b16 v[148:149], v5 offset:17408
    v_mfma_f32_16x16x32_bf16 v[44:47], v[120:123], v[116:119], v[44:47]
    ds_read_b64_tr_b16 v[150:151], v5 offset:19712
    v_mfma_f32_16x16x32_bf16 v[48:51], v[124:127], v[112:115], v[48:51]
    ds_read_b64_tr_b16 v[152:153], v5 offset:17440
    v_mfma_f32_16x16x32_bf16 v[52:55], v[124:127], v[116:119], v[52:55]
    ds_read_b64_tr_b16 v[154:155], v5 offset:19744
    v_mfma_f32_16x16x32_bf16 v[56:59], v[128:131], v[112:115], v[56:59]
    ds_read_b64_tr_b16 v[156:157], v5 offset:17472
    v_mfma_f32_16x16x32_bf16 v[60:63], v[128:131], v[116:119], v[60:63]
    ds_read_b64_tr_b16 v[158:159], v5 offset:19776
    v_mfma_f32_16x16x32_bf16 v[64:67], v[132:135], v[112:115], v[64:67]
    ds_read_b64_tr_b16 v[160:161], v5 offset:17504
    v_mfma_f32_16x16x32_bf16 v[68:71], v[132:135], v[116:119], v[68:71]
    ds_read_b64_tr_b16 v[162:163], v5 offset:19808
    v_mfma_f32_16x16x32_bf16 v[72:75], v[136:139], v[112:115], v[72:75]
    ds_read_b64_tr_b16 v[164:165], v5 offset:17536
    v_mfma_f32_16x16x32_bf16 v[76:79], v[136:139], v[116:119], v[76:79]
    ds_read_b64_tr_b16 v[166:167], v5 offset:19840
    s_barrier
    s_waitcnt lgkmcnt(0)
    ds_read_b128 v[112:115], v7 offset:0
    ds_read_b128 v[116:119], v7 offset:1024
    v_mfma_f32_16x16x32_bf16 v[40:43], v[148:151], v[140:143], v[40:43]
    ds_read_b64_tr_b16 v[120:121], v9 offset:0
    v_mfma_f32_16x16x32_bf16 v[44:47], v[148:151], v[144:147], v[44:47]
    ds_read_b64_tr_b16 v[122:123], v9 offset:2304
    v_mfma_f32_16x16x32_bf16 v[48:51], v[152:155], v[140:143], v[48:51]
    ds_read_b64_tr_b16 v[124:125], v9 offset:32
    v_mfma_f32_16x16x32_bf16 v[52:55], v[152:155], v[144:147], v[52:55]
    ds_read_b64_tr_b16 v[126:127], v9 offset:2336
    v_mfma_f32_16x16x32_bf16 v[56:59], v[156:159], v[140:143], v[56:59]
    ds_read_b64_tr_b16 v[128:129], v9 offset:64
    v_mfma_f32_16x16x32_bf16 v[60:63], v[156:159], v[144:147], v[60:63]
    ds_read_b64_tr_b16 v[130:131], v9 offset:2368
    v_mfma_f32_16x16x32_bf16 v[64:67], v[160:163], v[140:143], v[64:67]
    ds_read_b64_tr_b16 v[132:133], v9 offset:96
    v_mfma_f32_16x16x32_bf16 v[68:71], v[160:163], v[144:147], v[68:71]
    ds_read_b64_tr_b16 v[134:135], v9 offset:2400
    v_mfma_f32_16x16x32_bf16 v[72:75], v[164:167], v[140:143], v[72:75]
    ds_read_b64_tr_b16 v[136:137], v9 offset:128
    v_mfma_f32_16x16x32_bf16 v[76:79], v[164:167], v[144:147], v[76:79]
    ds_read_b64_tr_b16 v[138:139], v9 offset:2432
    s_barrier
    s_waitcnt lgkmcnt(0)
    ds_read_b128 v[140:143], v7 offset:17408
    ds_read_b128 v[144:147], v7 offset:18432
    v_mfma_f32_16x16x32_bf16 v[40:43], v[120:123], v[112:115], v[40:43]
    ds_read_b64_tr_b16 v[148:149], v9 offset:17408
    v_mfma_f32_16x16x32_bf16 v[44:47], v[120:123], v[116:119], v[44:47]
    ds_read_b64_tr_b16 v[150:151], v9 offset:19712
    v_mfma_f32_16x16x32_bf16 v[48:51], v[124:127], v[112:115], v[48:51]
    ds_read_b64_tr_b16 v[152:153], v9 offset:17440
    v_mfma_f32_16x16x32_bf16 v[52:55], v[124:127], v[116:119], v[52:55]
    ds_read_b64_tr_b16 v[154:155], v9 offset:19744
    v_mfma_f32_16x16x32_bf16 v[56:59], v[128:131], v[112:115], v[56:59]
    ds_read_b64_tr_b16 v[156:157], v9 offset:17472
    v_mfma_f32_16x16x32_bf16 v[60:63], v[128:131], v[116:119], v[60:63]
    ds_read_b64_tr_b16 v[158:159], v9 offset:19776
    v_mfma_f32_16x16x32_bf16 v[64:67], v[132:135], v[112:115], v[64:67]
    ds_read_b64_tr_b16 v[160:161], v9 offset:17504
    v_mfma_f32_16x16x32_bf16 v[68:71], v[132:135], v[116:119], v[68:71]
    ds_read_b64_tr_b16 v[162:163], v9 offset:19808
    v_mfma_f32_16x16x32_bf16 v[72:75], v[136:139], v[112:115], v[72:75]
    ds_read_b64_tr_b16 v[164:165], v9 offset:17536
    v_mfma_f32_16x16x32_bf16 v[76:79], v[136:139], v[116:119], v[76:79]
    ds_read_b64_tr_b16 v[166:167], v9 offset:19840
    s_barrier
    s_waitcnt lgkmcnt(0)
    ds_read_b128 v[112:115], v7 offset:34816
    ds_read_b128 v[116:119], v7 offset:35840
    v_mfma_f32_16x16x32_bf16 v[40:43], v[148:151], v[140:143], v[40:43]
    ds_read_b64_tr_b16 v[120:121], v9 offset:34816
    v_mfma_f32_16x16x32_bf16 v[44:47], v[148:151], v[144:147], v[44:47]
    ds_read_b64_tr_b16 v[122:123], v9 offset:37120
    v_mfma_f32_16x16x32_bf16 v[48:51], v[152:155], v[140:143], v[48:51]
    ds_read_b64_tr_b16 v[124:125], v9 offset:34848
    v_mfma_f32_16x16x32_bf16 v[52:55], v[152:155], v[144:147], v[52:55]
    ds_read_b64_tr_b16 v[126:127], v9 offset:37152
    v_mfma_f32_16x16x32_bf16 v[56:59], v[156:159], v[140:143], v[56:59]
    ds_read_b64_tr_b16 v[128:129], v9 offset:34880
    v_mfma_f32_16x16x32_bf16 v[60:63], v[156:159], v[144:147], v[60:63]
    ds_read_b64_tr_b16 v[130:131], v9 offset:37184
    v_mfma_f32_16x16x32_bf16 v[64:67], v[160:163], v[140:143], v[64:67]
    ds_read_b64_tr_b16 v[132:133], v9 offset:34912
    v_mfma_f32_16x16x32_bf16 v[68:71], v[160:163], v[144:147], v[68:71]
    ds_read_b64_tr_b16 v[134:135], v9 offset:37216
    v_mfma_f32_16x16x32_bf16 v[72:75], v[164:167], v[140:143], v[72:75]
    ds_read_b64_tr_b16 v[136:137], v9 offset:34944
    v_mfma_f32_16x16x32_bf16 v[76:79], v[164:167], v[144:147], v[76:79]
    ds_read_b64_tr_b16 v[138:139], v9 offset:37248
    s_barrier
    s_waitcnt lgkmcnt(0)
    ds_read_b128 v[140:143], v4 offset:36864
    ds_read_b128 v[144:147], v4 offset:37888
    v_mfma_f32_16x16x32_bf16 v[40:43], v[120:123], v[112:115], v[40:43]
    ds_read_b64_tr_b16 v[148:149], v5 offset:36864
    v_mfma_f32_16x16x32_bf16 v[44:47], v[120:123], v[116:119], v[44:47]
    ds_read_b64_tr_b16 v[150:151], v5 offset:39168
    v_mfma_f32_16x16x32_bf16 v[48:51], v[124:127], v[112:115], v[48:51]
    ds_read_b64_tr_b16 v[152:153], v5 offset:36896
    v_mfma_f32_16x16x32_bf16 v[52:55], v[124:127], v[116:119], v[52:55]
    ds_read_b64_tr_b16 v[154:155], v5 offset:39200
    v_mfma_f32_16x16x32_bf16 v[56:59], v[128:131], v[112:115], v[56:59]
    ds_read_b64_tr_b16 v[156:157], v5 offset:36928
    v_mfma_f32_16x16x32_bf16 v[60:63], v[128:131], v[116:119], v[60:63]
    ds_read_b64_tr_b16 v[158:159], v5 offset:39232
    v_mfma_f32_16x16x32_bf16 v[64:67], v[132:135], v[112:115], v[64:67]
    ds_read_b64_tr_b16 v[160:161], v5 offset:36960
    v_mfma_f32_16x16x32_bf16 v[68:71], v[132:135], v[116:119], v[68:71]
    ds_read_b64_tr_b16 v[162:163], v5 offset:39264
    v_mfma_f32_16x16x32_bf16 v[72:75], v[136:139], v[112:115], v[72:75]
    ds_read_b64_tr_b16 v[164:165], v5 offset:36992
    v_mfma_f32_16x16x32_bf16 v[76:79], v[136:139], v[116:119], v[76:79]
    ds_read_b64_tr_b16 v[166:167], v5 offset:39296
    s_barrier
    s_waitcnt lgkmcnt(0)
    ds_read_b128 v[112:115], v6 offset:0
    ds_read_b128 v[116:119], v6 offset:1024
    v_mfma_f32_16x16x32_bf16 v[40:43], v[148:151], v[140:143], v[40:43]
    ds_read_b64_tr_b16 v[120:121], v8 offset:0
    v_mfma_f32_16x16x32_bf16 v[44:47], v[148:151], v[144:147], v[44:47]
    ds_read_b64_tr_b16 v[122:123], v8 offset:2304
    v_mfma_f32_16x16x32_bf16 v[48:51], v[152:155], v[140:143], v[48:51]
    ds_read_b64_tr_b16 v[124:125], v8 offset:32
    v_mfma_f32_16x16x32_bf16 v[52:55], v[152:155], v[144:147], v[52:55]
    ds_read_b64_tr_b16 v[126:127], v8 offset:2336
    v_mfma_f32_16x16x32_bf16 v[56:59], v[156:159], v[140:143], v[56:59]
    ds_read_b64_tr_b16 v[128:129], v8 offset:64
    v_mfma_f32_16x16x32_bf16 v[60:63], v[156:159], v[144:147], v[60:63]
    ds_read_b64_tr_b16 v[130:131], v8 offset:2368
    v_mfma_f32_16x16x32_bf16 v[64:67], v[160:163], v[140:143], v[64:67]
    ds_read_b64_tr_b16 v[132:133], v8 offset:96
    v_mfma_f32_16x16x32_bf16 v[68:71], v[160:163], v[144:147], v[68:71]
    ds_read_b64_tr_b16 v[134:135], v8 offset:2400
    v_mfma_f32_16x16x32_bf16 v[72:75], v[164:167], v[140:143], v[72:75]
    ds_read_b64_tr_b16 v[136:137], v8 offset:128
    v_mfma_f32_16x16x32_bf16 v[76:79], v[164:167], v[144:147], v[76:79]
    ds_read_b64_tr_b16 v[138:139], v8 offset:2432
    s_barrier
    s_waitcnt lgkmcnt(0)
    ds_read_b128 v[140:143], v6 offset:17408
    ds_read_b128 v[144:147], v6 offset:18432
    v_mfma_f32_16x16x32_bf16 v[40:43], v[120:123], v[112:115], v[40:43]
    ds_read_b64_tr_b16 v[148:149], v8 offset:17408
    v_mfma_f32_16x16x32_bf16 v[44:47], v[120:123], v[116:119], v[44:47]
    ds_read_b64_tr_b16 v[150:151], v8 offset:19712
    v_mfma_f32_16x16x32_bf16 v[48:51], v[124:127], v[112:115], v[48:51]
    ds_read_b64_tr_b16 v[152:153], v8 offset:17440
    v_mfma_f32_16x16x32_bf16 v[52:55], v[124:127], v[116:119], v[52:55]
    ds_read_b64_tr_b16 v[154:155], v8 offset:19744
    v_mfma_f32_16x16x32_bf16 v[56:59], v[128:131], v[112:115], v[56:59]
    ds_read_b64_tr_b16 v[156:157], v8 offset:17472
    v_mfma_f32_16x16x32_bf16 v[60:63], v[128:131], v[116:119], v[60:63]
    ds_read_b64_tr_b16 v[158:159], v8 offset:19776
    v_mfma_f32_16x16x32_bf16 v[64:67], v[132:135], v[112:115], v[64:67]
    ds_read_b64_tr_b16 v[160:161], v8 offset:17504
    v_mfma_f32_16x16x32_bf16 v[68:71], v[132:135], v[116:119], v[68:71]
    ds_read_b64_tr_b16 v[162:163], v8 offset:19808
    v_mfma_f32_16x16x32_bf16 v[72:75], v[136:139], v[112:115], v[72:75]
    ds_read_b64_tr_b16 v[164:165], v8 offset:17536
    v_mfma_f32_16x16x32_bf16 v[76:79], v[136:139], v[116:119], v[76:79]
    ds_read_b64_tr_b16 v[166:167], v8 offset:19840
    s_barrier
    s_waitcnt lgkmcnt(0)
    ds_read_b128 v[112:115], v6 offset:34816
    ds_read_b128 v[116:119], v6 offset:35840
    v_mfma_f32_16x16x32_bf16 v[40:43], v[148:151], v[140:143], v[40:43]
    ds_read_b64_tr_b16 v[120:121], v8 offset:34816
    v_mfma_f32_16x16x32_bf16 v[44:47], v[148:151], v[144:147], v[44:47]
    ds_read_b64_tr_b16 v[122:123], v8 offset:37120
    v_mfma_f32_16x16x32_bf16 v[48:51], v[152:155], v[140:143], v[48:51]
    ds_read_b64_tr_b16 v[124:125], v8 offset:34848
    v_mfma_f32_16x16x32_bf16 v[52:55], v[152:155], v[144:147], v[52:55]
    ds_read_b64_tr_b16 v[126:127], v8 offset:37152
    v_mfma_f32_16x16x32_bf16 v[56:59], v[156:159], v[140:143], v[56:59]
    ds_read_b64_tr_b16 v[128:129], v8 offset:34880
    v_mfma_f32_16x16x32_bf16 v[60:63], v[156:159], v[144:147], v[60:63]
    ds_read_b64_tr_b16 v[130:131], v8 offset:37184
    v_mfma_f32_16x16x32_bf16 v[64:67], v[160:163], v[140:143], v[64:67]
    ds_read_b64_tr_b16 v[132:133], v8 offset:34912
    v_mfma_f32_16x16x32_bf16 v[68:71], v[160:163], v[144:147], v[68:71]
    ds_read_b64_tr_b16 v[134:135], v8 offset:37216
    v_mfma_f32_16x16x32_bf16 v[72:75], v[164:167], v[140:143], v[72:75]
    ds_read_b64_tr_b16 v[136:137], v8 offset:34944
    v_mfma_f32_16x16x32_bf16 v[76:79], v[164:167], v[144:147], v[76:79]
    ds_read_b64_tr_b16 v[138:139], v8 offset:37248
    s_barrier
    s_waitcnt lgkmcnt(0)
    s_add_u32 s66, s69, 0
    v_add_u32 v11, s66, v25
    ds_read_b64 v[140:141], v11 offset:0
    ds_read_b64 v[142:143], v11 offset:512
    ds_read_b64 v[144:145], v11 offset:1024
    ds_read_b64 v[146:147], v11 offset:1536
    v_mfma_f32_16x16x32_bf16 v[40:43], v[120:123], v[112:115], v[40:43]
    ds_read_b64_tr_b16 v[148:149], v5 offset:0
    v_mfma_f32_16x16x32_bf16 v[44:47], v[120:123], v[116:119], v[44:47]
    ds_read_b64_tr_b16 v[150:151], v5 offset:2304
    v_mfma_f32_16x16x32_bf16 v[48:51], v[124:127], v[112:115], v[48:51]
    ds_read_b64_tr_b16 v[152:153], v5 offset:32
    v_mfma_f32_16x16x32_bf16 v[52:55], v[124:127], v[116:119], v[52:55]
    ds_read_b64_tr_b16 v[154:155], v5 offset:2336
    v_mfma_f32_16x16x32_bf16 v[56:59], v[128:131], v[112:115], v[56:59]
    ds_read_b64_tr_b16 v[156:157], v5 offset:64
    v_mfma_f32_16x16x32_bf16 v[60:63], v[128:131], v[116:119], v[60:63]
    ds_read_b64_tr_b16 v[158:159], v5 offset:2368
    v_mfma_f32_16x16x32_bf16 v[64:67], v[132:135], v[112:115], v[64:67]
    ds_read_b64_tr_b16 v[160:161], v5 offset:96
    v_mfma_f32_16x16x32_bf16 v[68:71], v[132:135], v[116:119], v[68:71]
    ds_read_b64_tr_b16 v[162:163], v5 offset:2400
    v_mfma_f32_16x16x32_bf16 v[72:75], v[136:139], v[112:115], v[72:75]
    ds_read_b64_tr_b16 v[164:165], v5 offset:128
    v_mfma_f32_16x16x32_bf16 v[76:79], v[136:139], v[116:119], v[76:79]
    ds_read_b64_tr_b16 v[166:167], v5 offset:2432
    s_barrier
    s_waitcnt lgkmcnt(0)
    s_add_u32 s66, s69, 17408
    v_add_u32 v11, s66, v25
    ds_read_b64 v[112:113], v11 offset:0
    ds_read_b64 v[114:115], v11 offset:512
    ds_read_b64 v[116:117], v11 offset:1024
    ds_read_b64 v[118:119], v11 offset:1536
    v_mfma_f32_16x16x32_bf16 v[40:43], v[148:151], v[140:143], v[40:43]
    ds_read_b64_tr_b16 v[120:121], v5 offset:17408
    v_mfma_f32_16x16x32_bf16 v[44:47], v[148:151], v[144:147], v[44:47]
    ds_read_b64_tr_b16 v[122:123], v5 offset:19712
    v_mfma_f32_16x16x32_bf16 v[48:51], v[152:155], v[140:143], v[48:51]
    ds_read_b64_tr_b16 v[124:125], v5 offset:17440
    v_mfma_f32_16x16x32_bf16 v[52:55], v[152:155], v[144:147], v[52:55]
    ds_read_b64_tr_b16 v[126:127], v5 offset:19744
    v_mfma_f32_16x16x32_bf16 v[56:59], v[156:159], v[140:143], v[56:59]
    ds_read_b64_tr_b16 v[128:129], v5 offset:17472
    v_mfma_f32_16x16x32_bf16 v[60:63], v[156:159], v[144:147], v[60:63]
    ds_read_b64_tr_b16 v[130:131], v5 offset:19776
    v_mfma_f32_16x16x32_bf16 v[64:67], v[160:163], v[140:143], v[64:67]
    ds_read_b64_tr_b16 v[132:133], v5 offset:17504
    v_mfma_f32_16x16x32_bf16 v[68:71], v[160:163], v[144:147], v[68:71]
    ds_read_b64_tr_b16 v[134:135], v5 offset:19808
    v_mfma_f32_16x16x32_bf16 v[72:75], v[164:167], v[140:143], v[72:75]
    ds_read_b64_tr_b16 v[136:137], v5 offset:17536
    v_mfma_f32_16x16x32_bf16 v[76:79], v[164:167], v[144:147], v[76:79]
    ds_read_b64_tr_b16 v[138:139], v5 offset:19840
    s_barrier
    s_waitcnt lgkmcnt(0)
    s_add_u32 s66, s69, 106496
    v_add_u32 v11, s66, v25
    ds_read_b64 v[140:141], v11 offset:0
    ds_read_b64 v[142:143], v11 offset:512
    ds_read_b64 v[144:145], v11 offset:1024
    ds_read_b64 v[146:147], v11 offset:1536
    v_mfma_f32_16x16x32_bf16 v[40:43], v[120:123], v[112:115], v[40:43]
    ds_read_b64_tr_b16 v[148:149], v9 offset:0
    v_mfma_f32_16x16x32_bf16 v[44:47], v[120:123], v[116:119], v[44:47]
    ds_read_b64_tr_b16 v[150:151], v9 offset:2304
    v_mfma_f32_16x16x32_bf16 v[48:51], v[124:127], v[112:115], v[48:51]
    ds_read_b64_tr_b16 v[152:153], v9 offset:32
    v_mfma_f32_16x16x32_bf16 v[52:55], v[124:127], v[116:119], v[52:55]
    ds_read_b64_tr_b16 v[154:155], v9 offset:2336
    v_mfma_f32_16x16x32_bf16 v[56:59], v[128:131], v[112:115], v[56:59]
    ds_read_b64_tr_b16 v[156:157], v9 offset:64
    v_mfma_f32_16x16x32_bf16 v[60:63], v[128:131], v[116:119], v[60:63]
    ds_read_b64_tr_b16 v[158:159], v9 offset:2368
    v_mfma_f32_16x16x32_bf16 v[64:67], v[132:135], v[112:115], v[64:67]
    ds_read_b64_tr_b16 v[160:161], v9 offset:96
    v_mfma_f32_16x16x32_bf16 v[68:71], v[132:135], v[116:119], v[68:71]
    ds_read_b64_tr_b16 v[162:163], v9 offset:2400
    v_mfma_f32_16x16x32_bf16 v[72:75], v[136:139], v[112:115], v[72:75]
    ds_read_b64_tr_b16 v[164:165], v9 offset:128
    v_mfma_f32_16x16x32_bf16 v[76:79], v[136:139], v[116:119], v[76:79]
    ds_read_b64_tr_b16 v[166:167], v9 offset:2432
    s_barrier
    s_waitcnt lgkmcnt(0)
    s_add_u32 s66, s69, 123904
    v_add_u32 v11, s66, v25
    ds_read_b64 v[112:113], v11 offset:0
    ds_read_b64 v[114:115], v11 offset:512
    ds_read_b64 v[116:117], v11 offset:1024
    ds_read_b64 v[118:119], v11 offset:1536
    v_mfma_f32_16x16x32_bf16 v[40:43], v[148:151], v[140:143], v[40:43]
    ds_read_b64_tr_b16 v[120:121], v9 offset:17408
    v_mfma_f32_16x16x32_bf16 v[44:47], v[148:151], v[144:147], v[44:47]
    ds_read_b64_tr_b16 v[122:123], v9 offset:19712
    v_mfma_f32_16x16x32_bf16 v[48:51], v[152:155], v[140:143], v[48:51]
    ds_read_b64_tr_b16 v[124:125], v9 offset:17440
    v_mfma_f32_16x16x32_bf16 v[52:55], v[152:155], v[144:147], v[52:55]
    ds_read_b64_tr_b16 v[126:127], v9 offset:19744
    v_mfma_f32_16x16x32_bf16 v[56:59], v[156:159], v[140:143], v[56:59]
    ds_read_b64_tr_b16 v[128:129], v9 offset:17472
    v_mfma_f32_16x16x32_bf16 v[60:63], v[156:159], v[144:147], v[60:63]
    ds_read_b64_tr_b16 v[130:131], v9 offset:19776
    v_mfma_f32_16x16x32_bf16 v[64:67], v[160:163], v[140:143], v[64:67]
    ds_read_b64_tr_b16 v[132:133], v9 offset:17504
    v_mfma_f32_16x16x32_bf16 v[68:71], v[160:163], v[144:147], v[68:71]
    ds_read_b64_tr_b16 v[134:135], v9 offset:19808
    v_mfma_f32_16x16x32_bf16 v[72:75], v[164:167], v[140:143], v[72:75]
    ds_read_b64_tr_b16 v[136:137], v9 offset:17536
    v_mfma_f32_16x16x32_bf16 v[76:79], v[164:167], v[144:147], v[76:79]
    ds_read_b64_tr_b16 v[138:139], v9 offset:19840
    s_waitcnt lgkmcnt(0)
    v_mfma_f32_16x16x32_bf16 v[40:43], v[120:123], v[112:115], v[40:43]
    v_mfma_f32_16x16x32_bf16 v[44:47], v[120:123], v[116:119], v[44:47]
    v_mfma_f32_16x16x32_bf16 v[48:51], v[124:127], v[112:115], v[48:51]
    v_mfma_f32_16x16x32_bf16 v[52:55], v[124:127], v[116:119], v[52:55]
    v_mfma_f32_16x16x32_bf16 v[56:59], v[128:131], v[112:115], v[56:59]
    v_mfma_f32_16x16x32_bf16 v[60:63], v[128:131], v[116:119], v[60:63]
    v_mfma_f32_16x16x32_bf16 v[64:67], v[132:135], v[112:115], v[64:67]
    v_mfma_f32_16x16x32_bf16 v[68:71], v[132:135], v[116:119], v[68:71]
    v_mfma_f32_16x16x32_bf16 v[72:75], v[136:139], v[112:115], v[72:75]
    v_mfma_f32_16x16x32_bf16 v[76:79], v[136:139], v[116:119], v[76:79]
    s_barrier
    s_mul_i32 s66, s63, 5120
    s_xor_b32 s67, s63, 1
    s_mul_i32 s67, s67, 5120
    v_add_u32 v5, s66, v24
    v_add_u32 v6, s67, v24
    s_and_b32 s64, s63, 1
    s_cmp_lg_u32 s64, 0
    s_cbranch_scc1 Lkh1_a_1
    ds_write_b128 v5, v[44:47] offset:0
    ds_write_b128 v5, v[52:55] offset:1024
    ds_write_b128 v5, v[60:63] offset:2048
    ds_write_b128 v5, v[68:71] offset:3072
    ds_write_b128 v5, v[76:79] offset:4096
    s_waitcnt lgkmcnt(0)
    s_barrier
    ds_read_b128 v[44:47], v6 offset:0
    ds_read_b128 v[52:55], v6 offset:1024
    ds_read_b128 v[60:63], v6 offset:2048
    ds_read_b128 v[68:71], v6 offset:3072
    ds_read_b128 v[76:79], v6 offset:4096
    s_waitcnt vmcnt(1)
    s_waitcnt lgkmcnt(4)
    v_add_f32 v40, v40, v44
    v_add_f32 v41, v41, v45
    v_add_f32 v42, v42, v46
    v_add_f32 v43, v43, v47
    v_lshlrev_b32 v44, 16, v236
    v_and_b32 v45, s83, v236
    v_lshlrev_b32 v46, 16, v237
    v_and_b32 v47, s83, v237
    v_add_f32 v40, v40, v44
    v_add_f32 v41, v41, v45
    v_add_f32 v42, v42, v46
    v_add_f32 v43, v43, v47
    v_cvt_pk_bf16_f32 v40, v40, v41
    v_cvt_pk_bf16_f32 v41, v42, v43
    buffer_store_dwordx2 v[40:41], v10, s[48:51], 0 offen offset:0
    s_waitcnt lgkmcnt(3)
    v_add_f32 v48, v48, v52
    v_add_f32 v49, v49, v53
    v_add_f32 v50, v50, v54
    v_add_f32 v51, v51, v55
    v_lshlrev_b32 v52, 16, v238
    v_and_b32 v53, s83, v238
    v_lshlrev_b32 v54, 16, v239
    v_and_b32 v55, s83, v239
    v_add_f32 v48, v48, v52
    v_add_f32 v49, v49, v53
    v_add_f32 v50, v50, v54
    v_add_f32 v51, v51, v55
    v_cvt_pk_bf16_f32 v48, v48, v49
    v_cvt_pk_bf16_f32 v49, v50, v51
    buffer_store_dwordx2 v[48:49], v10, s[48:51], 0 offen offset:32
    s_waitcnt lgkmcnt(2)
    v_add_f32 v56, v56, v60
    v_add_f32 v57, v57, v61
    v_add_f32 v58, v58, v62
    v_add_f32 v59, v59, v63
    v_lshlrev_b32 v60, 16, v240
    v_and_b32 v61, s83, v240
    v_lshlrev_b32 v62, 16, v241
    v_and_b32 v63, s83, v241
    v_add_f32 v56, v56, v60
    v_add_f32 v57, v57, v61
    v_add_f32 v58, v58, v62
    v_add_f32 v59, v59, v63
    v_cvt_pk_bf16_f32 v56, v56, v57
    v_cvt_pk_bf16_f32 v57, v58, v59
    buffer_store_dwordx2 v[56:57], v10, s[48:51], 0 offen offset:64
    s_waitcnt lgkmcnt(1)
    v_add_f32 v64, v64, v68
    v_add_f32 v65, v65, v69
    v_add_f32 v66, v66, v70
    v_add_f32 v67, v67, v71
    v_lshlrev_b32 v68, 16, v242
    v_and_b32 v69, s83, v242
    v_lshlrev_b32 v70, 16, v243
    v_and_b32 v71, s83, v243
    v_add_f32 v64, v64, v68
    v_add_f32 v65, v65, v69
    v_add_f32 v66, v66, v70
    v_add_f32 v67, v67, v71
    v_cvt_pk_bf16_f32 v64, v64, v65
    v_cvt_pk_bf16_f32 v65, v66, v67
    buffer_store_dwordx2 v[64:65], v10, s[48:51], 0 offen offset:96
    s_waitcnt lgkmcnt(0)
    v_add_f32 v72, v72, v76
    v_add_f32 v73, v73, v77
    v_add_f32 v74, v74, v78
    v_add_f32 v75, v75, v79
    v_lshlrev_b32 v76, 16, v244
    v_and_b32 v77, s83, v244
    v_lshlrev_b32 v78, 16, v245
    v_and_b32 v79, s83, v245
    v_add_f32 v72, v72, v76
    v_add_f32 v73, v73, v77
    v_add_f32 v74, v74, v78
    v_add_f32 v75, v75, v79
    v_cvt_pk_bf16_f32 v72, v72, v73
    v_cvt_pk_bf16_f32 v73, v74, v75
    s_mov_b32 exec_hi, 0
    buffer_store_dwordx2 v[72:73], v10, s[48:51], 0 offen offset:128
    s_mov_b64 exec, -1
    s_branch Lkhj_a_2
Lkh1_a_1:
    s_nop 7
    ds_write_b128 v5, v[40:43] offset:0
    ds_write_b128 v5, v[48:51] offset:1024
    ds_write_b128 v5, v[56:59] offset:2048
    ds_write_b128 v5, v[64:67] offset:3072
    ds_write_b128 v5, v[72:75] offset:4096
    s_waitcnt lgkmcnt(0)
    s_barrier
    ds_read_b128 v[40:43], v6 offset:0
    ds_read_b128 v[48:51], v6 offset:1024
    ds_read_b128 v[56:59], v6 offset:2048
    ds_read_b128 v[64:67], v6 offset:3072
    ds_read_b128 v[72:75], v6 offset:4096
    s_waitcnt vmcnt(1)
    s_waitcnt lgkmcnt(4)
    v_add_f32 v44, v44, v40
    v_add_f32 v45, v45, v41
    v_add_f32 v46, v46, v42
    v_add_f32 v47, v47, v43
    v_lshlrev_b32 v40, 16, v236
    v_and_b32 v41, s83, v236
    v_lshlrev_b32 v42, 16, v237
    v_and_b32 v43, s83, v237
    v_add_f32 v44, v44, v40
    v_add_f32 v45, v45, v41
    v_add_f32 v46, v46, v42
    v_add_f32 v47, v47, v43
    v_cvt_pk_bf16_f32 v44, v44, v45
    v_cvt_pk_bf16_f32 v45, v46, v47
    buffer_store_dwordx2 v[44:45], v10, s[48:51], 0 offen offset:0
    s_waitcnt lgkmcnt(3)
    v_add_f32 v52, v52, v48
    v_add_f32 v53, v53, v49
    v_add_f32 v54, v54, v50
    v_add_f32 v55, v55, v51
    v_lshlrev_b32 v48, 16, v238
    v_and_b32 v49, s83, v238
    v_lshlrev_b32 v50, 16, v239
    v_and_b32 v51, s83, v239
    v_add_f32 v52, v52, v48
    v_add_f32 v53, v53, v49
    v_add_f32 v54, v54, v50
    v_add_f32 v55, v55, v51
    v_cvt_pk_bf16_f32 v52, v52, v53
    v_cvt_pk_bf16_f32 v53, v54, v55
    buffer_store_dwordx2 v[52:53], v10, s[48:51], 0 offen offset:32
    s_waitcnt lgkmcnt(2)
    v_add_f32 v60, v60, v56
    v_add_f32 v61, v61, v57
    v_add_f32 v62, v62, v58
    v_add_f32 v63, v63, v59
    v_lshlrev_b32 v56, 16, v240
    v_and_b32 v57, s83, v240
    v_lshlrev_b32 v58, 16, v241
    v_and_b32 v59, s83, v241
    v_add_f32 v60, v60, v56
    v_add_f32 v61, v61, v57
    v_add_f32 v62, v62, v58
    v_add_f32 v63, v63, v59
    v_cvt_pk_bf16_f32 v60, v60, v61
    v_cvt_pk_bf16_f32 v61, v62, v63
    buffer_store_dwordx2 v[60:61], v10, s[48:51], 0 offen offset:64
    s_waitcnt lgkmcnt(1)
    v_add_f32 v68, v68, v64
    v_add_f32 v69, v69, v65
    v_add_f32 v70, v70, v66
    v_add_f32 v71, v71, v67
    v_lshlrev_b32 v64, 16, v242
    v_and_b32 v65, s83, v242
    v_lshlrev_b32 v66, 16, v243
    v_and_b32 v67, s83, v243
    v_add_f32 v68, v68, v64
    v_add_f32 v69, v69, v65
    v_add_f32 v70, v70, v66
    v_add_f32 v71, v71, v67
    v_cvt_pk_bf16_f32 v68, v68, v69
    v_cvt_pk_bf16_f32 v69, v70, v71
    buffer_store_dwordx2 v[68:69], v10, s[48:51], 0 offen offset:96
    s_waitcnt lgkmcnt(0)
    v_add_f32 v76, v76, v72
    v_add_f32 v77, v77, v73
    v_add_f32 v78, v78, v74
    v_add_f32 v79, v79, v75
    v_lshlrev_b32 v72, 16, v244
    v_and_b32 v73, s83, v244
    v_lshlrev_b32 v74, 16, v245
    v_and_b32 v75, s83, v245
    v_add_f32 v76, v76, v72
    v_add_f32 v77, v77, v73
    v_add_f32 v78, v78, v74
    v_add_f32 v79, v79, v75
    v_cvt_pk_bf16_f32 v76, v76, v77
    v_cvt_pk_bf16_f32 v77, v78, v79
    s_mov_b32 exec_hi, 0
    buffer_store_dwordx2 v[76:77], v10, s[48:51], 0 offen offset:128
    s_mov_b64 exec, -1
Lkhj_a_2:
    s_endpgm
L_roleB:
    s_mov_b32 s101, 0
    s_mov_b32 s36, s26
    s_mov_b32 s37, s27
    s_mov_b32 s38, 268435456
    s_mov_b32 s39, 0x20000
    s_mov_b32 s80, 0xbdd2d3e8
    s_mov_b32 s81, 0x3fb8aa3b
    s_mov_b32 s82, 0x3f803f80
    s_mov_b32 s83, 0xffff0000
    s_mov_b32 s32, s14
    s_mov_b32 s33, s15
    s_mov_b32 s34, 5308416
    s_mov_b32 s35, 0x20000
    s_lshl_b32 s72, s63, 10
    s_lshl_b32 s74, s63, 12
    s_lshl_b32 s78, s63, 11
    s_mul_i32 s87, s63, 3072
    s_lshl_b32 s86, s61, 8
    s_lshl_b32 s88, s61, 5
    s_add_u32 s88, s88, 4096
    v_lshlrev_b32 v32, 4, v1
    v_and_b32 v9, 6, v8
    v_and_b32 v10, 7, v1
    v_xor_b32 v9, v9, v10
    v_lshlrev_b32 v9, 4, v9
    s_mul_i32 s64, s63, 24
    v_add_u32 v10, s64, v8
    v_mul_u32_u24 v10, 9216, v10
    v_add_u32 v16, v10, v9
    v_add_u32 v17, 72704, v16
    v_add_u32 v18, 145408, v16
    v_lshrrev_b32 v10, 1, v1
    s_lshl_b32 s64, s63, 5
    v_add_u32 v10, s64, v10
    v_mul_u32_u24 v11, 9216, v10
    v_and_b32 v10, 1, v1
    v_lshl_add_u32 v19, v10, 4, v11
    v_lshlrev_b32 v36, 7, v1
    s_mul_i32 s79, s61, 165888
    s_add_u32 s79, s79, 28311552
    v_add_u32 v30, s74, v32
    s_add_u32 s64, s72, 16384
    v_add_u32 v31, s64, v32
    v_mov_b32 v104, 0xbdd2d3e8
    v_mov_b32 v105, 0xbdd2d3e8
    v_mov_b32 v106, 0xc0135761
    v_mov_b32 v107, 0xc0135761
    v_mov_b32 v108, 0x3f800000
    v_mov_b32 v109, 0x3f800000
    s_mul_i32 s64, s63, 12288
    s_add_u32 s64, s64, 92160
    v_add_u32 v33, s64, v32
    s_mul_i32 s75, s61, 589824
    s_lshl_b32 s64, s60, 19
    s_add_u32 s40, s16, s64
    s_addc_u32 s41, s17, 0
    s_mov_b32 s42, 524288
    s_mov_b32 s43, 0x20000
    s_lshl_b32 s64, s60, 2
    s_add_u32 s64, s64, s63
    s_add_u32 s64, s64, 0
    s_mul_i32 s65, s64, 3641
    s_lshr_b32 s65, s65, 16
    s_mul_i32 s66, s65, 18
    s_sub_u32 s66, s64, s66
    s_lshl_b32 s66, s66, 6
    v_add_u32 v4, s66, v1
    v_mul_u32_u24 v5, 3641, v4
    v_lshrrev_b32 v5, 16, v5
    v_mul_u32_u24 v7, 18, v5
    v_sub_u32 v6, v4, v7
    v_mul_u32_u24 v8, 21846, v6
    v_lshrrev_b32 v8, 16, v8
    v_mul_u32_u24 v7, 3, v8
    v_sub_u32 v9, v6, v7
    v_lshrrev_b32 v6, 1, v8
    v_mul_u32_u24 v7, 1152, v6
    v_cmp_eq_u32 vcc, 1, v6
    v_subrev_u32 v6, 8, v7
    s_nop 0
    v_cndmask_b32 v7, v7, v6, vcc
    v_and_b32 v8, 1, v8
    v_mul_u32_u24 v8, 36, v8
    v_add_u32 v7, v7, v8
    v_lshl_add_u32 v7, v9, 4, v7
    v_mul_u32_u24 v5, 3456, v5
    v_add_u32 v5, v5, v7
    s_mul_i32 s65, s65, 221184
    s_mul_i32 s66, s61, 72
    s_add_u32 s65, s65, s66
    v_mov_b32 v88, v5
    s_mov_b32 s44, s65
    s_lshl_b32 s64, s60, 2
    s_add_u32 s64, s64, s63
    s_add_u32 s64, s64, 64
    s_mul_i32 s65, s64, 3641
    s_lshr_b32 s65, s65, 16
    s_mul_i32 s66, s65, 18
    s_sub_u32 s66, s64, s66
    s_lshl_b32 s66, s66, 6
    v_add_u32 v4, s66, v1
    v_mul_u32_u24 v5, 3641, v4
    v_lshrrev_b32 v5, 16, v5
    v_mul_u32_u24 v7, 18, v5
    v_sub_u32 v6, v4, v7
    v_mul_u32_u24 v8, 21846, v6
    v_lshrrev_b32 v8, 16, v8
    v_mul_u32_u24 v7, 3, v8
    v_sub_u32 v9, v6, v7
    v_lshrrev_b32 v6, 1, v8
    v_mul_u32_u24 v7, 1152, v6
    v_cmp_eq_u32 vcc, 1, v6
    v_subrev_u32 v6, 8, v7
    s_nop 0
    v_cndmask_b32 v7, v7, v6, vcc
    v_and_b32 v8, 1, v8
    v_mul_u32_u24 v8, 36, v8
    v_add_u32 v7, v7, v8
    v_lshl_add_u32 v7, v9, 4, v7
    v_mul_u32_u24 v5, 3456, v5
    v_add_u32 v5, v5, v7
    s_mul_i32 s65, s65, 221184
    s_mul_i32 s66, s61, 72
    s_add_u32 s65, s65, s66
    v_mov_b32 v89, v5
    s_mov_b32 s45, s65
    s_lshl_b32 s64, s60, 2
    s_add_u32 s64, s64, s63
    s_add_u32 s64, s64, 128
    s_mul_i32 s65, s64, 3641
    s_lshr_b32 s65, s65, 16
    s_mul_i32 s66, s65, 18
    s_sub_u32 s66, s64, s66
    s_lshl_b32 s66, s66, 6
    v_add_u32 v4, s66, v1
    v_mul_u32_u24 v5, 3641, v4
    v_lshrrev_b32 v5, 16, v5
    v_mul_u32_u24 v7, 18, v5
    v_sub_u32 v6, v4, v7
    v_mul_u32_u24 v8, 21846, v6
    v_lshrrev_b32 v8, 16, v8
    v_mul_u32_u24 v7, 3, v8
    v_sub_u32 v9, v6, v7
    v_lshrrev_b32 v6, 1, v8
    v_mul_u32_u24 v7, 1152, v6
    v_cmp_eq_u32 vcc, 1, v6
    v_subrev_u32 v6, 8, v7
    s_nop 0
    v_cndmask_b32 v7, v7, v6, vcc
    v_and_b32 v8, 1, v8
    v_mul_u32_u24 v8, 36, v8
    v_add_u32 v7, v7, v8
    v_lshl_add_u32 v7, v9, 4, v7
    v_mul_u32_u24 v5, 3456, v5
    v_add_u32 v5, v5, v7
    s_mul_i32 s65, s65, 221184
    s_mul_i32 s66, s61, 72
    s_add_u32 s65, s65, s66
    v_mov_b32 v90, v5
    s_mov_b32 s46, s65
    s_lshl_b32 s64, s63, 7
    s_add_u32 s64, s64, 0
    v_add_u32 v4, s64, v1
    v_mul_u32_u24 v76, 7282, v4
    v_lshrrev_b32 v76, 16, v76
    v_mul_u32_u24 v5, 9, v76
    v_sub_u32 v77, v4, v5
    s_lshl_b32 s64, s63, 7
    s_add_u32 s64, s64, 64
    v_add_u32 v4, s64, v1
    v_mul_u32_u24 v78, 7282, v4
    v_lshrrev_b32 v78, 16, v78
    v_mul_u32_u24 v5, 9, v78
    v_sub_u32 v79, v4, v5
    v_add_u32 v4, 512, v1
    v_mul_u32_u24 v80, 7282, v4
    v_lshrrev_b32 v80, 16, v80
    v_mul_u32_u24 v5, 9, v80
    v_sub_u32 v81, v4, v5
    s_lshl_b32 s70, s60, 1
    s_and_b32 s64, s61, 1
    s_add_u32 s70, s70, s64
    s_lshr_b32 s71, s61, 1
    s_mul_i32 s71, s71, 144
    s_add_u32 s65, s70, 23
    s_mul_i32 s65, s65, 73728
    s_add_u32 s47, s65, s71
    v_mul_u32_u24 v91, 1152, v76
    v_lshl_add_u32 v91, v77, 4, v91
    v_mul_u32_u24 v92, 1152, v78
    v_lshl_add_u32 v92, v79, 4, v92
    v_mul_u32_u24 v93, 1152, v80
    v_lshl_add_u32 v93, v81, 4, v93
    s_lshl_b32 s70, s60, 1
    s_and_b32 s64, s61, 1
    s_add_u32 s70, s70, s64
    s_lshr_b32 s71, s61, 1
    s_mul_i32 s71, s71, 144
    s_cmp_gt_u32 s70, 8
    s_cbranch_scc1 Lr3y_b_3
    s_mov_b32 s48, s10
    s_mov_b32 s49, s11
    s_mov_b32 s50, 663552
    s_mov_b32 s51, 0x20000
    s_cmp_eq_u32 s70, 8
    s_cbranch_scc1 Lr3ol_b_2
    s_mul_i32 s65, s70, 82944
    v_lshrrev_b32 v5, 5, v76
    v_bfe_u32 v6, v76, 4, 1
    v_and_b32 v7, 3, v76
    v_lshl_add_u32 v6, v6, 2, v7
    v_bfe_u32 v7, v76, 2, 2
    v_mul_u32_u24 v7, 9, v7
    v_mul_u32_u24 v5, 36, v5
    v_add3_u32 v76, v5, v6, v7
    v_lshrrev_b32 v5, 5, v78
    v_bfe_u32 v6, v78, 4, 1
    v_and_b32 v7, 3, v78
    v_lshl_add_u32 v6, v6, 2, v7
    v_bfe_u32 v7, v78, 2, 2
    v_mul_u32_u24 v7, 9, v7
    v_mul_u32_u24 v5, 36, v5
    v_add3_u32 v78, v5, v6, v7
    v_lshrrev_b32 v5, 5, v80
    v_bfe_u32 v6, v80, 4, 1
    v_and_b32 v7, 3, v80
    v_lshl_add_u32 v6, v6, 2, v7
    v_bfe_u32 v7, v80, 2, 2
    v_mul_u32_u24 v7, 9, v7
    v_mul_u32_u24 v5, 36, v5
    v_add3_u32 v80, v5, v6, v7
    s_branch Lr3e_b_1
Lr3ol_b_2:
    s_mov_b32 s65, 0
    v_lshrrev_b32 v5, 5, v76
    v_bfe_u32 v6, v76, 4, 1
    v_and_b32 v7, 3, v76
    v_lshl_add_u32 v6, v6, 2, v7
    v_bfe_u32 v7, v76, 2, 2
    v_mul_u32_u24 v7, 9, v7
    v_lshl_add_u32 v5, v5, 3, v6
    v_mul_u32_u24 v5, 36, v5
    v_add3_u32 v76, v5, v7, 8
    v_lshrrev_b32 v5, 5, v78
    v_bfe_u32 v6, v78, 4, 1
    v_and_b32 v7, 3, v78
    v_lshl_add_u32 v6, v6, 2, v7
    v_bfe_u32 v7, v78, 2, 2
    v_mul_u32_u24 v7, 9, v7
    v_lshl_add_u32 v5, v5, 3, v6
    v_mul_u32_u24 v5, 36, v5
    v_add3_u32 v78, v5, v7, 8
    v_lshrrev_b32 v5, 5, v80
    v_bfe_u32 v6, v80, 4, 1
    v_and_b32 v7, 3, v80
    v_lshl_add_u32 v6, v6, 2, v7
    v_bfe_u32 v7, v80, 2, 2
    v_mul_u32_u24 v7, 9, v7
    v_lshl_add_u32 v5, v5, 3, v6
    v_mul_u32_u24 v5, 36, v5
    v_add3_u32 v80, v5, v7, 8
    s_branch Lr3e_b_1
Lr3y_b_3:
    s_mov_b32 s48, s20
    s_mov_b32 s49, s21
    s_mov_b32 s50, 2654208
    s_mov_b32 s51, 0x20000
    s_sub_u32 s65, s70, 9
    s_mul_i32 s65, s65, 73728
Lr3e_b_1:
    s_add_u32 s57, s65, s71
    v_mul_u32_u24 v76, 1152, v76
    v_lshl_add_u32 v76, v77, 4, v76
    v_mul_u32_u24 v78, 1152, v78
    v_lshl_add_u32 v78, v79, 4, v78
    v_mul_u32_u24 v80, 1152, v80
    v_lshl_add_u32 v80, v81, 4, v80
    s_lshl_b32 s64, s63, 6
    s_add_u32 s64, s64, 0
    v_add_u32 v6, s64, v1
    v_lshlrev_b32 v86, 2, v6
    v_mul_u32_u24 v7, 7282, v6
    v_lshrrev_b32 v7, 16, v7
    v_mul_u32_u24 v9, 9, v7
    v_sub_u32 v8, v6, v9
    v_cmp_lt_u32 vcc, 17, v7
    v_add_u32 v9, 6, v7
    s_nop 0
    v_cndmask_b32 v7, v7, v9, vcc
    v_mul_u32_u24 v7, 40, v7
    v_lshl_add_u32 v7, v8, 2, v7
    v_add_u32 v7, 160768, v7
    v_mov_b32 v9, 153600
    v_cmp_gt_u32 vcc, 324, v6
    s_nop 1
    v_cndmask_b32 v84, v9, v7, vcc
    s_lshl_b32 s64, s63, 6
    s_add_u32 s64, s64, 256
    v_add_u32 v6, s64, v1
    v_lshlrev_b32 v87, 2, v6
    v_mul_u32_u24 v7, 7282, v6
    v_lshrrev_b32 v7, 16, v7
    v_mul_u32_u24 v9, 9, v7
    v_sub_u32 v8, v6, v9
    v_cmp_lt_u32 vcc, 17, v7
    v_add_u32 v9, 6, v7
    s_nop 0
    v_cndmask_b32 v7, v7, v9, vcc
    v_mul_u32_u24 v7, 40, v7
    v_lshl_add_u32 v7, v8, 2, v7
    v_add_u32 v7, 160768, v7
    v_mov_b32 v9, 153600
    v_cmp_gt_u32 vcc, 324, v6
    s_nop 1
    v_cndmask_b32 v85, v9, v7, vcc
    v_lshrrev_b32 v6, 3, v1
    v_and_b32 v7, 7, v1
    v_xor_b32 v7, v7, v6
    v_lshlrev_b32 v7, 4, v7
    v_and_b32 v8, 3, v6
    v_lshrrev_b32 v6, 5, v1
    v_lshl_add_u32 v8, v6, 3, v8
    s_lshl_b32 s64, s63, 5
    v_add_u32 v8, s64, v8
    v_lshl_add_u32 v7, v8, 12, v7
    v_add_u32 v26, 0, v7
    v_add_u32 v27, 64512, v7
    v_add_u32 v28, 14336, v7
    v_add_u32 v29, 78848, v7
    s_lshl_b32 s64, s60, 2
    s_xor_b32 s65, s63, 3
    s_or_b32 s64, s64, s65
    s_cmp_eq_u32 s64, 0
    s_cselect_b32 s58, 0, 0x7ff00000
    v_mov_b32 v4, 0
    v_mov_b32 v5, 0
    v_mov_b32 v6, 0
    v_mov_b32 v7, 0
    v_add_u32 v9, s58, v32
    s_mul_i32 s64, s61, 6144
    s_add_u32 s64, s64, 23592960
    buffer_store_dwordx4 v[4:7], v9, s[36:39], s64 offen offset:0 sc1
    buffer_store_dwordx4 v[4:7], v9, s[36:39], s64 offen offset:1024 sc1
    buffer_store_dwordx4 v[4:7], v9, s[36:39], s64 offen offset:2048 sc1
    buffer_store_dwordx4 v[4:7], v9, s[36:39], s64 offen offset:3072 sc1
    s_add_u32 s64, s64, 4096
    buffer_store_dwordx4 v[4:7], v9, s[36:39], s64 offen offset:0 sc1
    buffer_store_dwordx4 v[4:7], v9, s[36:39], s64 offen offset:1024 sc1
    v_lshrrev_b32 v12, 2, v1
    v_lshlrev_b32 v12, 6, v12
    v_and_b32 v13, 3, v1
    v_add_u32 v12, v12, v13
    v_mul_u32_u24 v12, 4352, v12
    v_add_u32 v12, s58, v12
    s_mul_i32 s64, s61, 17408
    s_add_u32 s64, s64, 24117248
    s_mov_b64 exec, 268435455
    buffer_store_dword v4, v12, s[36:39], s64 offen sc1
    s_mov_b64 exec, -1
    s_lshl_b32 s64, s60, 4
    s_add_u32 s64, s64, s61
    s_lshl_b32 s64, s64, 10
    s_lshl_b32 s65, s63, 8
    s_add_u32 s64, s64, s65
    s_add_u32 s59, s64, 23068672
    v_mov_b32 v4, -1
    v_mov_b32 v5, -1
    v_mov_b32 v6, -1
    v_mov_b32 v7, -1
    s_mov_b64 exec, 0xffff
    buffer_store_dwordx4 v[4:7], v32, s[36:39], s59 offen sc1
    s_mov_b64 exec, -1
    s_mul_i32 s98, s101, 2
    s_add_u32 s98, s98, 0
    s_sub_u32 s99, s98, 6
    s_cselect_b32 s98, s98, s99
    s_mul_i32 s98, s98, 884736
    s_add_u32 s85, s98, s88
    s_add_u32 s85, s85, 4608
    s_cmp_ge_u32 s63, 3
    s_cbranch_scc1 Lc_b_4
    s_add_u32 m0, s72, 159744
    s_nop 0
    buffer_load_dwordx4 v19, s[32:35], s85 offen lds
Lc_b_4:
    s_add_u32 s98, s98, s86
    s_add_u32 s98, s98, 4736
    s_add_u32 m0, s87, 147456
    s_nop 0
    buffer_load_dwordx4 v16, s[32:35], s98 offen offset:0 lds
    buffer_load_dwordx4 v17, s[32:35], s98 offen offset:1024 lds
    buffer_load_dwordx4 v18, s[32:35], s98 offen offset:2048 lds
    s_mul_i32 s64, s2, 81
    s_mul_i32 s65, s63, 21
    s_add_u32 s64, s64, s65
    v_add_u32 v4, s64, v1
    v_mul_u32_u24 v5, 58255, v4
    v_lshrrev_b32 v5, 21, v5
    v_mul_u32_u24 v6, 36, v5
    v_sub_u32 v4, v4, v6
    v_mul_u32_u24 v5, 9216, v5
    v_lshl_add_u32 v37, v4, 7, v5
    s_mov_b32 s64, 4608
    s_mov_b64 exec, 0x1fffff
    buffer_load_dword v249, v37, s[32:35], s64 offen
    s_mov_b64 exec, -1
    s_barrier
    s_mul_i32 s98, s101, 2
    s_add_u32 s98, s98, 1
    s_sub_u32 s99, s98, 6
    s_cselect_b32 s98, s98, s99
    s_mul_i32 s98, s98, 884736
    s_add_u32 s85, s98, s88
    s_add_u32 s85, s85, 4608
    s_cmp_ge_u32 s63, 3
    s_cbranch_scc1 Lc_b_5
    s_add_u32 m0, s72, 12288
    s_nop 0
    buffer_load_dwordx4 v19, s[32:35], s85 offen lds
Lc_b_5:
    s_add_u32 s98, s98, s86
    s_add_u32 s98, s98, 4736
    s_add_u32 m0, s87, 0
    s_nop 0
    buffer_load_dwordx4 v16, s[32:35], s98 offen offset:0 lds
    buffer_load_dwordx4 v17, s[32:35], s98 offen offset:1024 lds
    buffer_load_dwordx4 v18, s[32:35], s98 offen offset:2048 lds
    s_mul_i32 s98, s101, 2
    s_add_u32 s98, s98, 2
    s_sub_u32 s99, s98, 6
    s_cselect_b32 s98, s98, s99
    s_mul_i32 s98, s98, 884736
    s_add_u32 s85, s98, s88
    s_add_u32 s85, s85, 4608
    s_cmp_ge_u32 s63, 3
    s_cbranch_scc1 Lc_b_6
    s_add_u32 m0, s72, 30720
    s_nop 0
    buffer_load_dwordx4 v19, s[32:35], s85 offen lds
Lc_b_6:
    s_add_u32 s98, s98, s86
    s_add_u32 s98, s98, 4736
    s_add_u32 m0, s87, 18432
    s_nop 0
    buffer_load_dwordx4 v16, s[32:35], s98 offen offset:0 lds
    buffer_load_dwordx4 v17, s[32:35], s98 offen offset:1024 lds
    buffer_load_dwordx4 v18, s[32:35], s98 offen offset:2048 lds
    s_mul_i32 s98, s101, 2
    s_add_u32 s98, s98, 3
    s_sub_u32 s99, s98, 6
    s_cselect_b32 s98, s98, s99
    s_mul_i32 s98, s98, 884736
    s_add_u32 s85, s98, s88
    s_add_u32 s85, s85, 4608
    s_cmp_ge_u32 s63, 3
    s_cbranch_scc1 Lc_b_7
    s_add_u32 m0, s72, 49152
    s_nop 0
    buffer_load_dwordx4 v19, s[32:35], s85 offen lds
Lc_b_7:
    s_add_u32 s98, s98, s86
    s_add_u32 s98, s98, 4736
    s_add_u32 m0, s87, 36864
    s_nop 0
    buffer_load_dwordx4 v16, s[32:35], s98 offen offset:0 lds
    buffer_load_dwordx4 v17, s[32:35], s98 offen offset:1024 lds
    buffer_load_dwordx4 v18, s[32:35], s98 offen offset:2048 lds
    s_mul_i32 s98, s101, 2
    s_add_u32 s98, s98, 4
    s_sub_u32 s99, s98, 6
    s_cselect_b32 s98, s98, s99
    s_mul_i32 s98, s98, 884736
    s_add_u32 s85, s98, s88
    s_add_u32 s85, s85, 4608
    s_cmp_ge_u32 s63, 3
    s_cbranch_scc1 Lc_b_8
    s_add_u32 m0, s72, 67584
    s_nop 0
    buffer_load_dwordx4 v19, s[32:35], s85 offen lds
Lc_b_8:
    s_add_u32 s98, s98, s86
    s_add_u32 s98, s98, 4736
    s_add_u32 m0, s87, 55296
    s_nop 0
    buffer_load_dwordx4 v16, s[32:35], s98 offen offset:0 lds
    buffer_load_dwordx4 v17, s[32:35], s98 offen offset:1024 lds
    buffer_load_dwordx4 v18, s[32:35], s98 offen offset:2048 lds
    s_waitcnt vmcnt(16)
    s_mov_b32 s52, s24
    s_mov_b32 s53, s25
    s_mov_b32 s54, 256
    s_mov_b32 s55, 0x20000
    s_mov_b64 exec, 1
    v_mov_b32 v5, 1
    v_mov_b32 v4, s58
    s_lshl_b32 s64, s61, 2
    buffer_store_dword v5, v4, s[52:55], s64 offen sc1
    s_mov_b64 exec, -1
    s_mov_b32 s52, s6
    s_mov_b32 s53, s7
    s_mov_b32 s54, 1990656
    s_mov_b32 s55, 0x20000
    buffer_load_dwordx4 v[40:43], v88, s[52:55], s44 offen
    buffer_load_dwordx4 v[44:47], v89, s[52:55], s45 offen
    buffer_load_dwordx4 v[48:51], v90, s[52:55], s46 offen
    s_mul_i32 s64, s61, 1296
    s_sub_u32 s65, 20736, s64
    s_add_u32 s52, s8, s64
    s_addc_u32 s53, s9, 0
    s_mov_b32 s54, s65
    s_mov_b32 s55, 0x20000
    buffer_load_dword v86, v86, s[52:55], 0 offen
    buffer_load_dword v87, v87, s[52:55], 0 offen
    s_waitcnt vmcnt(19)
    s_barrier
    s_mul_i32 s98, s101, 2
    s_add_u32 s98, s98, 5
    s_sub_u32 s99, s98, 6
    s_cselect_b32 s98, s98, s99
    s_mul_i32 s98, s98, 884736
    s_add_u32 s85, s98, s88
    s_add_u32 s85, s85, 4608
    s_cmp_ge_u32 s63, 3
    s_cbranch_scc1 Lc_b_9
    s_add_u32 m0, s72, 86016
    s_nop 0
    buffer_load_dwordx4 v19, s[32:35], s85 offen lds
Lc_b_9:
    s_add_u32 s98, s98, s86
    s_add_u32 s98, s98, 4736
    s_add_u32 m0, s87, 73728
    s_nop 0
    buffer_load_dwordx4 v16, s[32:35], s98 offen offset:0 lds
    buffer_load_dwordx4 v17, s[32:35], s98 offen offset:1024 lds
    buffer_load_dwordx4 v18, s[32:35], s98 offen offset:2048 lds
    s_waitcnt vmcnt(18)
    s_barrier
    s_mov_b32 s52, s24
    s_mov_b32 s53, s25
    s_mov_b32 s54, 256
    s_mov_b32 s55, 0x20000
    s_mov_b32 s64, 0
    v_lshlrev_b32 v4, 2, v1
    s_mov_b64 exec, 65535
    buffer_load_dword v248, v4, s[52:55], s64 offen sc1
    s_mov_b64 exec, -1
    s_waitcnt vmcnt(16)
    s_barrier
    s_waitcnt vmcnt(13)
    s_barrier
    s_mul_i32 s98, s101, 2
    s_add_u32 s98, s98, 0
    s_sub_u32 s99, s98, 6
    s_cselect_b32 s98, s98, s99
    s_mul_i32 s98, s98, 884736
    s_add_u32 s98, s98, s86
    s_add_u32 s98, s98, 4608
    s_add_u32 m0, s87, 0
    s_nop 0
    buffer_load_dwordx4 v16, s[32:35], s98 offen offset:0 lds
    v_mov_b32 v8, 0
    v_mov_b32 v9, 0
    v_mov_b32 v10, 0
    v_mov_b32 v11, 0
    s_add_u32 s64, s72, 160768
    v_add_u32 v6, s64, v32
    v_min_u32 v6, 163632, v6
    ds_write_b128 v6, v[8:11]
    s_mul_i32 s64, s2, 81
    s_mul_i32 s65, s63, 21
    s_add_u32 s64, s64, s65
    v_add_u32 v4, s64, v1
    v_mul_u32_u24 v5, 58255, v4
    v_lshrrev_b32 v5, 21, v5
    v_mul_u32_u24 v6, 36, v5
    v_sub_u32 v4, v4, v6
    v_mul_u32_u24 v5, 9216, v5
    v_lshl_add_u32 v37, v4, 7, v5
    s_mov_b32 s64, 0
    s_mov_b64 exec, 0x1fffff
    buffer_load_dword v249, v37, s[32:35], s64 offen
    s_mov_b64 exec, -1
    buffer_load_dwordx4 v17, s[32:35], s98 offen offset:1024 lds
    buffer_load_dwordx4 v18, s[32:35], s98 offen offset:2048 lds
    s_waitcnt vmcnt(14)
    s_barrier
    s_mul_i32 s98, s101, 2
    s_add_u32 s98, s98, 1
    s_sub_u32 s99, s98, 6
    s_cselect_b32 s98, s98, s99
    s_mul_i32 s98, s98, 884736
    s_add_u32 s98, s98, s86
    s_add_u32 s98, s98, 4608
    s_add_u32 m0, s87, 18432
    s_nop 0
    buffer_load_dwordx4 v16, s[32:35], s98 offen offset:0 lds
    s_waitcnt vmcnt(5)
    s_mov_b64 exec, 65535
    v_cmp_ne_u32 vcc, 1, v248
    s_mov_b32 s66, 0x8000
    s_nop 1
    s_cbranch_vccz Lpe_b_11
    s_mov_b32 s52, s24
    s_mov_b32 s53, s25
    s_mov_b32 s54, 256
    s_mov_b32 s55, 0x20000
    s_mov_b32 s64, 0
    v_lshlrev_b32 v4, 2, v1
Lp_b_10:
    buffer_load_dword v248, v4, s[52:55], s64 offen sc1
    s_waitcnt vmcnt(0)
    v_cmp_ne_u32 vcc, 1, v248
    s_sub_u32 s66, s66, 1
    s_cmp_eq_u32 s66, 0
    s_cbranch_scc1 Lpe_b_11
    s_cbranch_vccnz Lp_b_10
Lpe_b_11:
    s_mov_b64 exec, -1
    buffer_load_dwordx4 v17, s[32:35], s98 offen offset:1024 lds
    s_lshl_b32 s64, s60, 2
    s_add_u32 s64, s64, s63
    s_mul_i32 s64, s64, 4352
    s_add_u32 s64, s64, 24117248
    s_mov_b64 exec, 1
    v_mov_b32 v4, 0
    v_mov_b32 v5, 1
    buffer_atomic_add v5, v4, s[36:39], s64 offen sc1
    s_mov_b64 exec, -1
    s_waitcnt lgkmcnt(0)
    buffer_load_dwordx4 v18, s[32:35], s98 offen offset:2048 lds
    s_barrier
    s_mul_i32 s98, s101, 2
    s_add_u32 s98, s98, 2
    s_sub_u32 s99, s98, 6
    s_cselect_b32 s98, s98, s99
    s_mul_i32 s98, s98, 884736
    s_add_u32 s98, s98, s86
    s_add_u32 s98, s98, 4608
    s_add_u32 m0, s87, 36864
    s_nop 0
    buffer_load_dwordx4 v16, s[32:35], s98 offen offset:0 lds
    ds_write_b32 v84, v86
    ds_write_b32 v85, v87
    s_lshl_b32 s64, s60, 2
    s_add_u32 s64, s64, s63
    s_add_u32 s64, s64, 0
    s_cmp_lt_u32 s64, 162
    s_cselect_b32 s65, 0, 0x7ff00000
    s_lshl_b32 s64, s64, 10
    s_add_u32 s64, s64, s79
    v_add_u32 v4, s65, v32
    buffer_store_dwordx4 v[40:43], v4, s[36:39], s64 offen sc1
    buffer_load_dwordx4 v17, s[32:35], s98 offen offset:1024 lds
    buffer_load_dwordx4 v18, s[32:35], s98 offen offset:2048 lds
    s_waitcnt vmcnt(8)
    s_barrier
    s_mul_i32 s98, s101, 2
    s_add_u32 s98, s98, 3
    s_sub_u32 s99, s98, 6
    s_cselect_b32 s98, s98, s99
    s_mul_i32 s98, s98, 884736
    s_add_u32 s98, s98, s86
    s_add_u32 s98, s98, 4608
    s_add_u32 m0, s87, 55296
    s_nop 0
    buffer_load_dwordx4 v16, s[32:35], s98 offen offset:0 lds
    s_lshl_b32 s64, s60, 2
    s_add_u32 s64, s64, s63
    s_add_u32 s64, s64, 64
    s_cmp_lt_u32 s64, 162
    s_cselect_b32 s65, 0, 0x7ff00000
    s_lshl_b32 s64, s64, 10
    s_add_u32 s64, s64, s79
    v_add_u32 v4, s65, v32
    buffer_store_dwordx4 v[44:47], v4, s[36:39], s64 offen sc1
    buffer_load_dwordx4 v17, s[32:35], s98 offen offset:1024 lds
    buffer_load_dwordx4 v18, s[32:35], s98 offen offset:2048 lds
    s_waitcnt vmcnt(8)
    s_barrier
    s_mul_i32 s98, s101, 2
    s_add_u32 s98, s98, 4
    s_sub_u32 s99, s98, 6
    s_cselect_b32 s98, s98, s99
    s_mul_i32 s98, s98, 884736
    s_add_u32 s98, s98, s86
    s_add_u32 s98, s98, 4608
    s_add_u32 m0, s87, 73728
    s_nop 0
    buffer_load_dwordx4 v16, s[32:35], s98 offen offset:0 lds
    s_lshl_b32 s64, s60, 2
    s_add_u32 s64, s64, s63
    s_add_u32 s64, s64, 128
    s_cmp_lt_u32 s64, 162
    s_cselect_b32 s65, 0, 0x7ff00000
    s_lshl_b32 s64, s64, 10
    s_add_u32 s64, s64, s79
    v_add_u32 v4, s65, v32
    buffer_store_dwordx4 v[48:51], v4, s[36:39], s64 offen sc1
    buffer_load_dwordx4 v17, s[32:35], s98 offen offset:1024 lds
    buffer_load_dwordx4 v18, s[32:35], s98 offen offset:2048 lds
    s_waitcnt vmcnt(8)
    s_barrier
    s_mul_i32 s98, s101, 2
    s_add_u32 s98, s98, 5
    s_sub_u32 s99, s98, 6
    s_cselect_b32 s98, s98, s99
    s_mul_i32 s98, s98, 884736
    s_add_u32 s98, s98, s86
    s_add_u32 s98, s98, 4608
    s_add_u32 m0, s87, 0
    s_nop 0
    buffer_load_dwordx4 v16, s[32:35], s98 offen offset:0 lds
    buffer_load_dwordx4 v17, s[32:35], s98 offen offset:1024 lds
    buffer_load_dwordx4 v18, s[32:35], s98 offen offset:2048 lds
    s_waitcnt vmcnt(7)
    s_barrier
    s_mul_i32 s98, s101, 2
    s_add_u32 s98, s98, 0
    s_sub_u32 s99, s98, 6
    s_cselect_b32 s98, s98, s99
    s_mul_i32 s98, s98, 884736
    s_add_u32 s98, s98, s86
    s_add_u32 m0, s87, 18432
    s_nop 0
    buffer_load_dwordx4 v16, s[32:35], s98 offen offset:0 lds
    s_lshl_b32 s64, s60, 2
    s_add_u32 s64, s64, s63
    s_mul_i32 s64, s64, 4352
    s_add_u32 s64, s64, 24117248
    v_mov_b32 v4, 0
    s_mov_b64 exec, 1
    buffer_load_dword v248, v4, s[36:39], s64 offen sc1
    s_mov_b64 exec, -1
    buffer_load_dwordx4 v17, s[32:35], s98 offen offset:1024 lds
    buffer_load_dwordx4 v18, s[32:35], s98 offen offset:2048 lds
    s_waitcnt vmcnt(7)
    s_barrier
    s_mul_i32 s98, s101, 2
    s_add_u32 s98, s98, 1
    s_sub_u32 s99, s98, 6
    s_cselect_b32 s98, s98, s99
    s_mul_i32 s98, s98, 884736
    s_add_u32 s98, s98, s86
    s_add_u32 m0, s87, 36864
    s_nop 0
    buffer_load_dwordx4 v16, s[32:35], s98 offen offset:0 lds
    buffer_load_dwordx4 v17, s[32:35], s98 offen offset:1024 lds
    buffer_load_dwordx4 v18, s[32:35], s98 offen offset:2048 lds
    s_waitcnt vmcnt(7)
    s_barrier
LB_pz:
    s_mul_i32 s98, s101, 2
    s_add_u32 s98, s98, 2
    s_sub_u32 s99, s98, 6
    s_cselect_b32 s98, s98, s99
    s_mul_i32 s98, s98, 884736
    s_add_u32 s98, s98, s86
    s_add_u32 m0, s87, 55296
    s_nop 0
    buffer_load_dwordx4 v16, s[32:35], s98 offen offset:0 lds
    s_waitcnt vmcnt(6)
    s_mov_b64 exec, 1
    v_cmp_ne_u32 vcc, 16, v248
    s_mov_b32 s66, 0x8000
    s_nop 1
    s_cbranch_vccz Lpe_b_13
    s_lshl_b32 s64, s60, 2
    s_add_u32 s64, s64, s63
    s_mul_i32 s64, s64, 4352
    s_add_u32 s64, s64, 24117248
    v_mov_b32 v4, 0
Lp_b_12:
    buffer_load_dword v248, v4, s[36:39], s64 offen sc1
    s_waitcnt vmcnt(0)
    v_cmp_ne_u32 vcc, 16, v248
    s_sub_u32 s66, s66, 1
    s_cmp_eq_u32 s66, 0
    s_cbranch_scc1 Lpe_b_13
    s_cbranch_vccnz Lp_b_12
Lpe_b_13:
    s_mov_b64 exec, -1
    s_lshl_b32 s64, s61, 2
    s_add_u32 s64, s64, s63
    s_mul_i32 s64, s64, 4352
    s_add_u32 s64, s64, 25509888
    s_mov_b64 exec, 1
    v_mov_b32 v4, 0
    v_mov_b32 v5, 1
    buffer_atomic_add v5, v4, s[36:39], s64 offen sc1
    s_mov_b64 exec, -1
    buffer_load_dwordx4 v17, s[32:35], s98 offen offset:1024 lds
    buffer_load_dwordx4 v18, s[32:35], s98 offen offset:2048 lds
    v_lshlrev_b32 v37, 7, v1
    s_lshl_b32 s64, s61, 15
    s_lshl_b32 s65, s63, 13
    s_add_u32 s64, s64, s65
    buffer_load_dword v249, v37, s[40:43], s64 offen
    s_waitcnt vmcnt(8)
    s_barrier
    s_mul_i32 s98, s101, 2
    s_add_u32 s98, s98, 3
    s_sub_u32 s99, s98, 6
    s_cselect_b32 s98, s98, s99
    s_mul_i32 s98, s98, 884736
    s_add_u32 s98, s98, s86
    s_add_u32 m0, s87, 73728
    s_nop 0
    buffer_load_dwordx4 v16, s[32:35], s98 offen offset:0 lds
    ds_read_b128 v[200:203], v33 offset:0
    ds_read_b128 v[204:207], v33 offset:1024
    ds_read_b128 v[208:211], v33 offset:2048
    ds_read_b128 v[212:215], v33 offset:3072
    ds_read_b128 v[216:219], v33 offset:4096
    ds_read_b128 v[220:223], v33 offset:5120
    ds_read_b128 v[224:227], v33 offset:6144
    ds_read_b128 v[228:231], v33 offset:7168
    ds_read_b128 v[232:235], v33 offset:8192
    buffer_load_dwordx4 v17, s[32:35], s98 offen offset:1024 lds
    buffer_load_dwordx4 v18, s[32:35], s98 offen offset:2048 lds
    s_waitcnt vmcnt(8)
    s_barrier
    s_mul_i32 s98, s101, 2
    s_add_u32 s98, s98, 4
    s_sub_u32 s99, s98, 6
    s_cselect_b32 s98, s98, s99
    s_mul_i32 s98, s98, 884736
    s_add_u32 s98, s98, s86
    s_add_u32 m0, s87, 0
    s_nop 0
    buffer_load_dwordx4 v16, s[32:35], s98 offen offset:0 lds
    buffer_load_dwordx4 v17, s[32:35], s98 offen offset:1024 lds
    buffer_load_dwordx4 v18, s[32:35], s98 offen offset:2048 lds
    s_waitcnt vmcnt(7)
    s_barrier
    s_mul_i32 s98, s101, 2
    s_add_u32 s98, s98, 5
    s_sub_u32 s99, s98, 6
    s_cselect_b32 s98, s98, s99
    s_mul_i32 s98, s98, 884736
    s_add_u32 s98, s98, s86
    s_add_u32 m0, s87, 18432
    s_nop 0
    buffer_load_dwordx4 v16, s[32:35], s98 offen offset:0 lds
    buffer_load_dwordx4 v[52:55], v76, s[48:51], s57 offen
    buffer_load_dwordx4 v[56:59], v78, s[48:51], s57 offen
    buffer_load_dwordx4 v[60:63], v80, s[48:51], s57 offen
    s_mov_b32 s52, s20
    s_mov_b32 s53, s21
    s_mov_b32 s54, 2654208
    s_mov_b32 s55, 0x20000
    buffer_load_dwordx4 v[64:67], v91, s[52:55], s47 offen
    buffer_load_dwordx4 v[68:71], v92, s[52:55], s47 offen
    buffer_load_dwordx4 v[72:75], v93, s[52:55], s47 offen
    buffer_load_dwordx4 v17, s[32:35], s98 offen offset:1024 lds
    buffer_load_dwordx4 v18, s[32:35], s98 offen offset:2048 lds
    s_waitcnt vmcnt(12)
    s_barrier
    s_mul_i32 s98, s101, 2
    s_add_u32 s98, s98, 0
    s_sub_u32 s99, s98, 6
    s_cselect_b32 s98, s98, s99
    s_mul_i32 s98, s98, 884736
    s_add_u32 s85, s98, s88
    s_cmp_ge_u32 s63, 3
    s_cbranch_scc1 Lc_b_14
    s_add_u32 m0, s72, 49152
    s_nop 0
    buffer_load_dwordx4 v19, s[32:35], s85 offen lds
Lc_b_14:
    s_add_u32 s98, s98, s86
    s_add_u32 s98, s98, 128
    s_add_u32 m0, s87, 36864
    s_waitcnt lgkmcnt(0)
    s_lshl_b32 s64, s60, 14
    s_lshl_b32 s65, s63, 8
    s_add_u32 s64, s64, s65
    s_add_u32 s64, s64, 23068672
    v_lshlrev_b32 v6, 10, v3
    v_lshl_add_u32 v6, v2, 4, v6
    buffer_load_dwordx4 v[184:187], v6, s[36:39], s64 offen sc1
    s_add_u32 s64, s64, 4096
    buffer_load_dwordx4 v[188:191], v6, s[36:39], s64 offen sc1
    s_add_u32 s64, s64, 4096
    buffer_load_dwordx4 v[192:195], v6, s[36:39], s64 offen sc1
    s_add_u32 s64, s64, 4096
    buffer_load_dwordx4 v[196:199], v6, s[36:39], s64 offen sc1
    buffer_load_dwordx4 v16, s[32:35], s98 offen offset:0 lds
    buffer_load_dwordx4 v17, s[32:35], s98 offen offset:1024 lds
    buffer_load_dwordx4 v18, s[32:35], s98 offen offset:2048 lds
    s_waitcnt vmcnt(16)
    s_barrier
    s_mul_i32 s98, s101, 2
    s_add_u32 s98, s98, 1
    s_sub_u32 s99, s98, 6
    s_cselect_b32 s98, s98, s99
    s_mul_i32 s98, s98, 884736
    s_add_u32 s85, s98, s88
    s_cmp_ge_u32 s63, 3
    s_cbranch_scc1 Lc_b_15
    s_add_u32 m0, s72, 67584
    s_nop 0
    buffer_load_dwordx4 v19, s[32:35], s85 offen lds
Lc_b_15:
    s_add_u32 s98, s98, s86
    s_add_u32 s98, s98, 128
    s_add_u32 m0, s87, 55296
    s_waitcnt vmcnt(3)
    v_max3_u32 v7, v184, v185, v186
    v_max3_u32 v8, v187, v188, v189
    v_max3_u32 v7, v7, v190, v191
    v_max3_u32 v8, v8, v192, v193
    v_max3_u32 v7, v7, v194, v195
    v_max3_u32 v8, v8, v196, v197
    v_max3_u32 v7, v7, v198, v199
    v_max_u32 v7, v7, v8
    v_cmp_eq_u32 vcc, -1, v7
    s_mov_b32 s66, 0x8000
    s_nop 1
    s_cbranch_vccz Lspe_b_17
Lsp_b_16:
    s_lshl_b32 s64, s60, 14
    s_lshl_b32 s65, s63, 8
    s_add_u32 s64, s64, s65
    s_add_u32 s64, s64, 23068672
    v_lshlrev_b32 v6, 10, v3
    v_lshl_add_u32 v6, v2, 4, v6
    buffer_load_dwordx4 v[184:187], v6, s[36:39], s64 offen sc1
    s_add_u32 s64, s64, 4096
    buffer_load_dwordx4 v[188:191], v6, s[36:39], s64 offen sc1
    s_add_u32 s64, s64, 4096
    buffer_load_dwordx4 v[192:195], v6, s[36:39], s64 offen sc1
    s_add_u32 s64, s64, 4096
    buffer_load_dwordx4 v[196:199], v6, s[36:39], s64 offen sc1
    s_waitcnt vmcnt(0)
    v_max3_u32 v7, v184, v185, v186
    v_max3_u32 v8, v187, v188, v189
    v_max3_u32 v7, v7, v190, v191
    v_max3_u32 v8, v8, v192, v193
    v_max3_u32 v7, v7, v194, v195
    v_max3_u32 v8, v8, v196, v197
    v_max3_u32 v7, v7, v198, v199
    v_max_u32 v7, v7, v8
    v_cmp_eq_u32 vcc, -1, v7
    s_sub_u32 s66, s66, 1
    s_cmp_eq_u32 s66, 0
    s_cbranch_scc1 Lspe_b_17
    s_cbranch_vccnz Lsp_b_16
Lspe_b_17:
    buffer_load_dwordx4 v16, s[32:35], s98 offen offset:0 lds
    buffer_load_dwordx4 v17, s[32:35], s98 offen offset:1024 lds
    buffer_load_dwordx4 v18, s[32:35], s98 offen offset:2048 lds
    s_barrier
    s_mul_i32 s98, s101, 2
    s_add_u32 s98, s98, 2
    s_sub_u32 s99, s98, 6
    s_cselect_b32 s98, s98, s99
    s_mul_i32 s98, s98, 884736
    s_add_u32 s85, s98, s88
    s_cmp_ge_u32 s63, 3
    s_cbranch_scc1 Lc_b_18
    s_add_u32 m0, s72, 86016
    s_nop 0
    buffer_load_dwordx4 v19, s[32:35], s85 offen lds
Lc_b_18:
    s_add_u32 s98, s98, s86
    s_add_u32 s98, s98, 128
    s_add_u32 m0, s87, 73728
    s_nop 0
    buffer_load_dwordx4 v16, s[32:35], s98 offen offset:0 lds
    buffer_load_dwordx4 v17, s[32:35], s98 offen offset:1024 lds
    buffer_load_dwordx4 v18, s[32:35], s98 offen offset:2048 lds
    s_waitcnt vmcnt(6)
    s_barrier
    s_mul_i32 s98, s101, 2
    s_add_u32 s98, s98, 3
    s_sub_u32 s99, s98, 6
    s_cselect_b32 s98, s98, s99
    s_mul_i32 s98, s98, 884736
    s_add_u32 s85, s98, s88
    s_cmp_ge_u32 s63, 3
    s_cbranch_scc1 Lc_b_19
    s_add_u32 m0, s72, 12288
    s_nop 0
    buffer_load_dwordx4 v19, s[32:35], s85 offen lds
Lc_b_19:
    s_add_u32 s98, s98, s86
    s_add_u32 s98, s98, 128
    s_add_u32 m0, s87, 0
    s_lshl_b32 s64, s61, 2
    s_add_u32 s64, s64, s63
    s_mul_i32 s64, s64, 4352
    s_add_u32 s64, s64, 25509888
    v_mov_b32 v4, 0
    s_mov_b64 exec, 1
    buffer_load_dword v35, v4, s[36:39], s64 offen sc1
    s_mov_b64 exec, -1
    buffer_load_dwordx4 v16, s[32:35], s98 offen offset:0 lds
    v_add_f32 v184, v184, v188
    v_add_f32 v192, v192, v196
    v_add_f32 v185, v185, v189
    v_add_f32 v193, v193, v197
    v_add_f32 v186, v186, v190
    v_add_f32 v194, v194, v198
    v_add_f32 v187, v187, v191
    v_add_f32 v195, v195, v199
    v_add_f32 v184, v184, v192
    v_add_f32 v185, v185, v193
    v_add_f32 v186, v186, v194
    v_add_f32 v187, v187, v195
    buffer_load_dwordx4 v17, s[32:35], s98 offen offset:1024 lds
    v_mov_b32 v188, v184
    v_mov_b32 v189, v185
    v_mov_b32 v190, v186
    v_mov_b32 v191, v187
    v_permlane16_swap_b32 v184, v188
    v_permlane16_swap_b32 v185, v189
    v_permlane16_swap_b32 v186, v190
    v_permlane16_swap_b32 v187, v191
    v_add_f32 v184, v184, v188
    v_add_f32 v185, v185, v189
    v_add_f32 v186, v186, v190
    v_add_f32 v187, v187, v191
    buffer_load_dwordx4 v18, s[32:35], s98 offen offset:2048 lds
    s_waitcnt vmcnt(7)
    s_barrier
    s_mul_i32 s98, s101, 2
    s_add_u32 s98, s98, 4
    s_sub_u32 s99, s98, 6
    s_cselect_b32 s98, s98, s99
    s_mul_i32 s98, s98, 884736
    s_add_u32 s85, s98, s88
    s_cmp_ge_u32 s63, 3
    s_cbranch_scc1 Lc_b_20
    s_add_u32 m0, s72, 30720
    s_nop 0
    buffer_load_dwordx4 v19, s[32:35], s85 offen lds
Lc_b_20:
    s_add_u32 s98, s98, s86
    s_add_u32 s98, s98, 128
    s_add_u32 m0, s87, 18432
    v_mov_b32 v188, v184
    v_mov_b32 v189, v185
    v_mov_b32 v190, v186
    v_mov_b32 v191, v187
    v_permlane32_swap_b32 v184, v188
    v_permlane32_swap_b32 v185, v189
    v_permlane32_swap_b32 v186, v190
    v_permlane32_swap_b32 v187, v191
    v_add_f32 v184, v184, v188
    v_add_f32 v185, v185, v189
    v_add_f32 v186, v186, v190
    v_add_f32 v187, v187, v191
    buffer_load_dwordx4 v16, s[32:35], s98 offen offset:0 lds
    v_mul_f32 v184, 0x39e38e39, v184
    v_mul_f32 v185, 0x39e38e39, v185
    v_mul_f32 v186, 0x39e38e39, v186
    v_mul_f32 v187, 0x39e38e39, v187
    v_fma_f32 v186, -v184, v184, v186
    v_fma_f32 v187, -v185, v185, v187
    v_max_f32 v186, 0, v186
    v_max_f32 v187, 0, v187
    v_add_f32 v186, 0x3727c5ac, v186
    v_add_f32 v187, 0x3727c5ac, v187
    v_rsq_f32 v188, v186
    v_rsq_f32 v189, v187
    v_mul_f32 v190, -v184, v188
    v_mul_f32 v191, -v185, v189
    buffer_load_dwordx4 v17, s[32:35], s98 offen offset:1024 lds
    buffer_load_dwordx4 v18, s[32:35], s98 offen offset:2048 lds
    s_mul_i32 s64, s63, 12288
    s_add_u32 s64, s64, 103424
    v_lshlrev_b32 v6, 4, v2
    v_add_u32 v6, s64, v6
    v_lshlrev_b32 v7, 6, v3
    v_add_u32 v7, s64, v7
    ds_write_b128 v6, v[188:191]
    ds_read_b128 v[184:187], v7 offset:0
    ds_read_b128 v[188:191], v7 offset:16
    ds_read_b128 v[192:195], v7 offset:32
    ds_read_b128 v[196:199], v7 offset:48
    s_lshl_b32 s73, s61, 6
    s_lshl_b32 s64, s60, 2
    s_add_u32 s73, s73, s64
    s_add_u32 s73, s73, s63
    s_mul_i32 s73, s73, 9216
    s_waitcnt vmcnt(7)
    s_barrier
    s_mul_i32 s98, s101, 2
    s_add_u32 s98, s98, 5
    s_sub_u32 s99, s98, 6
    s_cselect_b32 s98, s98, s99
    s_mul_i32 s98, s98, 884736
    s_add_u32 s85, s98, s88
    s_cmp_ge_u32 s63, 3
    s_cbranch_scc1 Lc_b_21
    s_add_u32 m0, s72, 49152
    s_nop 0
    buffer_load_dwordx4 v19, s[32:35], s85 offen lds
Lc_b_21:
    s_add_u32 s98, s98, s86
    s_add_u32 s98, s98, 128
    s_add_u32 m0, s87, 36864
    s_waitcnt vmcnt(6)
    s_mov_b64 exec, 1
    v_cmp_ne_u32 vcc, 16, v35
    s_mov_b32 s66, 0x8000
    s_nop 1
    s_cbranch_vccz Lpe_b_23
    s_lshl_b32 s64, s61, 2
    s_add_u32 s64, s64, s63
    s_mul_i32 s64, s64, 4352
    s_add_u32 s64, s64, 25509888
    v_mov_b32 v4, 0
Lp_b_22:
    buffer_load_dword v35, v4, s[36:39], s64 offen sc1
    s_waitcnt vmcnt(0)
    v_cmp_ne_u32 vcc, 16, v35
    s_sub_u32 s66, s66, 1
    s_cmp_eq_u32 s66, 0
    s_cbranch_scc1 Lpe_b_23
    s_cbranch_vccnz Lp_b_22
Lpe_b_23:
    s_mov_b64 exec, -1
    buffer_load_dwordx4 v16, s[32:35], s98 offen offset:0 lds
    buffer_load_dwordx4 v17, s[32:35], s98 offen offset:1024 lds
    s_waitcnt lgkmcnt(0)
    v_lshlrev_b32 v112, 16, v200
    v_and_b32 v113, s83, v200
    v_lshlrev_b32 v114, 16, v201
    v_and_b32 v115, s83, v201
    v_lshlrev_b32 v116, 16, v202
    v_and_b32 v117, s83, v202
    v_lshlrev_b32 v118, 16, v203
    v_and_b32 v119, s83, v203
    buffer_load_dwordx4 v18, s[32:35], s98 offen offset:2048 lds
    v_fma_f32 v112, v112, v184, v186
    v_fma_f32 v113, v113, v185, v187
    v_fma_f32 v114, v114, v188, v190
    v_fma_f32 v115, v115, v189, v191
    v_fma_f32 v116, v116, v192, v194
    v_fma_f32 v117, v117, v193, v195
    v_fma_f32 v118, v118, v196, v198
    v_fma_f32 v119, v119, v197, v199
    s_waitcnt vmcnt(6)
    s_barrier
    s_mul_i32 s98, s101, 3
    s_add_u32 s98, s98, 0
    s_sub_u32 s99, s98, 9
    s_cselect_b32 s98, s98, s99
    s_mul_i32 s98, s98, 18432
    s_add_u32 s98, s98, s79
    s_cmp_ge_u32 s63, 2
    s_cbranch_scc1 Lc_b_24
    s_add_u32 m0, s72, 71680
    s_nop 0
    buffer_load_dwordx4 v31, s[36:39], s98 offen sc1 lds
Lc_b_24:
    s_add_u32 m0, s74, 55296
    v_cvt_pk_bf16_f32 v112, v112, v113
    v_cvt_pk_bf16_f32 v113, v114, v115
    v_cvt_pk_bf16_f32 v114, v116, v117
    v_cvt_pk_bf16_f32 v115, v118, v119
    buffer_store_dwordx4 v[112:115], v32, s[36:39], s73 offen offset:0 sc1
    buffer_load_dwordx4 v30, s[36:39], s98 offen offset:0 sc1 lds
    v_lshlrev_b32 v120, 16, v204
    v_and_b32 v121, s83, v204
    v_lshlrev_b32 v122, 16, v205
    v_and_b32 v123, s83, v205
    v_lshlrev_b32 v124, 16, v206
    v_and_b32 v125, s83, v206
    v_lshlrev_b32 v126, 16, v207
    v_and_b32 v127, s83, v207
    buffer_load_dwordx4 v30, s[36:39], s98 offen offset:1024 sc1 lds
    buffer_load_dwordx4 v30, s[36:39], s98 offen offset:2048 sc1 lds
    v_fma_f32 v120, v120, v184, v186
    v_fma_f32 v121, v121, v185, v187
    v_fma_f32 v122, v122, v188, v190
    v_fma_f32 v123, v123, v189, v191
    v_fma_f32 v124, v124, v192, v194
    v_fma_f32 v125, v125, v193, v195
    v_fma_f32 v126, v126, v196, v198
    v_fma_f32 v127, v127, v197, v199
    buffer_load_dwordx4 v30, s[36:39], s98 offen offset:3072 sc1 lds
    v_cvt_pk_bf16_f32 v120, v120, v121
    v_cvt_pk_bf16_f32 v121, v122, v123
    v_cvt_pk_bf16_f32 v122, v124, v125
    v_cvt_pk_bf16_f32 v123, v126, v127
    buffer_store_dwordx4 v[120:123], v32, s[36:39], s73 offen offset:1024 sc1
    s_waitcnt vmcnt(9)
    s_barrier
    s_mul_i32 s98, s101, 3
    s_add_u32 s98, s98, 1
    s_sub_u32 s99, s98, 9
    s_cselect_b32 s98, s98, s99
    s_mul_i32 s98, s98, 18432
    s_add_u32 s98, s98, s79
    s_cmp_ge_u32 s63, 2
    s_cbranch_scc1 Lc_b_25
    s_add_u32 m0, s72, 90112
    s_nop 0
    buffer_load_dwordx4 v31, s[36:39], s98 offen sc1 lds
Lc_b_25:
    s_add_u32 m0, s74, 73728
    v_lshlrev_b32 v128, 16, v208
    v_and_b32 v129, s83, v208
    v_lshlrev_b32 v130, 16, v209
    v_and_b32 v131, s83, v209
    v_lshlrev_b32 v132, 16, v210
    v_and_b32 v133, s83, v210
    v_lshlrev_b32 v134, 16, v211
    v_and_b32 v135, s83, v211
    buffer_load_dwordx4 v30, s[36:39], s98 offen offset:0 sc1 lds
    buffer_load_dwordx4 v30, s[36:39], s98 offen offset:1024 sc1 lds
    v_fma_f32 v128, v128, v184, v186
    v_fma_f32 v129, v129, v185, v187
    v_fma_f32 v130, v130, v188, v190
    v_fma_f32 v131, v131, v189, v191
    v_fma_f32 v132, v132, v192, v194
    v_fma_f32 v133, v133, v193, v195
    v_fma_f32 v134, v134, v196, v198
    v_fma_f32 v135, v135, v197, v199
    buffer_load_dwordx4 v30, s[36:39], s98 offen offset:2048 sc1 lds
    v_cvt_pk_bf16_f32 v128, v128, v129
    v_cvt_pk_bf16_f32 v129, v130, v131
    v_cvt_pk_bf16_f32 v130, v132, v133
    v_cvt_pk_bf16_f32 v131, v134, v135
    buffer_store_dwordx4 v[128:131], v32, s[36:39], s73 offen offset:2048 sc1
    buffer_load_dwordx4 v30, s[36:39], s98 offen offset:3072 sc1 lds
    s_waitcnt vmcnt(11)
    s_barrier
    s_mul_i32 s98, s101, 3
    s_add_u32 s98, s98, 2
    s_sub_u32 s99, s98, 9
    s_cselect_b32 s98, s98, s99
    s_mul_i32 s98, s98, 18432
    s_add_u32 s98, s98, s79
    s_cmp_ge_u32 s63, 2
    s_cbranch_scc1 Lc_b_26
    s_add_u32 m0, s72, 16384
    s_nop 0
    buffer_load_dwordx4 v31, s[36:39], s98 offen sc1 lds
Lc_b_26:
    s_add_u32 m0, s74, 0
    v_lshlrev_b32 v136, 16, v212
    v_and_b32 v137, s83, v212
    v_lshlrev_b32 v138, 16, v213
    v_and_b32 v139, s83, v213
    v_lshlrev_b32 v140, 16, v214
    v_and_b32 v141, s83, v214
    v_lshlrev_b32 v142, 16, v215
    v_and_b32 v143, s83, v215
    buffer_load_dwordx4 v30, s[36:39], s98 offen offset:0 sc1 lds
    v_fma_f32 v136, v136, v184, v186
    v_fma_f32 v137, v137, v185, v187
    v_fma_f32 v138, v138, v188, v190
    v_fma_f32 v139, v139, v189, v191
    v_fma_f32 v140, v140, v192, v194
    v_fma_f32 v141, v141, v193, v195
    v_fma_f32 v142, v142, v196, v198
    v_fma_f32 v143, v143, v197, v199
    buffer_load_dwordx4 v30, s[36:39], s98 offen offset:1024 sc1 lds
    buffer_load_dwordx4 v30, s[36:39], s98 offen offset:2048 sc1 lds
    v_cvt_pk_bf16_f32 v136, v136, v137
    v_cvt_pk_bf16_f32 v137, v138, v139
    v_cvt_pk_bf16_f32 v138, v140, v141
    v_cvt_pk_bf16_f32 v139, v142, v143
    buffer_store_dwordx4 v[136:139], v32, s[36:39], s73 offen offset:3072 sc1
    buffer_load_dwordx4 v30, s[36:39], s98 offen offset:3072 sc1 lds
    s_waitcnt vmcnt(11)
    s_barrier
    s_mul_i32 s98, s101, 3
    s_add_u32 s98, s98, 3
    s_sub_u32 s99, s98, 9
    s_cselect_b32 s98, s98, s99
    s_mul_i32 s98, s98, 18432
    s_add_u32 s98, s98, s79
    s_cmp_ge_u32 s63, 2
    s_cbranch_scc1 Lc_b_27
    s_add_u32 m0, s72, 34816
    s_nop 0
    buffer_load_dwordx4 v31, s[36:39], s98 offen sc1 lds
Lc_b_27:
    s_add_u32 m0, s74, 18432
    v_lshlrev_b32 v144, 16, v216
    v_and_b32 v145, s83, v216
    v_lshlrev_b32 v146, 16, v217
    v_and_b32 v147, s83, v217
    v_lshlrev_b32 v148, 16, v218
    v_and_b32 v149, s83, v218
    v_lshlrev_b32 v150, 16, v219
    v_and_b32 v151, s83, v219
    buffer_load_dwordx4 v30, s[36:39], s98 offen offset:0 sc1 lds
    v_fma_f32 v144, v144, v184, v186
    v_fma_f32 v145, v145, v185, v187
    v_fma_f32 v146, v146, v188, v190
    v_fma_f32 v147, v147, v189, v191
    v_fma_f32 v148, v148, v192, v194
    v_fma_f32 v149, v149, v193, v195
    v_fma_f32 v150, v150, v196, v198
    v_fma_f32 v151, v151, v197, v199
    buffer_load_dwordx4 v30, s[36:39], s98 offen offset:1024 sc1 lds
    v_cvt_pk_bf16_f32 v144, v144, v145
    v_cvt_pk_bf16_f32 v145, v146, v147
    v_cvt_pk_bf16_f32 v146, v148, v149
    v_cvt_pk_bf16_f32 v147, v150, v151
    s_add_u32 s73, s73, 4096
    buffer_store_dwordx4 v[144:147], v32, s[36:39], s73 offen offset:0 sc1
    buffer_load_dwordx4 v30, s[36:39], s98 offen offset:2048 sc1 lds
    buffer_load_dwordx4 v30, s[36:39], s98 offen offset:3072 sc1 lds
    v_lshlrev_b32 v152, 16, v220
    v_and_b32 v153, s83, v220
    v_lshlrev_b32 v154, 16, v221
    v_and_b32 v155, s83, v221
    v_lshlrev_b32 v156, 16, v222
    v_and_b32 v157, s83, v222
    v_lshlrev_b32 v158, 16, v223
    v_and_b32 v159, s83, v223
    s_waitcnt vmcnt(10)
    s_barrier
    s_mul_i32 s98, s101, 3
    s_add_u32 s98, s98, 4
    s_sub_u32 s99, s98, 9
    s_cselect_b32 s98, s98, s99
    s_mul_i32 s98, s98, 18432
    s_add_u32 s98, s98, s79
    s_cmp_ge_u32 s63, 2
    s_cbranch_scc1 Lc_b_28
    s_add_u32 m0, s72, 53248
    s_nop 0
    buffer_load_dwordx4 v31, s[36:39], s98 offen sc1 lds
Lc_b_28:
    s_add_u32 m0, s74, 36864
    v_fma_f32 v152, v152, v184, v186
    v_fma_f32 v153, v153, v185, v187
    v_fma_f32 v154, v154, v188, v190
    v_fma_f32 v155, v155, v189, v191
    v_fma_f32 v156, v156, v192, v194
    v_fma_f32 v157, v157, v193, v195
    v_fma_f32 v158, v158, v196, v198
    v_fma_f32 v159, v159, v197, v199
    buffer_load_dwordx4 v30, s[36:39], s98 offen offset:0 sc1 lds
    v_cvt_pk_bf16_f32 v152, v152, v153
    v_cvt_pk_bf16_f32 v153, v154, v155
    v_cvt_pk_bf16_f32 v154, v156, v157
    v_cvt_pk_bf16_f32 v155, v158, v159
    buffer_store_dwordx4 v[152:155], v32, s[36:39], s73 offen offset:1024 sc1
    buffer_load_dwordx4 v30, s[36:39], s98 offen offset:1024 sc1 lds
    buffer_load_dwordx4 v30, s[36:39], s98 offen offset:2048 sc1 lds
    buffer_load_dwordx4 v30, s[36:39], s98 offen offset:3072 sc1 lds
    s_waitcnt vmcnt(10)
    s_barrier
    s_mul_i32 s98, s101, 3
    s_add_u32 s98, s98, 5
    s_sub_u32 s99, s98, 9
    s_cselect_b32 s98, s98, s99
    s_mul_i32 s98, s98, 18432
    s_add_u32 s98, s98, s79
    s_cmp_ge_u32 s63, 2
    s_cbranch_scc1 Lc_b_29
    s_add_u32 m0, s72, 71680
    s_nop 0
    buffer_load_dwordx4 v31, s[36:39], s98 offen sc1 lds
Lc_b_29:
    s_add_u32 m0, s74, 55296
    v_lshlrev_b32 v160, 16, v224
    v_and_b32 v161, s83, v224
    v_lshlrev_b32 v162, 16, v225
    v_and_b32 v163, s83, v225
    v_lshlrev_b32 v164, 16, v226
    v_and_b32 v165, s83, v226
    v_lshlrev_b32 v166, 16, v227
    v_and_b32 v167, s83, v227
    buffer_load_dwordx4 v30, s[36:39], s98 offen offset:0 sc1 lds
    v_fma_f32 v160, v160, v184, v186
    v_fma_f32 v161, v161, v185, v187
    v_fma_f32 v162, v162, v188, v190
    v_fma_f32 v163, v163, v189, v191
    v_fma_f32 v164, v164, v192, v194
    v_fma_f32 v165, v165, v193, v195
    v_fma_f32 v166, v166, v196, v198
    v_fma_f32 v167, v167, v197, v199
    buffer_load_dwordx4 v30, s[36:39], s98 offen offset:1024 sc1 lds
    v_cvt_pk_bf16_f32 v160, v160, v161
    v_cvt_pk_bf16_f32 v161, v162, v163
    v_cvt_pk_bf16_f32 v162, v164, v165
    v_cvt_pk_bf16_f32 v163, v166, v167
    buffer_store_dwordx4 v[160:163], v32, s[36:39], s73 offen offset:2048 sc1
    buffer_load_dwordx4 v30, s[36:39], s98 offen offset:2048 sc1 lds
    buffer_load_dwordx4 v30, s[36:39], s98 offen offset:3072 sc1 lds
    v_lshlrev_b32 v168, 16, v228
    v_and_b32 v169, s83, v228
    v_lshlrev_b32 v170, 16, v229
    v_and_b32 v171, s83, v229
    v_lshlrev_b32 v172, 16, v230
    v_and_b32 v173, s83, v230
    v_lshlrev_b32 v174, 16, v231
    v_and_b32 v175, s83, v231
    s_waitcnt vmcnt(10)
    s_barrier
    s_mul_i32 s98, s101, 3
    s_add_u32 s98, s98, 6
    s_sub_u32 s99, s98, 9
    s_cselect_b32 s98, s98, s99
    s_mul_i32 s98, s98, 18432
    s_add_u32 s98, s98, s79
    s_cmp_ge_u32 s63, 2
    s_cbranch_scc1 Lc_b_30
    s_add_u32 m0, s72, 90112
    s_nop 0
    buffer_load_dwordx4 v31, s[36:39], s98 offen sc1 lds
Lc_b_30:
    s_add_u32 m0, s74, 73728
    v_fma_f32 v168, v168, v184, v186
    v_fma_f32 v169, v169, v185, v187
    v_fma_f32 v170, v170, v188, v190
    v_fma_f32 v171, v171, v189, v191
    v_fma_f32 v172, v172, v192, v194
    v_fma_f32 v173, v173, v193, v195
    v_fma_f32 v174, v174, v196, v198
    v_fma_f32 v175, v175, v197, v199
    buffer_load_dwordx4 v30, s[36:39], s98 offen offset:0 sc1 lds
    v_cvt_pk_bf16_f32 v168, v168, v169
    v_cvt_pk_bf16_f32 v169, v170, v171
    v_cvt_pk_bf16_f32 v170, v172, v173
    v_cvt_pk_bf16_f32 v171, v174, v175
    buffer_store_dwordx4 v[168:171], v32, s[36:39], s73 offen offset:3072 sc1
    buffer_load_dwordx4 v30, s[36:39], s98 offen offset:1024 sc1 lds
    buffer_load_dwordx4 v30, s[36:39], s98 offen offset:2048 sc1 lds
    buffer_load_dwordx4 v30, s[36:39], s98 offen offset:3072 sc1 lds
    s_waitcnt vmcnt(10)
    s_barrier
    s_mul_i32 s98, s101, 3
    s_add_u32 s98, s98, 7
    s_sub_u32 s99, s98, 9
    s_cselect_b32 s98, s98, s99
    s_mul_i32 s98, s98, 18432
    s_add_u32 s98, s98, s79
    s_cmp_ge_u32 s63, 2
    s_cbranch_scc1 Lc_b_31
    s_add_u32 m0, s72, 16384
    s_nop 0
    buffer_load_dwordx4 v31, s[36:39], s98 offen sc1 lds
Lc_b_31:
    s_add_u32 m0, s74, 0
    v_lshlrev_b32 v176, 16, v232
    v_and_b32 v177, s83, v232
    v_lshlrev_b32 v178, 16, v233
    v_and_b32 v179, s83, v233
    v_lshlrev_b32 v180, 16, v234
    v_and_b32 v181, s83, v234
    v_lshlrev_b32 v182, 16, v235
    v_and_b32 v183, s83, v235
    buffer_load_dwordx4 v30, s[36:39], s98 offen offset:0 sc1 lds
    v_fma_f32 v176, v176, v184, v186
    v_fma_f32 v177, v177, v185, v187
    v_fma_f32 v178, v178, v188, v190
    v_fma_f32 v179, v179, v189, v191
    v_fma_f32 v180, v180, v192, v194
    v_fma_f32 v181, v181, v193, v195
    v_fma_f32 v182, v182, v196, v198
    v_fma_f32 v183, v183, v197, v199
    buffer_load_dwordx4 v30, s[36:39], s98 offen offset:1024 sc1 lds
    v_cvt_pk_bf16_f32 v176, v176, v177
    v_cvt_pk_bf16_f32 v177, v178, v179
    v_cvt_pk_bf16_f32 v178, v180, v181
    v_cvt_pk_bf16_f32 v179, v182, v183
    s_add_u32 s73, s73, 4096
    buffer_store_dwordx4 v[176:179], v32, s[36:39], s73 offen offset:0 sc1
    buffer_load_dwordx4 v30, s[36:39], s98 offen offset:2048 sc1 lds
    buffer_load_dwordx4 v30, s[36:39], s98 offen offset:3072 sc1 lds
    s_waitcnt vmcnt(10)
    s_barrier
    s_mul_i32 s98, s101, 3
    s_add_u32 s98, s98, 8
    s_sub_u32 s99, s98, 9
    s_cselect_b32 s98, s98, s99
    s_mul_i32 s98, s98, 18432
    s_add_u32 s98, s98, s79
    s_cmp_ge_u32 s63, 2
    s_cbranch_scc1 Lc_b_32
    s_add_u32 m0, s72, 34816
    s_nop 0
    buffer_load_dwordx4 v31, s[36:39], s98 offen sc1 lds
Lc_b_32:
    s_add_u32 m0, s74, 18432
    s_lshl_b32 s70, s60, 1
    s_and_b32 s64, s61, 1
    s_add_u32 s70, s70, s64
    s_cmp_lt_u32 s70, 45
    s_cselect_b32 s71, 0, 0x7ff00000
    s_lshr_b32 s64, s61, 1
    s_mul_i32 s64, s64, 45
    s_add_u32 s64, s64, s70
    s_mul_i32 s64, s64, 9216
    s_add_u32 s64, s64, 32505856
    s_add_u32 s65, s71, s78
    v_add_u32 v4, s65, v32
    buffer_store_dwordx4 v[52:55], v4, s[36:39], s64 offen offset:0 sc1
    buffer_load_dwordx4 v30, s[36:39], s98 offen offset:0 sc1 lds
    buffer_load_dwordx4 v30, s[36:39], s98 offen offset:1024 sc1 lds
    buffer_load_dwordx4 v30, s[36:39], s98 offen offset:2048 sc1 lds
    buffer_load_dwordx4 v30, s[36:39], s98 offen offset:3072 sc1 lds
    s_waitcnt vmcnt(10)
    s_barrier
    s_add_u32 m0, s74, 36864
    s_mov_b32 s98, 0
    buffer_load_dwordx4 v26, s[40:43], s98 offen offset:0 lds
    s_waitcnt vmcnt(8)
    s_lshl_b32 s64, s61, 2
    s_add_u32 s64, s64, s63
    s_mul_i32 s64, s64, 4352
    s_add_u32 s64, s64, 24395776
    s_mov_b64 exec, 1
    v_mov_b32 v4, 0
    v_mov_b32 v5, 1
    buffer_atomic_add v5, v4, s[36:39], s64 offen sc1
    s_mov_b64 exec, -1
    buffer_load_dwordx4 v27, s[40:43], s98 offen offset:1024 lds
    s_lshl_b32 s70, s60, 1
    s_and_b32 s64, s61, 1
    s_add_u32 s70, s70, s64
    s_cmp_lt_u32 s70, 45
    s_cselect_b32 s71, 0, 0x7ff00000
    s_lshr_b32 s64, s61, 1
    s_mul_i32 s64, s64, 45
    s_add_u32 s64, s64, s70
    s_mul_i32 s64, s64, 9216
    s_add_u32 s64, s64, 32505856
    s_add_u32 s65, s71, s78
    v_add_u32 v4, s65, v32
    buffer_store_dwordx4 v[56:59], v4, s[36:39], s64 offen offset:1024 sc1
    buffer_load_dwordx4 v28, s[40:43], s98 offen offset:2048 lds
    buffer_load_dwordx4 v29, s[40:43], s98 offen offset:3072 lds
    s_waitcnt vmcnt(11)
    s_barrier
    s_lshl_b32 s70, s60, 1
    s_and_b32 s64, s61, 1
    s_add_u32 s70, s70, s64
    s_cmp_lt_u32 s70, 45
    s_cselect_b32 s71, 0, 0x7ff00000
    s_lshr_b32 s64, s61, 1
    s_mul_i32 s64, s64, 45
    s_add_u32 s64, s64, s70
    s_mul_i32 s64, s64, 9216
    s_add_u32 s64, s64, 32505856
    s_cmp_eq_u32 s63, 0
    s_cselect_b32 s65, s71, 0x7ff00000
    s_add_u32 s65, s65, 8192
    v_add_u32 v4, s65, v32
    buffer_store_dwordx4 v[60:63], v4, s[36:39], s64 offen sc1
    s_waitcnt vmcnt(7)
    s_barrier
    s_add_u32 m0, s74, 71680
    s_mov_b32 s98, 128
    buffer_load_dwordx4 v26, s[40:43], s98 offen offset:0 lds
    s_lshl_b32 s70, s60, 1
    s_and_b32 s64, s61, 1
    s_add_u32 s70, s70, s64
    s_add_u32 s70, s70, 32
    s_cmp_lt_u32 s70, 45
    s_cselect_b32 s71, 0, 0x7ff00000
    s_lshr_b32 s64, s61, 1
    s_mul_i32 s64, s64, 45
    s_add_u32 s64, s64, s70
    s_mul_i32 s64, s64, 9216
    s_add_u32 s64, s64, 32505856
    s_add_u32 s65, s71, s78
    v_add_u32 v4, s65, v32
    buffer_store_dwordx4 v[64:67], v4, s[36:39], s64 offen offset:0 sc1
    buffer_load_dwordx4 v27, s[40:43], s98 offen offset:1024 lds
    buffer_load_dwordx4 v28, s[40:43], s98 offen offset:2048 lds
    buffer_load_dwordx4 v29, s[40:43], s98 offen offset:3072 lds
LB_p2:
    s_lshl_b32 s64, s61, 2
    s_add_u32 s64, s64, s63
    s_mul_i32 s64, s64, 4352
    s_add_u32 s64, s64, 24395776
    v_mov_b32 v4, 0
    s_mov_b64 exec, 1
    buffer_load_dword v248, v4, s[36:39], s64 offen sc1
    s_mov_b64 exec, -1
    s_waitcnt vmcnt(0)
    s_mov_b64 exec, 1
    v_cmp_ne_u32 vcc, 16, v248
    s_mov_b32 s66, 0x8000
    s_nop 1
    s_cbranch_vccz Lpe_b_34
    s_lshl_b32 s64, s61, 2
    s_add_u32 s64, s64, s63
    s_mul_i32 s64, s64, 4352
    s_add_u32 s64, s64, 24395776
    v_mov_b32 v4, 0
Lp_b_33:
    buffer_load_dword v248, v4, s[36:39], s64 offen sc1
    s_waitcnt vmcnt(0)
    v_cmp_ne_u32 vcc, 16, v248
    s_sub_u32 s66, s66, 1
    s_cmp_eq_u32 s66, 0
    s_cbranch_scc1 Lpe_b_34
    s_cbranch_vccnz Lp_b_33
Lpe_b_34:
    s_mov_b64 exec, -1
    s_lshl_b32 s70, s60, 1
    s_and_b32 s64, s61, 1
    s_add_u32 s70, s70, s64
    s_add_u32 s70, s70, 32
    s_cmp_lt_u32 s70, 45
    s_cselect_b32 s71, 0, 0x7ff00000
    s_lshr_b32 s64, s61, 1
    s_mul_i32 s64, s64, 45
    s_add_u32 s64, s64, s70
    s_mul_i32 s64, s64, 9216
    s_add_u32 s64, s64, 32505856
    s_add_u32 s65, s71, s78
    v_add_u32 v4, s65, v32
    buffer_store_dwordx4 v[68:71], v4, s[36:39], s64 offen offset:1024 sc1
    s_lshl_b32 s70, s60, 1
    s_and_b32 s64, s61, 1
    s_add_u32 s70, s70, s64
    s_add_u32 s70, s70, 32
    s_cmp_lt_u32 s70, 45
    s_cselect_b32 s71, 0, 0x7ff00000
    s_lshr_b32 s64, s61, 1
    s_mul_i32 s64, s64, 45
    s_add_u32 s64, s64, s70
    s_mul_i32 s64, s64, 9216
    s_add_u32 s64, s64, 32505856
    s_cmp_eq_u32 s63, 0
    s_cselect_b32 s65, s71, 0x7ff00000
    s_add_u32 s65, s65, 8192
    v_add_u32 v4, s65, v32
    buffer_store_dwordx4 v[72:75], v4, s[36:39], s64 offen sc1
    s_barrier
    s_add_u32 s98, s75, 0
    s_cmp_ge_u32 s63, 2
    s_cbranch_scc1 Lc_b_35
    s_add_u32 m0, s72, 69632
    s_nop 0
    buffer_load_dwordx4 v31, s[36:39], s98 offen sc1 lds
Lc_b_35:
    s_add_u32 m0, s74, 53248
    s_nop 0
    buffer_load_dwordx4 v30, s[36:39], s98 offen offset:0 sc1 lds
    buffer_load_dwordx4 v30, s[36:39], s98 offen offset:1024 sc1 lds
    buffer_load_dwordx4 v30, s[36:39], s98 offen offset:2048 sc1 lds
    buffer_load_dwordx4 v30, s[36:39], s98 offen offset:3072 sc1 lds
    s_add_u32 s98, s75, 18432
    s_cmp_ge_u32 s63, 2
    s_cbranch_scc1 Lc_b_36
    s_add_u32 m0, s72, 104448
    s_nop 0
    buffer_load_dwordx4 v31, s[36:39], s98 offen sc1 lds
Lc_b_36:
    s_add_u32 m0, s74, 88064
    s_nop 0
    buffer_load_dwordx4 v30, s[36:39], s98 offen offset:0 sc1 lds
    buffer_load_dwordx4 v30, s[36:39], s98 offen offset:1024 sc1 lds
    buffer_load_dwordx4 v30, s[36:39], s98 offen offset:2048 sc1 lds
    buffer_load_dwordx4 v30, s[36:39], s98 offen offset:3072 sc1 lds
    s_add_u32 m0, s74, 0
    s_mov_b32 s98, 256
    buffer_load_dwordx4 v26, s[40:43], s98 offen offset:0 lds
    buffer_load_dwordx4 v27, s[40:43], s98 offen offset:1024 lds
    buffer_load_dwordx4 v28, s[40:43], s98 offen offset:2048 lds
    buffer_load_dwordx4 v29, s[40:43], s98 offen offset:3072 lds
    s_add_u32 s98, s75, 36864
    s_cmp_ge_u32 s63, 2
    s_cbranch_scc1 Lc_b_37
    s_add_u32 m0, s72, 32768
    s_nop 0
    buffer_load_dwordx4 v31, s[36:39], s98 offen sc1 lds
Lc_b_37:
    s_add_u32 m0, s74, 16384
    s_nop 0
    buffer_load_dwordx4 v30, s[36:39], s98 offen offset:0 sc1 lds
    buffer_load_dwordx4 v30, s[36:39], s98 offen offset:1024 sc1 lds
    buffer_load_dwordx4 v30, s[36:39], s98 offen offset:2048 sc1 lds
    buffer_load_dwordx4 v30, s[36:39], s98 offen offset:3072 sc1 lds
    s_lshr_b32 s70, s61, 1
    s_mul_i32 s77, s70, 414720
    s_add_u32 s77, s77, 32505856
    s_lshl_b32 s76, s60, 1
    s_and_b32 s64, s61, 1
    s_add_u32 s76, s76, s64
    s_mul_i32 s76, s76, 368640
    s_add_u32 s76, s76, 10485760
    v_add_u32 v34, s78, v32
    v_add_u32 v35, 8192, v32
    s_and_b32 s91, s61, 1
    s_lshl_b32 s91, s91, 1
    s_and_b32 s64, s63, 1
    s_add_u32 s91, s91, s64
    s_add_u32 s56, s76, 73728
    s_add_u32 s57, s77, 82944
    s_mov_b32 s59, 0
    s_lshl_b32 s44, s63, 13
    s_mul_i32 s45, s63, 9216
    s_add_u32 s46, s45, s75
    s_lshl_b32 s64, s63, 17
    v_add_u32 v26, s64, v26
    v_add_u32 v27, s64, v27
    v_add_u32 v28, s64, v28
    v_add_u32 v29, s64, v29
    s_waitcnt vmcnt(12)
    s_barrier
    s_cmp_ge_u32 s63, 2
    s_cbranch_scc1 Lwork_b_38
    s_waitcnt vmcnt(8)
    s_barrier
    s_add_u32 m0, s44, 106496
    s_mov_b32 s98, 384
    buffer_load_dwordx4 v26, s[40:43], s98 offen offset:0 lds
    buffer_load_dwordx4 v27, s[40:43], s98 offen offset:1024 lds
    buffer_load_dwordx4 v28, s[40:43], s98 offen offset:2048 lds
    buffer_load_dwordx4 v29, s[40:43], s98 offen offset:3072 lds
    s_add_u32 m0, s45, 122880
    s_add_u32 s98, s46, 55296
    buffer_load_dwordx4 v32, s[36:39], s98 offen offset:0 sc1 lds
    buffer_load_dwordx4 v32, s[36:39], s98 offen offset:1024 sc1 lds
    buffer_load_dwordx4 v32, s[36:39], s98 offen offset:2048 sc1 lds
    buffer_load_dwordx4 v32, s[36:39], s98 offen offset:3072 sc1 lds
    s_add_u32 m0, s44, 110592
    s_mov_b32 s98, 131456
    buffer_load_dwordx4 v26, s[40:43], s98 offen offset:0 lds
    buffer_load_dwordx4 v27, s[40:43], s98 offen offset:1024 lds
    buffer_load_dwordx4 v28, s[40:43], s98 offen offset:2048 lds
    buffer_load_dwordx4 v29, s[40:43], s98 offen offset:3072 lds
    s_add_u32 m0, s45, 126976
    s_add_u32 s98, s46, 59392
    buffer_load_dwordx4 v32, s[36:39], s98 offen offset:0 sc1 lds
    buffer_load_dwordx4 v32, s[36:39], s98 offen offset:1024 sc1 lds
    buffer_load_dwordx4 v32, s[36:39], s98 offen offset:2048 sc1 lds
    buffer_load_dwordx4 v32, s[36:39], s98 offen offset:3072 sc1 lds
    s_add_u32 m0, s45, 131072
    s_add_u32 s98, s46, 63488
    buffer_load_dwordx4 v32, s[36:39], s98 offen sc1 lds
    s_waitcnt vmcnt(17)
    s_barrier
    s_add_u32 m0, s44, 36864
    s_mov_b32 s98, 512
    buffer_load_dwordx4 v26, s[40:43], s98 offen offset:0 lds
    buffer_load_dwordx4 v27, s[40:43], s98 offen offset:1024 lds
    buffer_load_dwordx4 v28, s[40:43], s98 offen offset:2048 lds
    buffer_load_dwordx4 v29, s[40:43], s98 offen offset:3072 lds
    s_add_u32 m0, s45, 53248
    s_add_u32 s98, s46, 73728
    buffer_load_dwordx4 v32, s[36:39], s98 offen offset:0 sc1 lds
    buffer_load_dwordx4 v32, s[36:39], s98 offen offset:1024 sc1 lds
    buffer_load_dwordx4 v32, s[36:39], s98 offen offset:2048 sc1 lds
    buffer_load_dwordx4 v32, s[36:39], s98 offen offset:3072 sc1 lds
    s_add_u32 m0, s44, 40960
    s_mov_b32 s98, 131584
    buffer_load_dwordx4 v26, s[40:43], s98 offen offset:0 lds
    buffer_load_dwordx4 v27, s[40:43], s98 offen offset:1024 lds
    buffer_load_dwordx4 v28, s[40:43], s98 offen offset:2048 lds
    buffer_load_dwordx4 v29, s[40:43], s98 offen offset:3072 lds
    s_add_u32 m0, s45, 57344
    s_add_u32 s98, s46, 77824
    buffer_load_dwordx4 v32, s[36:39], s98 offen offset:0 sc1 lds
    buffer_load_dwordx4 v32, s[36:39], s98 offen offset:1024 sc1 lds
    buffer_load_dwordx4 v32, s[36:39], s98 offen offset:2048 sc1 lds
    buffer_load_dwordx4 v32, s[36:39], s98 offen offset:3072 sc1 lds
    s_add_u32 m0, s45, 61440
    s_add_u32 s98, s46, 81920
    buffer_load_dwordx4 v32, s[36:39], s98 offen sc1 lds
    s_waitcnt vmcnt(17)
    s_barrier
    s_add_u32 m0, s44, 71680
    s_mov_b32 s98, 640
    buffer_load_dwordx4 v26, s[40:43], s98 offen offset:0 lds
    buffer_load_dwordx4 v27, s[40:43], s98 offen offset:1024 lds
    buffer_load_dwordx4 v28, s[40:43], s98 offen offset:2048 lds
    buffer_load_dwordx4 v29, s[40:43], s98 offen offset:3072 lds
    s_add_u32 m0, s45, 88064
    s_add_u32 s98, s46, 92160
    buffer_load_dwordx4 v32, s[36:39], s98 offen offset:0 sc1 lds
    buffer_load_dwordx4 v32, s[36:39], s98 offen offset:1024 sc1 lds
    buffer_load_dwordx4 v32, s[36:39], s98 offen offset:2048 sc1 lds
    buffer_load_dwordx4 v32, s[36:39], s98 offen offset:3072 sc1 lds
    s_add_u32 m0, s44, 75776
    s_mov_b32 s98, 131712
    buffer_load_dwordx4 v26, s[40:43], s98 offen offset:0 lds
    buffer_load_dwordx4 v27, s[40:43], s98 offen offset:1024 lds
    buffer_load_dwordx4 v28, s[40:43], s98 offen offset:2048 lds
    buffer_load_dwordx4 v29, s[40:43], s98 offen offset:3072 lds
    s_add_u32 m0, s45, 92160
    s_add_u32 s98, s46, 96256
    buffer_load_dwordx4 v32, s[36:39], s98 offen offset:0 sc1 lds
    buffer_load_dwordx4 v32, s[36:39], s98 offen offset:1024 sc1 lds
    buffer_load_dwordx4 v32, s[36:39], s98 offen offset:2048 sc1 lds
    buffer_load_dwordx4 v32, s[36:39], s98 offen offset:3072 sc1 lds
    s_add_u32 m0, s45, 96256
    s_add_u32 s98, s46, 100352
    buffer_load_dwordx4 v32, s[36:39], s98 offen sc1 lds
    s_lshr_b32 s70, s61, 1
    s_lshl_b32 s64, s70, 2
    s_add_u32 s64, s64, s63
    s_mul_i32 s64, s64, 4352
    s_add_u32 s64, s64, 25788416
    s_mov_b64 exec, 1
    v_mov_b32 v4, 0
    v_mov_b32 v5, 1
    buffer_atomic_add v5, v4, s[36:39], s64 offen sc1
    s_mov_b64 exec, -1
    s_waitcnt vmcnt(18)
    s_barrier
    s_add_u32 m0, s44, 0
    s_mov_b32 s98, 768
    buffer_load_dwordx4 v26, s[40:43], s98 offen offset:0 lds
    buffer_load_dwordx4 v27, s[40:43], s98 offen offset:1024 lds
    buffer_load_dwordx4 v28, s[40:43], s98 offen offset:2048 lds
    buffer_load_dwordx4 v29, s[40:43], s98 offen offset:3072 lds
    s_add_u32 m0, s45, 16384
    s_add_u32 s98, s46, 110592
    buffer_load_dwordx4 v32, s[36:39], s98 offen offset:0 sc1 lds
    buffer_load_dwordx4 v32, s[36:39], s98 offen offset:1024 sc1 lds
    buffer_load_dwordx4 v32, s[36:39], s98 offen offset:2048 sc1 lds
    buffer_load_dwordx4 v32, s[36:39], s98 offen offset:3072 sc1 lds
    s_add_u32 m0, s44, 4096
    s_mov_b32 s98, 131840
    buffer_load_dwordx4 v26, s[40:43], s98 offen offset:0 lds
    buffer_load_dwordx4 v27, s[40:43], s98 offen offset:1024 lds
    buffer_load_dwordx4 v28, s[40:43], s98 offen offset:2048 lds
    buffer_load_dwordx4 v29, s[40:43], s98 offen offset:3072 lds
    s_add_u32 m0, s45, 20480
    s_add_u32 s98, s46, 114688
    buffer_load_dwordx4 v32, s[36:39], s98 offen offset:0 sc1 lds
    buffer_load_dwordx4 v32, s[36:39], s98 offen offset:1024 sc1 lds
    buffer_load_dwordx4 v32, s[36:39], s98 offen offset:2048 sc1 lds
    buffer_load_dwordx4 v32, s[36:39], s98 offen offset:3072 sc1 lds
    s_add_u32 m0, s45, 24576
    s_add_u32 s98, s46, 118784
    buffer_load_dwordx4 v32, s[36:39], s98 offen sc1 lds
    s_waitcnt vmcnt(18)
    s_barrier
    s_add_u32 m0, s44, 106496
    s_mov_b32 s98, 896
    buffer_load_dwordx4 v26, s[40:43], s98 offen offset:0 lds
    buffer_load_dwordx4 v27, s[40:43], s98 offen offset:1024 lds
    buffer_load_dwordx4 v28, s[40:43], s98 offen offset:2048 lds
    buffer_load_dwordx4 v29, s[40:43], s98 offen offset:3072 lds
    s_add_u32 m0, s45, 122880
    s_add_u32 s98, s46, 129024
    buffer_load_dwordx4 v32, s[36:39], s98 offen offset:0 sc1 lds
    buffer_load_dwordx4 v32, s[36:39], s98 offen offset:1024 sc1 lds
    buffer_load_dwordx4 v32, s[36:39], s98 offen offset:2048 sc1 lds
    buffer_load_dwordx4 v32, s[36:39], s98 offen offset:3072 sc1 lds
    s_add_u32 m0, s44, 110592
    s_mov_b32 s98, 131968
    buffer_load_dwordx4 v26, s[40:43], s98 offen offset:0 lds
    buffer_load_dwordx4 v27, s[40:43], s98 offen offset:1024 lds
    buffer_load_dwordx4 v28, s[40:43], s98 offen offset:2048 lds
    buffer_load_dwordx4 v29, s[40:43], s98 offen offset:3072 lds
    s_add_u32 m0, s45, 126976
    s_add_u32 s98, s46, 133120
    buffer_load_dwordx4 v32, s[36:39], s98 offen offset:0 sc1 lds
    buffer_load_dwordx4 v32, s[36:39], s98 offen offset:1024 sc1 lds
    buffer_load_dwordx4 v32, s[36:39], s98 offen offset:2048 sc1 lds
    buffer_load_dwordx4 v32, s[36:39], s98 offen offset:3072 sc1 lds
    s_add_u32 m0, s45, 131072
    s_add_u32 s98, s46, 137216
    buffer_load_dwordx4 v32, s[36:39], s98 offen sc1 lds
    s_waitcnt vmcnt(17)
    s_barrier
    s_add_u32 m0, s44, 36864
    s_mov_b32 s98, 1024
    buffer_load_dwordx4 v26, s[40:43], s98 offen offset:0 lds
    buffer_load_dwordx4 v27, s[40:43], s98 offen offset:1024 lds
    buffer_load_dwordx4 v28, s[40:43], s98 offen offset:2048 lds
    buffer_load_dwordx4 v29, s[40:43], s98 offen offset:3072 lds
    s_add_u32 m0, s45, 53248
    s_add_u32 s98, s46, 147456
    buffer_load_dwordx4 v32, s[36:39], s98 offen offset:0 sc1 lds
    buffer_load_dwordx4 v32, s[36:39], s98 offen offset:1024 sc1 lds
    buffer_load_dwordx4 v32, s[36:39], s98 offen offset:2048 sc1 lds
    buffer_load_dwordx4 v32, s[36:39], s98 offen offset:3072 sc1 lds
    s_add_u32 m0, s44, 40960
    s_mov_b32 s98, 132096
    buffer_load_dwordx4 v26, s[40:43], s98 offen offset:0 lds
    buffer_load_dwordx4 v27, s[40:43], s98 offen offset:1024 lds
    buffer_load_dwordx4 v28, s[40:43], s98 offen offset:2048 lds
    buffer_load_dwordx4 v29, s[40:43], s98 offen offset:3072 lds
    s_add_u32 m0, s45, 57344
    s_add_u32 s98, s46, 151552
    buffer_load_dwordx4 v32, s[36:39], s98 offen offset:0 sc1 lds
    buffer_load_dwordx4 v32, s[36:39], s98 offen offset:1024 sc1 lds
    buffer_load_dwordx4 v32, s[36:39], s98 offen offset:2048 sc1 lds
    buffer_load_dwordx4 v32, s[36:39], s98 offen offset:3072 sc1 lds
    s_add_u32 m0, s45, 61440
    s_add_u32 s98, s46, 155648
    buffer_load_dwordx4 v32, s[36:39], s98 offen sc1 lds
    s_waitcnt vmcnt(17)
    s_barrier
    s_add_u32 m0, s44, 71680
    s_mov_b32 s98, 1152
    buffer_load_dwordx4 v26, s[40:43], s98 offen offset:0 lds
    buffer_load_dwordx4 v27, s[40:43], s98 offen offset:1024 lds
    buffer_load_dwordx4 v28, s[40:43], s98 offen offset:2048 lds
    buffer_load_dwordx4 v29, s[40:43], s98 offen offset:3072 lds
    s_add_u32 m0, s45, 88064
    s_add_u32 s98, s46, 165888
    buffer_load_dwordx4 v32, s[36:39], s98 offen offset:0 sc1 lds
    buffer_load_dwordx4 v32, s[36:39], s98 offen offset:1024 sc1 lds
    buffer_load_dwordx4 v32, s[36:39], s98 offen offset:2048 sc1 lds
    buffer_load_dwordx4 v32, s[36:39], s98 offen offset:3072 sc1 lds
    s_add_u32 m0, s44, 75776
    s_mov_b32 s98, 132224
    buffer_load_dwordx4 v26, s[40:43], s98 offen offset:0 lds
    buffer_load_dwordx4 v27, s[40:43], s98 offen offset:1024 lds
    buffer_load_dwordx4 v28, s[40:43], s98 offen offset:2048 lds
    buffer_load_dwordx4 v29, s[40:43], s98 offen offset:3072 lds
    s_add_u32 m0, s45, 92160
    s_add_u32 s98, s46, 169984
    buffer_load_dwordx4 v32, s[36:39], s98 offen offset:0 sc1 lds
    buffer_load_dwordx4 v32, s[36:39], s98 offen offset:1024 sc1 lds
    buffer_load_dwordx4 v32, s[36:39], s98 offen offset:2048 sc1 lds
    buffer_load_dwordx4 v32, s[36:39], s98 offen offset:3072 sc1 lds
    s_add_u32 m0, s45, 96256
    s_add_u32 s98, s46, 174080
    buffer_load_dwordx4 v32, s[36:39], s98 offen sc1 lds
    s_waitcnt vmcnt(17)
    s_barrier
    s_add_u32 m0, s44, 0
    s_mov_b32 s98, 1280
    buffer_load_dwordx4 v26, s[40:43], s98 offen offset:0 lds
    buffer_load_dwordx4 v27, s[40:43], s98 offen offset:1024 lds
    buffer_load_dwordx4 v28, s[40:43], s98 offen offset:2048 lds
    buffer_load_dwordx4 v29, s[40:43], s98 offen offset:3072 lds
    s_add_u32 m0, s45, 16384
    s_add_u32 s98, s46, 184320
    buffer_load_dwordx4 v32, s[36:39], s98 offen offset:0 sc1 lds
    buffer_load_dwordx4 v32, s[36:39], s98 offen offset:1024 sc1 lds
    buffer_load_dwordx4 v32, s[36:39], s98 offen offset:2048 sc1 lds
    buffer_load_dwordx4 v32, s[36:39], s98 offen offset:3072 sc1 lds
    s_add_u32 m0, s44, 4096
    s_mov_b32 s98, 132352
    buffer_load_dwordx4 v26, s[40:43], s98 offen offset:0 lds
    buffer_load_dwordx4 v27, s[40:43], s98 offen offset:1024 lds
    buffer_load_dwordx4 v28, s[40:43], s98 offen offset:2048 lds
    buffer_load_dwordx4 v29, s[40:43], s98 offen offset:3072 lds
    s_add_u32 m0, s45, 20480
    s_add_u32 s98, s46, 188416
    buffer_load_dwordx4 v32, s[36:39], s98 offen offset:0 sc1 lds
    buffer_load_dwordx4 v32, s[36:39], s98 offen offset:1024 sc1 lds
    buffer_load_dwordx4 v32, s[36:39], s98 offen offset:2048 sc1 lds
    buffer_load_dwordx4 v32, s[36:39], s98 offen offset:3072 sc1 lds
    s_add_u32 m0, s45, 24576
    s_add_u32 s98, s46, 192512
    buffer_load_dwordx4 v32, s[36:39], s98 offen sc1 lds
    s_waitcnt vmcnt(17)
    s_barrier
    s_add_u32 m0, s44, 106496
    s_mov_b32 s98, 1408
    buffer_load_dwordx4 v26, s[40:43], s98 offen offset:0 lds
    buffer_load_dwordx4 v27, s[40:43], s98 offen offset:1024 lds
    buffer_load_dwordx4 v28, s[40:43], s98 offen offset:2048 lds
    buffer_load_dwordx4 v29, s[40:43], s98 offen offset:3072 lds
    s_add_u32 m0, s45, 122880
    s_add_u32 s98, s46, 202752
    buffer_load_dwordx4 v32, s[36:39], s98 offen offset:0 sc1 lds
    buffer_load_dwordx4 v32, s[36:39], s98 offen offset:1024 sc1 lds
    buffer_load_dwordx4 v32, s[36:39], s98 offen offset:2048 sc1 lds
    buffer_load_dwordx4 v32, s[36:39], s98 offen offset:3072 sc1 lds
    s_add_u32 m0, s44, 110592
    s_mov_b32 s98, 132480
    buffer_load_dwordx4 v26, s[40:43], s98 offen offset:0 lds
    buffer_load_dwordx4 v27, s[40:43], s98 offen offset:1024 lds
    buffer_load_dwordx4 v28, s[40:43], s98 offen offset:2048 lds
    buffer_load_dwordx4 v29, s[40:43], s98 offen offset:3072 lds
    s_add_u32 m0, s45, 126976
    s_add_u32 s98, s46, 206848
    buffer_load_dwordx4 v32, s[36:39], s98 offen offset:0 sc1 lds
    buffer_load_dwordx4 v32, s[36:39], s98 offen offset:1024 sc1 lds
    buffer_load_dwordx4 v32, s[36:39], s98 offen offset:2048 sc1 lds
    buffer_load_dwordx4 v32, s[36:39], s98 offen offset:3072 sc1 lds
    s_add_u32 m0, s45, 131072
    s_add_u32 s98, s46, 210944
    buffer_load_dwordx4 v32, s[36:39], s98 offen sc1 lds
    s_waitcnt vmcnt(17)
    s_barrier
    s_add_u32 m0, s44, 36864
    s_mov_b32 s98, 1536
    buffer_load_dwordx4 v26, s[40:43], s98 offen offset:0 lds
    buffer_load_dwordx4 v27, s[40:43], s98 offen offset:1024 lds
    buffer_load_dwordx4 v28, s[40:43], s98 offen offset:2048 lds
    buffer_load_dwordx4 v29, s[40:43], s98 offen offset:3072 lds
    s_add_u32 m0, s45, 53248
    s_add_u32 s98, s46, 221184
    buffer_load_dwordx4 v32, s[36:39], s98 offen offset:0 sc1 lds
    buffer_load_dwordx4 v32, s[36:39], s98 offen offset:1024 sc1 lds
    buffer_load_dwordx4 v32, s[36:39], s98 offen offset:2048 sc1 lds
    buffer_load_dwordx4 v32, s[36:39], s98 offen offset:3072 sc1 lds
    s_add_u32 m0, s44, 40960
    s_mov_b32 s98, 132608
    buffer_load_dwordx4 v26, s[40:43], s98 offen offset:0 lds
    buffer_load_dwordx4 v27, s[40:43], s98 offen offset:1024 lds
    buffer_load_dwordx4 v28, s[40:43], s98 offen offset:2048 lds
    buffer_load_dwordx4 v29, s[40:43], s98 offen offset:3072 lds
    s_add_u32 m0, s45, 57344
    s_add_u32 s98, s46, 225280
    buffer_load_dwordx4 v32, s[36:39], s98 offen offset:0 sc1 lds
    buffer_load_dwordx4 v32, s[36:39], s98 offen offset:1024 sc1 lds
    buffer_load_dwordx4 v32, s[36:39], s98 offen offset:2048 sc1 lds
    buffer_load_dwordx4 v32, s[36:39], s98 offen offset:3072 sc1 lds
    s_add_u32 m0, s45, 61440
    s_add_u32 s98, s46, 229376
    buffer_load_dwordx4 v32, s[36:39], s98 offen sc1 lds
    s_waitcnt vmcnt(17)
    s_barrier
    s_add_u32 m0, s44, 71680
    s_mov_b32 s98, 1664
    buffer_load_dwordx4 v26, s[40:43], s98 offen offset:0 lds
    buffer_load_dwordx4 v27, s[40:43], s98 offen offset:1024 lds
    buffer_load_dwordx4 v28, s[40:43], s98 offen offset:2048 lds
    buffer_load_dwordx4 v29, s[40:43], s98 offen offset:3072 lds
    s_add_u32 m0, s45, 88064
    s_add_u32 s98, s46, 239616
    buffer_load_dwordx4 v32, s[36:39], s98 offen offset:0 sc1 lds
    buffer_load_dwordx4 v32, s[36:39], s98 offen offset:1024 sc1 lds
    buffer_load_dwordx4 v32, s[36:39], s98 offen offset:2048 sc1 lds
    buffer_load_dwordx4 v32, s[36:39], s98 offen offset:3072 sc1 lds
    s_add_u32 m0, s44, 75776
    s_mov_b32 s98, 132736
    buffer_load_dwordx4 v26, s[40:43], s98 offen offset:0 lds
    buffer_load_dwordx4 v27, s[40:43], s98 offen offset:1024 lds
    buffer_load_dwordx4 v28, s[40:43], s98 offen offset:2048 lds
    buffer_load_dwordx4 v29, s[40:43], s98 offen offset:3072 lds
    s_add_u32 m0, s45, 92160
    s_add_u32 s98, s46, 243712
    buffer_load_dwordx4 v32, s[36:39], s98 offen offset:0 sc1 lds
    buffer_load_dwordx4 v32, s[36:39], s98 offen offset:1024 sc1 lds
    buffer_load_dwordx4 v32, s[36:39], s98 offen offset:2048 sc1 lds
    buffer_load_dwordx4 v32, s[36:39], s98 offen offset:3072 sc1 lds
    s_add_u32 m0, s45, 96256
    s_add_u32 s98, s46, 247808
    buffer_load_dwordx4 v32, s[36:39], s98 offen sc1 lds
    s_waitcnt vmcnt(17)
    s_barrier
    s_add_u32 m0, s44, 0
    s_mov_b32 s98, 1792
    buffer_load_dwordx4 v26, s[40:43], s98 offen offset:0 lds
    buffer_load_dwordx4 v27, s[40:43], s98 offen offset:1024 lds
    buffer_load_dwordx4 v28, s[40:43], s98 offen offset:2048 lds
    buffer_load_dwordx4 v29, s[40:43], s98 offen offset:3072 lds
    s_add_u32 m0, s45, 16384
    s_add_u32 s98, s46, 258048
    buffer_load_dwordx4 v32, s[36:39], s98 offen offset:0 sc1 lds
    buffer_load_dwordx4 v32, s[36:39], s98 offen offset:1024 sc1 lds
    buffer_load_dwordx4 v32, s[36:39], s98 offen offset:2048 sc1 lds
    buffer_load_dwordx4 v32, s[36:39], s98 offen offset:3072 sc1 lds
    s_add_u32 m0, s44, 4096
    s_mov_b32 s98, 132864
    buffer_load_dwordx4 v26, s[40:43], s98 offen offset:0 lds
    buffer_load_dwordx4 v27, s[40:43], s98 offen offset:1024 lds
    buffer_load_dwordx4 v28, s[40:43], s98 offen offset:2048 lds
    buffer_load_dwordx4 v29, s[40:43], s98 offen offset:3072 lds
    s_add_u32 m0, s45, 20480
    s_add_u32 s98, s46, 262144
    buffer_load_dwordx4 v32, s[36:39], s98 offen offset:0 sc1 lds
    buffer_load_dwordx4 v32, s[36:39], s98 offen offset:1024 sc1 lds
    buffer_load_dwordx4 v32, s[36:39], s98 offen offset:2048 sc1 lds
    buffer_load_dwordx4 v32, s[36:39], s98 offen offset:3072 sc1 lds
    s_add_u32 m0, s45, 24576
    s_add_u32 s98, s46, 266240
    buffer_load_dwordx4 v32, s[36:39], s98 offen sc1 lds
    s_waitcnt vmcnt(17)
    s_barrier
    s_add_u32 m0, s44, 106496
    s_mov_b32 s98, 1920
    buffer_load_dwordx4 v26, s[40:43], s98 offen offset:0 lds
    buffer_load_dwordx4 v27, s[40:43], s98 offen offset:1024 lds
    buffer_load_dwordx4 v28, s[40:43], s98 offen offset:2048 lds
    buffer_load_dwordx4 v29, s[40:43], s98 offen offset:3072 lds
    s_add_u32 m0, s45, 122880
    s_add_u32 s98, s46, 276480
    buffer_load_dwordx4 v32, s[36:39], s98 offen offset:0 sc1 lds
    buffer_load_dwordx4 v32, s[36:39], s98 offen offset:1024 sc1 lds
    buffer_load_dwordx4 v32, s[36:39], s98 offen offset:2048 sc1 lds
    buffer_load_dwordx4 v32, s[36:39], s98 offen offset:3072 sc1 lds
    s_add_u32 m0, s44, 110592
    s_mov_b32 s98, 132992
    buffer_load_dwordx4 v26, s[40:43], s98 offen offset:0 lds
    buffer_load_dwordx4 v27, s[40:43], s98 offen offset:1024 lds
    buffer_load_dwordx4 v28, s[40:43], s98 offen offset:2048 lds
    buffer_load_dwordx4 v29, s[40:43], s98 offen offset:3072 lds
    s_add_u32 m0, s45, 126976
    s_add_u32 s98, s46, 280576
    buffer_load_dwordx4 v32, s[36:39], s98 offen offset:0 sc1 lds
    buffer_load_dwordx4 v32, s[36:39], s98 offen offset:1024 sc1 lds
    buffer_load_dwordx4 v32, s[36:39], s98 offen offset:2048 sc1 lds
    buffer_load_dwordx4 v32, s[36:39], s98 offen offset:3072 sc1 lds
    s_add_u32 m0, s45, 131072
    s_add_u32 s98, s46, 284672
    buffer_load_dwordx4 v32, s[36:39], s98 offen sc1 lds
    s_waitcnt vmcnt(17)
    s_barrier
    s_add_u32 m0, s44, 36864
    s_mov_b32 s98, 2048
    buffer_load_dwordx4 v26, s[40:43], s98 offen offset:0 lds
    buffer_load_dwordx4 v27, s[40:43], s98 offen offset:1024 lds
    buffer_load_dwordx4 v28, s[40:43], s98 offen offset:2048 lds
    buffer_load_dwordx4 v29, s[40:43], s98 offen offset:3072 lds
    s_add_u32 m0, s45, 53248
    s_add_u32 s98, s46, 294912
    buffer_load_dwordx4 v32, s[36:39], s98 offen offset:0 sc1 lds
    buffer_load_dwordx4 v32, s[36:39], s98 offen offset:1024 sc1 lds
    buffer_load_dwordx4 v32, s[36:39], s98 offen offset:2048 sc1 lds
    buffer_load_dwordx4 v32, s[36:39], s98 offen offset:3072 sc1 lds
    s_add_u32 m0, s44, 40960
    s_mov_b32 s98, 133120
    buffer_load_dwordx4 v26, s[40:43], s98 offen offset:0 lds
    buffer_load_dwordx4 v27, s[40:43], s98 offen offset:1024 lds
    buffer_load_dwordx4 v28, s[40:43], s98 offen offset:2048 lds
    buffer_load_dwordx4 v29, s[40:43], s98 offen offset:3072 lds
    s_add_u32 m0, s45, 57344
    s_add_u32 s98, s46, 299008
    buffer_load_dwordx4 v32, s[36:39], s98 offen offset:0 sc1 lds
    buffer_load_dwordx4 v32, s[36:39], s98 offen offset:1024 sc1 lds
    buffer_load_dwordx4 v32, s[36:39], s98 offen offset:2048 sc1 lds
    buffer_load_dwordx4 v32, s[36:39], s98 offen offset:3072 sc1 lds
    s_add_u32 m0, s45, 61440
    s_add_u32 s98, s46, 303104
    buffer_load_dwordx4 v32, s[36:39], s98 offen sc1 lds
    s_waitcnt vmcnt(17)
    s_barrier
    s_add_u32 m0, s44, 71680
    s_mov_b32 s98, 2176
    buffer_load_dwordx4 v26, s[40:43], s98 offen offset:0 lds
    buffer_load_dwordx4 v27, s[40:43], s98 offen offset:1024 lds
    buffer_load_dwordx4 v28, s[40:43], s98 offen offset:2048 lds
    buffer_load_dwordx4 v29, s[40:43], s98 offen offset:3072 lds
    s_add_u32 m0, s45, 88064
    s_add_u32 s98, s46, 313344
    buffer_load_dwordx4 v32, s[36:39], s98 offen offset:0 sc1 lds
    buffer_load_dwordx4 v32, s[36:39], s98 offen offset:1024 sc1 lds
    buffer_load_dwordx4 v32, s[36:39], s98 offen offset:2048 sc1 lds
    buffer_load_dwordx4 v32, s[36:39], s98 offen offset:3072 sc1 lds
    s_add_u32 m0, s44, 75776
    s_mov_b32 s98, 133248
    buffer_load_dwordx4 v26, s[40:43], s98 offen offset:0 lds
    buffer_load_dwordx4 v27, s[40:43], s98 offen offset:1024 lds
    buffer_load_dwordx4 v28, s[40:43], s98 offen offset:2048 lds
    buffer_load_dwordx4 v29, s[40:43], s98 offen offset:3072 lds
    s_add_u32 m0, s45, 92160
    s_add_u32 s98, s46, 317440
    buffer_load_dwordx4 v32, s[36:39], s98 offen offset:0 sc1 lds
    buffer_load_dwordx4 v32, s[36:39], s98 offen offset:1024 sc1 lds
    buffer_load_dwordx4 v32, s[36:39], s98 offen offset:2048 sc1 lds
    buffer_load_dwordx4 v32, s[36:39], s98 offen offset:3072 sc1 lds
    s_add_u32 m0, s45, 96256
    s_add_u32 s98, s46, 321536
    buffer_load_dwordx4 v32, s[36:39], s98 offen sc1 lds
    s_waitcnt vmcnt(17)
    s_barrier
    s_add_u32 m0, s44, 0
    s_mov_b32 s98, 2304
    buffer_load_dwordx4 v26, s[40:43], s98 offen offset:0 lds
    buffer_load_dwordx4 v27, s[40:43], s98 offen offset:1024 lds
    buffer_load_dwordx4 v28, s[40:43], s98 offen offset:2048 lds
    buffer_load_dwordx4 v29, s[40:43], s98 offen offset:3072 lds
    s_add_u32 m0, s45, 16384
    s_add_u32 s98, s46, 331776
    buffer_load_dwordx4 v32, s[36:39], s98 offen offset:0 sc1 lds
    buffer_load_dwordx4 v32, s[36:39], s98 offen offset:1024 sc1 lds
    buffer_load_dwordx4 v32, s[36:39], s98 offen offset:2048 sc1 lds
    buffer_load_dwordx4 v32, s[36:39], s98 offen offset:3072 sc1 lds
    s_add_u32 m0, s44, 4096
    s_mov_b32 s98, 133376
    buffer_load_dwordx4 v26, s[40:43], s98 offen offset:0 lds
    buffer_load_dwordx4 v27, s[40:43], s98 offen offset:1024 lds
    buffer_load_dwordx4 v28, s[40:43], s98 offen offset:2048 lds
    buffer_load_dwordx4 v29, s[40:43], s98 offen offset:3072 lds
    s_add_u32 m0, s45, 20480
    s_add_u32 s98, s46, 335872
    buffer_load_dwordx4 v32, s[36:39], s98 offen offset:0 sc1 lds
    buffer_load_dwordx4 v32, s[36:39], s98 offen offset:1024 sc1 lds
    buffer_load_dwordx4 v32, s[36:39], s98 offen offset:2048 sc1 lds
    buffer_load_dwordx4 v32, s[36:39], s98 offen offset:3072 sc1 lds
    s_add_u32 m0, s45, 24576
    s_add_u32 s98, s46, 339968
    buffer_load_dwordx4 v32, s[36:39], s98 offen sc1 lds
    s_waitcnt vmcnt(17)
    s_barrier
    s_add_u32 m0, s44, 106496
    s_mov_b32 s98, 2432
    buffer_load_dwordx4 v26, s[40:43], s98 offen offset:0 lds
    buffer_load_dwordx4 v27, s[40:43], s98 offen offset:1024 lds
    buffer_load_dwordx4 v28, s[40:43], s98 offen offset:2048 lds
    buffer_load_dwordx4 v29, s[40:43], s98 offen offset:3072 lds
    s_add_u32 m0, s45, 122880
    s_add_u32 s98, s46, 350208
    buffer_load_dwordx4 v32, s[36:39], s98 offen offset:0 sc1 lds
    buffer_load_dwordx4 v32, s[36:39], s98 offen offset:1024 sc1 lds
    buffer_load_dwordx4 v32, s[36:39], s98 offen offset:2048 sc1 lds
    buffer_load_dwordx4 v32, s[36:39], s98 offen offset:3072 sc1 lds
    s_add_u32 m0, s44, 110592
    s_mov_b32 s98, 133504
    buffer_load_dwordx4 v26, s[40:43], s98 offen offset:0 lds
    buffer_load_dwordx4 v27, s[40:43], s98 offen offset:1024 lds
    buffer_load_dwordx4 v28, s[40:43], s98 offen offset:2048 lds
    buffer_load_dwordx4 v29, s[40:43], s98 offen offset:3072 lds
    s_add_u32 m0, s45, 126976
    s_add_u32 s98, s46, 354304
    buffer_load_dwordx4 v32, s[36:39], s98 offen offset:0 sc1 lds
    buffer_load_dwordx4 v32, s[36:39], s98 offen offset:1024 sc1 lds
    buffer_load_dwordx4 v32, s[36:39], s98 offen offset:2048 sc1 lds
    buffer_load_dwordx4 v32, s[36:39], s98 offen offset:3072 sc1 lds
    s_add_u32 m0, s45, 131072
    s_add_u32 s98, s46, 358400
    buffer_load_dwordx4 v32, s[36:39], s98 offen sc1 lds
    s_waitcnt vmcnt(17)
    s_barrier
    s_add_u32 m0, s44, 36864
    s_mov_b32 s98, 2560
    buffer_load_dwordx4 v26, s[40:43], s98 offen offset:0 lds
    buffer_load_dwordx4 v27, s[40:43], s98 offen offset:1024 lds
    buffer_load_dwordx4 v28, s[40:43], s98 offen offset:2048 lds
    buffer_load_dwordx4 v29, s[40:43], s98 offen offset:3072 lds
    s_add_u32 m0, s45, 53248
    s_add_u32 s98, s46, 368640
    buffer_load_dwordx4 v32, s[36:39], s98 offen offset:0 sc1 lds
    buffer_load_dwordx4 v32, s[36:39], s98 offen offset:1024 sc1 lds
    buffer_load_dwordx4 v32, s[36:39], s98 offen offset:2048 sc1 lds
    buffer_load_dwordx4 v32, s[36:39], s98 offen offset:3072 sc1 lds
    s_add_u32 m0, s44, 40960
    s_mov_b32 s98, 133632
    buffer_load_dwordx4 v26, s[40:43], s98 offen offset:0 lds
    buffer_load_dwordx4 v27, s[40:43], s98 offen offset:1024 lds
    buffer_load_dwordx4 v28, s[40:43], s98 offen offset:2048 lds
    buffer_load_dwordx4 v29, s[40:43], s98 offen offset:3072 lds
    s_add_u32 m0, s45, 57344
    s_add_u32 s98, s46, 372736
    buffer_load_dwordx4 v32, s[36:39], s98 offen offset:0 sc1 lds
    buffer_load_dwordx4 v32, s[36:39], s98 offen offset:1024 sc1 lds
    buffer_load_dwordx4 v32, s[36:39], s98 offen offset:2048 sc1 lds
    buffer_load_dwordx4 v32, s[36:39], s98 offen offset:3072 sc1 lds
    s_add_u32 m0, s45, 61440
    s_add_u32 s98, s46, 376832
    buffer_load_dwordx4 v32, s[36:39], s98 offen sc1 lds
    s_waitcnt vmcnt(17)
    s_barrier
    s_add_u32 m0, s44, 71680
    s_mov_b32 s98, 2688
    buffer_load_dwordx4 v26, s[40:43], s98 offen offset:0 lds
    buffer_load_dwordx4 v27, s[40:43], s98 offen offset:1024 lds
    buffer_load_dwordx4 v28, s[40:43], s98 offen offset:2048 lds
    buffer_load_dwordx4 v29, s[40:43], s98 offen offset:3072 lds
    s_add_u32 m0, s45, 88064
    s_add_u32 s98, s46, 387072
    buffer_load_dwordx4 v32, s[36:39], s98 offen offset:0 sc1 lds
    buffer_load_dwordx4 v32, s[36:39], s98 offen offset:1024 sc1 lds
    buffer_load_dwordx4 v32, s[36:39], s98 offen offset:2048 sc1 lds
    buffer_load_dwordx4 v32, s[36:39], s98 offen offset:3072 sc1 lds
    s_add_u32 m0, s44, 75776
    s_mov_b32 s98, 133760
    buffer_load_dwordx4 v26, s[40:43], s98 offen offset:0 lds
    buffer_load_dwordx4 v27, s[40:43], s98 offen offset:1024 lds
    buffer_load_dwordx4 v28, s[40:43], s98 offen offset:2048 lds
    buffer_load_dwordx4 v29, s[40:43], s98 offen offset:3072 lds
    s_add_u32 m0, s45, 92160
    s_add_u32 s98, s46, 391168
    buffer_load_dwordx4 v32, s[36:39], s98 offen offset:0 sc1 lds
    buffer_load_dwordx4 v32, s[36:39], s98 offen offset:1024 sc1 lds
    buffer_load_dwordx4 v32, s[36:39], s98 offen offset:2048 sc1 lds
    buffer_load_dwordx4 v32, s[36:39], s98 offen offset:3072 sc1 lds
    s_add_u32 m0, s45, 96256
    s_add_u32 s98, s46, 395264
    buffer_load_dwordx4 v32, s[36:39], s98 offen sc1 lds
    s_waitcnt vmcnt(17)
    s_barrier
    s_add_u32 m0, s44, 0
    s_mov_b32 s98, 2816
    buffer_load_dwordx4 v26, s[40:43], s98 offen offset:0 lds
    buffer_load_dwordx4 v27, s[40:43], s98 offen offset:1024 lds
    buffer_load_dwordx4 v28, s[40:43], s98 offen offset:2048 lds
    buffer_load_dwordx4 v29, s[40:43], s98 offen offset:3072 lds
    s_add_u32 m0, s45, 16384
    s_add_u32 s98, s46, 405504
    buffer_load_dwordx4 v32, s[36:39], s98 offen offset:0 sc1 lds
    buffer_load_dwordx4 v32, s[36:39], s98 offen offset:1024 sc1 lds
    buffer_load_dwordx4 v32, s[36:39], s98 offen offset:2048 sc1 lds
    buffer_load_dwordx4 v32, s[36:39], s98 offen offset:3072 sc1 lds
    s_add_u32 m0, s44, 4096
    s_mov_b32 s98, 133888
    buffer_load_dwordx4 v26, s[40:43], s98 offen offset:0 lds
    buffer_load_dwordx4 v27, s[40:43], s98 offen offset:1024 lds
    buffer_load_dwordx4 v28, s[40:43], s98 offen offset:2048 lds
    buffer_load_dwordx4 v29, s[40:43], s98 offen offset:3072 lds
    s_add_u32 m0, s45, 20480
    s_add_u32 s98, s46, 409600
    buffer_load_dwordx4 v32, s[36:39], s98 offen offset:0 sc1 lds
    buffer_load_dwordx4 v32, s[36:39], s98 offen offset:1024 sc1 lds
    buffer_load_dwordx4 v32, s[36:39], s98 offen offset:2048 sc1 lds
    buffer_load_dwordx4 v32, s[36:39], s98 offen offset:3072 sc1 lds
    s_add_u32 m0, s45, 24576
    s_add_u32 s98, s46, 413696
    buffer_load_dwordx4 v32, s[36:39], s98 offen sc1 lds
    s_waitcnt vmcnt(17)
    s_barrier
    s_add_u32 m0, s44, 106496
    s_mov_b32 s98, 2944
    buffer_load_dwordx4 v26, s[40:43], s98 offen offset:0 lds
    buffer_load_dwordx4 v27, s[40:43], s98 offen offset:1024 lds
    buffer_load_dwordx4 v28, s[40:43], s98 offen offset:2048 lds
    buffer_load_dwordx4 v29, s[40:43], s98 offen offset:3072 lds
    s_add_u32 m0, s45, 122880
    s_add_u32 s98, s46, 423936
    buffer_load_dwordx4 v32, s[36:39], s98 offen offset:0 sc1 lds
    buffer_load_dwordx4 v32, s[36:39], s98 offen offset:1024 sc1 lds
    buffer_load_dwordx4 v32, s[36:39], s98 offen offset:2048 sc1 lds
    buffer_load_dwordx4 v32, s[36:39], s98 offen offset:3072 sc1 lds
    s_add_u32 m0, s44, 110592
    s_mov_b32 s98, 134016
    buffer_load_dwordx4 v26, s[40:43], s98 offen offset:0 lds
    buffer_load_dwordx4 v27, s[40:43], s98 offen offset:1024 lds
    buffer_load_dwordx4 v28, s[40:43], s98 offen offset:2048 lds
    buffer_load_dwordx4 v29, s[40:43], s98 offen offset:3072 lds
    s_add_u32 m0, s45, 126976
    s_add_u32 s98, s46, 428032
    buffer_load_dwordx4 v32, s[36:39], s98 offen offset:0 sc1 lds
    buffer_load_dwordx4 v32, s[36:39], s98 offen offset:1024 sc1 lds
    buffer_load_dwordx4 v32, s[36:39], s98 offen offset:2048 sc1 lds
    buffer_load_dwordx4 v32, s[36:39], s98 offen offset:3072 sc1 lds
    s_add_u32 m0, s45, 131072
    s_add_u32 s98, s46, 432128
    buffer_load_dwordx4 v32, s[36:39], s98 offen sc1 lds
    s_waitcnt vmcnt(17)
    s_barrier
    s_add_u32 m0, s44, 36864
    s_mov_b32 s98, 3072
    buffer_load_dwordx4 v26, s[40:43], s98 offen offset:0 lds
    buffer_load_dwordx4 v27, s[40:43], s98 offen offset:1024 lds
    buffer_load_dwordx4 v28, s[40:43], s98 offen offset:2048 lds
    buffer_load_dwordx4 v29, s[40:43], s98 offen offset:3072 lds
    s_add_u32 m0, s45, 53248
    s_add_u32 s98, s46, 442368
    buffer_load_dwordx4 v32, s[36:39], s98 offen offset:0 sc1 lds
    buffer_load_dwordx4 v32, s[36:39], s98 offen offset:1024 sc1 lds
    buffer_load_dwordx4 v32, s[36:39], s98 offen offset:2048 sc1 lds
    buffer_load_dwordx4 v32, s[36:39], s98 offen offset:3072 sc1 lds
    s_add_u32 m0, s44, 40960
    s_mov_b32 s98, 134144
    buffer_load_dwordx4 v26, s[40:43], s98 offen offset:0 lds
    buffer_load_dwordx4 v27, s[40:43], s98 offen offset:1024 lds
    buffer_load_dwordx4 v28, s[40:43], s98 offen offset:2048 lds
    buffer_load_dwordx4 v29, s[40:43], s98 offen offset:3072 lds
    s_add_u32 m0, s45, 57344
    s_add_u32 s98, s46, 446464
    buffer_load_dwordx4 v32, s[36:39], s98 offen offset:0 sc1 lds
    buffer_load_dwordx4 v32, s[36:39], s98 offen offset:1024 sc1 lds
    buffer_load_dwordx4 v32, s[36:39], s98 offen offset:2048 sc1 lds
    buffer_load_dwordx4 v32, s[36:39], s98 offen offset:3072 sc1 lds
    s_add_u32 m0, s45, 61440
    s_add_u32 s98, s46, 450560
    buffer_load_dwordx4 v32, s[36:39], s98 offen sc1 lds
    s_waitcnt vmcnt(17)
    s_barrier
    s_add_u32 m0, s44, 71680
    s_mov_b32 s98, 3200
    buffer_load_dwordx4 v26, s[40:43], s98 offen offset:0 lds
    buffer_load_dwordx4 v27, s[40:43], s98 offen offset:1024 lds
    buffer_load_dwordx4 v28, s[40:43], s98 offen offset:2048 lds
    buffer_load_dwordx4 v29, s[40:43], s98 offen offset:3072 lds
    s_add_u32 m0, s45, 88064
    s_add_u32 s98, s46, 460800
    buffer_load_dwordx4 v32, s[36:39], s98 offen offset:0 sc1 lds
    buffer_load_dwordx4 v32, s[36:39], s98 offen offset:1024 sc1 lds
    buffer_load_dwordx4 v32, s[36:39], s98 offen offset:2048 sc1 lds
    buffer_load_dwordx4 v32, s[36:39], s98 offen offset:3072 sc1 lds
    s_add_u32 m0, s44, 75776
    s_mov_b32 s98, 134272
    buffer_load_dwordx4 v26, s[40:43], s98 offen offset:0 lds
    buffer_load_dwordx4 v27, s[40:43], s98 offen offset:1024 lds
    buffer_load_dwordx4 v28, s[40:43], s98 offen offset:2048 lds
    buffer_load_dwordx4 v29, s[40:43], s98 offen offset:3072 lds
    s_add_u32 m0, s45, 92160
    s_add_u32 s98, s46, 464896
    buffer_load_dwordx4 v32, s[36:39], s98 offen offset:0 sc1 lds
    buffer_load_dwordx4 v32, s[36:39], s98 offen offset:1024 sc1 lds
    buffer_load_dwordx4 v32, s[36:39], s98 offen offset:2048 sc1 lds
    buffer_load_dwordx4 v32, s[36:39], s98 offen offset:3072 sc1 lds
    s_add_u32 m0, s45, 96256
    s_add_u32 s98, s46, 468992
    buffer_load_dwordx4 v32, s[36:39], s98 offen sc1 lds
    s_waitcnt vmcnt(17)
    s_barrier
    s_add_u32 m0, s44, 0
    s_mov_b32 s98, 3328
    buffer_load_dwordx4 v26, s[40:43], s98 offen offset:0 lds
    buffer_load_dwordx4 v27, s[40:43], s98 offen offset:1024 lds
    buffer_load_dwordx4 v28, s[40:43], s98 offen offset:2048 lds
    buffer_load_dwordx4 v29, s[40:43], s98 offen offset:3072 lds
    s_add_u32 m0, s45, 16384
    s_add_u32 s98, s46, 479232
    buffer_load_dwordx4 v32, s[36:39], s98 offen offset:0 sc1 lds
    buffer_load_dwordx4 v32, s[36:39], s98 offen offset:1024 sc1 lds
    buffer_load_dwordx4 v32, s[36:39], s98 offen offset:2048 sc1 lds
    buffer_load_dwordx4 v32, s[36:39], s98 offen offset:3072 sc1 lds
    s_add_u32 m0, s44, 4096
    s_mov_b32 s98, 134400
    buffer_load_dwordx4 v26, s[40:43], s98 offen offset:0 lds
    buffer_load_dwordx4 v27, s[40:43], s98 offen offset:1024 lds
    buffer_load_dwordx4 v28, s[40:43], s98 offen offset:2048 lds
    buffer_load_dwordx4 v29, s[40:43], s98 offen offset:3072 lds
    s_add_u32 m0, s45, 20480
    s_add_u32 s98, s46, 483328
    buffer_load_dwordx4 v32, s[36:39], s98 offen offset:0 sc1 lds
    buffer_load_dwordx4 v32, s[36:39], s98 offen offset:1024 sc1 lds
    buffer_load_dwordx4 v32, s[36:39], s98 offen offset:2048 sc1 lds
    buffer_load_dwordx4 v32, s[36:39], s98 offen offset:3072 sc1 lds
    s_add_u32 m0, s45, 24576
    s_add_u32 s98, s46, 487424
    buffer_load_dwordx4 v32, s[36:39], s98 offen sc1 lds
    s_waitcnt vmcnt(17)
    s_barrier
    s_add_u32 m0, s44, 106496
    s_mov_b32 s98, 3456
    buffer_load_dwordx4 v26, s[40:43], s98 offen offset:0 lds
    buffer_load_dwordx4 v27, s[40:43], s98 offen offset:1024 lds
    buffer_load_dwordx4 v28, s[40:43], s98 offen offset:2048 lds
    buffer_load_dwordx4 v29, s[40:43], s98 offen offset:3072 lds
    s_add_u32 m0, s45, 122880
    s_add_u32 s98, s46, 497664
    buffer_load_dwordx4 v32, s[36:39], s98 offen offset:0 sc1 lds
    buffer_load_dwordx4 v32, s[36:39], s98 offen offset:1024 sc1 lds
    buffer_load_dwordx4 v32, s[36:39], s98 offen offset:2048 sc1 lds
    buffer_load_dwordx4 v32, s[36:39], s98 offen offset:3072 sc1 lds
    s_add_u32 m0, s44, 110592
    s_mov_b32 s98, 134528
    buffer_load_dwordx4 v26, s[40:43], s98 offen offset:0 lds
    buffer_load_dwordx4 v27, s[40:43], s98 offen offset:1024 lds
    buffer_load_dwordx4 v28, s[40:43], s98 offen offset:2048 lds
    buffer_load_dwordx4 v29, s[40:43], s98 offen offset:3072 lds
    s_add_u32 m0, s45, 126976
    s_add_u32 s98, s46, 501760
    buffer_load_dwordx4 v32, s[36:39], s98 offen offset:0 sc1 lds
    buffer_load_dwordx4 v32, s[36:39], s98 offen offset:1024 sc1 lds
    buffer_load_dwordx4 v32, s[36:39], s98 offen offset:2048 sc1 lds
    buffer_load_dwordx4 v32, s[36:39], s98 offen offset:3072 sc1 lds
    s_add_u32 m0, s45, 131072
    s_add_u32 s98, s46, 505856
    buffer_load_dwordx4 v32, s[36:39], s98 offen sc1 lds
    s_waitcnt vmcnt(17)
    s_barrier
    s_add_u32 m0, s44, 36864
    s_mov_b32 s98, 3584
    buffer_load_dwordx4 v26, s[40:43], s98 offen offset:0 lds
    buffer_load_dwordx4 v27, s[40:43], s98 offen offset:1024 lds
    buffer_load_dwordx4 v28, s[40:43], s98 offen offset:2048 lds
    buffer_load_dwordx4 v29, s[40:43], s98 offen offset:3072 lds
    s_add_u32 m0, s45, 53248
    s_add_u32 s98, s46, 516096
    buffer_load_dwordx4 v32, s[36:39], s98 offen offset:0 sc1 lds
    buffer_load_dwordx4 v32, s[36:39], s98 offen offset:1024 sc1 lds
    buffer_load_dwordx4 v32, s[36:39], s98 offen offset:2048 sc1 lds
    buffer_load_dwordx4 v32, s[36:39], s98 offen offset:3072 sc1 lds
    s_add_u32 m0, s44, 40960
    s_mov_b32 s98, 134656
    buffer_load_dwordx4 v26, s[40:43], s98 offen offset:0 lds
    buffer_load_dwordx4 v27, s[40:43], s98 offen offset:1024 lds
    buffer_load_dwordx4 v28, s[40:43], s98 offen offset:2048 lds
    buffer_load_dwordx4 v29, s[40:43], s98 offen offset:3072 lds
    s_add_u32 m0, s45, 57344
    s_add_u32 s98, s46, 520192
    buffer_load_dwordx4 v32, s[36:39], s98 offen offset:0 sc1 lds
    buffer_load_dwordx4 v32, s[36:39], s98 offen offset:1024 sc1 lds
    buffer_load_dwordx4 v32, s[36:39], s98 offen offset:2048 sc1 lds
    buffer_load_dwordx4 v32, s[36:39], s98 offen offset:3072 sc1 lds
    s_add_u32 m0, s45, 61440
    s_add_u32 s98, s46, 524288
    buffer_load_dwordx4 v32, s[36:39], s98 offen sc1 lds
    s_waitcnt vmcnt(17)
    s_barrier
    s_add_u32 m0, s44, 71680
    s_mov_b32 s98, 3712
    buffer_load_dwordx4 v26, s[40:43], s98 offen offset:0 lds
    buffer_load_dwordx4 v27, s[40:43], s98 offen offset:1024 lds
    buffer_load_dwordx4 v28, s[40:43], s98 offen offset:2048 lds
    buffer_load_dwordx4 v29, s[40:43], s98 offen offset:3072 lds
    s_add_u32 m0, s45, 88064
    s_add_u32 s98, s46, 534528
    buffer_load_dwordx4 v32, s[36:39], s98 offen offset:0 sc1 lds
    buffer_load_dwordx4 v32, s[36:39], s98 offen offset:1024 sc1 lds
    buffer_load_dwordx4 v32, s[36:39], s98 offen offset:2048 sc1 lds
    buffer_load_dwordx4 v32, s[36:39], s98 offen offset:3072 sc1 lds
    s_add_u32 m0, s44, 75776
    s_mov_b32 s98, 134784
    buffer_load_dwordx4 v26, s[40:43], s98 offen offset:0 lds
    buffer_load_dwordx4 v27, s[40:43], s98 offen offset:1024 lds
    buffer_load_dwordx4 v28, s[40:43], s98 offen offset:2048 lds
    buffer_load_dwordx4 v29, s[40:43], s98 offen offset:3072 lds
    s_add_u32 m0, s45, 92160
    s_add_u32 s98, s46, 538624
    buffer_load_dwordx4 v32, s[36:39], s98 offen offset:0 sc1 lds
    buffer_load_dwordx4 v32, s[36:39], s98 offen offset:1024 sc1 lds
    buffer_load_dwordx4 v32, s[36:39], s98 offen offset:2048 sc1 lds
    buffer_load_dwordx4 v32, s[36:39], s98 offen offset:3072 sc1 lds
    s_add_u32 m0, s45, 96256
    s_add_u32 s98, s46, 542720
    buffer_load_dwordx4 v32, s[36:39], s98 offen sc1 lds
    s_waitcnt vmcnt(17)
    s_barrier
    s_add_u32 m0, s44, 0
    s_mov_b32 s98, 3840
    buffer_load_dwordx4 v26, s[40:43], s98 offen offset:0 lds
    buffer_load_dwordx4 v27, s[40:43], s98 offen offset:1024 lds
    buffer_load_dwordx4 v28, s[40:43], s98 offen offset:2048 lds
    buffer_load_dwordx4 v29, s[40:43], s98 offen offset:3072 lds
    s_add_u32 m0, s45, 16384
    s_add_u32 s98, s46, 552960
    buffer_load_dwordx4 v32, s[36:39], s98 offen offset:0 sc1 lds
    buffer_load_dwordx4 v32, s[36:39], s98 offen offset:1024 sc1 lds
    buffer_load_dwordx4 v32, s[36:39], s98 offen offset:2048 sc1 lds
    buffer_load_dwordx4 v32, s[36:39], s98 offen offset:3072 sc1 lds
    s_add_u32 m0, s44, 4096
    s_mov_b32 s98, 134912
    buffer_load_dwordx4 v26, s[40:43], s98 offen offset:0 lds
    buffer_load_dwordx4 v27, s[40:43], s98 offen offset:1024 lds
    buffer_load_dwordx4 v28, s[40:43], s98 offen offset:2048 lds
    buffer_load_dwordx4 v29, s[40:43], s98 offen offset:3072 lds
    s_add_u32 m0, s45, 20480
    s_add_u32 s98, s46, 557056
    buffer_load_dwordx4 v32, s[36:39], s98 offen offset:0 sc1 lds
    buffer_load_dwordx4 v32, s[36:39], s98 offen offset:1024 sc1 lds
    buffer_load_dwordx4 v32, s[36:39], s98 offen offset:2048 sc1 lds
    buffer_load_dwordx4 v32, s[36:39], s98 offen offset:3072 sc1 lds
    s_add_u32 m0, s45, 24576
    s_add_u32 s98, s46, 561152
    buffer_load_dwordx4 v32, s[36:39], s98 offen sc1 lds
    s_waitcnt vmcnt(17)
    s_barrier
    s_add_u32 m0, s44, 106496
    s_mov_b32 s98, 3968
    buffer_load_dwordx4 v26, s[40:43], s98 offen offset:0 lds
    buffer_load_dwordx4 v27, s[40:43], s98 offen offset:1024 lds
    buffer_load_dwordx4 v28, s[40:43], s98 offen offset:2048 lds
    buffer_load_dwordx4 v29, s[40:43], s98 offen offset:3072 lds
    s_add_u32 m0, s45, 122880
    s_add_u32 s98, s46, 571392
    buffer_load_dwordx4 v32, s[36:39], s98 offen offset:0 sc1 lds
    buffer_load_dwordx4 v32, s[36:39], s98 offen offset:1024 sc1 lds
    buffer_load_dwordx4 v32, s[36:39], s98 offen offset:2048 sc1 lds
    buffer_load_dwordx4 v32, s[36:39], s98 offen offset:3072 sc1 lds
    s_add_u32 m0, s44, 110592
    s_mov_b32 s98, 135040
    buffer_load_dwordx4 v26, s[40:43], s98 offen offset:0 lds
    buffer_load_dwordx4 v27, s[40:43], s98 offen offset:1024 lds
    buffer_load_dwordx4 v28, s[40:43], s98 offen offset:2048 lds
    buffer_load_dwordx4 v29, s[40:43], s98 offen offset:3072 lds
    s_add_u32 m0, s45, 126976
    s_add_u32 s98, s46, 575488
    buffer_load_dwordx4 v32, s[36:39], s98 offen offset:0 sc1 lds
    buffer_load_dwordx4 v32, s[36:39], s98 offen offset:1024 sc1 lds
    buffer_load_dwordx4 v32, s[36:39], s98 offen offset:2048 sc1 lds
    buffer_load_dwordx4 v32, s[36:39], s98 offen offset:3072 sc1 lds
    s_add_u32 m0, s45, 131072
    s_add_u32 s98, s46, 579584
    buffer_load_dwordx4 v32, s[36:39], s98 offen sc1 lds
    s_branch Ljoin_b_39
Lwork_b_38:
    s_waitcnt vmcnt(8)
    s_barrier
    v_lshrrev_b32 v6, 2, v2
    v_lshl_add_u32 v6, v3, 2, v6
    v_and_b32 v8, 3, v2
    v_lshlrev_b32 v8, 3, v8
    v_mul_u32_u24 v7, 72, v6
    v_add_u32 v7, v7, v8
    v_mul_u32_u24 v6, 80, v6
    v_add_u32 v6, v6, v8
    s_and_b32 s64, s63, 1
    s_mul_i32 s66, s64, 4608
    s_add_u32 s66, s66, 151552
    v_add_u32 v7, s66, v7
    s_mul_i32 s66, s64, 40
    s_add_u32 s66, s66, 141312
    v_add_u32 v6, s66, v6
    ds_read_b64_tr_b16 v[112:113], v6 offset:0
    ds_read_b64_tr_b16 v[114:115], v6 offset:1280
    ds_read_b64_tr_b16 v[116:117], v6 offset:32
    ds_read_b64_tr_b16 v[118:119], v6 offset:1312
    ds_read_b64_tr_b16 v[128:129], v7 offset:0
    ds_read_b64_tr_b16 v[130:131], v7 offset:1152
    ds_read_b64_tr_b16 v[132:133], v7 offset:32
    ds_read_b64_tr_b16 v[134:135], v7 offset:1184
    ds_read_b64_tr_b16 v[136:137], v7 offset:64
    ds_read_b64_tr_b16 v[138:139], v7 offset:1216
    ds_read_b64_tr_b16 v[120:121], v6 offset:2560
    ds_read_b64_tr_b16 v[122:123], v6 offset:3840
    ds_read_b64_tr_b16 v[124:125], v6 offset:2592
    ds_read_b64_tr_b16 v[126:127], v6 offset:3872
    ds_read_b64_tr_b16 v[140:141], v7 offset:2304
    ds_read_b64_tr_b16 v[142:143], v7 offset:3456
    ds_read_b64_tr_b16 v[144:145], v7 offset:2336
    ds_read_b64_tr_b16 v[146:147], v7 offset:3488
    ds_read_b64_tr_b16 v[148:149], v7 offset:2368
    ds_read_b64_tr_b16 v[150:151], v7 offset:3520
    s_waitcnt lgkmcnt(0)
    v_mfma_f32_16x16x32_bf16 v[160:163], v[128:131], v[112:115], 0
    v_mfma_f32_16x16x32_bf16 v[164:167], v[132:135], v[112:115], 0
    v_mfma_f32_16x16x32_bf16 v[168:171], v[136:139], v[112:115], 0
    v_mfma_f32_16x16x32_bf16 v[172:175], v[128:131], v[116:119], 0
    v_mfma_f32_16x16x32_bf16 v[176:179], v[132:135], v[116:119], 0
    v_mfma_f32_16x16x32_bf16 v[180:183], v[136:139], v[116:119], 0
    v_mfma_f32_16x16x32_bf16 v[160:163], v[140:143], v[120:123], v[160:163]
    v_mfma_f32_16x16x32_bf16 v[164:167], v[144:147], v[120:123], v[164:167]
    v_mfma_f32_16x16x32_bf16 v[168:171], v[148:151], v[120:123], v[168:171]
    v_mfma_f32_16x16x32_bf16 v[172:175], v[140:143], v[124:127], v[172:175]
    v_mfma_f32_16x16x32_bf16 v[176:179], v[144:147], v[124:127], v[176:179]
    v_mfma_f32_16x16x32_bf16 v[180:183], v[148:151], v[124:127], v[180:183]
    s_waitcnt vmcnt(0)
    s_barrier
    s_barrier
    s_lshr_b32 s70, s61, 1
    s_lshl_b32 s64, s70, 2
    s_add_u32 s64, s64, s63
    s_mul_i32 s64, s64, 4352
    s_add_u32 s64, s64, 25788416
    s_mov_b64 exec, 1
    v_mov_b32 v4, 0
    v_mov_b32 v5, 1
    buffer_atomic_add v5, v4, s[36:39], s64 offen sc1
    s_mov_b64 exec, -1
    s_barrier
    s_barrier
    s_barrier
    s_barrier
    v_lshrrev_b32 v6, 2, v2
    v_lshl_add_u32 v6, v3, 2, v6
    v_and_b32 v8, 3, v2
    v_lshlrev_b32 v8, 3, v8
    v_mul_u32_u24 v7, 72, v6
    v_add_u32 v7, v7, v8
    v_mul_u32_u24 v6, 80, v6
    v_add_u32 v6, v6, v8
    s_and_b32 s64, s63, 1
    s_mul_i32 s66, s64, 4608
    s_add_u32 s66, s66, 151552
    v_add_u32 v7, s66, v7
    s_mul_i32 s66, s64, 40
    s_add_u32 s66, s66, 146432
    v_add_u32 v6, s66, v6
    ds_read_b64_tr_b16 v[112:113], v6 offset:0
    ds_read_b64_tr_b16 v[114:115], v6 offset:1280
    ds_read_b64_tr_b16 v[116:117], v6 offset:32
    ds_read_b64_tr_b16 v[118:119], v6 offset:1312
    ds_read_b64_tr_b16 v[128:129], v7 offset:0
    ds_read_b64_tr_b16 v[130:131], v7 offset:1152
    ds_read_b64_tr_b16 v[132:133], v7 offset:32
    ds_read_b64_tr_b16 v[134:135], v7 offset:1184
    ds_read_b64_tr_b16 v[136:137], v7 offset:64
    ds_read_b64_tr_b16 v[138:139], v7 offset:1216
    ds_read_b64_tr_b16 v[120:121], v6 offset:2560
    ds_read_b64_tr_b16 v[122:123], v6 offset:3840
    ds_read_b64_tr_b16 v[124:125], v6 offset:2592
    ds_read_b64_tr_b16 v[126:127], v6 offset:3872
    ds_read_b64_tr_b16 v[140:141], v7 offset:2304
    ds_read_b64_tr_b16 v[142:143], v7 offset:3456
    ds_read_b64_tr_b16 v[144:145], v7 offset:2336
    ds_read_b64_tr_b16 v[146:147], v7 offset:3488
    ds_read_b64_tr_b16 v[148:149], v7 offset:2368
    ds_read_b64_tr_b16 v[150:151], v7 offset:3520
    s_waitcnt lgkmcnt(0)
    v_mfma_f32_16x16x32_bf16 v[160:163], v[128:131], v[112:115], v[160:163]
    v_mfma_f32_16x16x32_bf16 v[164:167], v[132:135], v[112:115], v[164:167]
    v_mfma_f32_16x16x32_bf16 v[168:171], v[136:139], v[112:115], v[168:171]
    v_mfma_f32_16x16x32_bf16 v[172:175], v[128:131], v[116:119], v[172:175]
    v_mfma_f32_16x16x32_bf16 v[176:179], v[132:135], v[116:119], v[176:179]
    v_mfma_f32_16x16x32_bf16 v[180:183], v[136:139], v[116:119], v[180:183]
    v_mfma_f32_16x16x32_bf16 v[160:163], v[140:143], v[120:123], v[160:163]
    v_mfma_f32_16x16x32_bf16 v[164:167], v[144:147], v[120:123], v[164:167]
    v_mfma_f32_16x16x32_bf16 v[168:171], v[148:151], v[120:123], v[168:171]
    v_mfma_f32_16x16x32_bf16 v[172:175], v[140:143], v[124:127], v[172:175]
    v_mfma_f32_16x16x32_bf16 v[176:179], v[144:147], v[124:127], v[176:179]
    v_mfma_f32_16x16x32_bf16 v[180:183], v[148:151], v[124:127], v[180:183]
    s_barrier
    s_and_b32 s64, s63, 1
    v_mul_u32_u24 v6, 320, v3
    v_lshl_add_u32 v6, v2, 2, v6
    s_mul_i32 s66, s64, 2880
    s_add_u32 s66, s66, 151552
    v_add_u32 v6, s66, v6
    s_mov_b32 exec_lo, 0xffffffff
    s_mov_b32 exec_hi, 0xffffffff
    ds_write_b32 v6, v160 offset:0
    ds_write_b32 v6, v161 offset:80
    ds_write_b32 v6, v162 offset:160
    ds_write_b32 v6, v163 offset:240
    s_mov_b32 exec_lo, 0xffffffff
    s_mov_b32 exec_hi, 0xffffffff
    ds_write_b32 v6, v164 offset:1280
    ds_write_b32 v6, v165 offset:1360
    ds_write_b32 v6, v166 offset:1440
    ds_write_b32 v6, v167 offset:1520
    s_mov_b32 exec_lo, 0xffff
    s_mov_b32 exec_hi, 0x0
    ds_write_b32 v6, v168 offset:2560
    ds_write_b32 v6, v169 offset:2640
    ds_write_b32 v6, v170 offset:2720
    ds_write_b32 v6, v171 offset:2800
    s_mov_b32 exec_lo, 0xf000f
    s_mov_b32 exec_hi, 0xf000f
    ds_write_b32 v6, v172 offset:64
    ds_write_b32 v6, v173 offset:144
    ds_write_b32 v6, v174 offset:224
    ds_write_b32 v6, v175 offset:304
    s_mov_b32 exec_lo, 0xf000f
    s_mov_b32 exec_hi, 0xf000f
    ds_write_b32 v6, v176 offset:1344
    ds_write_b32 v6, v177 offset:1424
    ds_write_b32 v6, v178 offset:1504
    ds_write_b32 v6, v179 offset:1584
    s_mov_b32 exec_lo, 0xf
    s_mov_b32 exec_hi, 0x0
    ds_write_b32 v6, v180 offset:2624
    ds_write_b32 v6, v181 offset:2704
    ds_write_b32 v6, v182 offset:2784
    ds_write_b32 v6, v183 offset:2864
    s_mov_b64 exec, -1
    s_and_b32 s64, s63, 1
    s_mul_i32 s64, s64, 2880
    v_lshlrev_b32 v37, 2, v1
    v_add_u32 v37, s64, v37
    v_add_u32 v6, 151552, v37
    ds_read_b32 v112, v6 offset:0
    ds_read_b32 v113, v6 offset:256
    ds_read_b32 v114, v6 offset:512
    ds_read_b32 v115, v6 offset:768
    ds_read_b32 v116, v6 offset:1024
    ds_read_b32 v117, v6 offset:1280
    ds_read_b32 v118, v6 offset:1536
    ds_read_b32 v119, v6 offset:1792
    ds_read_b32 v120, v6 offset:2048
    ds_read_b32 v121, v6 offset:2304
    ds_read_b32 v122, v6 offset:2560
    ds_read_b32 v123, v6 offset:2816
    s_mul_i32 s58, s61, 6144
    s_add_u32 s58, s58, 23592960
    s_barrier
    s_waitcnt lgkmcnt(0)
    buffer_atomic_add_f32 v112, v37, s[36:39], s58 offen offset:0 sc1
    buffer_atomic_add_f32 v113, v37, s[36:39], s58 offen offset:256 sc1
    buffer_atomic_add_f32 v114, v37, s[36:39], s58 offen offset:512 sc1
    buffer_atomic_add_f32 v115, v37, s[36:39], s58 offen offset:768 sc1
    buffer_atomic_add_f32 v116, v37, s[36:39], s58 offen offset:1024 sc1
    buffer_atomic_add_f32 v117, v37, s[36:39], s58 offen offset:1280 sc1
    buffer_atomic_add_f32 v118, v37, s[36:39], s58 offen offset:1536 sc1
    buffer_atomic_add_f32 v119, v37, s[36:39], s58 offen offset:1792 sc1
    buffer_atomic_add_f32 v120, v37, s[36:39], s58 offen offset:2048 sc1
    buffer_atomic_add_f32 v121, v37, s[36:39], s58 offen offset:2304 sc1
    buffer_atomic_add_f32 v122, v37, s[36:39], s58 offen offset:2560 sc1
    s_mov_b64 exec, 0xffff
    buffer_atomic_add_f32 v123, v37, s[36:39], s58 offen offset:2816 sc1
    s_mov_b64 exec, -1
    s_barrier
    v_mov_b32 v8, 0
    v_mov_b32 v9, 0
    v_mov_b32 v10, 0
    v_mov_b32 v11, 0
    s_and_b32 s64, s63, 1
    s_mul_i32 s64, s64, 3072
    s_add_u32 s64, s64, 141312
    v_add_u32 v6, s64, v32
    ds_write_b128 v6, v[8:11] offset:0
    ds_write_b128 v6, v[8:11] offset:1024
    ds_write_b128 v6, v[8:11] offset:2048
    s_barrier
    s_barrier
    s_waitcnt vmcnt(0) lgkmcnt(0)
    s_lshl_b32 s64, s61, 2
    s_add_u32 s64, s64, s63
    s_mul_i32 s64, s64, 4352
    s_add_u32 s64, s64, 25231360
    s_mov_b64 exec, 1
    v_mov_b32 v4, 0
    v_mov_b32 v5, 1
    buffer_atomic_add v5, v4, s[36:39], s64 offen sc1
    s_mov_b64 exec, -1
    s_barrier
    s_barrier
    s_barrier
    s_barrier
    s_lshl_b32 s64, s61, 2
    s_add_u32 s64, s64, s63
    s_mul_i32 s64, s64, 4352
    s_add_u32 s64, s64, 25231360
    v_mov_b32 v4, 0
    s_mov_b64 exec, 1
    buffer_load_dword v248, v4, s[36:39], s64 offen sc1
    s_mov_b64 exec, -1
    s_waitcnt vmcnt(0)
    s_mov_b64 exec, 1
    v_cmp_ne_u32 vcc, 16, v248
    s_mov_b32 s66, 0x8000
    s_nop 1
    s_cbranch_vccz Lpe_b_41
    s_lshl_b32 s64, s61, 2
    s_add_u32 s64, s64, s63
    s_mul_i32 s64, s64, 4352
    s_add_u32 s64, s64, 25231360
    v_mov_b32 v4, 0
Lp_b_40:
    buffer_load_dword v248, v4, s[36:39], s64 offen sc1
    s_waitcnt vmcnt(0)
    v_cmp_ne_u32 vcc, 16, v248
    s_sub_u32 s66, s66, 1
    s_cmp_eq_u32 s66, 0
    s_cbranch_scc1 Lpe_b_41
    s_cbranch_vccnz Lp_b_40
Lpe_b_41:
    s_mov_b64 exec, -1
    s_and_b32 s65, s63, 1
    s_mul_i32 s66, s65, 2880
    s_mul_i32 s65, s65, 3072
    s_mul_i32 s64, s61, 6144
    s_add_u32 s64, s64, 23592960
    s_add_u32 s64, s64, s66
    s_add_u32 m0, s65, 151552
    s_nop 0
    buffer_load_dwordx4 v32, s[36:39], s64 offen offset:0 sc1 lds
    buffer_load_dwordx4 v32, s[36:39], s64 offen offset:1024 sc1 lds
    buffer_load_dwordx4 v32, s[36:39], s64 offen offset:2048 sc1 lds
    s_barrier
    s_waitcnt vmcnt(0)
    s_and_b32 s66, s63, 1
    s_mul_i32 s65, s66, 3072
    s_add_u32 s65, s65, 151552
    v_mul_u32_u24 v6, 80, v1
    v_add_u32 v6, s65, v6
    ds_read_b128 v[112:115], v6 offset:0
    ds_read_b128 v[116:119], v6 offset:16
    ds_read_b128 v[120:123], v6 offset:32
    ds_read_b128 v[124:127], v6 offset:48
    ds_read_b128 v[128:131], v6 offset:64
    s_mul_i32 s65, s66, 1920
    s_add_u32 s65, s65, 141312
    v_mul_u32_u24 v37, 48, v1
    v_add_u32 v37, s65, v37
    s_waitcnt lgkmcnt(0)
    v_cvt_pk_bf16_f32 v76, v112, v113
    v_cvt_pk_bf16_f32 v77, v114, v115
    v_cvt_pk_bf16_f32 v78, v116, v117
    v_cvt_pk_bf16_f32 v79, v118, v119
    v_cvt_pk_bf16_f32 v80, v120, v130
    v_mov_b32 v81, 0
    v_cvt_pk_bf16_f32 v82, v121, v122
    v_cvt_pk_bf16_f32 v83, v123, v124
    v_cvt_pk_bf16_f32 v84, v125, v126
    v_cvt_pk_bf16_f32 v85, v127, v128
    v_cvt_pk_bf16_f32 v86, v129, v130
    v_mov_b32 v87, 0
    s_mov_b32 exec_hi, 15
    ds_write_b128 v37, v[76:79] offset:0
    ds_write_b128 v37, v[80:83] offset:16
    ds_write_b128 v37, v[84:87] offset:32
    s_mov_b64 exec, -1
    s_waitcnt lgkmcnt(0)
    s_barrier
    s_lshr_b32 s70, s61, 1
    s_and_b32 s65, s63, 1
    s_lshl_b32 s65, s65, 1
    s_lshl_b32 s64, s70, 2
    s_add_u32 s64, s64, s65
    s_mul_i32 s64, s64, 4352
    s_add_u32 s64, s64, 25788416
    v_mul_u32_u24 v4, 4352, v1
    s_mov_b64 exec, 3
    buffer_load_dword v248, v4, s[36:39], s64 offen sc1
    s_mov_b64 exec, -1
    s_barrier
    s_waitcnt vmcnt(0)
    s_mov_b64 exec, 3
    v_cmp_ne_u32 vcc, 32, v248
    s_mov_b32 s66, 0x8000
    s_nop 1
    s_cbranch_vccz Lpe_b_43
    s_and_b32 s65, s63, 1
    s_lshl_b32 s65, s65, 1
    s_lshl_b32 s64, s70, 2
    s_add_u32 s64, s64, s65
    s_mul_i32 s64, s64, 4352
    s_add_u32 s64, s64, 25788416
    v_mul_u32_u24 v4, 4352, v1
Lp_b_42:
    buffer_load_dword v248, v4, s[36:39], s64 offen sc1
    s_waitcnt vmcnt(0)
    v_cmp_ne_u32 vcc, 32, v248
    s_sub_u32 s66, s66, 1
    s_cmp_eq_u32 s66, 0
    s_cbranch_scc1 Lpe_b_43
    s_cbranch_vccnz Lp_b_42
Lpe_b_43:
    s_mov_b64 exec, -1
    s_barrier
    s_barrier
    s_barrier
    s_and_b32 s64, s63, 1
    s_add_u32 s66, s64, 0
    s_mul_i32 s65, s66, 2304
    s_add_u32 s65, s65, 151552
    v_add_u32 v6, s65, v32
    v_lshlrev_b32 v7, 1, v1
    v_add_u32 v8, s65, v7
    ds_read_b128 v[40:43], v6 offset:0
    ds_read_u16 v48, v8 offset:2048
    ds_read_b128 v[44:47], v6 offset:1024
    ds_read_u16 v49, v8 offset:2176
    s_and_b32 s64, s63, 1
    s_add_u32 s66, s64, 2
    s_mul_i32 s65, s66, 2304
    s_add_u32 s65, s65, 151552
    v_add_u32 v6, s65, v32
    v_lshlrev_b32 v7, 1, v1
    v_add_u32 v8, s65, v7
    ds_read_b128 v[52:55], v6 offset:0
    ds_read_u16 v60, v8 offset:2048
    ds_read_b128 v[56:59], v6 offset:1024
    ds_read_u16 v61, v8 offset:2176
    s_waitcnt lgkmcnt(0)
    s_lshl_b32 s65, s60, 1
    s_add_u32 s65, s65, 0
    s_mul_i32 s65, s65, 368640
    s_and_b32 s64, s63, 1
    s_lshl_b32 s64, s64, 11
    s_add_u32 s65, s65, s64
    s_add_u32 s65, s65, 10485760
    s_lshl_b32 s64, s61, 12
    s_add_u32 s66, s65, s64
    s_lshr_b32 s64, s61, 3
    s_lshl_b32 s64, s64, 12
    s_add_u32 s65, s65, s64
    s_add_u32 s65, s65, 65536
    s_and_b32 s64, s61, 7
    s_lshl_b32 s64, s64, 7
    s_add_u32 s65, s65, s64
    v_lshlrev_b32 v7, 1, v1
    buffer_store_dwordx4 v[40:43], v32, s[36:39], s66 offen offset:0 sc1
    buffer_store_short v48, v7, s[36:39], s65 offen offset:0 sc1
    buffer_store_dwordx4 v[44:47], v32, s[36:39], s66 offen offset:1024 sc1
    buffer_store_short v49, v7, s[36:39], s65 offen offset:1024 sc1
    s_barrier
    s_lshl_b32 s65, s60, 1
    s_add_u32 s65, s65, 1
    s_mul_i32 s65, s65, 368640
    s_and_b32 s64, s63, 1
    s_lshl_b32 s64, s64, 11
    s_add_u32 s65, s65, s64
    s_add_u32 s65, s65, 10485760
    s_lshl_b32 s64, s61, 12
    s_add_u32 s66, s65, s64
    s_lshr_b32 s64, s61, 3
    s_lshl_b32 s64, s64, 12
    s_add_u32 s65, s65, s64
    s_add_u32 s65, s65, 65536
    s_and_b32 s64, s61, 7
    s_lshl_b32 s64, s64, 7
    s_add_u32 s65, s65, s64
    v_lshlrev_b32 v7, 1, v1
    buffer_store_dwordx4 v[52:55], v32, s[36:39], s66 offen offset:0 sc1
    buffer_store_short v60, v7, s[36:39], s65 offen offset:0 sc1
    buffer_store_dwordx4 v[56:59], v32, s[36:39], s66 offen offset:1024 sc1
    buffer_store_short v61, v7, s[36:39], s65 offen offset:1024 sc1
    s_barrier
    s_barrier
    s_waitcnt vmcnt(0)
    s_lshl_b32 s64, s60, 2
    s_add_u32 s64, s64, s63
    s_mul_i32 s64, s64, 4352
    s_add_u32 s64, s64, 24674304
    s_mov_b64 exec, 1
    v_mov_b32 v4, 0
    v_mov_b32 v5, 1
    buffer_atomic_add v5, v4, s[36:39], s64 offen sc1
    s_mov_b64 exec, -1
    s_barrier
    s_barrier
    s_barrier
    s_barrier
    s_lshl_b32 s64, s60, 2
    s_add_u32 s64, s64, s63
    s_mul_i32 s64, s64, 4352
    s_add_u32 s64, s64, 24674304
    v_mov_b32 v4, 0
    s_mov_b64 exec, 1
    buffer_load_dword v248, v4, s[36:39], s64 offen sc1
    s_mov_b64 exec, -1
    s_waitcnt vmcnt(0)
    s_mov_b64 exec, 1
    v_cmp_ne_u32 vcc, 16, v248
    s_mov_b32 s66, 0x8000
    s_nop 1
    s_cbranch_vccz Lpe_b_45
    s_lshl_b32 s64, s60, 2
    s_add_u32 s64, s64, s63
    s_mul_i32 s64, s64, 4352
    s_add_u32 s64, s64, 24674304
    v_mov_b32 v4, 0
Lp_b_44:
    buffer_load_dword v248, v4, s[36:39], s64 offen sc1
    s_waitcnt vmcnt(0)
    v_cmp_ne_u32 vcc, 16, v248
    s_sub_u32 s66, s66, 1
    s_cmp_eq_u32 s66, 0
    s_cbranch_scc1 Lpe_b_45
    s_cbranch_vccnz Lp_b_44
Lpe_b_45:
    s_mov_b64 exec, -1
    s_waitcnt vmcnt(0) lgkmcnt(0)
    s_barrier
    s_barrier
    s_barrier
    s_barrier
    s_barrier
    s_barrier
    s_barrier
    s_barrier
    s_barrier
    s_barrier
    s_barrier
    s_barrier
    s_lshl_b32 s64, s60, 2
    s_add_u32 s64, s64, s91
    s_mul_i32 s64, s64, 4352
    s_add_u32 s64, s64, 24952832
    v_mov_b32 v4, 0
    s_mov_b64 exec, 1
    buffer_load_dword v248, v4, s[36:39], s64 offen sc1
    s_mov_b64 exec, -1
    s_waitcnt vmcnt(0)
    s_mov_b64 exec, 1
    v_cmp_ne_u32 vcc, 16, v248
    s_mov_b32 s66, 0x8000
    s_nop 1
    s_cbranch_vccz Lpe_b_47
    s_lshl_b32 s64, s60, 2
    s_add_u32 s64, s64, s91
    s_mul_i32 s64, s64, 4352
    s_add_u32 s64, s64, 24952832
    v_mov_b32 v4, 0
Lp_b_46:
    buffer_load_dword v248, v4, s[36:39], s64 offen sc1
    s_waitcnt vmcnt(0)
    v_cmp_ne_u32 vcc, 16, v248
    s_sub_u32 s66, s66, 1
    s_cmp_eq_u32 s66, 0
    s_cbranch_scc1 Lpe_b_47
    s_cbranch_vccnz Lp_b_46
Lpe_b_47:
    s_mov_b64 exec, -1
    s_barrier
    s_barrier
    s_barrier
    s_barrier
    s_barrier
    s_barrier
    s_barrier
    s_barrier
    s_barrier
    s_barrier
    s_barrier
    s_barrier
    s_barrier
    s_barrier
    s_barrier
    s_barrier
    s_barrier
    s_barrier
    s_barrier
    s_barrier
    s_barrier
    s_barrier
    s_barrier
    s_barrier
    s_barrier
    s_barrier
    s_barrier
    s_barrier
    s_barrier
    s_barrier
    s_barrier
    s_barrier
    s_barrier
    s_barrier
    s_barrier
    s_barrier
    s_barrier
    s_barrier
    s_barrier
    s_endpgm
Ljoin_b_39:
LB_p3:
    s_waitcnt vmcnt(17)
    s_barrier
    s_add_u32 s98, s77, 0
    s_cmp_ge_u32 s63, 1
    s_cbranch_scc1 Lc_b_48
    s_mov_b32 m0, 157696
    s_nop 0
    buffer_load_dwordx4 v35, s[36:39], s98 offen sc1 lds
Lc_b_48:
    s_add_u32 m0, s74, 149504
    s_nop 0
    buffer_load_dwordx4 v30, s[36:39], s98 offen offset:0 sc1 lds
    buffer_load_dwordx4 v30, s[36:39], s98 offen offset:1024 sc1 lds
    buffer_load_dwordx4 v30, s[36:39], s98 offen offset:2048 sc1 lds
    buffer_load_dwordx4 v30, s[36:39], s98 offen offset:3072 sc1 lds
    s_add_u32 s98, s76, 0
    s_add_u32 m0, s74, 141312
    s_nop 0
    buffer_load_dwordx4 v30, s[36:39], s98 offen offset:0 sc1 lds
    buffer_load_dwordx4 v30, s[36:39], s98 offen offset:1024 sc1 lds
    buffer_load_dwordx4 v30, s[36:39], s98 offen offset:2048 sc1 lds
    buffer_load_dwordx4 v30, s[36:39], s98 offen offset:3072 sc1 lds
    s_add_u32 s98, s77, 9216
    s_cmp_ge_u32 s63, 1
    s_cbranch_scc1 Lc_b_49
    s_mov_b32 m0, 53248
    s_nop 0
    buffer_load_dwordx4 v35, s[36:39], s98 offen sc1 lds
Lc_b_49:
    s_add_u32 m0, s74, 45056
    s_nop 0
    buffer_load_dwordx4 v30, s[36:39], s98 offen offset:0 sc1 lds
    buffer_load_dwordx4 v30, s[36:39], s98 offen offset:1024 sc1 lds
    buffer_load_dwordx4 v30, s[36:39], s98 offen offset:2048 sc1 lds
    buffer_load_dwordx4 v30, s[36:39], s98 offen offset:3072 sc1 lds
    s_add_u32 s98, s76, 8192
    s_add_u32 m0, s74, 36864
    s_nop 0
    buffer_load_dwordx4 v30, s[36:39], s98 offen offset:0 sc1 lds
    buffer_load_dwordx4 v30, s[36:39], s98 offen offset:1024 sc1 lds
    buffer_load_dwordx4 v30, s[36:39], s98 offen offset:2048 sc1 lds
    buffer_load_dwordx4 v30, s[36:39], s98 offen offset:3072 sc1 lds
    s_add_u32 s98, s77, 18432
    s_cmp_ge_u32 s63, 1
    s_cbranch_scc1 Lc_b_50
    s_mov_b32 m0, 70656
    s_nop 0
    buffer_load_dwordx4 v35, s[36:39], s98 offen sc1 lds
Lc_b_50:
    s_add_u32 m0, s74, 62464
    s_nop 0
    buffer_load_dwordx4 v30, s[36:39], s98 offen offset:0 sc1 lds
    buffer_load_dwordx4 v30, s[36:39], s98 offen offset:1024 sc1 lds
    buffer_load_dwordx4 v30, s[36:39], s98 offen offset:2048 sc1 lds
    buffer_load_dwordx4 v30, s[36:39], s98 offen offset:3072 sc1 lds
    s_add_u32 s98, s76, 16384
    s_add_u32 m0, s74, 54272
    s_nop 0
    buffer_load_dwordx4 v30, s[36:39], s98 offen offset:0 sc1 lds
    buffer_load_dwordx4 v30, s[36:39], s98 offen offset:1024 sc1 lds
    buffer_load_dwordx4 v30, s[36:39], s98 offen offset:2048 sc1 lds
    buffer_load_dwordx4 v30, s[36:39], s98 offen offset:3072 sc1 lds
    s_waitcnt vmcnt(24)
    s_barrier
    s_add_u32 s98, s77, 27648
    s_cmp_ge_u32 s63, 1
    s_cbranch_scc1 Lc_b_51
    s_mov_b32 m0, 88064
    s_nop 0
    buffer_load_dwordx4 v35, s[36:39], s98 offen sc1 lds
Lc_b_51:
    s_add_u32 m0, s74, 79872
    s_nop 0
    buffer_load_dwordx4 v30, s[36:39], s98 offen offset:0 sc1 lds
    buffer_load_dwordx4 v30, s[36:39], s98 offen offset:1024 sc1 lds
    buffer_load_dwordx4 v30, s[36:39], s98 offen offset:2048 sc1 lds
    buffer_load_dwordx4 v30, s[36:39], s98 offen offset:3072 sc1 lds
    s_add_u32 s98, s76, 24576
    s_add_u32 m0, s74, 71680
    s_nop 0
    buffer_load_dwordx4 v30, s[36:39], s98 offen offset:0 sc1 lds
    buffer_load_dwordx4 v30, s[36:39], s98 offen offset:1024 sc1 lds
    buffer_load_dwordx4 v30, s[36:39], s98 offen offset:2048 sc1 lds
    buffer_load_dwordx4 v30, s[36:39], s98 offen offset:3072 sc1 lds
    s_add_u32 s98, s77, 36864
    s_cmp_ge_u32 s63, 1
    s_cbranch_scc1 Lc_b_52
    s_mov_b32 m0, 105472
    s_nop 0
    buffer_load_dwordx4 v35, s[36:39], s98 offen sc1 lds
Lc_b_52:
    s_add_u32 m0, s74, 97280
    s_nop 0
    buffer_load_dwordx4 v30, s[36:39], s98 offen offset:0 sc1 lds
    buffer_load_dwordx4 v30, s[36:39], s98 offen offset:1024 sc1 lds
    buffer_load_dwordx4 v30, s[36:39], s98 offen offset:2048 sc1 lds
    buffer_load_dwordx4 v30, s[36:39], s98 offen offset:3072 sc1 lds
    s_add_u32 s98, s76, 32768
    s_add_u32 m0, s74, 89088
    s_nop 0
    buffer_load_dwordx4 v30, s[36:39], s98 offen offset:0 sc1 lds
    buffer_load_dwordx4 v30, s[36:39], s98 offen offset:1024 sc1 lds
    buffer_load_dwordx4 v30, s[36:39], s98 offen offset:2048 sc1 lds
    buffer_load_dwordx4 v30, s[36:39], s98 offen offset:3072 sc1 lds
    s_barrier
    s_add_u32 s98, s77, 46080
    s_cmp_ge_u32 s63, 1
    s_cbranch_scc1 Lc_b_53
    s_mov_b32 m0, 16384
    s_nop 0
    buffer_load_dwordx4 v35, s[36:39], s98 offen sc1 lds
Lc_b_53:
    s_add_u32 m0, s74, 8192
    s_nop 0
    buffer_load_dwordx4 v30, s[36:39], s98 offen offset:0 sc1 lds
    buffer_load_dwordx4 v30, s[36:39], s98 offen offset:1024 sc1 lds
    buffer_load_dwordx4 v30, s[36:39], s98 offen offset:2048 sc1 lds
    buffer_load_dwordx4 v30, s[36:39], s98 offen offset:3072 sc1 lds
    s_add_u32 s98, s76, 40960
    s_add_u32 m0, s74, 0
    s_nop 0
    buffer_load_dwordx4 v30, s[36:39], s98 offen offset:0 sc1 lds
    buffer_load_dwordx4 v30, s[36:39], s98 offen offset:1024 sc1 lds
    buffer_load_dwordx4 v30, s[36:39], s98 offen offset:2048 sc1 lds
    buffer_load_dwordx4 v30, s[36:39], s98 offen offset:3072 sc1 lds
    s_add_u32 s98, s77, 55296
    s_cmp_ge_u32 s63, 1
    s_cbranch_scc1 Lc_b_54
    s_mov_b32 m0, 33792
    s_nop 0
    buffer_load_dwordx4 v35, s[36:39], s98 offen sc1 lds
Lc_b_54:
    s_add_u32 m0, s74, 25600
    s_nop 0
    buffer_load_dwordx4 v30, s[36:39], s98 offen offset:0 sc1 lds
    buffer_load_dwordx4 v30, s[36:39], s98 offen offset:1024 sc1 lds
    buffer_load_dwordx4 v30, s[36:39], s98 offen offset:2048 sc1 lds
    buffer_load_dwordx4 v30, s[36:39], s98 offen offset:3072 sc1 lds
    s_add_u32 s98, s76, 49152
    s_add_u32 m0, s74, 17408
    s_nop 0
    buffer_load_dwordx4 v30, s[36:39], s98 offen offset:0 sc1 lds
    buffer_load_dwordx4 v30, s[36:39], s98 offen offset:1024 sc1 lds
    buffer_load_dwordx4 v30, s[36:39], s98 offen offset:2048 sc1 lds
    buffer_load_dwordx4 v30, s[36:39], s98 offen offset:3072 sc1 lds
    s_waitcnt vmcnt(48)
    s_barrier
    s_waitcnt vmcnt(40)
    s_barrier
    s_waitcnt vmcnt(32)
    s_barrier
    s_waitcnt vmcnt(24)
    s_barrier
    s_add_u32 s98, s77, 64512
    s_cmp_ge_u32 s63, 1
    s_cbranch_scc1 Lc_b_55
    s_mov_b32 m0, 122880
    s_nop 0
    buffer_load_dwordx4 v35, s[36:39], s98 offen sc1 lds
Lc_b_55:
    s_add_u32 m0, s74, 114688
    s_nop 0
    buffer_load_dwordx4 v30, s[36:39], s98 offen offset:0 sc1 lds
    buffer_load_dwordx4 v30, s[36:39], s98 offen offset:1024 sc1 lds
    buffer_load_dwordx4 v30, s[36:39], s98 offen offset:2048 sc1 lds
    buffer_load_dwordx4 v30, s[36:39], s98 offen offset:3072 sc1 lds
    s_add_u32 s98, s76, 57344
    s_add_u32 m0, s74, 106496
    s_nop 0
    buffer_load_dwordx4 v30, s[36:39], s98 offen offset:0 sc1 lds
    buffer_load_dwordx4 v30, s[36:39], s98 offen offset:1024 sc1 lds
    buffer_load_dwordx4 v30, s[36:39], s98 offen offset:2048 sc1 lds
    buffer_load_dwordx4 v30, s[36:39], s98 offen offset:3072 sc1 lds
    s_add_u32 s98, s77, 73728
    s_cmp_ge_u32 s63, 1
    s_cbranch_scc1 Lc_b_56
    s_mov_b32 m0, 140288
    s_nop 0
    buffer_load_dwordx4 v35, s[36:39], s98 offen sc1 lds
Lc_b_56:
    s_add_u32 m0, s74, 132096
    s_nop 0
    buffer_load_dwordx4 v30, s[36:39], s98 offen offset:0 sc1 lds
    buffer_load_dwordx4 v30, s[36:39], s98 offen offset:1024 sc1 lds
    buffer_load_dwordx4 v30, s[36:39], s98 offen offset:2048 sc1 lds
    buffer_load_dwordx4 v30, s[36:39], s98 offen offset:3072 sc1 lds
    s_add_u32 s98, s76, 65536
    s_add_u32 m0, s74, 123904
    s_nop 0
    buffer_load_dwordx4 v30, s[36:39], s98 offen offset:0 sc1 lds
    buffer_load_dwordx4 v30, s[36:39], s98 offen offset:1024 sc1 lds
    buffer_load_dwordx4 v30, s[36:39], s98 offen offset:2048 sc1 lds
    buffer_load_dwordx4 v30, s[36:39], s98 offen offset:3072 sc1 lds
    s_waitcnt vmcnt(32)
    s_barrier
    s_add_u32 s98, s59, 0
    s_and_b32 s98, s98, 31
    s_mul_i32 s98, s98, 9216
    s_add_u32 s98, s98, s57
    s_cmp_ge_u32 s63, 1
    s_cbranch_scc1 Lc_b_57
    s_mov_b32 m0, 157696
    s_nop 0
    buffer_load_dwordx4 v35, s[36:39], s98 offen sc1 lds
Lc_b_57:
    s_add_u32 m0, s74, 149504
    s_nop 0
    buffer_load_dwordx4 v30, s[36:39], s98 offen offset:0 sc1 lds
    buffer_load_dwordx4 v30, s[36:39], s98 offen offset:1024 sc1 lds
    buffer_load_dwordx4 v30, s[36:39], s98 offen offset:2048 sc1 lds
    buffer_load_dwordx4 v30, s[36:39], s98 offen offset:3072 sc1 lds
    s_add_u32 s98, s59, 1
    s_and_b32 s98, s98, 31
    s_mul_i32 s98, s98, 9216
    s_add_u32 s98, s98, s57
    s_cmp_ge_u32 s63, 1
    s_cbranch_scc1 Lc_b_58
    s_mov_b32 m0, 53248
    s_nop 0
    buffer_load_dwordx4 v35, s[36:39], s98 offen sc1 lds
Lc_b_58:
    s_add_u32 m0, s74, 45056
    s_nop 0
    buffer_load_dwordx4 v30, s[36:39], s98 offen offset:0 sc1 lds
    buffer_load_dwordx4 v30, s[36:39], s98 offen offset:1024 sc1 lds
    buffer_load_dwordx4 v30, s[36:39], s98 offen offset:2048 sc1 lds
    buffer_load_dwordx4 v30, s[36:39], s98 offen offset:3072 sc1 lds
    s_add_u32 s98, s59, 2
    s_and_b32 s98, s98, 31
    s_mul_i32 s98, s98, 9216
    s_add_u32 s98, s98, s57
    s_cmp_ge_u32 s63, 1
    s_cbranch_scc1 Lc_b_59
    s_mov_b32 m0, 70656
    s_nop 0
    buffer_load_dwordx4 v35, s[36:39], s98 offen sc1 lds
Lc_b_59:
    s_add_u32 m0, s74, 62464
    s_nop 0
    buffer_load_dwordx4 v30, s[36:39], s98 offen offset:0 sc1 lds
    buffer_load_dwordx4 v30, s[36:39], s98 offen offset:1024 sc1 lds
    buffer_load_dwordx4 v30, s[36:39], s98 offen offset:2048 sc1 lds
    buffer_load_dwordx4 v30, s[36:39], s98 offen offset:3072 sc1 lds
    s_waitcnt vmcnt(36)
    s_barrier
    s_add_u32 s98, s59, 3
    s_and_b32 s98, s98, 31
    s_mul_i32 s98, s98, 9216
    s_add_u32 s98, s98, s57
    s_cmp_ge_u32 s63, 1
    s_cbranch_scc1 Lc_b_60
    s_mov_b32 m0, 88064
    s_nop 0
    buffer_load_dwordx4 v35, s[36:39], s98 offen sc1 lds
Lc_b_60:
    s_add_u32 m0, s74, 79872
    s_nop 0
    buffer_load_dwordx4 v30, s[36:39], s98 offen offset:0 sc1 lds
    buffer_load_dwordx4 v30, s[36:39], s98 offen offset:1024 sc1 lds
    buffer_load_dwordx4 v30, s[36:39], s98 offen offset:2048 sc1 lds
    buffer_load_dwordx4 v30, s[36:39], s98 offen offset:3072 sc1 lds
    s_waitcnt vmcnt(32)
    s_barrier
    s_add_u32 s98, s59, 4
    s_and_b32 s98, s98, 31
    s_mul_i32 s98, s98, 9216
    s_add_u32 s98, s98, s57
    s_cmp_ge_u32 s63, 1
    s_cbranch_scc1 Lc_b_61
    s_mov_b32 m0, 105472
    s_nop 0
    buffer_load_dwordx4 v35, s[36:39], s98 offen sc1 lds
Lc_b_61:
    s_add_u32 m0, s74, 97280
    s_nop 0
    buffer_load_dwordx4 v30, s[36:39], s98 offen offset:0 sc1 lds
    buffer_load_dwordx4 v30, s[36:39], s98 offen offset:1024 sc1 lds
    buffer_load_dwordx4 v30, s[36:39], s98 offen offset:2048 sc1 lds
    buffer_load_dwordx4 v30, s[36:39], s98 offen offset:3072 sc1 lds
    s_waitcnt vmcnt(28)
    s_barrier
    s_add_u32 s98, s59, 5
    s_and_b32 s98, s98, 31
    s_mul_i32 s98, s98, 9216
    s_add_u32 s98, s98, s57
    s_cmp_ge_u32 s63, 1
    s_cbranch_scc1 Lc_b_62
    s_mov_b32 m0, 16384
    s_nop 0
    buffer_load_dwordx4 v35, s[36:39], s98 offen sc1 lds
Lc_b_62:
    s_add_u32 m0, s74, 8192
    s_nop 0
    buffer_load_dwordx4 v30, s[36:39], s98 offen offset:0 sc1 lds
    buffer_load_dwordx4 v30, s[36:39], s98 offen offset:1024 sc1 lds
    buffer_load_dwordx4 v30, s[36:39], s98 offen offset:2048 sc1 lds
    buffer_load_dwordx4 v30, s[36:39], s98 offen offset:3072 sc1 lds
    s_waitcnt vmcnt(24)
    s_barrier
    s_add_u32 s98, s59, 6
    s_and_b32 s98, s98, 31
    s_mul_i32 s98, s98, 9216
    s_add_u32 s98, s98, s57
    s_cmp_ge_u32 s63, 1
    s_cbranch_scc1 Lc_b_63
    s_mov_b32 m0, 33792
    s_nop 0
    buffer_load_dwordx4 v35, s[36:39], s98 offen sc1 lds
Lc_b_63:
    s_add_u32 m0, s74, 25600
    s_nop 0
    buffer_load_dwordx4 v30, s[36:39], s98 offen offset:0 sc1 lds
    buffer_load_dwordx4 v30, s[36:39], s98 offen offset:1024 sc1 lds
    buffer_load_dwordx4 v30, s[36:39], s98 offen offset:2048 sc1 lds
    buffer_load_dwordx4 v30, s[36:39], s98 offen offset:3072 sc1 lds
    s_barrier
    s_add_u32 s98, s59, 0
    s_and_b32 s98, s98, 31
    s_mul_i32 s98, s98, 8192
    s_add_u32 s98, s98, s56
    s_add_u32 m0, s74, 141312
    s_nop 0
    buffer_load_dwordx4 v30, s[36:39], s98 offen offset:0 sc1 lds
    buffer_load_dwordx4 v30, s[36:39], s98 offen offset:1024 sc1 lds
    buffer_load_dwordx4 v30, s[36:39], s98 offen offset:2048 sc1 lds
    buffer_load_dwordx4 v30, s[36:39], s98 offen offset:3072 sc1 lds
    s_add_u32 s98, s59, 1
    s_and_b32 s98, s98, 31
    s_mul_i32 s98, s98, 8192
    s_add_u32 s98, s98, s56
    s_add_u32 m0, s74, 36864
    s_nop 0
    buffer_load_dwordx4 v30, s[36:39], s98 offen offset:0 sc1 lds
    buffer_load_dwordx4 v30, s[36:39], s98 offen offset:1024 sc1 lds
    buffer_load_dwordx4 v30, s[36:39], s98 offen offset:2048 sc1 lds
    buffer_load_dwordx4 v30, s[36:39], s98 offen offset:3072 sc1 lds
    s_add_u32 s98, s59, 2
    s_and_b32 s98, s98, 31
    s_mul_i32 s98, s98, 8192
    s_add_u32 s98, s98, s56
    s_add_u32 m0, s74, 54272
    s_nop 0
    buffer_load_dwordx4 v30, s[36:39], s98 offen offset:0 sc1 lds
    buffer_load_dwordx4 v30, s[36:39], s98 offen offset:1024 sc1 lds
    buffer_load_dwordx4 v30, s[36:39], s98 offen offset:2048 sc1 lds
    buffer_load_dwordx4 v30, s[36:39], s98 offen offset:3072 sc1 lds
    s_waitcnt vmcnt(8)
    s_barrier
    s_add_u32 s98, s59, 3
    s_and_b32 s98, s98, 31
    s_mul_i32 s98, s98, 8192
    s_add_u32 s98, s98, s56
    s_add_u32 m0, s74, 71680
    s_nop 0
    buffer_load_dwordx4 v30, s[36:39], s98 offen offset:0 sc1 lds
    buffer_load_dwordx4 v30, s[36:39], s98 offen offset:1024 sc1 lds
    buffer_load_dwordx4 v30, s[36:39], s98 offen offset:2048 sc1 lds
    buffer_load_dwordx4 v30, s[36:39], s98 offen offset:3072 sc1 lds
    s_add_u32 s98, s59, 4
    s_and_b32 s98, s98, 31
    s_mul_i32 s98, s98, 8192
    s_add_u32 s98, s98, s56
    s_add_u32 m0, s74, 89088
    s_nop 0
    buffer_load_dwordx4 v30, s[36:39], s98 offen offset:0 sc1 lds
    buffer_load_dwordx4 v30, s[36:39], s98 offen offset:1024 sc1 lds
    buffer_load_dwordx4 v30, s[36:39], s98 offen offset:2048 sc1 lds
    buffer_load_dwordx4 v30, s[36:39], s98 offen offset:3072 sc1 lds
    s_add_u32 s98, s59, 5
    s_and_b32 s98, s98, 31
    s_mul_i32 s98, s98, 8192
    s_add_u32 s98, s98, s56
    s_add_u32 m0, s74, 0
    s_nop 0
    buffer_load_dwordx4 v30, s[36:39], s98 offen offset:0 sc1 lds
    buffer_load_dwordx4 v30, s[36:39], s98 offen offset:1024 sc1 lds
    buffer_load_dwordx4 v30, s[36:39], s98 offen offset:2048 sc1 lds
    buffer_load_dwordx4 v30, s[36:39], s98 offen offset:3072 sc1 lds
    s_waitcnt vmcnt(16)
    s_barrier
    s_add_u32 s98, s59, 6
    s_and_b32 s98, s98, 31
    s_mul_i32 s98, s98, 8192
    s_add_u32 s98, s98, s56
    s_add_u32 m0, s74, 17408
    s_nop 0
    buffer_load_dwordx4 v30, s[36:39], s98 offen offset:0 sc1 lds
    buffer_load_dwordx4 v30, s[36:39], s98 offen offset:1024 sc1 lds
    buffer_load_dwordx4 v30, s[36:39], s98 offen offset:2048 sc1 lds
    buffer_load_dwordx4 v30, s[36:39], s98 offen offset:3072 sc1 lds
    s_add_u32 s98, s59, 7
    s_and_b32 s98, s98, 31
    s_mul_i32 s98, s98, 9216
    s_add_u32 s98, s98, s57
    s_cmp_ge_u32 s63, 1
    s_cbranch_scc1 Lc_b_64
    s_mov_b32 m0, 122880
    s_nop 0
    buffer_load_dwordx4 v35, s[36:39], s98 offen sc1 lds
Lc_b_64:
    s_add_u32 m0, s74, 114688
    s_nop 0
    buffer_load_dwordx4 v30, s[36:39], s98 offen offset:0 sc1 lds
    buffer_load_dwordx4 v30, s[36:39], s98 offen offset:1024 sc1 lds
    buffer_load_dwordx4 v30, s[36:39], s98 offen offset:2048 sc1 lds
    buffer_load_dwordx4 v30, s[36:39], s98 offen offset:3072 sc1 lds
    s_add_u32 s98, s59, 7
    s_and_b32 s98, s98, 31
    s_mul_i32 s98, s98, 8192
    s_add_u32 s98, s98, s56
    s_add_u32 m0, s74, 106496
    s_nop 0
    buffer_load_dwordx4 v30, s[36:39], s98 offen offset:0 sc1 lds
    buffer_load_dwordx4 v30, s[36:39], s98 offen offset:1024 sc1 lds
    buffer_load_dwordx4 v30, s[36:39], s98 offen offset:2048 sc1 lds
    buffer_load_dwordx4 v30, s[36:39], s98 offen offset:3072 sc1 lds
    s_waitcnt vmcnt(24)
    s_barrier
    s_add_u32 s98, s59, 8
    s_and_b32 s98, s98, 31
    s_mul_i32 s98, s98, 9216
    s_add_u32 s98, s98, s57
    s_cmp_ge_u32 s63, 1
    s_cbranch_scc1 Lc_b_65
    s_mov_b32 m0, 140288
    s_nop 0
    buffer_load_dwordx4 v35, s[36:39], s98 offen sc1 lds
Lc_b_65:
    s_add_u32 m0, s74, 132096
    s_nop 0
    buffer_load_dwordx4 v30, s[36:39], s98 offen offset:0 sc1 lds
    buffer_load_dwordx4 v30, s[36:39], s98 offen offset:1024 sc1 lds
    buffer_load_dwordx4 v30, s[36:39], s98 offen offset:2048 sc1 lds
    buffer_load_dwordx4 v30, s[36:39], s98 offen offset:3072 sc1 lds
    s_add_u32 s98, s59, 8
    s_and_b32 s98, s98, 31
    s_mul_i32 s98, s98, 8192
    s_add_u32 s98, s98, s56
    s_add_u32 m0, s74, 123904
    s_nop 0
    buffer_load_dwordx4 v30, s[36:39], s98 offen offset:0 sc1 lds
    buffer_load_dwordx4 v30, s[36:39], s98 offen offset:1024 sc1 lds
    buffer_load_dwordx4 v30, s[36:39], s98 offen offset:2048 sc1 lds
    buffer_load_dwordx4 v30, s[36:39], s98 offen offset:3072 sc1 lds
    s_add_u32 s98, s59, 9
    s_and_b32 s98, s98, 31
    s_mul_i32 s98, s98, 9216
    s_add_u32 s98, s98, s57
    s_cmp_ge_u32 s63, 1
    s_cbranch_scc1 Lc_b_66
    s_mov_b32 m0, 157696
    s_nop 0
    buffer_load_dwordx4 v35, s[36:39], s98 offen sc1 lds
Lc_b_66:
    s_add_u32 m0, s74, 149504
    s_nop 0
    buffer_load_dwordx4 v30, s[36:39], s98 offen offset:0 sc1 lds
    buffer_load_dwordx4 v30, s[36:39], s98 offen offset:1024 sc1 lds
    buffer_load_dwordx4 v30, s[36:39], s98 offen offset:2048 sc1 lds
    buffer_load_dwordx4 v30, s[36:39], s98 offen offset:3072 sc1 lds
    s_add_u32 s98, s59, 9
    s_and_b32 s98, s98, 31
    s_mul_i32 s98, s98, 8192
    s_add_u32 s98, s98, s56
    s_add_u32 m0, s74, 141312
    s_nop 0
    buffer_load_dwordx4 v30, s[36:39], s98 offen offset:0 sc1 lds
    buffer_load_dwordx4 v30, s[36:39], s98 offen offset:1024 sc1 lds
    buffer_load_dwordx4 v30, s[36:39], s98 offen offset:2048 sc1 lds
    buffer_load_dwordx4 v30, s[36:39], s98 offen offset:3072 sc1 lds
    s_waitcnt vmcnt(36)
    s_barrier
    s_add_u32 s98, s59, 10
    s_and_b32 s98, s98, 31
    s_mul_i32 s98, s98, 9216
    s_add_u32 s98, s98, s57
    s_cmp_ge_u32 s63, 1
    s_cbranch_scc1 Lc_b_67
    s_mov_b32 m0, 53248
    s_nop 0
    buffer_load_dwordx4 v35, s[36:39], s98 offen sc1 lds
Lc_b_67:
    s_add_u32 m0, s74, 45056
    s_nop 0
    buffer_load_dwordx4 v30, s[36:39], s98 offen offset:0 sc1 lds
    buffer_load_dwordx4 v30, s[36:39], s98 offen offset:1024 sc1 lds
    buffer_load_dwordx4 v30, s[36:39], s98 offen offset:2048 sc1 lds
    buffer_load_dwordx4 v30, s[36:39], s98 offen offset:3072 sc1 lds
    s_add_u32 s98, s59, 10
    s_and_b32 s98, s98, 31
    s_mul_i32 s98, s98, 8192
    s_add_u32 s98, s98, s56
    s_add_u32 m0, s74, 36864
    s_nop 0
    buffer_load_dwordx4 v30, s[36:39], s98 offen offset:0 sc1 lds
    buffer_load_dwordx4 v30, s[36:39], s98 offen offset:1024 sc1 lds
    buffer_load_dwordx4 v30, s[36:39], s98 offen offset:2048 sc1 lds
    buffer_load_dwordx4 v30, s[36:39], s98 offen offset:3072 sc1 lds
    s_waitcnt vmcnt(40)
    s_barrier
    s_add_u32 s98, s59, 11
    s_and_b32 s98, s98, 31
    s_mul_i32 s98, s98, 9216
    s_add_u32 s98, s98, s57
    s_cmp_ge_u32 s63, 1
    s_cbranch_scc1 Lc_b_68
    s_mov_b32 m0, 70656
    s_nop 0
    buffer_load_dwordx4 v35, s[36:39], s98 offen sc1 lds
Lc_b_68:
    s_add_u32 m0, s74, 62464
    s_nop 0
    buffer_load_dwordx4 v30, s[36:39], s98 offen offset:0 sc1 lds
    buffer_load_dwordx4 v30, s[36:39], s98 offen offset:1024 sc1 lds
    buffer_load_dwordx4 v30, s[36:39], s98 offen offset:2048 sc1 lds
    buffer_load_dwordx4 v30, s[36:39], s98 offen offset:3072 sc1 lds
    s_add_u32 s98, s59, 11
    s_and_b32 s98, s98, 31
    s_mul_i32 s98, s98, 8192
    s_add_u32 s98, s98, s56
    s_add_u32 m0, s74, 54272
    s_nop 0
    buffer_load_dwordx4 v30, s[36:39], s98 offen offset:0 sc1 lds
    buffer_load_dwordx4 v30, s[36:39], s98 offen offset:1024 sc1 lds
    buffer_load_dwordx4 v30, s[36:39], s98 offen offset:2048 sc1 lds
    buffer_load_dwordx4 v30, s[36:39], s98 offen offset:3072 sc1 lds
    s_waitcnt vmcnt(44)
    s_barrier
    s_add_u32 s98, s59, 12
    s_and_b32 s98, s98, 31
    s_mul_i32 s98, s98, 9216
    s_add_u32 s98, s98, s57
    s_cmp_ge_u32 s63, 1
    s_cbranch_scc1 Lc_b_69
    s_mov_b32 m0, 88064
    s_nop 0
    buffer_load_dwordx4 v35, s[36:39], s98 offen sc1 lds
Lc_b_69:
    s_add_u32 m0, s74, 79872
    s_nop 0
    buffer_load_dwordx4 v30, s[36:39], s98 offen offset:0 sc1 lds
    buffer_load_dwordx4 v30, s[36:39], s98 offen offset:1024 sc1 lds
    buffer_load_dwordx4 v30, s[36:39], s98 offen offset:2048 sc1 lds
    buffer_load_dwordx4 v30, s[36:39], s98 offen offset:3072 sc1 lds
    s_add_u32 s98, s59, 12
    s_and_b32 s98, s98, 31
    s_mul_i32 s98, s98, 8192
    s_add_u32 s98, s98, s56
    s_add_u32 m0, s74, 71680
    s_nop 0
    buffer_load_dwordx4 v30, s[36:39], s98 offen offset:0 sc1 lds
    buffer_load_dwordx4 v30, s[36:39], s98 offen offset:1024 sc1 lds
    buffer_load_dwordx4 v30, s[36:39], s98 offen offset:2048 sc1 lds
    buffer_load_dwordx4 v30, s[36:39], s98 offen offset:3072 sc1 lds
    s_waitcnt vmcnt(48)
    s_barrier
    s_add_u32 s98, s59, 13
    s_and_b32 s98, s98, 31
    s_mul_i32 s98, s98, 9216
    s_add_u32 s98, s98, s57
    s_cmp_ge_u32 s63, 1
    s_cbranch_scc1 Lc_b_70
    s_mov_b32 m0, 105472
    s_nop 0
    buffer_load_dwordx4 v35, s[36:39], s98 offen sc1 lds
Lc_b_70:
    s_add_u32 m0, s74, 97280
    s_nop 0
    buffer_load_dwordx4 v30, s[36:39], s98 offen offset:0 sc1 lds
    buffer_load_dwordx4 v30, s[36:39], s98 offen offset:1024 sc1 lds
    buffer_load_dwordx4 v30, s[36:39], s98 offen offset:2048 sc1 lds
    buffer_load_dwordx4 v30, s[36:39], s98 offen offset:3072 sc1 lds
    s_add_u32 s98, s59, 13
    s_and_b32 s98, s98, 31
    s_mul_i32 s98, s98, 8192
    s_add_u32 s98, s98, s56
    s_add_u32 m0, s74, 89088
    s_nop 0
    buffer_load_dwordx4 v30, s[36:39], s98 offen offset:0 sc1 lds
    buffer_load_dwordx4 v30, s[36:39], s98 offen offset:1024 sc1 lds
    buffer_load_dwordx4 v30, s[36:39], s98 offen offset:2048 sc1 lds
    buffer_load_dwordx4 v30, s[36:39], s98 offen offset:3072 sc1 lds
    s_waitcnt vmcnt(48)
    s_barrier
    s_add_u32 s98, s59, 14
    s_and_b32 s98, s98, 31
    s_mul_i32 s98, s98, 9216
    s_add_u32 s98, s98, s57
    s_cmp_ge_u32 s63, 1
    s_cbranch_scc1 Lc_b_71
    s_mov_b32 m0, 16384
    s_nop 0
    buffer_load_dwordx4 v35, s[36:39], s98 offen sc1 lds
Lc_b_71:
    s_add_u32 m0, s74, 8192
    s_nop 0
    buffer_load_dwordx4 v30, s[36:39], s98 offen offset:0 sc1 lds
    buffer_load_dwordx4 v30, s[36:39], s98 offen offset:1024 sc1 lds
    buffer_load_dwordx4 v30, s[36:39], s98 offen offset:2048 sc1 lds
    buffer_load_dwordx4 v30, s[36:39], s98 offen offset:3072 sc1 lds
    s_add_u32 s98, s59, 14
    s_and_b32 s98, s98, 31
    s_mul_i32 s98, s98, 8192
    s_add_u32 s98, s98, s56
    s_add_u32 m0, s74, 0
    s_nop 0
    buffer_load_dwordx4 v30, s[36:39], s98 offen offset:0 sc1 lds
    buffer_load_dwordx4 v30, s[36:39], s98 offen offset:1024 sc1 lds
    buffer_load_dwordx4 v30, s[36:39], s98 offen offset:2048 sc1 lds
    buffer_load_dwordx4 v30, s[36:39], s98 offen offset:3072 sc1 lds
    s_waitcnt vmcnt(48)
    s_barrier
    s_add_u32 s98, s59, 15
    s_and_b32 s98, s98, 31
    s_mul_i32 s98, s98, 9216
    s_add_u32 s98, s98, s57
    s_cmp_ge_u32 s63, 1
    s_cbranch_scc1 Lc_b_72
    s_mov_b32 m0, 33792
    s_nop 0
    buffer_load_dwordx4 v35, s[36:39], s98 offen sc1 lds
Lc_b_72:
    s_add_u32 m0, s74, 25600
    s_nop 0
    buffer_load_dwordx4 v30, s[36:39], s98 offen offset:0 sc1 lds
    buffer_load_dwordx4 v30, s[36:39], s98 offen offset:1024 sc1 lds
    buffer_load_dwordx4 v30, s[36:39], s98 offen offset:2048 sc1 lds
    buffer_load_dwordx4 v30, s[36:39], s98 offen offset:3072 sc1 lds
    s_add_u32 s98, s59, 15
    s_and_b32 s98, s98, 31
    s_mul_i32 s98, s98, 8192
    s_add_u32 s98, s98, s56
    s_add_u32 m0, s74, 17408
    s_nop 0
    buffer_load_dwordx4 v30, s[36:39], s98 offen offset:0 sc1 lds
    buffer_load_dwordx4 v30, s[36:39], s98 offen offset:1024 sc1 lds
    buffer_load_dwordx4 v30, s[36:39], s98 offen offset:2048 sc1 lds
    buffer_load_dwordx4 v30, s[36:39], s98 offen offset:3072 sc1 lds
    s_waitcnt vmcnt(48)
    s_barrier
    s_add_u32 s98, s59, 16
    s_and_b32 s98, s98, 31
    s_mul_i32 s98, s98, 9216
    s_add_u32 s98, s98, s57
    s_cmp_ge_u32 s63, 1
    s_cbranch_scc1 Lc_b_73
    s_mov_b32 m0, 122880
    s_nop 0
    buffer_load_dwordx4 v35, s[36:39], s98 offen sc1 lds
Lc_b_73:
    s_add_u32 m0, s74, 114688
    s_nop 0
    buffer_load_dwordx4 v30, s[36:39], s98 offen offset:0 sc1 lds
    buffer_load_dwordx4 v30, s[36:39], s98 offen offset:1024 sc1 lds
    buffer_load_dwordx4 v30, s[36:39], s98 offen offset:2048 sc1 lds
    buffer_load_dwordx4 v30, s[36:39], s98 offen offset:3072 sc1 lds
    s_add_u32 s98, s59, 16
    s_and_b32 s98, s98, 31
    s_mul_i32 s98, s98, 8192
    s_add_u32 s98, s98, s56
    s_add_u32 m0, s74, 106496
    s_nop 0
    buffer_load_dwordx4 v30, s[36:39], s98 offen offset:0 sc1 lds
    buffer_load_dwordx4 v30, s[36:39], s98 offen offset:1024 sc1 lds
    buffer_load_dwordx4 v30, s[36:39], s98 offen offset:2048 sc1 lds
    buffer_load_dwordx4 v30, s[36:39], s98 offen offset:3072 sc1 lds
    s_waitcnt vmcnt(48)
    s_barrier
    s_add_u32 s98, s59, 17
    s_and_b32 s98, s98, 31
    s_mul_i32 s98, s98, 9216
    s_add_u32 s98, s98, s57
    s_cmp_ge_u32 s63, 1
    s_cbranch_scc1 Lc_b_74
    s_mov_b32 m0, 140288
    s_nop 0
    buffer_load_dwordx4 v35, s[36:39], s98 offen sc1 lds
Lc_b_74:
    s_add_u32 m0, s74, 132096
    s_nop 0
    buffer_load_dwordx4 v30, s[36:39], s98 offen offset:0 sc1 lds
    buffer_load_dwordx4 v30, s[36:39], s98 offen offset:1024 sc1 lds
    buffer_load_dwordx4 v30, s[36:39], s98 offen offset:2048 sc1 lds
    buffer_load_dwordx4 v30, s[36:39], s98 offen offset:3072 sc1 lds
    s_add_u32 s98, s59, 17
    s_and_b32 s98, s98, 31
    s_mul_i32 s98, s98, 8192
    s_add_u32 s98, s98, s56
    s_add_u32 m0, s74, 123904
    s_nop 0
    buffer_load_dwordx4 v30, s[36:39], s98 offen offset:0 sc1 lds
    buffer_load_dwordx4 v30, s[36:39], s98 offen offset:1024 sc1 lds
    buffer_load_dwordx4 v30, s[36:39], s98 offen offset:2048 sc1 lds
    buffer_load_dwordx4 v30, s[36:39], s98 offen offset:3072 sc1 lds
    s_waitcnt vmcnt(48)
    s_barrier
    s_add_u32 s98, s59, 18
    s_and_b32 s98, s98, 31
    s_mul_i32 s98, s98, 9216
    s_add_u32 s98, s98, s57
    s_cmp_ge_u32 s63, 1
    s_cbranch_scc1 Lc_b_75
    s_mov_b32 m0, 157696
    s_nop 0
    buffer_load_dwordx4 v35, s[36:39], s98 offen sc1 lds
Lc_b_75:
    s_add_u32 m0, s74, 149504
    s_nop 0
    buffer_load_dwordx4 v30, s[36:39], s98 offen offset:0 sc1 lds
    buffer_load_dwordx4 v30, s[36:39], s98 offen offset:1024 sc1 lds
    buffer_load_dwordx4 v30, s[36:39], s98 offen offset:2048 sc1 lds
    buffer_load_dwordx4 v30, s[36:39], s98 offen offset:3072 sc1 lds
    s_add_u32 s98, s59, 18
    s_and_b32 s98, s98, 31
    s_mul_i32 s98, s98, 8192
    s_add_u32 s98, s98, s56
    s_add_u32 m0, s74, 141312
    s_nop 0
    buffer_load_dwordx4 v30, s[36:39], s98 offen offset:0 sc1 lds
    buffer_load_dwordx4 v30, s[36:39], s98 offen offset:1024 sc1 lds
    buffer_load_dwordx4 v30, s[36:39], s98 offen offset:2048 sc1 lds
    buffer_load_dwordx4 v30, s[36:39], s98 offen offset:3072 sc1 lds
    s_waitcnt vmcnt(48)
    s_barrier
    s_add_u32 s98, s59, 19
    s_and_b32 s98, s98, 31
    s_mul_i32 s98, s98, 9216
    s_add_u32 s98, s98, s57
    s_cmp_ge_u32 s63, 1
    s_cbranch_scc1 Lc_b_76
    s_mov_b32 m0, 53248
    s_nop 0
    buffer_load_dwordx4 v35, s[36:39], s98 offen sc1 lds
Lc_b_76:
    s_add_u32 m0, s74, 45056
    s_nop 0
    buffer_load_dwordx4 v30, s[36:39], s98 offen offset:0 sc1 lds
    buffer_load_dwordx4 v30, s[36:39], s98 offen offset:1024 sc1 lds
    buffer_load_dwordx4 v30, s[36:39], s98 offen offset:2048 sc1 lds
    buffer_load_dwordx4 v30, s[36:39], s98 offen offset:3072 sc1 lds
    s_add_u32 s98, s59, 19
    s_and_b32 s98, s98, 31
    s_mul_i32 s98, s98, 8192
    s_add_u32 s98, s98, s56
    s_add_u32 m0, s74, 36864
    s_nop 0
    buffer_load_dwordx4 v30, s[36:39], s98 offen offset:0 sc1 lds
    buffer_load_dwordx4 v30, s[36:39], s98 offen offset:1024 sc1 lds
    buffer_load_dwordx4 v30, s[36:39], s98 offen offset:2048 sc1 lds
    buffer_load_dwordx4 v30, s[36:39], s98 offen offset:3072 sc1 lds
    s_waitcnt vmcnt(48)
    s_barrier
    s_add_u32 s98, s59, 20
    s_and_b32 s98, s98, 31
    s_mul_i32 s98, s98, 9216
    s_add_u32 s98, s98, s57
    s_cmp_ge_u32 s63, 1
    s_cbranch_scc1 Lc_b_77
    s_mov_b32 m0, 70656
    s_nop 0
    buffer_load_dwordx4 v35, s[36:39], s98 offen sc1 lds
Lc_b_77:
    s_add_u32 m0, s74, 62464
    s_nop 0
    buffer_load_dwordx4 v30, s[36:39], s98 offen offset:0 sc1 lds
    buffer_load_dwordx4 v30, s[36:39], s98 offen offset:1024 sc1 lds
    buffer_load_dwordx4 v30, s[36:39], s98 offen offset:2048 sc1 lds
    buffer_load_dwordx4 v30, s[36:39], s98 offen offset:3072 sc1 lds
    s_add_u32 s98, s59, 20
    s_and_b32 s98, s98, 31
    s_mul_i32 s98, s98, 8192
    s_add_u32 s98, s98, s56
    s_add_u32 m0, s74, 54272
    s_nop 0
    buffer_load_dwordx4 v30, s[36:39], s98 offen offset:0 sc1 lds
    buffer_load_dwordx4 v30, s[36:39], s98 offen offset:1024 sc1 lds
    buffer_load_dwordx4 v30, s[36:39], s98 offen offset:2048 sc1 lds
    buffer_load_dwordx4 v30, s[36:39], s98 offen offset:3072 sc1 lds
    s_waitcnt vmcnt(48)
    s_barrier
    s_add_u32 s98, s59, 21
    s_and_b32 s98, s98, 31
    s_mul_i32 s98, s98, 9216
    s_add_u32 s98, s98, s57
    s_cmp_ge_u32 s63, 1
    s_cbranch_scc1 Lc_b_78
    s_mov_b32 m0, 88064
    s_nop 0
    buffer_load_dwordx4 v35, s[36:39], s98 offen sc1 lds
Lc_b_78:
    s_add_u32 m0, s74, 79872
    s_nop 0
    buffer_load_dwordx4 v30, s[36:39], s98 offen offset:0 sc1 lds
    buffer_load_dwordx4 v30, s[36:39], s98 offen offset:1024 sc1 lds
    buffer_load_dwordx4 v30, s[36:39], s98 offen offset:2048 sc1 lds
    buffer_load_dwordx4 v30, s[36:39], s98 offen offset:3072 sc1 lds
    s_add_u32 s98, s59, 21
    s_and_b32 s98, s98, 31
    s_mul_i32 s98, s98, 8192
    s_add_u32 s98, s98, s56
    s_add_u32 m0, s74, 71680
    s_nop 0
    buffer_load_dwordx4 v30, s[36:39], s98 offen offset:0 sc1 lds
    buffer_load_dwordx4 v30, s[36:39], s98 offen offset:1024 sc1 lds
    buffer_load_dwordx4 v30, s[36:39], s98 offen offset:2048 sc1 lds
    buffer_load_dwordx4 v30, s[36:39], s98 offen offset:3072 sc1 lds
    s_waitcnt vmcnt(48)
    s_barrier
    s_add_u32 s98, s59, 22
    s_and_b32 s98, s98, 31
    s_mul_i32 s98, s98, 9216
    s_add_u32 s98, s98, s57
    s_cmp_ge_u32 s63, 1
    s_cbranch_scc1 Lc_b_79
    s_mov_b32 m0, 105472
    s_nop 0
    buffer_load_dwordx4 v35, s[36:39], s98 offen sc1 lds
Lc_b_79:
    s_add_u32 m0, s74, 97280
    s_nop 0
    buffer_load_dwordx4 v30, s[36:39], s98 offen offset:0 sc1 lds
    buffer_load_dwordx4 v30, s[36:39], s98 offen offset:1024 sc1 lds
    buffer_load_dwordx4 v30, s[36:39], s98 offen offset:2048 sc1 lds
    buffer_load_dwordx4 v30, s[36:39], s98 offen offset:3072 sc1 lds
    s_add_u32 s98, s59, 22
    s_and_b32 s98, s98, 31
    s_mul_i32 s98, s98, 8192
    s_add_u32 s98, s98, s56
    s_add_u32 m0, s74, 89088
    s_nop 0
    buffer_load_dwordx4 v30, s[36:39], s98 offen offset:0 sc1 lds
    buffer_load_dwordx4 v30, s[36:39], s98 offen offset:1024 sc1 lds
    buffer_load_dwordx4 v30, s[36:39], s98 offen offset:2048 sc1 lds
    buffer_load_dwordx4 v30, s[36:39], s98 offen offset:3072 sc1 lds
    s_waitcnt vmcnt(48)
    s_barrier
    s_add_u32 s98, s59, 23
    s_and_b32 s98, s98, 31
    s_mul_i32 s98, s98, 9216
    s_add_u32 s98, s98, s57
    s_cmp_ge_u32 s63, 1
    s_cbranch_scc1 Lc_b_80
    s_mov_b32 m0, 16384
    s_nop 0
    buffer_load_dwordx4 v35, s[36:39], s98 offen sc1 lds
Lc_b_80:
    s_add_u32 m0, s74, 8192
    s_nop 0
    buffer_load_dwordx4 v30, s[36:39], s98 offen offset:0 sc1 lds
    buffer_load_dwordx4 v30, s[36:39], s98 offen offset:1024 sc1 lds
    buffer_load_dwordx4 v30, s[36:39], s98 offen offset:2048 sc1 lds
    buffer_load_dwordx4 v30, s[36:39], s98 offen offset:3072 sc1 lds
    s_add_u32 s98, s59, 23
    s_and_b32 s98, s98, 31
    s_mul_i32 s98, s98, 8192
    s_add_u32 s98, s98, s56
    s_add_u32 m0, s74, 0
    s_nop 0
    buffer_load_dwordx4 v30, s[36:39], s98 offen offset:0 sc1 lds
    buffer_load_dwordx4 v30, s[36:39], s98 offen offset:1024 sc1 lds
    buffer_load_dwordx4 v30, s[36:39], s98 offen offset:2048 sc1 lds
    buffer_load_dwordx4 v30, s[36:39], s98 offen offset:3072 sc1 lds
    s_waitcnt vmcnt(48)
    s_barrier
    s_add_u32 s98, s59, 24
    s_and_b32 s98, s98, 31
    s_mul_i32 s98, s98, 9216
    s_add_u32 s98, s98, s57
    s_cmp_ge_u32 s63, 1
    s_cbranch_scc1 Lc_b_81
    s_mov_b32 m0, 33792
    s_nop 0
    buffer_load_dwordx4 v35, s[36:39], s98 offen sc1 lds
Lc_b_81:
    s_add_u32 m0, s74, 25600
    s_nop 0
    buffer_load_dwordx4 v30, s[36:39], s98 offen offset:0 sc1 lds
    buffer_load_dwordx4 v30, s[36:39], s98 offen offset:1024 sc1 lds
    buffer_load_dwordx4 v30, s[36:39], s98 offen offset:2048 sc1 lds
    buffer_load_dwordx4 v30, s[36:39], s98 offen offset:3072 sc1 lds
    s_add_u32 s98, s59, 24
    s_and_b32 s98, s98, 31
    s_mul_i32 s98, s98, 8192
    s_add_u32 s98, s98, s56
    s_add_u32 m0, s74, 17408
    s_nop 0
    buffer_load_dwordx4 v30, s[36:39], s98 offen offset:0 sc1 lds
    buffer_load_dwordx4 v30, s[36:39], s98 offen offset:1024 sc1 lds
    buffer_load_dwordx4 v30, s[36:39], s98 offen offset:2048 sc1 lds
    buffer_load_dwordx4 v30, s[36:39], s98 offen offset:3072 sc1 lds
    s_waitcnt vmcnt(48)
    s_barrier
    s_add_u32 s98, s59, 25
    s_and_b32 s98, s98, 31
    s_mul_i32 s98, s98, 9216
    s_add_u32 s98, s98, s57
    s_cmp_ge_u32 s63, 1
    s_cbranch_scc1 Lc_b_82
    s_mov_b32 m0, 122880
    s_nop 0
    buffer_load_dwordx4 v35, s[36:39], s98 offen sc1 lds
Lc_b_82:
    s_add_u32 m0, s74, 114688
    s_nop 0
    buffer_load_dwordx4 v30, s[36:39], s98 offen offset:0 sc1 lds
    buffer_load_dwordx4 v30, s[36:39], s98 offen offset:1024 sc1 lds
    buffer_load_dwordx4 v30, s[36:39], s98 offen offset:2048 sc1 lds
    buffer_load_dwordx4 v30, s[36:39], s98 offen offset:3072 sc1 lds
    s_add_u32 s98, s59, 25
    s_and_b32 s98, s98, 31
    s_mul_i32 s98, s98, 8192
    s_add_u32 s98, s98, s56
    s_add_u32 m0, s74, 106496
    s_nop 0
    buffer_load_dwordx4 v30, s[36:39], s98 offen offset:0 sc1 lds
    buffer_load_dwordx4 v30, s[36:39], s98 offen offset:1024 sc1 lds
    buffer_load_dwordx4 v30, s[36:39], s98 offen offset:2048 sc1 lds
    buffer_load_dwordx4 v30, s[36:39], s98 offen offset:3072 sc1 lds
    s_waitcnt vmcnt(48)
    s_barrier
    s_add_u32 s98, s59, 26
    s_and_b32 s98, s98, 31
    s_mul_i32 s98, s98, 9216
    s_add_u32 s98, s98, s57
    s_cmp_ge_u32 s63, 1
    s_cbranch_scc1 Lc_b_83
    s_mov_b32 m0, 140288
    s_nop 0
    buffer_load_dwordx4 v35, s[36:39], s98 offen sc1 lds
Lc_b_83:
    s_add_u32 m0, s74, 132096
    s_nop 0
    buffer_load_dwordx4 v30, s[36:39], s98 offen offset:0 sc1 lds
    buffer_load_dwordx4 v30, s[36:39], s98 offen offset:1024 sc1 lds
    buffer_load_dwordx4 v30, s[36:39], s98 offen offset:2048 sc1 lds
    buffer_load_dwordx4 v30, s[36:39], s98 offen offset:3072 sc1 lds
    s_add_u32 s98, s59, 26
    s_and_b32 s98, s98, 31
    s_mul_i32 s98, s98, 8192
    s_add_u32 s98, s98, s56
    s_add_u32 m0, s74, 123904
    s_nop 0
    buffer_load_dwordx4 v30, s[36:39], s98 offen offset:0 sc1 lds
    buffer_load_dwordx4 v30, s[36:39], s98 offen offset:1024 sc1 lds
    buffer_load_dwordx4 v30, s[36:39], s98 offen offset:2048 sc1 lds
    buffer_load_dwordx4 v30, s[36:39], s98 offen offset:3072 sc1 lds
    s_waitcnt vmcnt(48)
    s_barrier
    s_add_u32 s98, s59, 27
    s_and_b32 s98, s98, 31
    s_mul_i32 s98, s98, 9216
    s_add_u32 s98, s98, s57
    s_cmp_ge_u32 s63, 1
    s_cbranch_scc1 Lc_b_84
    s_mov_b32 m0, 157696
    s_nop 0
    buffer_load_dwordx4 v35, s[36:39], s98 offen sc1 lds
Lc_b_84:
    s_add_u32 m0, s74, 149504
    s_nop 0
    buffer_load_dwordx4 v30, s[36:39], s98 offen offset:0 sc1 lds
    buffer_load_dwordx4 v30, s[36:39], s98 offen offset:1024 sc1 lds
    buffer_load_dwordx4 v30, s[36:39], s98 offen offset:2048 sc1 lds
    buffer_load_dwordx4 v30, s[36:39], s98 offen offset:3072 sc1 lds
    s_add_u32 s98, s59, 27
    s_and_b32 s98, s98, 31
    s_mul_i32 s98, s98, 8192
    s_add_u32 s98, s98, s56
    s_add_u32 m0, s74, 141312
    s_nop 0
    buffer_load_dwordx4 v30, s[36:39], s98 offen offset:0 sc1 lds
    buffer_load_dwordx4 v30, s[36:39], s98 offen offset:1024 sc1 lds
    buffer_load_dwordx4 v30, s[36:39], s98 offen offset:2048 sc1 lds
    buffer_load_dwordx4 v30, s[36:39], s98 offen offset:3072 sc1 lds
    s_waitcnt vmcnt(48)
    s_barrier
    s_add_u32 s98, s59, 28
    s_and_b32 s98, s98, 31
    s_mul_i32 s98, s98, 9216
    s_add_u32 s98, s98, s57
    s_cmp_ge_u32 s63, 1
    s_cbranch_scc1 Lc_b_85
    s_mov_b32 m0, 53248
    s_nop 0
    buffer_load_dwordx4 v35, s[36:39], s98 offen sc1 lds
Lc_b_85:
    s_add_u32 m0, s74, 45056
    s_nop 0
    buffer_load_dwordx4 v30, s[36:39], s98 offen offset:0 sc1 lds
    buffer_load_dwordx4 v30, s[36:39], s98 offen offset:1024 sc1 lds
    buffer_load_dwordx4 v30, s[36:39], s98 offen offset:2048 sc1 lds
    buffer_load_dwordx4 v30, s[36:39], s98 offen offset:3072 sc1 lds
    s_add_u32 s98, s59, 28
    s_and_b32 s98, s98, 31
    s_mul_i32 s98, s98, 8192
    s_add_u32 s98, s98, s56
    s_add_u32 m0, s74, 36864
    s_nop 0
    buffer_load_dwordx4 v30, s[36:39], s98 offen offset:0 sc1 lds
    buffer_load_dwordx4 v30, s[36:39], s98 offen offset:1024 sc1 lds
    buffer_load_dwordx4 v30, s[36:39], s98 offen offset:2048 sc1 lds
    buffer_load_dwordx4 v30, s[36:39], s98 offen offset:3072 sc1 lds
    s_waitcnt vmcnt(48)
    s_barrier
    s_add_u32 s98, s59, 29
    s_and_b32 s98, s98, 31
    s_mul_i32 s98, s98, 9216
    s_add_u32 s98, s98, s57
    s_cmp_ge_u32 s63, 1
    s_cbranch_scc1 Lc_b_86
    s_mov_b32 m0, 70656
    s_nop 0
    buffer_load_dwordx4 v35, s[36:39], s98 offen sc1 lds
Lc_b_86:
    s_add_u32 m0, s74, 62464
    s_nop 0
    buffer_load_dwordx4 v30, s[36:39], s98 offen offset:0 sc1 lds
    buffer_load_dwordx4 v30, s[36:39], s98 offen offset:1024 sc1 lds
    buffer_load_dwordx4 v30, s[36:39], s98 offen offset:2048 sc1 lds
    buffer_load_dwordx4 v30, s[36:39], s98 offen offset:3072 sc1 lds
    s_add_u32 s98, s59, 29
    s_and_b32 s98, s98, 31
    s_mul_i32 s98, s98, 8192
    s_add_u32 s98, s98, s56
    s_add_u32 m0, s74, 54272
    s_nop 0
    buffer_load_dwordx4 v30, s[36:39], s98 offen offset:0 sc1 lds
    buffer_load_dwordx4 v30, s[36:39], s98 offen offset:1024 sc1 lds
    buffer_load_dwordx4 v30, s[36:39], s98 offen offset:2048 sc1 lds
    buffer_load_dwordx4 v30, s[36:39], s98 offen offset:3072 sc1 lds
    s_waitcnt vmcnt(48)
    s_barrier
    s_add_u32 s98, s59, 30
    s_and_b32 s98, s98, 31
    s_mul_i32 s98, s98, 9216
    s_add_u32 s98, s98, s57
    s_cmp_ge_u32 s63, 1
    s_cbranch_scc1 Lc_b_87
    s_mov_b32 m0, 88064
    s_nop 0
    buffer_load_dwordx4 v35, s[36:39], s98 offen sc1 lds
Lc_b_87:
    s_add_u32 m0, s74, 79872
    s_nop 0
    buffer_load_dwordx4 v30, s[36:39], s98 offen offset:0 sc1 lds
    buffer_load_dwordx4 v30, s[36:39], s98 offen offset:1024 sc1 lds
    buffer_load_dwordx4 v30, s[36:39], s98 offen offset:2048 sc1 lds
    buffer_load_dwordx4 v30, s[36:39], s98 offen offset:3072 sc1 lds
    s_add_u32 s98, s59, 30
    s_and_b32 s98, s98, 31
    s_mul_i32 s98, s98, 8192
    s_add_u32 s98, s98, s56
    s_add_u32 m0, s74, 71680
    s_nop 0
    buffer_load_dwordx4 v30, s[36:39], s98 offen offset:0 sc1 lds
    buffer_load_dwordx4 v30, s[36:39], s98 offen offset:1024 sc1 lds
    buffer_load_dwordx4 v30, s[36:39], s98 offen offset:2048 sc1 lds
    buffer_load_dwordx4 v30, s[36:39], s98 offen offset:3072 sc1 lds
    s_waitcnt vmcnt(48)
    s_barrier
    s_add_u32 s98, s59, 31
    s_and_b32 s98, s98, 31
    s_mul_i32 s98, s98, 9216
    s_add_u32 s98, s98, s57
    s_cmp_ge_u32 s63, 1
    s_cbranch_scc1 Lc_b_88
    s_mov_b32 m0, 105472
    s_nop 0
    buffer_load_dwordx4 v35, s[36:39], s98 offen sc1 lds
Lc_b_88:
    s_add_u32 m0, s74, 97280
    s_nop 0
    buffer_load_dwordx4 v30, s[36:39], s98 offen offset:0 sc1 lds
    buffer_load_dwordx4 v30, s[36:39], s98 offen offset:1024 sc1 lds
    buffer_load_dwordx4 v30, s[36:39], s98 offen offset:2048 sc1 lds
    buffer_load_dwordx4 v30, s[36:39], s98 offen offset:3072 sc1 lds
    s_add_u32 s98, s59, 31
    s_and_b32 s98, s98, 31
    s_mul_i32 s98, s98, 8192
    s_add_u32 s98, s98, s56
    s_add_u32 m0, s74, 89088
    s_nop 0
    buffer_load_dwordx4 v30, s[36:39], s98 offen offset:0 sc1 lds
    buffer_load_dwordx4 v30, s[36:39], s98 offen offset:1024 sc1 lds
    buffer_load_dwordx4 v30, s[36:39], s98 offen offset:2048 sc1 lds
    buffer_load_dwordx4 v30, s[36:39], s98 offen offset:3072 sc1 lds
    s_waitcnt vmcnt(48)
    s_barrier
    s_add_u32 s98, s77, 377856
    s_cmp_ge_u32 s63, 1
    s_cbranch_scc1 Lc_b_89
    s_mov_b32 m0, 16384
    s_nop 0
    buffer_load_dwordx4 v35, s[36:39], s98 offen sc1 lds
Lc_b_89:
    s_add_u32 m0, s74, 8192
    s_nop 0
    buffer_load_dwordx4 v30, s[36:39], s98 offen offset:0 sc1 lds
    buffer_load_dwordx4 v30, s[36:39], s98 offen offset:1024 sc1 lds
    buffer_load_dwordx4 v30, s[36:39], s98 offen offset:2048 sc1 lds
    buffer_load_dwordx4 v30, s[36:39], s98 offen offset:3072 sc1 lds
    s_add_u32 s98, s76, 335872
    s_add_u32 m0, s74, 0
    s_nop 0
    buffer_load_dwordx4 v30, s[36:39], s98 offen offset:0 sc1 lds
    buffer_load_dwordx4 v30, s[36:39], s98 offen offset:1024 sc1 lds
    buffer_load_dwordx4 v30, s[36:39], s98 offen offset:2048 sc1 lds
    buffer_load_dwordx4 v30, s[36:39], s98 offen offset:3072 sc1 lds
    s_waitcnt vmcnt(48)
    s_barrier
    s_add_u32 s98, s77, 387072
    s_cmp_ge_u32 s63, 1
    s_cbranch_scc1 Lc_b_90
    s_mov_b32 m0, 33792
    s_nop 0
    buffer_load_dwordx4 v35, s[36:39], s98 offen sc1 lds
Lc_b_90:
    s_add_u32 m0, s74, 25600
    s_nop 0
    buffer_load_dwordx4 v30, s[36:39], s98 offen offset:0 sc1 lds
    buffer_load_dwordx4 v30, s[36:39], s98 offen offset:1024 sc1 lds
    buffer_load_dwordx4 v30, s[36:39], s98 offen offset:2048 sc1 lds
    buffer_load_dwordx4 v30, s[36:39], s98 offen offset:3072 sc1 lds
    s_add_u32 s98, s76, 344064
    s_add_u32 m0, s74, 17408
    s_nop 0
    buffer_load_dwordx4 v30, s[36:39], s98 offen offset:0 sc1 lds
    buffer_load_dwordx4 v30, s[36:39], s98 offen offset:1024 sc1 lds
    buffer_load_dwordx4 v30, s[36:39], s98 offen offset:2048 sc1 lds
    buffer_load_dwordx4 v30, s[36:39], s98 offen offset:3072 sc1 lds
    s_waitcnt vmcnt(48)
    s_barrier
    s_add_u32 s98, s77, 396288
    s_cmp_ge_u32 s63, 1
    s_cbranch_scc1 Lc_b_91
    s_mov_b32 m0, 122880
    s_nop 0
    buffer_load_dwordx4 v35, s[36:39], s98 offen sc1 lds
Lc_b_91:
    s_add_u32 m0, s74, 114688
    s_nop 0
    buffer_load_dwordx4 v30, s[36:39], s98 offen offset:0 sc1 lds
    buffer_load_dwordx4 v30, s[36:39], s98 offen offset:1024 sc1 lds
    buffer_load_dwordx4 v30, s[36:39], s98 offen offset:2048 sc1 lds
    buffer_load_dwordx4 v30, s[36:39], s98 offen offset:3072 sc1 lds
    s_add_u32 s98, s76, 352256
    s_add_u32 m0, s74, 106496
    s_nop 0
    buffer_load_dwordx4 v30, s[36:39], s98 offen offset:0 sc1 lds
    buffer_load_dwordx4 v30, s[36:39], s98 offen offset:1024 sc1 lds
    buffer_load_dwordx4 v30, s[36:39], s98 offen offset:2048 sc1 lds
    buffer_load_dwordx4 v30, s[36:39], s98 offen offset:3072 sc1 lds
    s_waitcnt vmcnt(48)
    s_barrier
    s_add_u32 s98, s77, 405504
    s_cmp_ge_u32 s63, 1
    s_cbranch_scc1 Lc_b_92
    s_mov_b32 m0, 140288
    s_nop 0
    buffer_load_dwordx4 v35, s[36:39], s98 offen sc1 lds
Lc_b_92:
    s_add_u32 m0, s74, 132096
    s_nop 0
    buffer_load_dwordx4 v30, s[36:39], s98 offen offset:0 sc1 lds
    buffer_load_dwordx4 v30, s[36:39], s98 offen offset:1024 sc1 lds
    buffer_load_dwordx4 v30, s[36:39], s98 offen offset:2048 sc1 lds
    buffer_load_dwordx4 v30, s[36:39], s98 offen offset:3072 sc1 lds
    s_add_u32 s98, s76, 360448
    s_add_u32 m0, s74, 123904
    s_nop 0
    buffer_load_dwordx4 v30, s[36:39], s98 offen offset:0 sc1 lds
    buffer_load_dwordx4 v30, s[36:39], s98 offen offset:1024 sc1 lds
    buffer_load_dwordx4 v30, s[36:39], s98 offen offset:2048 sc1 lds
    buffer_load_dwordx4 v30, s[36:39], s98 offen offset:3072 sc1 lds
    s_waitcnt vmcnt(48)
    s_barrier
    s_waitcnt vmcnt(40)
    s_barrier
    s_waitcnt vmcnt(32)
    s_barrier
    s_waitcnt vmcnt(24)
    s_barrier
    s_waitcnt vmcnt(16)
    s_barrier
    s_waitcnt vmcnt(8)
    s_barrier
    s_waitcnt vmcnt(0)
    s_barrier
    s_barrier
    s_barrier
    s_endpgm
L_end:
    s_endpgm
.section .rodata,"a"
.p2align 6
.amdhsa_kernel parallel_sum__linear_kernel_hedgehog__mixer_gmlp__prompt_kernel
  .amdhsa_next_free_vgpr 256
  .amdhsa_next_free_sgpr 102
  .amdhsa_accum_offset 256
  .amdhsa_group_segment_fixed_size 0
  .amdhsa_kernarg_size 96
  .amdhsa_user_sgpr_count 2
  .amdhsa_user_sgpr_kernarg_segment_ptr 1
  .amdhsa_system_sgpr_workgroup_id_x 1
.end_amdhsa_kernel
```
